```python
import torch

def _softmax(x, axis=-1):
    return torch.softmax(x, dim=axis)

def _gelu(x):
    return torch.nn.functional.gelu(x, approximate='tanh')

def _silu(x):
    return torch.nn.functional.silu(x)

def _sigmoid(x):
    return torch.sigmoid(x)

def _layernorm(x, axis=-1, eps=1e-05):
    m = x.mean(dim=axis, keepdim=True)
    v = x.var(dim=axis, keepdim=True, unbiased=False)
    return (x - m) / torch.sqrt(v + eps)

def _scatter_add(tgt, idx, src, axis=0):
    return tgt.clone().index_add_(axis, idx, src)

def _segment_sum(src, seg, n):
    out = torch.zeros((n,) + src.shape[1:], dtype=src.dtype)
    return out.index_add_(0, seg, src)

def _pad(x, pw):
    flat = tuple((v for pair in reversed(pw) for v in pair))
    return torch.nn.functional.pad(x, flat)
kernel_name = 'sequential_preLN__compressed_kv_cla__mixer_gmlp__prompt'

def setup_inputs():

    _w = lambda a: (lambda t: t.to(torch.bfloat16) if t.is_floating_point() else t)(torch.as_tensor(a))

    def _A_setup():
        B, H, Sq, Sk, D, M = (1, 32, 2048, 2048, 128, 512)
        Dc = 4 * D
        return {'x': _w((lambda *s: torch.randn(*s, dtype=torch.bfloat16) * 0.05)(B, Sq, M)), 'c_kv': _w((lambda *s: torch.randn(*s, dtype=torch.bfloat16) * 0.4)(B, Sk, Dc)), 'w_q': _w((lambda *s: torch.randn(*s, dtype=torch.bfloat16) * 3.2)(M, H, D) * M ** (-0.5)), 'w_uk': _w((lambda *s: torch.randn(*s, dtype=torch.bfloat16) * 3.2)(Dc, H, D) * Dc ** (-0.5)), 'w_uv': _w((lambda *s: torch.randn(*s, dtype=torch.bfloat16) * 0.4)(Dc, H, D) * Dc ** (-0.5)), 'w_o': _w((lambda *s: torch.randn(*s, dtype=torch.bfloat16) * 0.4)(H, D, M) * (H * D) ** (-0.5))}
    _A_in = _A_setup()

    def _B_setup():
        B, S, D, F = (1, 2048, 512, 1792)
        Fh = F // 2
        return {'x': _w((lambda *s: torch.randn(*s, dtype=torch.bfloat16) * 0.05)(B, S, D)), 'w_in': _w((lambda *s: torch.randn(*s, dtype=torch.bfloat16) * 0.4)(D, 2 * Fh)), 'w_sp': _w(0.01 * (lambda *s: torch.randn(*s, dtype=torch.bfloat16) * 0.4)(S, S)), 'b_sp': _w(1.0 + 0.01 * (lambda *s: torch.randn(*s, dtype=torch.bfloat16) * 0.05)(S)), 'w_out': _w((lambda *s: torch.randn(*s, dtype=torch.bfloat16) * 0.05)(Fh, D))}
    _B_in = _B_setup()
    return {'A_x': _A_in['x'], 'A_c_kv': _A_in['c_kv'], 'A_w_q': _A_in['w_q'], 'A_w_uk': _A_in['w_uk'], 'A_w_uv': _A_in['w_uv'], 'A_w_o': _A_in['w_o'], 'B_x': _B_in['x'], 'B_w_in': _B_in['w_in'], 'B_w_sp': _B_in['w_sp'], 'B_b_sp': _B_in['b_sp'], 'B_w_out': _B_in['w_out']}

def reference(A_x, A_c_kv, A_w_q, A_w_uk, A_w_uv, A_w_o, B_x, B_w_in, B_w_sp, B_b_sp, B_w_out):

    def _A_ref(x, c_kv, w_q, w_uk, w_uv, w_o):
        B, Sq, M = (x.shape[0], x.shape[1], x.shape[2])
        Sk = c_kv.shape[1]
        H, D = (w_q.shape[1], w_q.shape[2])
        q = torch.einsum('bqm,mhd->bhqd', x, w_q)
        k = torch.einsum('bkc,chd->bhkd', c_kv, w_uk)
        v = torch.einsum('bkc,chd->bhkd', c_kv, w_uv)
        scores = torch.einsum('bhqd,bhkd->bhqk', q, k) * D ** (-0.5)
        off = Sk - Sq
        qi = torch.arange(Sq)[:, None]
        kj = torch.arange(Sk)[None, :]
        cmask = kj <= qi + off
        scores = torch.where(cmask[None, None], scores, -1000000000.0)
        p = _softmax(scores, axis=-1)
        ctx = torch.einsum('bhqk,bhkd->bhqd', p, v)
        return torch.einsum('bhqd,hdm->bqm', ctx, w_o)

    def _B_ref(x, w_in, w_sp, b_sp, w_out):
        B, S, D = x.shape
        F = w_in.shape[-1]
        Fh = F // 2
        z = _gelu(torch.einsum('bsd,df->bsf', x, w_in))
        z1 = z[..., :Fh].clone()
        z2 = _layernorm(z[..., Fh:], axis=-1)
        g = torch.einsum('ts,bsf->btf', w_sp, z2) + b_sp[None, :, None]
        return torch.einsum('bsf,fd->bsd', z1 * g, w_out)
    x = A_x
    h = x + _A_ref(_layernorm(x, axis=-1), A_c_kv, A_w_q, A_w_uk, A_w_uv, A_w_o)
    h2 = h + _B_ref(_layernorm(h, axis=-1), B_w_in, B_w_sp, B_b_sp, B_w_out)
    return h2
```

```asm
; @launch grid=(256,1,1) block=(256,1,1) lds=163840
.amdgcn_target "amdgcn-amd-amdhsa--gfx950"
.text
.globl sequential_preLN__compressed_kv_cla__mixer_gmlp__prompt_kernel
.p2align 8
.type sequential_preLN__compressed_kv_cla__mixer_gmlp__prompt_kernel,@function
sequential_preLN__compressed_kv_cla__mixer_gmlp__prompt_kernel:
 s_cmp_ge_u32 s2, 256
 s_cbranch_scc1 Lend
 s_load_dwordx16 s[64:79], s[0:1], 0
 s_load_dwordx8 s[80:87], s[0:1], 64
 s_load_dwordx4 s[88:91], s[0:1], 96
 v_lshrrev_b32 v1, 6, v0
 v_and_b32 v2, 63, v0
 v_readfirstlane_b32 s20, v1
 v_lshlrev_b32 v255, 4, v2
 v_cmp_eq_u32 vcc, 0, v0
 v_mov_b32 v3, 536870912
 v_mov_b32 v253, 1
 v_cndmask_b32 v254, v3, v0, vcc
 s_and_b32 s23, s2, 7
 s_lshl_b32 s23, s23, 2
 s_bfe_u32 s24, s2, 0x20003
 s_add_u32 s21, s23, s24
 s_lshr_b32 s22, s2, 5
 v_lshrrev_b32 v6, 3, v2
 v_and_b32 v7, 7, v2
 v_and_b32 v8, 6, v6
 v_xor_b32 v8, v8, v7
 v_lshlrev_b32 v8, 4, v8
 v_lshl_add_u32 v232, v6, 10, v8
 v_and_b32 v7, 4, v6
 v_add_u32 v7, v7, v6
 v_lshl_add_u32 v7, v7, 13, v8
 s_lshl_b32 s23, s21, 8
 v_add_u32 v233, s23, v7
 s_mov_b32 s40, 0
 s_mov_b32 s41, 130048
 s_mov_b32 s42, 30720
 s_mov_b32 s43, 160768
 s_lshr_b32 s23, s20, 1
 s_lshl_b32 s23, s23, 18
 s_and_b32 s24, s20, 1
 s_lshl_b32 s24, s24, 7
 s_add_u32 s52, s23, s24
 s_xor_b32 s26, s2, s22
 s_and_b32 s26, s26, 3
 s_lshl_b32 s23, s26, 7
 v_xor_b32 v232, s23, v232
 s_lshl_b32 s26, s26, 19
 s_xor_b32 s52, s52, s26
 s_lshl_b32 s55, s20, 12
 s_lshl_b32 s54, s20, 13
 s_add_u32 s54, s54, 65536
 s_lshl_b32 s23, s22, 18
 s_lshl_b32 s24, s20, 16
 s_add_u32 s32, s23, s24
 s_add_u32 s33, s32, 7168
 s_add_u32 s34, s32, 14336
 s_add_u32 s35, s32, 21504
 s_add_u32 s36, s32, 32768
 s_add_u32 s37, s32, 39936
 s_add_u32 s38, s32, 47104
 s_add_u32 s39, s32, 54272
 s_getpc_b64 s[28:29]
Lpc1:
 s_add_u32 s28, s28, Lmain-Lpc1
 s_addc_u32 s29, s29, 0
 s_bfe_u32 s23, s2, 0x30003
 s_lshl_b32 s23, s23, 2
 s_add_u32 s23, s23, s20
 s_mul_i32 s23, s23, 2048
 v_and_b32 v10, 240, v255
 v_lshl_add_u32 v10, v10, 3, s23
 global_load_dword v10, v10, s[28:29]
 s_waitcnt lgkmcnt(0)
 s_mov_b32 s8, s70
 s_mov_b32 s9, s71
 s_mov_b32 s10, 4194304
 s_mov_b32 s11, 0x20000
 s_mov_b32 s12, s66
 s_mov_b32 s13, s67
 s_mov_b32 s14, 2097152
 s_mov_b32 s15, 0x20000
 v_bfe_u32 v12, v0, 1, 6
 v_and_b32 v13, 1, v0
 v_lshlrev_b32 v13, 7, v13
 v_lshl_add_u32 v237, v12, 13, v13
 s_lshl_b32 s30, s22, 19
 s_lshl_b32 s24, s21, 8
 s_add_u32 s30, s30, s24
 s_xor_b32 s25, s52, 0
 s_add_u32 m0, s55, 0
 s_nop 0
 v_add_u32 v234, s25, v233
 buffer_load_dwordx4 v234, s[8:11], s40 offen  lds
 buffer_load_dwordx4 v234, s[8:11], s41 offen offset:1024  lds
 buffer_load_dwordx4 v234, s[8:11], s42 offen offset:2048  lds
 buffer_load_dwordx4 v234, s[8:11], s43 offen offset:3072  lds
 s_add_u32 m0, s54, 32768
 s_nop 0
 buffer_load_dwordx4 v232, s[12:15], s32 offen lds
 buffer_load_dwordx4 v232, s[12:15], s33 offen offset:1024 lds
 buffer_load_dwordx4 v232, s[12:15], s34 offen offset:2048 lds
 buffer_load_dwordx4 v232, s[12:15], s35 offen offset:3072 lds
 s_add_u32 m0, s54, 36864
 s_nop 0
 buffer_load_dwordx4 v232, s[12:15], s36 offen lds
 buffer_load_dwordx4 v232, s[12:15], s37 offen offset:1024 lds
 buffer_load_dwordx4 v232, s[12:15], s38 offen offset:2048 lds
 buffer_load_dwordx4 v232, s[12:15], s39 offen offset:3072 lds
 v_xor_b32 v232, 128, v232
 s_mov_b32 s4, s90
 s_mov_b32 s5, s91
 s_mov_b32 s6, 268435456
 s_mov_b32 s7, 0x20000
 s_mov_b32 s16, s64
 s_mov_b32 s17, s65
 s_mov_b32 s18, 2097152
 s_mov_b32 s19, 0x20000
 s_lshl_b32 s56, s2, 13
 s_lshl_b32 s24, s20, 11
 s_add_u32 s56, s56, s24
 v_and_b32 v4, 15, v2
 v_lshrrev_b32 v5, 4, v2
 v_lshrrev_b32 v6, 2, v2
 v_lshlrev_b32 v7, 7, v6
 v_bfe_u32 v8, v6, 1, 2
 v_lshl_add_u32 v7, v8, 5, v7
 v_and_b32 v8, 3, v2
 v_lshl_add_u32 v224, v8, 3, v7
 v_xor_b32 v225, 32, v224
 v_xor_b32 v226, 64, v224
 v_xor_b32 v227, 96, v224
 v_and_b32 v6, 6, v4
 v_xor_b32 v6, v6, v5
 v_lshlrev_b32 v6, 4, v6
 v_lshl_add_u32 v6, v4, 7, v6
 v_add_u32 v228, s54, v6
 v_xor_b32 v229, 64, v228
 v_add_u32 v230, 0x10000, v228
 v_add_u32 v231, 0x10000, v229
 s_lshl_b32 s53, s20, 18
 s_xor_b32 s53, s53, s26
 s_lshl_b32 s23, s21, 20
 s_lshl_b32 s24, s22, 17
 s_add_u32 s23, s23, s24
 s_lshl_b32 s24, s20, 15
 s_add_u32 s23, s23, s24
 s_add_u32 s44, s23, 2097152
 s_add_u32 s45, s23, 2101248
 s_add_u32 s46, s23, 2105344
 s_add_u32 s47, s23, 2109440
 s_add_u32 s48, s23, 2113536
 s_add_u32 s49, s23, 2117632
 s_add_u32 s50, s23, 2121728
 s_add_u32 s51, s23, 2125824
 s_mov_b32 s57, 0xbb000000
 v_mov_b32 v236, 0
 v_mov_b32 v160, -1
 v_mov_b32 v161, -1
 v_mov_b32 v162, -1
 v_mov_b32 v163, -1
 v_mov_b32 v168, 0
 v_mov_b32 v169, 0
 v_mov_b32 v170, 0
 v_mov_b32 v171, 0
 s_lshl_b32 s23, s2, 2
 s_add_u32 s23, s23, s20
 s_mul_i32 s92, s23, 4096
 s_add_u32 s92, s92, 83361792
 s_mul_i32 s23, s23, 2048
 s_add_u32 s23, s23, 83099648
 s_cmp_lt_u32 s2, 32
 s_cselect_b32 s94, s23, 536870912
 s_cselect_b32 s92, s92, 536870912
 s_cselect_b32 s93, 0, 536870912
 s_mov_b64 exec, 0
 s_cmp_eq_u32 s20, 0
 s_cbranch_scc1 Lw1_0
 s_cmp_eq_u32 s20, 1
 s_cbranch_scc1 Lw1_1
 s_cmp_eq_u32 s20, 2
 s_cbranch_scc1 Lw1_2
 s_branch Lw1_3
Lw1_back:
 s_mov_b64 exec, -1
 s_xor_b32 s25, s52, 524288
 s_add_u32 m0, s55, 16384
 s_nop 0
 v_add_u32 v234, s25, v233
 buffer_load_dwordx4 v234, s[8:11], s40 offen  lds
 buffer_load_dwordx4 v234, s[8:11], s41 offen offset:1024  lds
 buffer_load_dwordx4 v234, s[8:11], s42 offen offset:2048  lds
 buffer_load_dwordx4 v234, s[8:11], s43 offen offset:3072  lds
 s_add_u32 m0, s54, 65536
 s_nop 0
 buffer_load_dwordx4 v232, s[12:15], s32 offen lds
 buffer_load_dwordx4 v232, s[12:15], s33 offen offset:1024 lds
 buffer_load_dwordx4 v232, s[12:15], s34 offen offset:2048 lds
 buffer_load_dwordx4 v232, s[12:15], s35 offen offset:3072 lds
 s_add_u32 m0, s54, 69632
 s_nop 0
 buffer_load_dwordx4 v232, s[12:15], s36 offen lds
 buffer_load_dwordx4 v232, s[12:15], s37 offen offset:1024 lds
 buffer_load_dwordx4 v232, s[12:15], s38 offen offset:2048 lds
 buffer_load_dwordx4 v232, s[12:15], s39 offen offset:3072 lds
 v_xor_b32 v232, 384, v232
 s_mov_b32 s60, s88
 s_mov_b32 s61, s89
 s_mov_b32 s62, 256
 s_mov_b32 s63, 0x20000
 s_branch Lmain
.p2align 12
Lmain:
Lw1_0:
 s_cbranch_execz Lw1_back
 s_waitcnt vmcnt(12)
 s_barrier
 ds_read_b128 a[0:3], v228 offset:32768
 ds_read_b128 a[16:19], v229 offset:32768
 ds_read_b128 a[4:7], v228 offset:34816
 ds_read_b128 a[20:23], v229 offset:34816
 ds_read_b128 a[8:11], v228 offset:36864
 ds_read_b128 a[24:27], v229 offset:36864
 ds_read_b128 a[12:15], v228 offset:38912
 ds_read_b128 a[28:31], v229 offset:38912
 ds_read_b64_tr_b16 v[192:193], v224 offset:0
 ds_read_b64_tr_b16 v[194:195], v224 offset:2048
 ds_read_b64_tr_b16 v[196:197], v224 offset:8192
 ds_read_b64_tr_b16 v[198:199], v224 offset:10240
 ds_read_b64_tr_b16 v[200:201], v225 offset:0
 ds_read_b64_tr_b16 v[202:203], v225 offset:2048
 ds_read_b64_tr_b16 v[204:205], v225 offset:8192
 ds_read_b64_tr_b16 v[206:207], v225 offset:10240
 s_waitcnt lgkmcnt(6)
 v_mfma_f32_16x16x32_bf16 v[0:3], v[192:195], a[0:3], 0
 s_waitcnt lgkmcnt(4)
 s_add_u32 m0, s54, 0
 ds_read_b64_tr_b16 v[208:209], v226 offset:0
 v_mfma_f32_16x16x32_bf16 v[0:3], v[196:199], a[16:19], v[0:3]
 ds_read_b64_tr_b16 v[210:211], v226 offset:2048
 v_mfma_f32_16x16x32_bf16 v[4:7], v[196:199], a[20:23], 0
 buffer_load_dwordx4 v232, s[12:15], s32 offen lds
 v_mfma_f32_16x16x32_bf16 v[4:7], v[192:195], a[4:7], v[4:7]
 ds_read_b64_tr_b16 v[212:213], v226 offset:8192
 v_mfma_f32_16x16x32_bf16 v[8:11], v[192:195], a[8:11], 0
 ds_read_b64_tr_b16 v[214:215], v226 offset:10240
 v_mfma_f32_16x16x32_bf16 v[8:11], v[196:199], a[24:27], v[8:11]
 v_mfma_f32_16x16x32_bf16 v[12:15], v[196:199], a[28:31], 0
 buffer_load_dwordx4 v232, s[12:15], s33 offen offset:1024 lds
 v_mfma_f32_16x16x32_bf16 v[12:15], v[192:195], a[12:15], v[12:15]
 s_waitcnt lgkmcnt(4)
 ds_read_b64_tr_b16 v[216:217], v227 offset:0
 v_mfma_f32_16x16x32_bf16 v[28:31], v[200:203], a[12:15], 0
 ds_read_b64_tr_b16 v[218:219], v227 offset:2048
 v_mfma_f32_16x16x32_bf16 v[28:31], v[204:207], a[28:31], v[28:31]
 ds_read_b64_tr_b16 v[220:221], v227 offset:8192
 v_mfma_f32_16x16x32_bf16 v[24:27], v[204:207], a[24:27], 0
 buffer_store_dwordx4 v[160:163], v255, s[4:7], s94 offen sc1
 v_mfma_f32_16x16x32_bf16 v[24:27], v[200:203], a[8:11], v[24:27]
 ds_read_b64_tr_b16 v[222:223], v227 offset:10240
 v_mfma_f32_16x16x32_bf16 v[20:23], v[200:203], a[4:7], 0
 v_mfma_f32_16x16x32_bf16 v[20:23], v[204:207], a[20:23], v[20:23]
 v_mfma_f32_16x16x32_bf16 v[16:19], v[204:207], a[16:19], 0
 buffer_store_dwordx4 v[160:163], v255, s[4:7], s94 offen offset:1024 sc1
 v_mfma_f32_16x16x32_bf16 v[16:19], v[200:203], a[0:3], v[16:19]
 s_waitcnt lgkmcnt(4)
 ds_read_b64_tr_b16 v[192:193], v224 offset:4096
 v_mfma_f32_16x16x32_bf16 v[32:35], v[208:211], a[0:3], 0
 ds_read_b64_tr_b16 v[194:195], v224 offset:6144
 v_mfma_f32_16x16x32_bf16 v[32:35], v[212:215], a[16:19], v[32:35]
 ds_read_b64_tr_b16 v[196:197], v224 offset:12288
 v_mfma_f32_16x16x32_bf16 v[36:39], v[212:215], a[20:23], 0
 buffer_store_dwordx4 v[168:171], v255, s[4:7], s92 offen sc1
 v_mfma_f32_16x16x32_bf16 v[36:39], v[208:211], a[4:7], v[36:39]
 ds_read_b64_tr_b16 v[198:199], v224 offset:14336
 v_mfma_f32_16x16x32_bf16 v[40:43], v[208:211], a[8:11], 0
 v_mfma_f32_16x16x32_bf16 v[40:43], v[212:215], a[24:27], v[40:43]
 v_mfma_f32_16x16x32_bf16 v[44:47], v[212:215], a[28:31], 0
 buffer_store_dwordx4 v[168:171], v255, s[4:7], s92 offen offset:1024 sc1
 v_mfma_f32_16x16x32_bf16 v[44:47], v[208:211], a[12:15], v[44:47]
 s_waitcnt lgkmcnt(4)
 ds_read_b64_tr_b16 v[200:201], v225 offset:4096
 v_mfma_f32_16x16x32_bf16 v[60:63], v[216:219], a[12:15], 0
 ds_read_b64_tr_b16 v[202:203], v225 offset:6144
 v_mfma_f32_16x16x32_bf16 v[60:63], v[220:223], a[28:31], v[60:63]
 ds_read_b64_tr_b16 v[204:205], v225 offset:12288
 v_mfma_f32_16x16x32_bf16 v[56:59], v[220:223], a[24:27], 0
 buffer_store_dwordx4 v[168:171], v255, s[4:7], s92 offen offset:2048 sc1
 v_mfma_f32_16x16x32_bf16 v[56:59], v[216:219], a[8:11], v[56:59]
 ds_read_b64_tr_b16 v[206:207], v225 offset:14336
 v_mfma_f32_16x16x32_bf16 v[52:55], v[216:219], a[4:7], 0
 v_mfma_f32_16x16x32_bf16 v[52:55], v[220:223], a[20:23], v[52:55]
 v_mfma_f32_16x16x32_bf16 v[48:51], v[220:223], a[16:19], 0
 buffer_load_dwordx4 v[128:131], v255, s[16:19], s56 offen
 v_mfma_f32_16x16x32_bf16 v[48:51], v[216:219], a[0:3], v[48:51]
 s_waitcnt lgkmcnt(4)
 ds_read_b64_tr_b16 v[208:209], v226 offset:4096
 v_mfma_f32_16x16x32_bf16 v[64:67], v[192:195], a[0:3], 0
 ds_read_b64_tr_b16 v[210:211], v226 offset:6144
 v_mfma_f32_16x16x32_bf16 v[64:67], v[196:199], a[16:19], v[64:67]
 ds_read_b64_tr_b16 v[212:213], v226 offset:12288
 v_mfma_f32_16x16x32_bf16 v[68:71], v[196:199], a[20:23], 0
 buffer_load_dwordx4 v[132:135], v255, s[16:19], s56 offen offset:1024
 v_mfma_f32_16x16x32_bf16 v[68:71], v[192:195], a[4:7], v[68:71]
 ds_read_b64_tr_b16 v[214:215], v226 offset:14336
 v_mfma_f32_16x16x32_bf16 v[72:75], v[192:195], a[8:11], 0
 v_mfma_f32_16x16x32_bf16 v[72:75], v[196:199], a[24:27], v[72:75]
 v_mfma_f32_16x16x32_bf16 v[76:79], v[196:199], a[28:31], 0
 buffer_store_dwordx4 v[168:171], v255, s[4:7], s92 offen offset:3072 sc1
 v_mfma_f32_16x16x32_bf16 v[76:79], v[192:195], a[12:15], v[76:79]
 s_waitcnt lgkmcnt(4)
 ds_read_b64_tr_b16 v[216:217], v227 offset:4096
 v_mfma_f32_16x16x32_bf16 v[92:95], v[200:203], a[12:15], 0
 ds_read_b64_tr_b16 v[218:219], v227 offset:6144
 v_mfma_f32_16x16x32_bf16 v[92:95], v[204:207], a[28:31], v[92:95]
 ds_read_b64_tr_b16 v[220:221], v227 offset:12288
 v_mfma_f32_16x16x32_bf16 v[88:91], v[204:207], a[24:27], 0
 buffer_load_dwordx4 v232, s[12:15], s34 offen offset:2048 lds
 v_mfma_f32_16x16x32_bf16 v[88:91], v[200:203], a[8:11], v[88:91]
 ds_read_b64_tr_b16 v[222:223], v227 offset:14336
 v_mfma_f32_16x16x32_bf16 v[84:87], v[200:203], a[4:7], 0
 s_waitcnt vmcnt(11)
 v_mfma_f32_16x16x32_bf16 v[84:87], v[204:207], a[20:23], v[84:87]
 s_barrier
 v_mfma_f32_16x16x32_bf16 v[80:83], v[204:207], a[16:19], 0
 buffer_load_dwordx4 v232, s[12:15], s35 offen offset:3072 lds
 v_mfma_f32_16x16x32_bf16 v[80:83], v[200:203], a[0:3], v[80:83]
 s_waitcnt lgkmcnt(4)
 s_add_u32 m0, s54, 4096
 ds_read_b128 a[32:35], v230 offset:0
 ds_read_b64_tr_b16 v[192:193], v224 offset:16384
 v_mfma_f32_16x16x32_bf16 v[96:99], v[208:211], a[0:3], 0
 ds_read_b128 a[48:51], v231 offset:0
 ds_read_b64_tr_b16 v[194:195], v224 offset:18432
 v_mfma_f32_16x16x32_bf16 v[96:99], v[212:215], a[16:19], v[96:99]
 ds_read_b128 a[36:39], v230 offset:2048
 ds_read_b64_tr_b16 v[196:197], v224 offset:24576
 v_mfma_f32_16x16x32_bf16 v[100:103], v[212:215], a[20:23], 0
 buffer_load_dwordx4 v232, s[12:15], s36 offen lds
 v_mfma_f32_16x16x32_bf16 v[100:103], v[208:211], a[4:7], v[100:103]
 ds_read_b128 a[52:55], v231 offset:2048
 ds_read_b64_tr_b16 v[198:199], v224 offset:26624
 v_mfma_f32_16x16x32_bf16 v[104:107], v[208:211], a[8:11], 0
 ds_read_b128 a[40:43], v230 offset:4096
 v_mfma_f32_16x16x32_bf16 v[104:107], v[212:215], a[24:27], v[104:107]
 ds_read_b128 a[56:59], v231 offset:4096
 v_mfma_f32_16x16x32_bf16 v[108:111], v[212:215], a[28:31], 0
 buffer_load_dwordx4 v232, s[12:15], s37 offen offset:1024 lds
 v_mfma_f32_16x16x32_bf16 v[108:111], v[208:211], a[12:15], v[108:111]
 s_waitcnt lgkmcnt(10)
 ds_read_b128 a[44:47], v230 offset:6144
 ds_read_b64_tr_b16 v[200:201], v225 offset:16384
 v_mfma_f32_16x16x32_bf16 v[124:127], v[216:219], a[12:15], 0
 ds_read_b128 a[60:63], v231 offset:6144
 ds_read_b64_tr_b16 v[202:203], v225 offset:18432
 v_mfma_f32_16x16x32_bf16 v[124:127], v[220:223], a[28:31], v[124:127]
 ds_read_b64_tr_b16 v[204:205], v225 offset:24576
 v_mfma_f32_16x16x32_bf16 v[120:123], v[220:223], a[24:27], 0
 buffer_load_dwordx4 v232, s[12:15], s38 offen offset:2048 lds
 v_mfma_f32_16x16x32_bf16 v[120:123], v[216:219], a[8:11], v[120:123]
 ds_read_b64_tr_b16 v[206:207], v225 offset:26624
 v_mfma_f32_16x16x32_bf16 v[116:119], v[216:219], a[4:7], 0
 v_mfma_f32_16x16x32_bf16 v[116:119], v[220:223], a[20:23], v[116:119]
 v_mfma_f32_16x16x32_bf16 v[112:115], v[220:223], a[16:19], 0
 buffer_load_dwordx4 v232, s[12:15], s39 offen offset:3072 lds
 v_mfma_f32_16x16x32_bf16 v[112:115], v[216:219], a[0:3], v[112:115]
 s_waitcnt lgkmcnt(8)
 s_xor_b32 s25, s52, 1048576
 ds_read_b64_tr_b16 v[208:209], v226 offset:16384
 v_xor_b32 v232, 128, v232
 v_mfma_f32_16x16x32_bf16 v[0:3], v[192:195], a[32:35], v[0:3]
 s_add_u32 m0, s55, 32768
 ds_read_b64_tr_b16 v[210:211], v226 offset:18432
 v_mfma_f32_16x16x32_bf16 v[0:3], v[196:199], a[48:51], v[0:3]
 ds_read_b64_tr_b16 v[212:213], v226 offset:24576
 v_add_u32 v234, s25, v233
 v_mfma_f32_16x16x32_bf16 v[4:7], v[196:199], a[52:55], v[4:7]
 buffer_load_dwordx4 v234, s[8:11], s40 offen  lds
 v_mfma_f32_16x16x32_bf16 v[4:7], v[192:195], a[36:39], v[4:7]
 s_waitcnt lgkmcnt(8)
 ds_read_b64_tr_b16 v[214:215], v226 offset:26624
 v_mfma_f32_16x16x32_bf16 v[8:11], v[192:195], a[40:43], v[8:11]
 v_mfma_f32_16x16x32_bf16 v[8:11], v[196:199], a[56:59], v[8:11]
 s_waitcnt lgkmcnt(4)
 v_mfma_f32_16x16x32_bf16 v[12:15], v[196:199], a[60:63], v[12:15]
 buffer_load_dwordx4 v234, s[8:11], s41 offen offset:1024  lds
 v_mfma_f32_16x16x32_bf16 v[12:15], v[192:195], a[44:47], v[12:15]
 ds_read_b64_tr_b16 v[216:217], v227 offset:16384
 v_mfma_f32_16x16x32_bf16 v[28:31], v[200:203], a[44:47], v[28:31]
 ds_read_b64_tr_b16 v[218:219], v227 offset:18432
 v_mfma_f32_16x16x32_bf16 v[28:31], v[204:207], a[60:63], v[28:31]
 ds_read_b64_tr_b16 v[220:221], v227 offset:24576
 v_mfma_f32_16x16x32_bf16 v[24:27], v[204:207], a[56:59], v[24:27]
 buffer_load_dwordx4 v234, s[8:11], s42 offen offset:2048  lds
 v_mfma_f32_16x16x32_bf16 v[24:27], v[200:203], a[40:43], v[24:27]
 ds_read_b64_tr_b16 v[222:223], v227 offset:26624
 v_mfma_f32_16x16x32_bf16 v[20:23], v[200:203], a[36:39], v[20:23]
 v_mfma_f32_16x16x32_bf16 v[20:23], v[204:207], a[52:55], v[20:23]
 v_mfma_f32_16x16x32_bf16 v[16:19], v[204:207], a[48:51], v[16:19]
 buffer_load_dwordx4 v234, s[8:11], s43 offen offset:3072  lds
 v_mfma_f32_16x16x32_bf16 v[16:19], v[200:203], a[32:35], v[16:19]
 s_waitcnt lgkmcnt(4)
 s_xor_b32 s25, s52, 1572864
 ds_read_b64_tr_b16 v[192:193], v224 offset:20480
 v_mfma_f32_16x16x32_bf16 v[32:35], v[208:211], a[32:35], v[32:35]
 s_add_u32 m0, s55, 49152
 ds_read_b64_tr_b16 v[194:195], v224 offset:22528
 v_mfma_f32_16x16x32_bf16 v[32:35], v[212:215], a[48:51], v[32:35]
 ds_read_b64_tr_b16 v[196:197], v224 offset:28672
 v_add_u32 v234, s25, v233
 v_mfma_f32_16x16x32_bf16 v[36:39], v[212:215], a[52:55], v[36:39]
 buffer_load_dwordx4 v234, s[8:11], s40 offen  lds
 v_mfma_f32_16x16x32_bf16 v[36:39], v[208:211], a[36:39], v[36:39]
 ds_read_b64_tr_b16 v[198:199], v224 offset:30720
 v_mfma_f32_16x16x32_bf16 v[40:43], v[208:211], a[40:43], v[40:43]
 s_mov_b32 s18, 4194304
 v_mfma_f32_16x16x32_bf16 v[40:43], v[212:215], a[56:59], v[40:43]
 v_mfma_f32_16x16x32_bf16 v[44:47], v[212:215], a[60:63], v[44:47]
 buffer_load_dwordx4 v234, s[8:11], s41 offen offset:1024  lds
 v_mfma_f32_16x16x32_bf16 v[44:47], v[208:211], a[44:47], v[44:47]
 s_waitcnt lgkmcnt(4)
 ds_read_b64_tr_b16 v[200:201], v225 offset:20480
 v_mfma_f32_16x16x32_bf16 v[60:63], v[216:219], a[44:47], v[60:63]
 ds_read_b64_tr_b16 v[202:203], v225 offset:22528
 v_mfma_f32_16x16x32_bf16 v[60:63], v[220:223], a[60:63], v[60:63]
 ds_read_b64_tr_b16 v[204:205], v225 offset:28672
 v_mfma_f32_16x16x32_bf16 v[56:59], v[220:223], a[56:59], v[56:59]
 buffer_load_dwordx4 v234, s[8:11], s42 offen offset:2048  lds
 v_mfma_f32_16x16x32_bf16 v[56:59], v[216:219], a[40:43], v[56:59]
 ds_read_b64_tr_b16 v[206:207], v225 offset:30720
 v_mfma_f32_16x16x32_bf16 v[52:55], v[216:219], a[36:39], v[52:55]
 v_mfma_f32_16x16x32_bf16 v[52:55], v[220:223], a[52:55], v[52:55]
 v_mfma_f32_16x16x32_bf16 v[48:51], v[220:223], a[48:51], v[48:51]
 buffer_load_dwordx4 v234, s[8:11], s43 offen offset:3072  lds
 v_mfma_f32_16x16x32_bf16 v[48:51], v[216:219], a[32:35], v[48:51]
 s_waitcnt lgkmcnt(4)
 s_add_u32 m0, s54, 32768
 ds_read_b64_tr_b16 v[208:209], v226 offset:20480
 v_mfma_f32_16x16x32_bf16 v[64:67], v[192:195], a[32:35], v[64:67]
 ds_read_b64_tr_b16 v[210:211], v226 offset:22528
 v_mfma_f32_16x16x32_bf16 v[64:67], v[196:199], a[48:51], v[64:67]
 ds_read_b64_tr_b16 v[212:213], v226 offset:28672
 v_mfma_f32_16x16x32_bf16 v[68:71], v[196:199], a[52:55], v[68:71]
 buffer_load_dwordx4 v232, s[12:15], s32 offen lds
 v_mfma_f32_16x16x32_bf16 v[68:71], v[192:195], a[36:39], v[68:71]
 ds_read_b64_tr_b16 v[214:215], v226 offset:30720
 v_mfma_f32_16x16x32_bf16 v[72:75], v[192:195], a[40:43], v[72:75]
 v_mfma_f32_16x16x32_bf16 v[72:75], v[196:199], a[56:59], v[72:75]
 v_mfma_f32_16x16x32_bf16 v[76:79], v[196:199], a[60:63], v[76:79]
 buffer_load_dwordx4 v232, s[12:15], s33 offen offset:1024 lds
 v_mfma_f32_16x16x32_bf16 v[76:79], v[192:195], a[44:47], v[76:79]
 s_waitcnt lgkmcnt(4)
 ds_read_b64_tr_b16 v[216:217], v227 offset:20480
 v_mfma_f32_16x16x32_bf16 v[92:95], v[200:203], a[44:47], v[92:95]
 ds_read_b64_tr_b16 v[218:219], v227 offset:22528
 v_mfma_f32_16x16x32_bf16 v[92:95], v[204:207], a[60:63], v[92:95]
 ds_read_b64_tr_b16 v[220:221], v227 offset:28672
 v_mfma_f32_16x16x32_bf16 v[88:91], v[204:207], a[56:59], v[88:91]
 buffer_load_dwordx4 v232, s[12:15], s34 offen offset:2048 lds
 v_mfma_f32_16x16x32_bf16 v[88:91], v[200:203], a[40:43], v[88:91]
 ds_read_b64_tr_b16 v[222:223], v227 offset:30720
 v_mfma_f32_16x16x32_bf16 v[84:87], v[200:203], a[36:39], v[84:87]
 s_waitcnt vmcnt(7)
 v_lshlrev_b32 v136, 16, v128
 v_lshlrev_b32 v144, 16, v132
 v_and_b32 v137, 0xffff0000, v128
 v_and_b32 v145, 0xffff0000, v132
 v_lshlrev_b32 v138, 16, v129
 v_lshlrev_b32 v146, 16, v133
 v_and_b32 v139, 0xffff0000, v129
 v_and_b32 v147, 0xffff0000, v133
 v_lshlrev_b32 v140, 16, v130
 v_lshlrev_b32 v148, 16, v134
 v_and_b32 v141, 0xffff0000, v130
 v_and_b32 v149, 0xffff0000, v134
 v_lshlrev_b32 v142, 16, v131
 v_lshlrev_b32 v150, 16, v135
 v_and_b32 v143, 0xffff0000, v131
 v_and_b32 v151, 0xffff0000, v135
 v_add_f32 v152, v136, v137
 v_add_f32 v154, v144, v145
 v_add_f32 v152, v152, v138
 v_add_f32 v154, v154, v146
 v_add_f32 v152, v152, v139
 v_add_f32 v154, v154, v147
 v_add_f32 v152, v152, v140
 v_add_f32 v154, v154, v148
 v_add_f32 v152, v152, v141
 v_add_f32 v154, v154, v149
 v_add_f32 v152, v152, v142
 v_add_f32 v154, v154, v150
 v_add_f32 v152, v152, v143
 v_add_f32 v154, v154, v151
 s_nop 0
 v_add_f32_dpp v152, v152, v152 row_ror:8 row_mask:0xf bank_mask:0xf
 s_nop 0
 v_add_f32_dpp v154, v154, v154 row_ror:8 row_mask:0xf bank_mask:0xf
 s_nop 0
 v_add_f32_dpp v152, v152, v152 row_ror:4 row_mask:0xf bank_mask:0xf
 s_nop 0
 v_add_f32_dpp v154, v154, v154 row_ror:4 row_mask:0xf bank_mask:0xf
 s_nop 0
 v_add_f32_dpp v152, v152, v152 row_ror:2 row_mask:0xf bank_mask:0xf
 s_nop 0
 v_add_f32_dpp v154, v154, v154 row_ror:2 row_mask:0xf bank_mask:0xf
 s_nop 0
 v_add_f32_dpp v152, v152, v152 row_ror:1 row_mask:0xf bank_mask:0xf
 s_nop 0
 v_add_f32_dpp v154, v154, v154 row_ror:1 row_mask:0xf bank_mask:0xf
 v_mov_b32 v153, v152
 v_mov_b32 v155, v154
 s_nop 0
 v_permlane16_swap_b32 v152, v153
 s_nop 0
 v_permlane16_swap_b32 v154, v155
 v_add_f32 v152, v152, v153
 v_add_f32 v154, v154, v155
 v_mov_b32 v153, v152
 v_mov_b32 v155, v154
 s_nop 0
 v_permlane32_swap_b32 v152, v153
 s_nop 0
 v_permlane32_swap_b32 v154, v155
 v_add_f32 v152, v152, v153
 v_add_f32 v154, v154, v155
 v_fmac_f32 v136, s57, v152
 v_fmac_f32 v144, s57, v154
 v_fmac_f32 v137, s57, v152
 v_fmac_f32 v145, s57, v154
 v_fmac_f32 v138, s57, v152
 v_fmac_f32 v146, s57, v154
 v_fmac_f32 v139, s57, v152
 v_fmac_f32 v147, s57, v154
 v_fmac_f32 v140, s57, v152
 v_fmac_f32 v148, s57, v154
 v_fmac_f32 v141, s57, v152
 v_fmac_f32 v149, s57, v154
 v_fmac_f32 v142, s57, v152
 v_fmac_f32 v150, s57, v154
 v_fmac_f32 v143, s57, v152
 v_fmac_f32 v151, s57, v154
 v_mul_f32 v152, v136, v136
 v_mul_f32 v154, v144, v144
 v_fmac_f32 v152, v137, v137
 v_fmac_f32 v154, v145, v145
 v_fmac_f32 v152, v138, v138
 v_fmac_f32 v154, v146, v146
 v_fmac_f32 v152, v139, v139
 v_fmac_f32 v154, v147, v147
 v_fmac_f32 v152, v140, v140
 v_fmac_f32 v154, v148, v148
 v_fmac_f32 v152, v141, v141
 v_fmac_f32 v154, v149, v149
 v_fmac_f32 v152, v142, v142
 v_fmac_f32 v154, v150, v150
 v_fmac_f32 v152, v143, v143
 v_fmac_f32 v154, v151, v151
 s_nop 0
 v_add_f32_dpp v152, v152, v152 row_ror:8 row_mask:0xf bank_mask:0xf
 s_nop 0
 v_add_f32_dpp v154, v154, v154 row_ror:8 row_mask:0xf bank_mask:0xf
 s_nop 0
 v_add_f32_dpp v152, v152, v152 row_ror:4 row_mask:0xf bank_mask:0xf
 s_nop 0
 v_add_f32_dpp v154, v154, v154 row_ror:4 row_mask:0xf bank_mask:0xf
 s_nop 0
 v_add_f32_dpp v152, v152, v152 row_ror:2 row_mask:0xf bank_mask:0xf
 s_nop 0
 v_add_f32_dpp v154, v154, v154 row_ror:2 row_mask:0xf bank_mask:0xf
 s_nop 0
 v_add_f32_dpp v152, v152, v152 row_ror:1 row_mask:0xf bank_mask:0xf
 s_nop 0
 v_add_f32_dpp v154, v154, v154 row_ror:1 row_mask:0xf bank_mask:0xf
 v_mov_b32 v153, v152
 v_mov_b32 v155, v154
 s_nop 0
 v_permlane16_swap_b32 v152, v153
 s_nop 0
 v_permlane16_swap_b32 v154, v155
 v_add_f32 v152, v152, v153
 v_add_f32 v154, v154, v155
 v_mov_b32 v153, v152
 v_mov_b32 v155, v154
 s_nop 0
 v_permlane32_swap_b32 v152, v153
 s_nop 0
 v_permlane32_swap_b32 v154, v155
 v_add_f32 v152, v152, v153
 v_add_f32 v154, v154, v155
 v_mul_f32 v152, 0x3b000000, v152
 v_mul_f32 v154, 0x3b000000, v154
 v_add_f32 v152, 0x3727c5ac, v152
 v_add_f32 v154, 0x3727c5ac, v154
 v_rsq_f32 v152, v152
 v_rsq_f32 v154, v154
 v_mul_f32 v152, 0x3e0293ee, v152
 v_mul_f32 v154, 0x3e0293ee, v154
 v_mul_f32 v136, v136, v152
 v_mul_f32 v144, v144, v154
 v_mul_f32 v137, v137, v152
 v_mul_f32 v145, v145, v154
 v_mul_f32 v138, v138, v152
 v_mul_f32 v146, v146, v154
 v_mul_f32 v139, v139, v152
 v_mul_f32 v147, v147, v154
 v_mul_f32 v140, v140, v152
 v_mul_f32 v148, v148, v154
 v_mul_f32 v141, v141, v152
 v_mul_f32 v149, v149, v154
 v_mul_f32 v142, v142, v152
 v_mul_f32 v150, v150, v154
 v_mul_f32 v143, v143, v152
 v_mul_f32 v151, v151, v154
 v_cvt_pk_bf16_f32 v128, v136, v137
 v_cvt_pk_bf16_f32 v132, v144, v145
 v_cvt_pk_bf16_f32 v129, v138, v139
 v_cvt_pk_bf16_f32 v133, v146, v147
 v_cvt_pk_bf16_f32 v130, v140, v141
 v_cvt_pk_bf16_f32 v134, v148, v149
 v_cvt_pk_bf16_f32 v131, v142, v143
 v_cvt_pk_bf16_f32 v135, v150, v151
 s_mov_b64 exec, 0
 s_cmp_eq_u32 s20, 0
 s_cbranch_scc1 Lw3_0
 s_cmp_eq_u32 s20, 1
 s_cbranch_scc1 Lw3_1
 s_cmp_eq_u32 s20, 2
 s_cbranch_scc1 Lw3_2
 s_branch Lw3_3
Lw3_back:
 s_mov_b64 exec, -1
 v_mfma_f32_16x16x32_bf16 v[84:87], v[204:207], a[52:55], v[84:87]
 s_barrier
 buffer_atomic_add v253, v254, s[60:63], s93 offen sc1
 v_mfma_f32_16x16x32_bf16 v[80:83], v[204:207], a[48:51], v[80:83]
 buffer_store_dwordx4 v[128:131], v255, s[4:7], s56 offen sc1
 v_mfma_f32_16x16x32_bf16 v[80:83], v[200:203], a[32:35], v[80:83]
 s_waitcnt lgkmcnt(4)
 ds_read_b128 a[64:67], v228 offset:0
 ds_read_b64_tr_b16 v[192:193], v224 offset:32768
 v_mfma_f32_16x16x32_bf16 v[96:99], v[208:211], a[32:35], v[96:99]
 ds_read_b128 a[80:83], v229 offset:0
 ds_read_b64_tr_b16 v[194:195], v224 offset:34816
 v_mfma_f32_16x16x32_bf16 v[96:99], v[212:215], a[48:51], v[96:99]
 ds_read_b128 a[68:71], v228 offset:2048
 ds_read_b64_tr_b16 v[196:197], v224 offset:40960
 v_mfma_f32_16x16x32_bf16 v[100:103], v[212:215], a[52:55], v[100:103]
 buffer_store_dwordx4 v[132:135], v255, s[4:7], s56 offen offset:1024 sc1
 v_mfma_f32_16x16x32_bf16 v[100:103], v[208:211], a[36:39], v[100:103]
 ds_read_b128 a[84:87], v229 offset:2048
 ds_read_b64_tr_b16 v[198:199], v224 offset:43008
 v_mfma_f32_16x16x32_bf16 v[104:107], v[208:211], a[40:43], v[104:107]
 ds_read_b128 a[72:75], v228 offset:4096
 v_mfma_f32_16x16x32_bf16 v[104:107], v[212:215], a[56:59], v[104:107]
 ds_read_b128 a[88:91], v229 offset:4096
 v_mfma_f32_16x16x32_bf16 v[108:111], v[212:215], a[60:63], v[108:111]
 buffer_load_dwordx4 v232, s[12:15], s35 offen offset:3072 lds
 v_mfma_f32_16x16x32_bf16 v[108:111], v[208:211], a[44:47], v[108:111]
 s_waitcnt lgkmcnt(10)
 s_add_u32 m0, s54, 36864
 ds_read_b128 a[76:79], v228 offset:6144
 ds_read_b64_tr_b16 v[200:201], v225 offset:32768
 v_mfma_f32_16x16x32_bf16 v[124:127], v[216:219], a[44:47], v[124:127]
 ds_read_b128 a[92:95], v229 offset:6144
 ds_read_b64_tr_b16 v[202:203], v225 offset:34816
 v_mfma_f32_16x16x32_bf16 v[124:127], v[220:223], a[60:63], v[124:127]
 ds_read_b64_tr_b16 v[204:205], v225 offset:40960
 v_mfma_f32_16x16x32_bf16 v[120:123], v[220:223], a[56:59], v[120:123]
 buffer_load_dwordx4 v232, s[12:15], s36 offen lds
 v_mfma_f32_16x16x32_bf16 v[120:123], v[216:219], a[40:43], v[120:123]
 ds_read_b64_tr_b16 v[206:207], v225 offset:43008
 v_mfma_f32_16x16x32_bf16 v[116:119], v[216:219], a[36:39], v[116:119]
 v_mfma_f32_16x16x32_bf16 v[116:119], v[220:223], a[52:55], v[116:119]
 v_mfma_f32_16x16x32_bf16 v[112:115], v[220:223], a[48:51], v[112:115]
 buffer_load_dwordx4 v232, s[12:15], s37 offen offset:1024 lds
 v_mfma_f32_16x16x32_bf16 v[112:115], v[216:219], a[32:35], v[112:115]
 s_waitcnt lgkmcnt(8)
 ds_read_b64_tr_b16 v[208:209], v226 offset:32768
 v_mfma_f32_16x16x32_bf16 v[0:3], v[192:195], a[64:67], v[0:3]
 ds_read_b64_tr_b16 v[210:211], v226 offset:34816
 v_mfma_f32_16x16x32_bf16 v[0:3], v[196:199], a[80:83], v[0:3]
 ds_read_b64_tr_b16 v[212:213], v226 offset:40960
 v_mfma_f32_16x16x32_bf16 v[4:7], v[196:199], a[84:87], v[4:7]
 buffer_load_dwordx4 v232, s[12:15], s38 offen offset:2048 lds
 v_mfma_f32_16x16x32_bf16 v[4:7], v[192:195], a[68:71], v[4:7]
 s_waitcnt lgkmcnt(8)
 ds_read_b64_tr_b16 v[214:215], v226 offset:43008
 v_mfma_f32_16x16x32_bf16 v[8:11], v[192:195], a[72:75], v[8:11]
 v_mfma_f32_16x16x32_bf16 v[8:11], v[196:199], a[88:91], v[8:11]
 s_waitcnt lgkmcnt(4)
 v_mfma_f32_16x16x32_bf16 v[12:15], v[196:199], a[92:95], v[12:15]
 buffer_load_dwordx4 v232, s[12:15], s39 offen offset:3072 lds
 v_mfma_f32_16x16x32_bf16 v[12:15], v[192:195], a[76:79], v[12:15]
 s_add_u32 m0, s54, 65536
 ds_read_b64_tr_b16 v[216:217], v227 offset:32768
 v_xor_b32 v232, 896, v232
 v_mfma_f32_16x16x32_bf16 v[28:31], v[200:203], a[76:79], v[28:31]
 ds_read_b64_tr_b16 v[218:219], v227 offset:34816
 v_mfma_f32_16x16x32_bf16 v[28:31], v[204:207], a[92:95], v[28:31]
 ds_read_b64_tr_b16 v[220:221], v227 offset:40960
 v_mfma_f32_16x16x32_bf16 v[24:27], v[204:207], a[88:91], v[24:27]
 buffer_load_dwordx4 v232, s[12:15], s32 offen lds
 v_mfma_f32_16x16x32_bf16 v[24:27], v[200:203], a[72:75], v[24:27]
 ds_read_b64_tr_b16 v[222:223], v227 offset:43008
 v_mfma_f32_16x16x32_bf16 v[20:23], v[200:203], a[68:71], v[20:23]
 v_mfma_f32_16x16x32_bf16 v[20:23], v[204:207], a[84:87], v[20:23]
 v_mfma_f32_16x16x32_bf16 v[16:19], v[204:207], a[80:83], v[16:19]
 buffer_load_dwordx4 v232, s[12:15], s33 offen offset:1024 lds
 v_mfma_f32_16x16x32_bf16 v[16:19], v[200:203], a[64:67], v[16:19]
 s_waitcnt lgkmcnt(4)
 ds_read_b64_tr_b16 v[192:193], v224 offset:36864
 v_mfma_f32_16x16x32_bf16 v[32:35], v[208:211], a[64:67], v[32:35]
 ds_read_b64_tr_b16 v[194:195], v224 offset:38912
 v_mfma_f32_16x16x32_bf16 v[32:35], v[212:215], a[80:83], v[32:35]
 ds_read_b64_tr_b16 v[196:197], v224 offset:45056
 v_mfma_f32_16x16x32_bf16 v[36:39], v[212:215], a[84:87], v[36:39]
 buffer_load_dwordx4 v232, s[12:15], s34 offen offset:2048 lds
 v_mfma_f32_16x16x32_bf16 v[36:39], v[208:211], a[68:71], v[36:39]
 ds_read_b64_tr_b16 v[198:199], v224 offset:47104
 v_mfma_f32_16x16x32_bf16 v[40:43], v[208:211], a[72:75], v[40:43]
 v_mfma_f32_16x16x32_bf16 v[40:43], v[212:215], a[88:91], v[40:43]
 v_mfma_f32_16x16x32_bf16 v[44:47], v[212:215], a[92:95], v[44:47]
 buffer_load_dwordx4 v232, s[12:15], s35 offen offset:3072 lds
 v_mfma_f32_16x16x32_bf16 v[44:47], v[208:211], a[76:79], v[44:47]
 s_waitcnt lgkmcnt(4)
 s_add_u32 m0, s54, 69632
 ds_read_b64_tr_b16 v[200:201], v225 offset:36864
 v_mfma_f32_16x16x32_bf16 v[60:63], v[216:219], a[76:79], v[60:63]
 ds_read_b64_tr_b16 v[202:203], v225 offset:38912
 v_mfma_f32_16x16x32_bf16 v[60:63], v[220:223], a[92:95], v[60:63]
 ds_read_b64_tr_b16 v[204:205], v225 offset:45056
 v_mfma_f32_16x16x32_bf16 v[56:59], v[220:223], a[88:91], v[56:59]
 buffer_load_dwordx4 v232, s[12:15], s36 offen lds
 v_mfma_f32_16x16x32_bf16 v[56:59], v[216:219], a[72:75], v[56:59]
 ds_read_b64_tr_b16 v[206:207], v225 offset:47104
 v_mfma_f32_16x16x32_bf16 v[52:55], v[216:219], a[68:71], v[52:55]
 v_mfma_f32_16x16x32_bf16 v[52:55], v[220:223], a[84:87], v[52:55]
 v_mfma_f32_16x16x32_bf16 v[48:51], v[220:223], a[80:83], v[48:51]
 buffer_load_dwordx4 v232, s[12:15], s37 offen offset:1024 lds
 v_mfma_f32_16x16x32_bf16 v[48:51], v[216:219], a[64:67], v[48:51]
 s_waitcnt lgkmcnt(4)
 ds_read_b64_tr_b16 v[208:209], v226 offset:36864
 v_mfma_f32_16x16x32_bf16 v[64:67], v[192:195], a[64:67], v[64:67]
 ds_read_b64_tr_b16 v[210:211], v226 offset:38912
 v_mfma_f32_16x16x32_bf16 v[64:67], v[196:199], a[80:83], v[64:67]
 ds_read_b64_tr_b16 v[212:213], v226 offset:45056
 v_mfma_f32_16x16x32_bf16 v[68:71], v[196:199], a[84:87], v[68:71]
 buffer_load_dwordx4 v232, s[12:15], s38 offen offset:2048 lds
 v_mfma_f32_16x16x32_bf16 v[68:71], v[192:195], a[68:71], v[68:71]
 ds_read_b64_tr_b16 v[214:215], v226 offset:47104
 v_mfma_f32_16x16x32_bf16 v[72:75], v[192:195], a[72:75], v[72:75]
 v_mfma_f32_16x16x32_bf16 v[72:75], v[196:199], a[88:91], v[72:75]
 v_mfma_f32_16x16x32_bf16 v[76:79], v[196:199], a[92:95], v[76:79]
 buffer_load_dwordx4 v232, s[12:15], s39 offen offset:3072 lds
 v_mfma_f32_16x16x32_bf16 v[76:79], v[192:195], a[76:79], v[76:79]
 s_waitcnt lgkmcnt(4)
 s_xor_b32 s25, s52, 2097152
 ds_read_b64_tr_b16 v[216:217], v227 offset:36864
 v_xor_b32 v232, 128, v232
 v_mfma_f32_16x16x32_bf16 v[92:95], v[200:203], a[76:79], v[92:95]
 s_add_u32 m0, s55, 0
 ds_read_b64_tr_b16 v[218:219], v227 offset:38912
 v_mfma_f32_16x16x32_bf16 v[92:95], v[204:207], a[92:95], v[92:95]
 ds_read_b64_tr_b16 v[220:221], v227 offset:45056
 v_add_u32 v234, s25, v233
 v_mfma_f32_16x16x32_bf16 v[88:91], v[204:207], a[88:91], v[88:91]
 buffer_load_dwordx4 v234, s[8:11], s40 offen  lds
 v_mfma_f32_16x16x32_bf16 v[88:91], v[200:203], a[72:75], v[88:91]
 ds_read_b64_tr_b16 v[222:223], v227 offset:47104
 v_mfma_f32_16x16x32_bf16 v[84:87], v[200:203], a[68:71], v[84:87]
 s_waitcnt vmcnt(9)
 v_mfma_f32_16x16x32_bf16 v[84:87], v[204:207], a[84:87], v[84:87]
 s_barrier
 v_mfma_f32_16x16x32_bf16 v[80:83], v[204:207], a[80:83], v[80:83]
 buffer_load_dwordx4 v234, s[8:11], s41 offen offset:1024  lds
 v_mfma_f32_16x16x32_bf16 v[80:83], v[200:203], a[64:67], v[80:83]
 s_waitcnt lgkmcnt(4)
 ds_read_b128 a[96:99], v228 offset:32768
 ds_read_b64_tr_b16 v[192:193], v224 offset:49152
 v_mfma_f32_16x16x32_bf16 v[96:99], v[208:211], a[64:67], v[96:99]
 ds_read_b128 a[112:115], v229 offset:32768
 ds_read_b64_tr_b16 v[194:195], v224 offset:51200
 v_mfma_f32_16x16x32_bf16 v[96:99], v[212:215], a[80:83], v[96:99]
 ds_read_b128 a[100:103], v228 offset:34816
 ds_read_b64_tr_b16 v[196:197], v224 offset:57344
 v_mfma_f32_16x16x32_bf16 v[100:103], v[212:215], a[84:87], v[100:103]
 buffer_load_dwordx4 v234, s[8:11], s42 offen offset:2048  lds
 v_mfma_f32_16x16x32_bf16 v[100:103], v[208:211], a[68:71], v[100:103]
 ds_read_b128 a[116:119], v229 offset:34816
 ds_read_b64_tr_b16 v[198:199], v224 offset:59392
 v_mfma_f32_16x16x32_bf16 v[104:107], v[208:211], a[72:75], v[104:107]
 ds_read_b128 a[104:107], v228 offset:36864
 v_mfma_f32_16x16x32_bf16 v[104:107], v[212:215], a[88:91], v[104:107]
 ds_read_b128 a[120:123], v229 offset:36864
 v_mfma_f32_16x16x32_bf16 v[108:111], v[212:215], a[92:95], v[108:111]
 buffer_load_dwordx4 v234, s[8:11], s43 offen offset:3072  lds
 v_mfma_f32_16x16x32_bf16 v[108:111], v[208:211], a[76:79], v[108:111]
 s_waitcnt lgkmcnt(10)
 s_add_u32 m0, s54, 0
 ds_read_b128 a[108:111], v228 offset:38912
 ds_read_b64_tr_b16 v[200:201], v225 offset:49152
 v_mfma_f32_16x16x32_bf16 v[124:127], v[216:219], a[76:79], v[124:127]
 ds_read_b128 a[124:127], v229 offset:38912
 ds_read_b64_tr_b16 v[202:203], v225 offset:51200
 v_mfma_f32_16x16x32_bf16 v[124:127], v[220:223], a[92:95], v[124:127]
 ds_read_b64_tr_b16 v[204:205], v225 offset:57344
 v_mfma_f32_16x16x32_bf16 v[120:123], v[220:223], a[88:91], v[120:123]
 buffer_load_dwordx4 v232, s[12:15], s32 offen lds
 v_mfma_f32_16x16x32_bf16 v[120:123], v[216:219], a[72:75], v[120:123]
 ds_read_b64_tr_b16 v[206:207], v225 offset:59392
 v_mfma_f32_16x16x32_bf16 v[116:119], v[216:219], a[68:71], v[116:119]
 v_mfma_f32_16x16x32_bf16 v[116:119], v[220:223], a[84:87], v[116:119]
 v_mfma_f32_16x16x32_bf16 v[112:115], v[220:223], a[80:83], v[112:115]
Lw1_1:
 s_cbranch_execz Lw1_back
 buffer_load_dwordx4 v232, s[12:15], s33 offen offset:1024 lds
 v_mfma_f32_16x16x32_bf16 v[112:115], v[216:219], a[64:67], v[112:115]
 s_waitcnt lgkmcnt(8)
 ds_read_b64_tr_b16 v[208:209], v226 offset:49152
 v_mfma_f32_16x16x32_bf16 v[0:3], v[192:195], a[96:99], v[0:3]
 ds_read_b64_tr_b16 v[210:211], v226 offset:51200
 v_mfma_f32_16x16x32_bf16 v[0:3], v[196:199], a[112:115], v[0:3]
 ds_read_b64_tr_b16 v[212:213], v226 offset:57344
 v_mfma_f32_16x16x32_bf16 v[4:7], v[196:199], a[116:119], v[4:7]
 buffer_load_dwordx4 v232, s[12:15], s34 offen offset:2048 lds
 v_mfma_f32_16x16x32_bf16 v[4:7], v[192:195], a[100:103], v[4:7]
 s_waitcnt lgkmcnt(8)
 ds_read_b64_tr_b16 v[214:215], v226 offset:59392
 v_mfma_f32_16x16x32_bf16 v[8:11], v[192:195], a[104:107], v[8:11]
 v_mfma_f32_16x16x32_bf16 v[8:11], v[196:199], a[120:123], v[8:11]
 s_waitcnt lgkmcnt(4)
 v_mfma_f32_16x16x32_bf16 v[12:15], v[196:199], a[124:127], v[12:15]
 buffer_load_dwordx4 v232, s[12:15], s35 offen offset:3072 lds
 v_mfma_f32_16x16x32_bf16 v[12:15], v[192:195], a[108:111], v[12:15]
 s_add_u32 m0, s54, 4096
 ds_read_b64_tr_b16 v[216:217], v227 offset:49152
 v_mfma_f32_16x16x32_bf16 v[28:31], v[200:203], a[108:111], v[28:31]
 ds_read_b64_tr_b16 v[218:219], v227 offset:51200
 v_mfma_f32_16x16x32_bf16 v[28:31], v[204:207], a[124:127], v[28:31]
 ds_read_b64_tr_b16 v[220:221], v227 offset:57344
 v_mfma_f32_16x16x32_bf16 v[24:27], v[204:207], a[120:123], v[24:27]
 buffer_load_dwordx4 v232, s[12:15], s36 offen lds
 v_mfma_f32_16x16x32_bf16 v[24:27], v[200:203], a[104:107], v[24:27]
 ds_read_b64_tr_b16 v[222:223], v227 offset:59392
 v_mfma_f32_16x16x32_bf16 v[20:23], v[200:203], a[100:103], v[20:23]
 v_mfma_f32_16x16x32_bf16 v[20:23], v[204:207], a[116:119], v[20:23]
 v_mfma_f32_16x16x32_bf16 v[16:19], v[204:207], a[112:115], v[16:19]
 buffer_load_dwordx4 v232, s[12:15], s37 offen offset:1024 lds
 v_mfma_f32_16x16x32_bf16 v[16:19], v[200:203], a[96:99], v[16:19]
 s_waitcnt lgkmcnt(4)
 ds_read_b64_tr_b16 v[192:193], v224 offset:53248
 v_mfma_f32_16x16x32_bf16 v[32:35], v[208:211], a[96:99], v[32:35]
 ds_read_b64_tr_b16 v[194:195], v224 offset:55296
 v_mfma_f32_16x16x32_bf16 v[32:35], v[212:215], a[112:115], v[32:35]
 ds_read_b64_tr_b16 v[196:197], v224 offset:61440
 v_mfma_f32_16x16x32_bf16 v[36:39], v[212:215], a[116:119], v[36:39]
 buffer_load_dwordx4 v232, s[12:15], s38 offen offset:2048 lds
 v_mfma_f32_16x16x32_bf16 v[36:39], v[208:211], a[100:103], v[36:39]
 ds_read_b64_tr_b16 v[198:199], v224 offset:63488
 v_mfma_f32_16x16x32_bf16 v[40:43], v[208:211], a[104:107], v[40:43]
 v_mfma_f32_16x16x32_bf16 v[40:43], v[212:215], a[120:123], v[40:43]
 v_mfma_f32_16x16x32_bf16 v[44:47], v[212:215], a[124:127], v[44:47]
 buffer_load_dword v235, v236, s[60:63], 0 offen sc1
 v_mfma_f32_16x16x32_bf16 v[44:47], v[208:211], a[108:111], v[44:47]
 s_waitcnt lgkmcnt(4)
 ds_read_b64_tr_b16 v[200:201], v225 offset:53248
 v_mfma_f32_16x16x32_bf16 v[60:63], v[216:219], a[108:111], v[60:63]
 ds_read_b64_tr_b16 v[202:203], v225 offset:55296
 v_mfma_f32_16x16x32_bf16 v[60:63], v[220:223], a[124:127], v[60:63]
 ds_read_b64_tr_b16 v[204:205], v225 offset:61440
 v_mfma_f32_16x16x32_bf16 v[56:59], v[220:223], a[120:123], v[56:59]
 buffer_load_dwordx4 v232, s[12:15], s39 offen offset:3072 lds
 v_mfma_f32_16x16x32_bf16 v[56:59], v[216:219], a[104:107], v[56:59]
 s_xor_b32 s25, s52, 2621440
 ds_read_b64_tr_b16 v[206:207], v225 offset:63488
 v_xor_b32 v232, 384, v232
 v_mfma_f32_16x16x32_bf16 v[52:55], v[216:219], a[100:103], v[52:55]
 s_add_u32 m0, s55, 16384
 v_mfma_f32_16x16x32_bf16 v[52:55], v[220:223], a[116:119], v[52:55]
 v_add_u32 v234, s25, v233
 v_mfma_f32_16x16x32_bf16 v[48:51], v[220:223], a[112:115], v[48:51]
 buffer_load_dwordx4 v234, s[8:11], s40 offen  lds
 v_mfma_f32_16x16x32_bf16 v[48:51], v[216:219], a[96:99], v[48:51]
 s_waitcnt lgkmcnt(4)
 ds_read_b64_tr_b16 v[208:209], v226 offset:53248
 v_mfma_f32_16x16x32_bf16 v[64:67], v[192:195], a[96:99], v[64:67]
 ds_read_b64_tr_b16 v[210:211], v226 offset:55296
 v_mfma_f32_16x16x32_bf16 v[64:67], v[196:199], a[112:115], v[64:67]
 ds_read_b64_tr_b16 v[212:213], v226 offset:61440
 v_mfma_f32_16x16x32_bf16 v[68:71], v[196:199], a[116:119], v[68:71]
 buffer_load_dwordx4 v234, s[8:11], s41 offen offset:1024  lds
 v_mfma_f32_16x16x32_bf16 v[68:71], v[192:195], a[100:103], v[68:71]
 ds_read_b64_tr_b16 v[214:215], v226 offset:63488
 v_mfma_f32_16x16x32_bf16 v[72:75], v[192:195], a[104:107], v[72:75]
 v_mfma_f32_16x16x32_bf16 v[72:75], v[196:199], a[120:123], v[72:75]
 v_mfma_f32_16x16x32_bf16 v[76:79], v[196:199], a[124:127], v[76:79]
 buffer_load_dwordx4 v234, s[8:11], s42 offen offset:2048  lds
 v_mfma_f32_16x16x32_bf16 v[76:79], v[192:195], a[108:111], v[76:79]
 s_waitcnt lgkmcnt(4)
 ds_read_b64_tr_b16 v[216:217], v227 offset:53248
 v_mfma_f32_16x16x32_bf16 v[92:95], v[200:203], a[108:111], v[92:95]
 ds_read_b64_tr_b16 v[218:219], v227 offset:55296
 v_mfma_f32_16x16x32_bf16 v[92:95], v[204:207], a[124:127], v[92:95]
 ds_read_b64_tr_b16 v[220:221], v227 offset:61440
 v_mfma_f32_16x16x32_bf16 v[88:91], v[204:207], a[120:123], v[88:91]
 buffer_load_dwordx4 v234, s[8:11], s43 offen offset:3072  lds
 v_mfma_f32_16x16x32_bf16 v[88:91], v[200:203], a[104:107], v[88:91]
 s_add_u32 m0, s54, 32768
 ds_read_b64_tr_b16 v[222:223], v227 offset:63488
 v_mfma_f32_16x16x32_bf16 v[84:87], v[200:203], a[100:103], v[84:87]
 s_waitcnt vmcnt(13)
 v_mfma_f32_16x16x32_bf16 v[84:87], v[204:207], a[116:119], v[84:87]
 s_barrier
 v_mfma_f32_16x16x32_bf16 v[80:83], v[204:207], a[112:115], v[80:83]
 buffer_load_dwordx4 v232, s[12:15], s32 offen lds
 v_mfma_f32_16x16x32_bf16 v[80:83], v[200:203], a[96:99], v[80:83]
 s_waitcnt lgkmcnt(4)
 ds_read_b128 a[128:131], v230 offset:0
 ds_read_b64_tr_b16 v[192:193], v224 offset:0
 v_mfma_f32_16x16x32_bf16 v[96:99], v[208:211], a[96:99], v[96:99]
 ds_read_b128 a[144:147], v231 offset:0
 ds_read_b64_tr_b16 v[194:195], v224 offset:2048
 v_mfma_f32_16x16x32_bf16 v[96:99], v[212:215], a[112:115], v[96:99]
 ds_read_b128 a[132:135], v230 offset:2048
 ds_read_b64_tr_b16 v[196:197], v224 offset:8192
 v_mfma_f32_16x16x32_bf16 v[100:103], v[212:215], a[116:119], v[100:103]
 buffer_load_dwordx4 v232, s[12:15], s33 offen offset:1024 lds
 v_mfma_f32_16x16x32_bf16 v[100:103], v[208:211], a[100:103], v[100:103]
 ds_read_b128 a[148:151], v231 offset:2048
 ds_read_b64_tr_b16 v[198:199], v224 offset:10240
 v_mfma_f32_16x16x32_bf16 v[104:107], v[208:211], a[104:107], v[104:107]
 ds_read_b128 a[136:139], v230 offset:4096
 v_mfma_f32_16x16x32_bf16 v[104:107], v[212:215], a[120:123], v[104:107]
 ds_read_b128 a[152:155], v231 offset:4096
 v_mfma_f32_16x16x32_bf16 v[108:111], v[212:215], a[124:127], v[108:111]
 buffer_load_dwordx4 v232, s[12:15], s34 offen offset:2048 lds
 v_mfma_f32_16x16x32_bf16 v[108:111], v[208:211], a[108:111], v[108:111]
 s_waitcnt lgkmcnt(10)
 ds_read_b128 a[140:143], v230 offset:6144
 ds_read_b64_tr_b16 v[200:201], v225 offset:0
 v_mfma_f32_16x16x32_bf16 v[124:127], v[216:219], a[108:111], v[124:127]
 ds_read_b128 a[156:159], v231 offset:6144
 ds_read_b64_tr_b16 v[202:203], v225 offset:2048
 v_mfma_f32_16x16x32_bf16 v[124:127], v[220:223], a[124:127], v[124:127]
 ds_read_b64_tr_b16 v[204:205], v225 offset:8192
 v_mfma_f32_16x16x32_bf16 v[120:123], v[220:223], a[120:123], v[120:123]
 buffer_load_dwordx4 v232, s[12:15], s35 offen offset:3072 lds
 v_mfma_f32_16x16x32_bf16 v[120:123], v[216:219], a[104:107], v[120:123]
 s_add_u32 m0, s54, 36864
 ds_read_b64_tr_b16 v[206:207], v225 offset:10240
 v_mfma_f32_16x16x32_bf16 v[116:119], v[216:219], a[100:103], v[116:119]
 v_mfma_f32_16x16x32_bf16 v[116:119], v[220:223], a[116:119], v[116:119]
 v_mfma_f32_16x16x32_bf16 v[112:115], v[220:223], a[112:115], v[112:115]
 buffer_load_dwordx4 v232, s[12:15], s36 offen lds
 v_mfma_f32_16x16x32_bf16 v[112:115], v[216:219], a[96:99], v[112:115]
 s_waitcnt lgkmcnt(8)
 ds_read_b64_tr_b16 v[208:209], v226 offset:0
 v_mfma_f32_16x16x32_bf16 v[0:3], v[192:195], a[128:131], v[0:3]
 ds_read_b64_tr_b16 v[210:211], v226 offset:2048
 v_mfma_f32_16x16x32_bf16 v[0:3], v[196:199], a[144:147], v[0:3]
 ds_read_b64_tr_b16 v[212:213], v226 offset:8192
 v_mfma_f32_16x16x32_bf16 v[4:7], v[196:199], a[148:151], v[4:7]
 buffer_load_dwordx4 v232, s[12:15], s37 offen offset:1024 lds
 v_mfma_f32_16x16x32_bf16 v[4:7], v[192:195], a[132:135], v[4:7]
 s_waitcnt lgkmcnt(8)
 ds_read_b64_tr_b16 v[214:215], v226 offset:10240
 v_mfma_f32_16x16x32_bf16 v[8:11], v[192:195], a[136:139], v[8:11]
 v_mfma_f32_16x16x32_bf16 v[8:11], v[196:199], a[152:155], v[8:11]
 s_waitcnt lgkmcnt(4)
 v_mfma_f32_16x16x32_bf16 v[12:15], v[196:199], a[156:159], v[12:15]
 buffer_load_dwordx4 v232, s[12:15], s38 offen offset:2048 lds
 v_mfma_f32_16x16x32_bf16 v[12:15], v[192:195], a[140:143], v[12:15]
 ds_read_b64_tr_b16 v[216:217], v227 offset:0
 v_mfma_f32_16x16x32_bf16 v[28:31], v[200:203], a[140:143], v[28:31]
 s_lshl_b32 s26, s2, 7
 ds_read_b64_tr_b16 v[218:219], v227 offset:2048
 v_mfma_f32_16x16x32_bf16 v[28:31], v[204:207], a[156:159], v[28:31]
 s_add_u32 s26, s26, 83558400
 ds_read_b64_tr_b16 v[220:221], v227 offset:8192
 v_mfma_f32_16x16x32_bf16 v[24:27], v[204:207], a[152:155], v[24:27]
 buffer_load_dwordx4 v232, s[12:15], s39 offen offset:3072 lds
 v_mfma_f32_16x16x32_bf16 v[24:27], v[200:203], a[136:139], v[24:27]
 s_xor_b32 s25, s52, 3145728
 ds_read_b64_tr_b16 v[222:223], v227 offset:10240
 v_xor_b32 v232, 128, v232
 v_mfma_f32_16x16x32_bf16 v[20:23], v[200:203], a[132:135], v[20:23]
 s_add_u32 m0, s55, 32768
 v_mfma_f32_16x16x32_bf16 v[20:23], v[204:207], a[148:151], v[20:23]
 v_add_u32 v234, s25, v233
 v_mfma_f32_16x16x32_bf16 v[16:19], v[204:207], a[144:147], v[16:19]
 buffer_load_dwordx4 v234, s[8:11], s40 offen  lds
 v_mfma_f32_16x16x32_bf16 v[16:19], v[200:203], a[128:131], v[16:19]
 s_waitcnt lgkmcnt(4)
 ds_read_b64_tr_b16 v[192:193], v224 offset:4096
 v_mfma_f32_16x16x32_bf16 v[32:35], v[208:211], a[128:131], v[32:35]
 ds_read_b64_tr_b16 v[194:195], v224 offset:6144
 v_mfma_f32_16x16x32_bf16 v[32:35], v[212:215], a[144:147], v[32:35]
 ds_read_b64_tr_b16 v[196:197], v224 offset:12288
 v_mfma_f32_16x16x32_bf16 v[36:39], v[212:215], a[148:151], v[36:39]
 buffer_load_dwordx4 v234, s[8:11], s41 offen offset:1024  lds
 v_mfma_f32_16x16x32_bf16 v[36:39], v[208:211], a[132:135], v[36:39]
 ds_read_b64_tr_b16 v[198:199], v224 offset:14336
 v_mfma_f32_16x16x32_bf16 v[40:43], v[208:211], a[136:139], v[40:43]
 v_mfma_f32_16x16x32_bf16 v[40:43], v[212:215], a[152:155], v[40:43]
 v_mfma_f32_16x16x32_bf16 v[44:47], v[212:215], a[156:159], v[44:47]
 buffer_load_dwordx4 v234, s[8:11], s42 offen offset:2048  lds
 v_mfma_f32_16x16x32_bf16 v[44:47], v[208:211], a[140:143], v[44:47]
 s_waitcnt lgkmcnt(4)
 ds_read_b64_tr_b16 v[200:201], v225 offset:4096
 v_mfma_f32_16x16x32_bf16 v[60:63], v[216:219], a[140:143], v[60:63]
 ds_read_b64_tr_b16 v[202:203], v225 offset:6144
 v_mfma_f32_16x16x32_bf16 v[60:63], v[220:223], a[156:159], v[60:63]
 ds_read_b64_tr_b16 v[204:205], v225 offset:12288
 v_mfma_f32_16x16x32_bf16 v[56:59], v[220:223], a[152:155], v[56:59]
 buffer_load_dwordx4 v234, s[8:11], s43 offen offset:3072  lds
 v_mfma_f32_16x16x32_bf16 v[56:59], v[216:219], a[136:139], v[56:59]
 s_add_u32 m0, s54, 65536
 ds_read_b64_tr_b16 v[206:207], v225 offset:14336
 v_mfma_f32_16x16x32_bf16 v[52:55], v[216:219], a[132:135], v[52:55]
 v_mfma_f32_16x16x32_bf16 v[52:55], v[220:223], a[148:151], v[52:55]
 v_mfma_f32_16x16x32_bf16 v[48:51], v[220:223], a[144:147], v[48:51]
 buffer_load_dwordx4 v232, s[12:15], s32 offen lds
 v_mfma_f32_16x16x32_bf16 v[48:51], v[216:219], a[128:131], v[48:51]
 s_waitcnt lgkmcnt(4)
 ds_read_b64_tr_b16 v[208:209], v226 offset:4096
 v_mfma_f32_16x16x32_bf16 v[64:67], v[192:195], a[128:131], v[64:67]
 ds_read_b64_tr_b16 v[210:211], v226 offset:6144
 v_mfma_f32_16x16x32_bf16 v[64:67], v[196:199], a[144:147], v[64:67]
 ds_read_b64_tr_b16 v[212:213], v226 offset:12288
 v_mfma_f32_16x16x32_bf16 v[68:71], v[196:199], a[148:151], v[68:71]
 buffer_load_dwordx4 v232, s[12:15], s33 offen offset:1024 lds
 v_mfma_f32_16x16x32_bf16 v[68:71], v[192:195], a[132:135], v[68:71]
 ds_read_b64_tr_b16 v[214:215], v226 offset:14336
 v_mfma_f32_16x16x32_bf16 v[72:75], v[192:195], a[136:139], v[72:75]
 v_mfma_f32_16x16x32_bf16 v[72:75], v[196:199], a[152:155], v[72:75]
 v_mfma_f32_16x16x32_bf16 v[76:79], v[196:199], a[156:159], v[76:79]
 buffer_load_dwordx4 v232, s[12:15], s34 offen offset:2048 lds
 v_mfma_f32_16x16x32_bf16 v[76:79], v[192:195], a[140:143], v[76:79]
 s_waitcnt lgkmcnt(4)
 ds_read_b64_tr_b16 v[216:217], v227 offset:4096
 v_mfma_f32_16x16x32_bf16 v[92:95], v[200:203], a[140:143], v[92:95]
 ds_read_b64_tr_b16 v[218:219], v227 offset:6144
 v_mfma_f32_16x16x32_bf16 v[92:95], v[204:207], a[156:159], v[92:95]
 ds_read_b64_tr_b16 v[220:221], v227 offset:12288
 v_mfma_f32_16x16x32_bf16 v[88:91], v[204:207], a[152:155], v[88:91]
 buffer_load_dwordx4 v232, s[12:15], s35 offen offset:3072 lds
 v_mfma_f32_16x16x32_bf16 v[88:91], v[200:203], a[136:139], v[88:91]
 s_add_u32 m0, s54, 69632
 ds_read_b64_tr_b16 v[222:223], v227 offset:14336
 v_mfma_f32_16x16x32_bf16 v[84:87], v[200:203], a[132:135], v[84:87]
 s_waitcnt vmcnt(16)
 v_mfma_f32_16x16x32_bf16 v[84:87], v[204:207], a[148:151], v[84:87]
 s_barrier
 v_cmp_gt_u32 vcc, 32, v235
 s_nop 1
 s_cbranch_vccnz Lspin2
Lback3:
 buffer_store_dword v253, v254, s[4:7], s26 offen sc1
 v_mfma_f32_16x16x32_bf16 v[80:83], v[204:207], a[144:147], v[80:83]
 buffer_load_dwordx4 v232, s[12:15], s36 offen lds
 v_mfma_f32_16x16x32_bf16 v[80:83], v[200:203], a[128:131], v[80:83]
 s_waitcnt lgkmcnt(4)
 ds_read_b128 a[160:163], v228 offset:0
 ds_read_b64_tr_b16 v[192:193], v224 offset:16384
 v_mfma_f32_16x16x32_bf16 v[96:99], v[208:211], a[128:131], v[96:99]
 ds_read_b128 a[176:179], v229 offset:0
 ds_read_b64_tr_b16 v[194:195], v224 offset:18432
 v_mfma_f32_16x16x32_bf16 v[96:99], v[212:215], a[144:147], v[96:99]
 ds_read_b128 a[164:167], v228 offset:2048
 ds_read_b64_tr_b16 v[196:197], v224 offset:24576
 v_mfma_f32_16x16x32_bf16 v[100:103], v[212:215], a[148:151], v[100:103]
 buffer_load_dwordx4 v232, s[12:15], s37 offen offset:1024 lds
 v_mfma_f32_16x16x32_bf16 v[100:103], v[208:211], a[132:135], v[100:103]
 ds_read_b128 a[180:183], v229 offset:2048
 ds_read_b64_tr_b16 v[198:199], v224 offset:26624
 v_mfma_f32_16x16x32_bf16 v[104:107], v[208:211], a[136:139], v[104:107]
 ds_read_b128 a[168:171], v228 offset:4096
 v_mfma_f32_16x16x32_bf16 v[104:107], v[212:215], a[152:155], v[104:107]
 ds_read_b128 a[184:187], v229 offset:4096
 v_mfma_f32_16x16x32_bf16 v[108:111], v[212:215], a[156:159], v[108:111]
 buffer_load_dwordx4 v232, s[12:15], s38 offen offset:2048 lds
 v_mfma_f32_16x16x32_bf16 v[108:111], v[208:211], a[140:143], v[108:111]
 s_waitcnt lgkmcnt(10)
 ds_read_b128 a[172:175], v228 offset:6144
 ds_read_b64_tr_b16 v[200:201], v225 offset:16384
 v_mfma_f32_16x16x32_bf16 v[124:127], v[216:219], a[140:143], v[124:127]
 ds_read_b128 a[188:191], v229 offset:6144
 ds_read_b64_tr_b16 v[202:203], v225 offset:18432
 v_mfma_f32_16x16x32_bf16 v[124:127], v[220:223], a[156:159], v[124:127]
 ds_read_b64_tr_b16 v[204:205], v225 offset:24576
 v_mfma_f32_16x16x32_bf16 v[120:123], v[220:223], a[152:155], v[120:123]
 buffer_load_dwordx4 v232, s[12:15], s39 offen offset:3072 lds
 v_mfma_f32_16x16x32_bf16 v[120:123], v[216:219], a[136:139], v[120:123]
 s_xor_b32 s25, s52, 3670016
 ds_read_b64_tr_b16 v[206:207], v225 offset:26624
 v_xor_b32 v232, 896, v232
 v_mfma_f32_16x16x32_bf16 v[116:119], v[216:219], a[132:135], v[116:119]
 s_add_u32 m0, s55, 49152
 v_mfma_f32_16x16x32_bf16 v[116:119], v[220:223], a[148:151], v[116:119]
 v_add_u32 v234, s25, v233
 v_mfma_f32_16x16x32_bf16 v[112:115], v[220:223], a[144:147], v[112:115]
 s_mov_b32 s16, s72
 buffer_load_dwordx4 v234, s[8:11], s40 offen  lds
 v_mfma_f32_16x16x32_bf16 v[112:115], v[216:219], a[128:131], v[112:115]
 s_waitcnt lgkmcnt(8)
 s_mov_b32 s17, s73
 ds_read_b64_tr_b16 v[208:209], v226 offset:16384
 v_mfma_f32_16x16x32_bf16 v[0:3], v[192:195], a[160:163], v[0:3]
 s_cmp_eq_u32 s20, 0
 s_cselect_b32 s31, s30, 536870912
 ds_read_b64_tr_b16 v[210:211], v226 offset:18432
 v_mfma_f32_16x16x32_bf16 v[0:3], v[196:199], a[176:179], v[0:3]
 ds_read_b64_tr_b16 v[212:213], v226 offset:24576
 v_mfma_f32_16x16x32_bf16 v[4:7], v[196:199], a[180:183], v[4:7]
 s_lshl_b32 s23, s22, 12
 buffer_load_dword v238, v237, s[16:19], s31 offen
 v_mfma_f32_16x16x32_bf16 v[4:7], v[192:195], a[164:167], v[4:7]
 s_waitcnt lgkmcnt(8)
 s_sub_u32 s24, 30720, s23
 ds_read_b64_tr_b16 v[214:215], v226 offset:26624
 v_mfma_f32_16x16x32_bf16 v[8:11], v[192:195], a[168:171], v[8:11]
 s_lshr_b32 s23, s23, 1
 v_mfma_f32_16x16x32_bf16 v[8:11], v[196:199], a[184:187], v[8:11]
 s_waitcnt lgkmcnt(4)
 s_add_u32 s23, s23, 83558400
 v_mfma_f32_16x16x32_bf16 v[12:15], v[196:199], a[188:191], v[12:15]
 s_mov_b32 s16, s72
 buffer_load_dwordx4 v234, s[8:11], s41 offen offset:1024  lds
 v_mfma_f32_16x16x32_bf16 v[12:15], v[192:195], a[172:175], v[12:15]
 s_mov_b32 s17, s73
 ds_read_b64_tr_b16 v[216:217], v227 offset:16384
 v_and_b32 v236, 240, v255
 v_mfma_f32_16x16x32_bf16 v[28:31], v[200:203], a[172:175], v[28:31]
 s_cmp_eq_u32 s20, 1
 s_cselect_b32 s31, s30, 536870912
 ds_read_b64_tr_b16 v[218:219], v227 offset:18432
 v_lshl_add_u32 v236, v236, 3, s23
 v_mfma_f32_16x16x32_bf16 v[28:31], v[204:207], a[188:191], v[28:31]
 ds_read_b64_tr_b16 v[220:221], v227 offset:24576
 v_bfe_u32 v235, v255, 8, 1
 v_mfma_f32_16x16x32_bf16 v[24:27], v[204:207], a[184:187], v[24:27]
 buffer_load_dword v238, v237, s[16:19], s31 offen
 v_mfma_f32_16x16x32_bf16 v[24:27], v[200:203], a[168:171], v[24:27]
 ds_read_b64_tr_b16 v[222:223], v227 offset:26624
 v_mad_u32_u24 v236, v235, s24, v236
 v_mfma_f32_16x16x32_bf16 v[20:23], v[200:203], a[164:167], v[20:23]
 v_mfma_f32_16x16x32_bf16 v[20:23], v[204:207], a[180:183], v[20:23]
 v_mfma_f32_16x16x32_bf16 v[16:19], v[204:207], a[176:179], v[16:19]
 buffer_load_dwordx4 v234, s[8:11], s42 offen offset:2048  lds
 v_mfma_f32_16x16x32_bf16 v[16:19], v[200:203], a[160:163], v[16:19]
 s_waitcnt lgkmcnt(4)
 ds_read_b64_tr_b16 v[192:193], v224 offset:20480
 v_mfma_f32_16x16x32_bf16 v[32:35], v[208:211], a[160:163], v[32:35]
 ds_read_b64_tr_b16 v[194:195], v224 offset:22528
 v_mfma_f32_16x16x32_bf16 v[32:35], v[212:215], a[176:179], v[32:35]
 ds_read_b64_tr_b16 v[196:197], v224 offset:28672
 v_mfma_f32_16x16x32_bf16 v[36:39], v[212:215], a[180:183], v[36:39]
 buffer_load_dwordx4 v234, s[8:11], s43 offen offset:3072  lds
 v_mfma_f32_16x16x32_bf16 v[36:39], v[208:211], a[164:167], v[36:39]
 ds_read_b64_tr_b16 v[198:199], v224 offset:30720
 v_mfma_f32_16x16x32_bf16 v[40:43], v[208:211], a[168:171], v[40:43]
 v_mfma_f32_16x16x32_bf16 v[40:43], v[212:215], a[184:187], v[40:43]
 v_mfma_f32_16x16x32_bf16 v[44:47], v[212:215], a[188:191], v[44:47]
 v_mfma_f32_16x16x32_bf16 v[44:47], v[208:211], a[172:175], v[44:47]
 s_waitcnt lgkmcnt(4)
 ds_read_b64_tr_b16 v[200:201], v225 offset:20480
 v_mfma_f32_16x16x32_bf16 v[60:63], v[216:219], a[172:175], v[60:63]
 ds_read_b64_tr_b16 v[202:203], v225 offset:22528
 v_mfma_f32_16x16x32_bf16 v[60:63], v[220:223], a[188:191], v[60:63]
 ds_read_b64_tr_b16 v[204:205], v225 offset:28672
 v_mfma_f32_16x16x32_bf16 v[56:59], v[220:223], a[184:187], v[56:59]
 v_mfma_f32_16x16x32_bf16 v[56:59], v[216:219], a[168:171], v[56:59]
 ds_read_b64_tr_b16 v[206:207], v225 offset:30720
 v_mfma_f32_16x16x32_bf16 v[52:55], v[216:219], a[164:167], v[52:55]
 v_mfma_f32_16x16x32_bf16 v[52:55], v[220:223], a[180:183], v[52:55]
 v_mfma_f32_16x16x32_bf16 v[48:51], v[220:223], a[176:179], v[48:51]
 v_mfma_f32_16x16x32_bf16 v[48:51], v[216:219], a[160:163], v[48:51]
 s_waitcnt lgkmcnt(4)
 ds_read_b64_tr_b16 v[208:209], v226 offset:20480
 v_mfma_f32_16x16x32_bf16 v[64:67], v[192:195], a[160:163], v[64:67]
 ds_read_b64_tr_b16 v[210:211], v226 offset:22528
 v_mfma_f32_16x16x32_bf16 v[64:67], v[196:199], a[176:179], v[64:67]
 ds_read_b64_tr_b16 v[212:213], v226 offset:28672
 v_mfma_f32_16x16x32_bf16 v[68:71], v[196:199], a[180:183], v[68:71]
 v_mfma_f32_16x16x32_bf16 v[68:71], v[192:195], a[164:167], v[68:71]
 ds_read_b64_tr_b16 v[214:215], v226 offset:30720
 v_mfma_f32_16x16x32_bf16 v[72:75], v[192:195], a[168:171], v[72:75]
 v_mfma_f32_16x16x32_bf16 v[72:75], v[196:199], a[184:187], v[72:75]
 v_mfma_f32_16x16x32_bf16 v[76:79], v[196:199], a[188:191], v[76:79]
 v_mfma_f32_16x16x32_bf16 v[76:79], v[192:195], a[172:175], v[76:79]
 s_waitcnt lgkmcnt(4)
 ds_read_b64_tr_b16 v[216:217], v227 offset:20480
 v_mfma_f32_16x16x32_bf16 v[92:95], v[200:203], a[172:175], v[92:95]
 ds_read_b64_tr_b16 v[218:219], v227 offset:22528
 v_mfma_f32_16x16x32_bf16 v[92:95], v[204:207], a[188:191], v[92:95]
 ds_read_b64_tr_b16 v[220:221], v227 offset:28672
 v_mfma_f32_16x16x32_bf16 v[88:91], v[204:207], a[184:187], v[88:91]
 s_mov_b32 s8, s72
 v_mfma_f32_16x16x32_bf16 v[88:91], v[200:203], a[168:171], v[88:91]
 s_mov_b32 s9, s73
 ds_read_b64_tr_b16 v[222:223], v227 offset:30720
 v_mfma_f32_16x16x32_bf16 v[84:87], v[200:203], a[164:167], v[84:87]
 s_xor_b32 s25, s53, 0
 s_waitcnt vmcnt(15)
 v_mfma_f32_16x16x32_bf16 v[84:87], v[204:207], a[180:183], v[84:87]
 s_add_u32 m0, s55, 0
 s_barrier
 v_mfma_f32_16x16x32_bf16 v[80:83], v[204:207], a[176:179], v[80:83]
 v_mfma_f32_16x16x32_bf16 v[80:83], v[200:203], a[160:163], v[80:83]
 s_waitcnt lgkmcnt(4)
 ds_read_b128 a[192:195], v228 offset:32768
 ds_read_b64_tr_b16 v[192:193], v224 offset:32768
 v_add_u32 v234, s25, v233
 v_mfma_f32_16x16x32_bf16 v[96:99], v[208:211], a[160:163], v[96:99]
 ds_read_b128 a[208:211], v229 offset:32768
 ds_read_b64_tr_b16 v[194:195], v224 offset:34816
 v_mfma_f32_16x16x32_bf16 v[96:99], v[212:215], a[176:179], v[96:99]
 ds_read_b128 a[196:199], v228 offset:34816
 ds_read_b64_tr_b16 v[196:197], v224 offset:40960
 v_mfma_f32_16x16x32_bf16 v[100:103], v[212:215], a[180:183], v[100:103]
 buffer_load_dwordx4 v234, s[8:11], s40 offen  lds
 v_mfma_f32_16x16x32_bf16 v[100:103], v[208:211], a[164:167], v[100:103]
 ds_read_b128 a[212:215], v229 offset:34816
 ds_read_b64_tr_b16 v[198:199], v224 offset:43008
 v_mfma_f32_16x16x32_bf16 v[104:107], v[208:211], a[168:171], v[104:107]
 ds_read_b128 a[200:203], v228 offset:36864
 v_mfma_f32_16x16x32_bf16 v[104:107], v[212:215], a[184:187], v[104:107]
 ds_read_b128 a[216:219], v229 offset:36864
 v_mfma_f32_16x16x32_bf16 v[108:111], v[212:215], a[188:191], v[108:111]
 buffer_load_dwordx4 v234, s[8:11], s41 offen offset:1024  lds
 v_mfma_f32_16x16x32_bf16 v[108:111], v[208:211], a[172:175], v[108:111]
 s_waitcnt lgkmcnt(10)
 ds_read_b128 a[204:207], v228 offset:38912
 ds_read_b64_tr_b16 v[200:201], v225 offset:32768
 v_mfma_f32_16x16x32_bf16 v[124:127], v[216:219], a[172:175], v[124:127]
 ds_read_b128 a[220:223], v229 offset:38912
 ds_read_b64_tr_b16 v[202:203], v225 offset:34816
 v_mfma_f32_16x16x32_bf16 v[124:127], v[220:223], a[188:191], v[124:127]
 ds_read_b64_tr_b16 v[204:205], v225 offset:40960
 v_mfma_f32_16x16x32_bf16 v[120:123], v[220:223], a[184:187], v[120:123]
 buffer_load_dwordx4 v234, s[8:11], s42 offen offset:2048  lds
 v_mfma_f32_16x16x32_bf16 v[120:123], v[216:219], a[168:171], v[120:123]
 ds_read_b64_tr_b16 v[206:207], v225 offset:43008
 v_mfma_f32_16x16x32_bf16 v[116:119], v[216:219], a[164:167], v[116:119]
 v_mfma_f32_16x16x32_bf16 v[116:119], v[220:223], a[180:183], v[116:119]
 v_mfma_f32_16x16x32_bf16 v[112:115], v[220:223], a[176:179], v[112:115]
 buffer_load_dwordx4 v234, s[8:11], s43 offen offset:3072  lds
 v_mfma_f32_16x16x32_bf16 v[112:115], v[216:219], a[160:163], v[112:115]
 s_waitcnt lgkmcnt(8)
 ds_read_b64_tr_b16 v[208:209], v226 offset:32768
 v_mfma_f32_16x16x32_bf16 v[0:3], v[192:195], a[192:195], v[0:3]
 ds_read_b64_tr_b16 v[210:211], v226 offset:34816
 v_mfma_f32_16x16x32_bf16 v[0:3], v[196:199], a[208:211], v[0:3]
 ds_read_b64_tr_b16 v[212:213], v226 offset:40960
 v_mfma_f32_16x16x32_bf16 v[4:7], v[196:199], a[212:215], v[4:7]
 v_mfma_f32_16x16x32_bf16 v[4:7], v[192:195], a[196:199], v[4:7]
 s_waitcnt lgkmcnt(8)
 ds_read_b64_tr_b16 v[214:215], v226 offset:43008
 v_mfma_f32_16x16x32_bf16 v[8:11], v[192:195], a[200:203], v[8:11]
 v_mfma_f32_16x16x32_bf16 v[8:11], v[196:199], a[216:219], v[8:11]
 s_waitcnt lgkmcnt(4)
 v_mfma_f32_16x16x32_bf16 v[12:15], v[196:199], a[220:223], v[12:15]
 v_mfma_f32_16x16x32_bf16 v[12:15], v[192:195], a[204:207], v[12:15]
 ds_read_b64_tr_b16 v[216:217], v227 offset:32768
 v_mfma_f32_16x16x32_bf16 v[28:31], v[200:203], a[204:207], v[28:31]
 ds_read_b64_tr_b16 v[218:219], v227 offset:34816
 v_mfma_f32_16x16x32_bf16 v[28:31], v[204:207], a[220:223], v[28:31]
 ds_read_b64_tr_b16 v[220:221], v227 offset:40960
 v_mfma_f32_16x16x32_bf16 v[24:27], v[204:207], a[216:219], v[24:27]
 s_xor_b32 s25, s53, 1048576
 v_mfma_f32_16x16x32_bf16 v[24:27], v[200:203], a[200:203], v[24:27]
 s_add_u32 m0, s55, 65536
 ds_read_b64_tr_b16 v[222:223], v227 offset:43008
 v_mfma_f32_16x16x32_bf16 v[20:23], v[200:203], a[196:199], v[20:23]
 v_add_u32 v234, s25, v233
 v_mfma_f32_16x16x32_bf16 v[20:23], v[204:207], a[212:215], v[20:23]
 v_mfma_f32_16x16x32_bf16 v[16:19], v[204:207], a[208:211], v[16:19]
 buffer_load_dwordx4 v234, s[8:11], s40 offen  lds
 v_mfma_f32_16x16x32_bf16 v[16:19], v[200:203], a[192:195], v[16:19]
 s_waitcnt lgkmcnt(4)
 ds_read_b64_tr_b16 v[192:193], v224 offset:36864
 v_mfma_f32_16x16x32_bf16 v[32:35], v[208:211], a[192:195], v[32:35]
 ds_read_b64_tr_b16 v[194:195], v224 offset:38912
 v_mfma_f32_16x16x32_bf16 v[32:35], v[212:215], a[208:211], v[32:35]
 ds_read_b64_tr_b16 v[196:197], v224 offset:45056
 v_mfma_f32_16x16x32_bf16 v[36:39], v[212:215], a[212:215], v[36:39]
 buffer_load_dwordx4 v234, s[8:11], s41 offen offset:1024  lds
 v_mfma_f32_16x16x32_bf16 v[36:39], v[208:211], a[196:199], v[36:39]
 ds_read_b64_tr_b16 v[198:199], v224 offset:47104
 v_mfma_f32_16x16x32_bf16 v[40:43], v[208:211], a[200:203], v[40:43]
 v_mfma_f32_16x16x32_bf16 v[40:43], v[212:215], a[216:219], v[40:43]
 v_mfma_f32_16x16x32_bf16 v[44:47], v[212:215], a[220:223], v[44:47]
 buffer_load_dwordx4 v234, s[8:11], s42 offen offset:2048  lds
 v_mfma_f32_16x16x32_bf16 v[44:47], v[208:211], a[204:207], v[44:47]
 s_waitcnt lgkmcnt(4)
 ds_read_b64_tr_b16 v[200:201], v225 offset:36864
 v_mfma_f32_16x16x32_bf16 v[60:63], v[216:219], a[204:207], v[60:63]
 s_mov_b32 s16, s68
 ds_read_b64_tr_b16 v[202:203], v225 offset:38912
 v_mfma_f32_16x16x32_bf16 v[60:63], v[220:223], a[220:223], v[60:63]
 s_mov_b32 s17, s69
 ds_read_b64_tr_b16 v[204:205], v225 offset:45056
 v_mfma_f32_16x16x32_bf16 v[56:59], v[220:223], a[216:219], v[56:59]
 s_cmp_eq_u32 s20, 2
 s_cselect_b32 s31, s30, 536870912
 buffer_load_dwordx4 v234, s[8:11], s43 offen offset:3072  lds
 v_mfma_f32_16x16x32_bf16 v[56:59], v[216:219], a[200:203], v[56:59]
 ds_read_b64_tr_b16 v[206:207], v225 offset:47104
 v_mfma_f32_16x16x32_bf16 v[52:55], v[216:219], a[196:199], v[52:55]
 v_mfma_f32_16x16x32_bf16 v[52:55], v[220:223], a[212:215], v[52:55]
 v_mfma_f32_16x16x32_bf16 v[48:51], v[220:223], a[208:211], v[48:51]
 buffer_load_dword v238, v237, s[16:19], s31 offen
 v_mfma_f32_16x16x32_bf16 v[48:51], v[216:219], a[192:195], v[48:51]
 s_waitcnt lgkmcnt(4)
 s_mov_b32 s16, s68
 ds_read_b64_tr_b16 v[208:209], v226 offset:36864
 v_mfma_f32_16x16x32_bf16 v[64:67], v[192:195], a[192:195], v[64:67]
 s_mov_b32 s17, s69
 ds_read_b64_tr_b16 v[210:211], v226 offset:38912
 v_mfma_f32_16x16x32_bf16 v[64:67], v[196:199], a[208:211], v[64:67]
 s_cmp_eq_u32 s20, 3
 s_cselect_b32 s31, s30, 536870912
 ds_read_b64_tr_b16 v[212:213], v226 offset:45056
 v_mfma_f32_16x16x32_bf16 v[68:71], v[196:199], a[212:215], v[68:71]
 buffer_load_dword v238, v237, s[16:19], s31 offen
 v_mfma_f32_16x16x32_bf16 v[68:71], v[192:195], a[196:199], v[68:71]
 ds_read_b64_tr_b16 v[214:215], v226 offset:47104
 v_mfma_f32_16x16x32_bf16 v[72:75], v[192:195], a[200:203], v[72:75]
 v_mfma_f32_16x16x32_bf16 v[72:75], v[196:199], a[216:219], v[72:75]
 v_mfma_f32_16x16x32_bf16 v[76:79], v[196:199], a[220:223], v[76:79]
 v_mfma_f32_16x16x32_bf16 v[76:79], v[192:195], a[204:207], v[76:79]
 s_waitcnt lgkmcnt(4)
 ds_read_b64_tr_b16 v[216:217], v227 offset:36864
 v_mfma_f32_16x16x32_bf16 v[92:95], v[200:203], a[204:207], v[92:95]
 ds_read_b64_tr_b16 v[218:219], v227 offset:38912
 v_mfma_f32_16x16x32_bf16 v[92:95], v[204:207], a[220:223], v[92:95]
 ds_read_b64_tr_b16 v[220:221], v227 offset:45056
 v_mfma_f32_16x16x32_bf16 v[88:91], v[204:207], a[216:219], v[88:91]
 s_xor_b32 s25, s53, 2097152
 v_mfma_f32_16x16x32_bf16 v[88:91], v[200:203], a[200:203], v[88:91]
 s_add_u32 m0, s55, 81920
 ds_read_b64_tr_b16 v[222:223], v227 offset:47104
 v_mfma_f32_16x16x32_bf16 v[84:87], v[200:203], a[196:199], v[84:87]
 s_waitcnt vmcnt(10)
 v_add_u32 v234, s25, v233
 v_mfma_f32_16x16x32_bf16 v[84:87], v[204:207], a[212:215], v[84:87]
 s_barrier
 v_mfma_f32_16x16x32_bf16 v[80:83], v[204:207], a[208:211], v[80:83]
 buffer_load_dwordx4 v234, s[8:11], s40 offen  lds
 v_mfma_f32_16x16x32_bf16 v[80:83], v[200:203], a[192:195], v[80:83]
 s_waitcnt lgkmcnt(4)
 ds_read_b128 a[224:227], v230 offset:0
 ds_read_b64_tr_b16 v[192:193], v224 offset:49152
 v_mfma_f32_16x16x32_bf16 v[96:99], v[208:211], a[192:195], v[96:99]
 ds_read_b128 a[240:243], v231 offset:0
 ds_read_b64_tr_b16 v[194:195], v224 offset:51200
 v_mfma_f32_16x16x32_bf16 v[96:99], v[212:215], a[208:211], v[96:99]
 ds_read_b128 a[228:231], v230 offset:2048
 ds_read_b64_tr_b16 v[196:197], v224 offset:57344
 v_mfma_f32_16x16x32_bf16 v[100:103], v[212:215], a[212:215], v[100:103]
 buffer_load_dwordx4 v234, s[8:11], s41 offen offset:1024  lds
 v_mfma_f32_16x16x32_bf16 v[100:103], v[208:211], a[196:199], v[100:103]
 ds_read_b128 a[244:247], v231 offset:2048
 ds_read_b64_tr_b16 v[198:199], v224 offset:59392
 v_mfma_f32_16x16x32_bf16 v[104:107], v[208:211], a[200:203], v[104:107]
Lw1_2:
 s_cbranch_execz Lw1_back
 ds_read_b128 a[232:235], v230 offset:4096
 v_mfma_f32_16x16x32_bf16 v[104:107], v[212:215], a[216:219], v[104:107]
 ds_read_b128 a[248:251], v231 offset:4096
 v_mfma_f32_16x16x32_bf16 v[108:111], v[212:215], a[220:223], v[108:111]
 buffer_load_dwordx4 v234, s[8:11], s42 offen offset:2048  lds
 v_mfma_f32_16x16x32_bf16 v[108:111], v[208:211], a[204:207], v[108:111]
 s_waitcnt lgkmcnt(10)
 ds_read_b128 a[236:239], v230 offset:6144
 ds_read_b64_tr_b16 v[200:201], v225 offset:49152
 v_mfma_f32_16x16x32_bf16 v[124:127], v[216:219], a[204:207], v[124:127]
 ds_read_b128 a[252:255], v231 offset:6144
 ds_read_b64_tr_b16 v[202:203], v225 offset:51200
 v_mfma_f32_16x16x32_bf16 v[124:127], v[220:223], a[220:223], v[124:127]
 ds_read_b64_tr_b16 v[204:205], v225 offset:57344
 v_mfma_f32_16x16x32_bf16 v[120:123], v[220:223], a[216:219], v[120:123]
 buffer_load_dwordx4 v234, s[8:11], s43 offen offset:3072  lds
 v_mfma_f32_16x16x32_bf16 v[120:123], v[216:219], a[200:203], v[120:123]
 ds_read_b64_tr_b16 v[206:207], v225 offset:59392
 v_mfma_f32_16x16x32_bf16 v[116:119], v[216:219], a[196:199], v[116:119]
 v_mfma_f32_16x16x32_bf16 v[116:119], v[220:223], a[212:215], v[116:119]
 v_mfma_f32_16x16x32_bf16 v[112:115], v[220:223], a[208:211], v[112:115]
 v_mfma_f32_16x16x32_bf16 v[112:115], v[216:219], a[192:195], v[112:115]
 s_waitcnt lgkmcnt(8)
 ds_read_b64_tr_b16 v[208:209], v226 offset:49152
 v_mfma_f32_16x16x32_bf16 v[0:3], v[192:195], a[224:227], v[0:3]
 ds_read_b64_tr_b16 v[210:211], v226 offset:51200
 v_add_u32 v244, 0x10000, v224
 v_mfma_f32_16x16x32_bf16 v[0:3], v[196:199], a[240:243], v[0:3]
 ds_read_b64_tr_b16 v[212:213], v226 offset:57344
 v_add_u32 v245, 0x10000, v225
 v_mfma_f32_16x16x32_bf16 v[4:7], v[196:199], a[244:247], v[4:7]
 v_mfma_f32_16x16x32_bf16 v[4:7], v[192:195], a[228:231], v[4:7]
 s_waitcnt lgkmcnt(8)
 ds_read_b64_tr_b16 v[214:215], v226 offset:59392
 v_add_u32 v246, 0x10000, v226
 v_mfma_f32_16x16x32_bf16 v[8:11], v[192:195], a[232:235], v[8:11]
 v_add_u32 v247, 0x10000, v227
 v_mfma_f32_16x16x32_bf16 v[8:11], v[196:199], a[248:251], v[8:11]
 s_waitcnt lgkmcnt(4)
 v_mfma_f32_16x16x32_bf16 v[12:15], v[196:199], a[252:255], v[12:15]
 v_mfma_f32_16x16x32_bf16 v[12:15], v[192:195], a[236:239], v[12:15]
 ds_read_b64_tr_b16 v[216:217], v227 offset:49152
 v_mfma_f32_16x16x32_bf16 v[28:31], v[200:203], a[236:239], v[28:31]
 ds_read_b64_tr_b16 v[218:219], v227 offset:51200
 v_mfma_f32_16x16x32_bf16 v[28:31], v[204:207], a[252:255], v[28:31]
 ds_read_b64_tr_b16 v[220:221], v227 offset:57344
 v_mfma_f32_16x16x32_bf16 v[24:27], v[204:207], a[248:251], v[24:27]
 s_xor_b32 s25, s53, 3145728
 v_mfma_f32_16x16x32_bf16 v[24:27], v[200:203], a[232:235], v[24:27]
 s_add_u32 m0, s55, 98304
 ds_read_b64_tr_b16 v[222:223], v227 offset:59392
 v_mfma_f32_16x16x32_bf16 v[20:23], v[200:203], a[228:231], v[20:23]
 v_add_u32 v234, s25, v233
 v_mfma_f32_16x16x32_bf16 v[20:23], v[204:207], a[244:247], v[20:23]
 v_mfma_f32_16x16x32_bf16 v[16:19], v[204:207], a[240:243], v[16:19]
 buffer_load_dwordx4 v234, s[8:11], s40 offen  lds
 v_mfma_f32_16x16x32_bf16 v[16:19], v[200:203], a[224:227], v[16:19]
 s_waitcnt lgkmcnt(4)
 ds_read_b64_tr_b16 v[192:193], v224 offset:53248
 v_mfma_f32_16x16x32_bf16 v[32:35], v[208:211], a[224:227], v[32:35]
 ds_read_b64_tr_b16 v[194:195], v224 offset:55296
 v_mfma_f32_16x16x32_bf16 v[32:35], v[212:215], a[240:243], v[32:35]
 ds_read_b64_tr_b16 v[196:197], v224 offset:61440
 v_mfma_f32_16x16x32_bf16 v[36:39], v[212:215], a[244:247], v[36:39]
 buffer_load_dwordx4 v234, s[8:11], s41 offen offset:1024  lds
 v_mfma_f32_16x16x32_bf16 v[36:39], v[208:211], a[228:231], v[36:39]
 ds_read_b64_tr_b16 v[198:199], v224 offset:63488
 v_mfma_f32_16x16x32_bf16 v[40:43], v[208:211], a[232:235], v[40:43]
 v_mfma_f32_16x16x32_bf16 v[40:43], v[212:215], a[248:251], v[40:43]
 v_mfma_f32_16x16x32_bf16 v[44:47], v[212:215], a[252:255], v[44:47]
 buffer_load_dwordx4 v234, s[8:11], s42 offen offset:2048  lds
 v_mfma_f32_16x16x32_bf16 v[44:47], v[208:211], a[236:239], v[44:47]
 s_waitcnt lgkmcnt(4)
 ds_read_b64_tr_b16 v[200:201], v225 offset:53248
 v_mfma_f32_16x16x32_bf16 v[60:63], v[216:219], a[236:239], v[60:63]
 ds_read_b64_tr_b16 v[202:203], v225 offset:55296
 v_mfma_f32_16x16x32_bf16 v[60:63], v[220:223], a[252:255], v[60:63]
 ds_read_b64_tr_b16 v[204:205], v225 offset:61440
 v_mfma_f32_16x16x32_bf16 v[56:59], v[220:223], a[248:251], v[56:59]
 buffer_load_dwordx4 v234, s[8:11], s43 offen offset:3072  lds
 v_mfma_f32_16x16x32_bf16 v[56:59], v[216:219], a[232:235], v[56:59]
 ds_read_b64_tr_b16 v[206:207], v225 offset:63488
 v_mfma_f32_16x16x32_bf16 v[52:55], v[216:219], a[228:231], v[52:55]
 v_mfma_f32_16x16x32_bf16 v[52:55], v[220:223], a[244:247], v[52:55]
 v_mfma_f32_16x16x32_bf16 v[48:51], v[220:223], a[240:243], v[48:51]
 v_mfma_f32_16x16x32_bf16 v[48:51], v[216:219], a[224:227], v[48:51]
 s_waitcnt lgkmcnt(4)
 ds_read_b64_tr_b16 v[208:209], v226 offset:53248
 v_mfma_f32_16x16x32_bf16 v[64:67], v[192:195], a[224:227], v[64:67]
 ds_read_b64_tr_b16 v[210:211], v226 offset:55296
 v_mfma_f32_16x16x32_bf16 v[64:67], v[196:199], a[240:243], v[64:67]
 ds_read_b64_tr_b16 v[212:213], v226 offset:61440
 v_mfma_f32_16x16x32_bf16 v[68:71], v[196:199], a[244:247], v[68:71]
 v_mfma_f32_16x16x32_bf16 v[68:71], v[192:195], a[228:231], v[68:71]
 ds_read_b64_tr_b16 v[214:215], v226 offset:63488
 v_mfma_f32_16x16x32_bf16 v[72:75], v[192:195], a[232:235], v[72:75]
 v_mfma_f32_16x16x32_bf16 v[72:75], v[196:199], a[248:251], v[72:75]
 v_mfma_f32_16x16x32_bf16 v[76:79], v[196:199], a[252:255], v[76:79]
 v_mfma_f32_16x16x32_bf16 v[76:79], v[192:195], a[236:239], v[76:79]
 s_waitcnt lgkmcnt(4)
 ds_read_b64_tr_b16 v[216:217], v227 offset:53248
 v_mfma_f32_16x16x32_bf16 v[92:95], v[200:203], a[236:239], v[92:95]
 ds_read_b64_tr_b16 v[218:219], v227 offset:55296
 v_mfma_f32_16x16x32_bf16 v[92:95], v[204:207], a[252:255], v[92:95]
 ds_read_b64_tr_b16 v[220:221], v227 offset:61440
 v_mfma_f32_16x16x32_bf16 v[88:91], v[204:207], a[248:251], v[88:91]
 s_xor_b32 s25, s53, 128
 v_mfma_f32_16x16x32_bf16 v[88:91], v[200:203], a[232:235], v[88:91]
 s_add_u32 m0, s55, 114688
 ds_read_b64_tr_b16 v[222:223], v227 offset:63488
 v_mfma_f32_16x16x32_bf16 v[84:87], v[200:203], a[228:231], v[84:87]
 s_waitcnt vmcnt(14)
 v_add_u32 v234, s25, v233
 v_mfma_f32_16x16x32_bf16 v[84:87], v[204:207], a[244:247], v[84:87]
 s_barrier
 v_mfma_f32_16x16x32_bf16 v[80:83], v[204:207], a[240:243], v[80:83]
 buffer_load_dwordx4 v234, s[8:11], s40 offen  lds
 v_mfma_f32_16x16x32_bf16 v[80:83], v[200:203], a[224:227], v[80:83]
 s_waitcnt lgkmcnt(4)
 ds_read_b64_tr_b16 v[192:193], v224 offset:0
 v_mfma_f32_16x16x32_bf16 v[96:99], v[208:211], a[224:227], v[96:99]
 ds_read_b64_tr_b16 v[194:195], v224 offset:2048
 v_mfma_f32_16x16x32_bf16 v[96:99], v[212:215], a[240:243], v[96:99]
 ds_read_b64_tr_b16 v[196:197], v224 offset:4096
 v_mfma_f32_16x16x32_bf16 v[100:103], v[212:215], a[244:247], v[100:103]
 buffer_load_dwordx4 v234, s[8:11], s41 offen offset:1024  lds
 v_mfma_f32_16x16x32_bf16 v[100:103], v[208:211], a[228:231], v[100:103]
 ds_read_b64_tr_b16 v[198:199], v224 offset:6144
 v_mfma_f32_16x16x32_bf16 v[104:107], v[208:211], a[232:235], v[104:107]
 ds_read_b64_tr_b16 v[200:201], v224 offset:8192
 v_mfma_f32_16x16x32_bf16 v[104:107], v[212:215], a[248:251], v[104:107]
 ds_read_b64_tr_b16 v[202:203], v224 offset:10240
 v_mfma_f32_16x16x32_bf16 v[108:111], v[212:215], a[252:255], v[108:111]
 buffer_load_dwordx4 v234, s[8:11], s42 offen offset:2048  lds
 v_mfma_f32_16x16x32_bf16 v[108:111], v[208:211], a[236:239], v[108:111]
 s_waitcnt lgkmcnt(6)
 ds_read_b64_tr_b16 v[204:205], v224 offset:12288
 ds_read_b64_tr_b16 v[206:207], v224 offset:14336
 v_mfma_f32_16x16x32_bf16 v[124:127], v[216:219], a[236:239], v[124:127]
 v_mfma_f32_16x16x32_bf16 v[124:127], v[220:223], a[252:255], v[124:127]
 v_mfma_f32_16x16x32_bf16 v[120:123], v[220:223], a[248:251], v[120:123]
 buffer_load_dword v235, v236, s[4:7], 0 offen sc1
 v_mfma_f32_16x16x32_bf16 v[120:123], v[216:219], a[232:235], v[120:123]
 v_mfma_f32_16x16x32_bf16 v[116:119], v[216:219], a[228:231], v[116:119]
 v_mfma_f32_16x16x32_bf16 v[116:119], v[220:223], a[244:247], v[116:119]
 v_mfma_f32_16x16x32_bf16 v[112:115], v[220:223], a[240:243], v[112:115]
 buffer_load_dwordx4 v234, s[8:11], s43 offen offset:3072  lds
 v_mfma_f32_16x16x32_bf16 v[112:115], v[216:219], a[224:227], v[112:115]
 s_waitcnt lgkmcnt(0)
 ds_read_b64_tr_b16 v[208:209], v225 offset:0
 v_mfma_f32_16x16x32_bf16 v[128:131], a[0:3], v[192:195], 0
 ds_read_b64_tr_b16 v[210:211], v225 offset:2048
 v_mfma_f32_16x16x32_bf16 v[128:131], a[16:19], v[196:199], v[128:131]
 ds_read_b64_tr_b16 v[212:213], v225 offset:4096
 v_mfma_f32_16x16x32_bf16 v[128:131], a[32:35], v[200:203], v[128:131]
 v_mfma_f32_16x16x32_bf16 v[128:131], a[48:51], v[204:207], v[128:131]
 ds_read_b64_tr_b16 v[214:215], v225 offset:6144
 v_mfma_f32_16x16x32_bf16 v[132:135], a[52:55], v[204:207], 0
 ds_read_b64_tr_b16 v[216:217], v225 offset:8192
 v_mfma_f32_16x16x32_bf16 v[132:135], a[36:39], v[200:203], v[132:135]
 ds_read_b64_tr_b16 v[218:219], v225 offset:10240
 v_mfma_f32_16x16x32_bf16 v[132:135], a[20:23], v[196:199], v[132:135]
 v_mfma_f32_16x16x32_bf16 v[132:135], a[4:7], v[192:195], v[132:135]
 ds_read_b64_tr_b16 v[220:221], v225 offset:12288
 ds_read_b64_tr_b16 v[222:223], v225 offset:14336
 v_mfma_f32_16x16x32_bf16 v[136:139], a[8:11], v[192:195], 0
 v_cvt_pk_bf16_f32 v0, v0, v1
 v_mfma_f32_16x16x32_bf16 v[136:139], a[24:27], v[196:199], v[136:139]
 v_mfma_f32_16x16x32_bf16 v[136:139], a[40:43], v[200:203], v[136:139]
 s_xor_b32 s25, s53, 1048704
 v_mfma_f32_16x16x32_bf16 v[136:139], a[56:59], v[204:207], v[136:139]
 s_add_u32 m0, s55, 16384
 v_cvt_pk_bf16_f32 v1, v2, v3
 v_mfma_f32_16x16x32_bf16 v[140:143], a[60:63], v[204:207], 0
 v_add_u32 v234, s25, v233
 v_mfma_f32_16x16x32_bf16 v[140:143], a[44:47], v[200:203], v[140:143]
 v_mfma_f32_16x16x32_bf16 v[140:143], a[28:31], v[196:199], v[140:143]
 buffer_load_dwordx4 v234, s[8:11], s40 offen  lds
 v_mfma_f32_16x16x32_bf16 v[140:143], a[12:15], v[192:195], v[140:143]
 s_waitcnt lgkmcnt(0)
 ds_read_b64_tr_b16 v[192:193], v226 offset:0
 v_cvt_pk_bf16_f32 v2, v16, v17
 v_mfma_f32_16x16x32_bf16 v[156:159], a[12:15], v[208:211], 0
 ds_read_b64_tr_b16 v[194:195], v226 offset:2048
 v_mfma_f32_16x16x32_bf16 v[156:159], a[28:31], v[212:215], v[156:159]
 ds_read_b64_tr_b16 v[196:197], v226 offset:4096
 v_mfma_f32_16x16x32_bf16 v[156:159], a[44:47], v[216:219], v[156:159]
 buffer_load_dwordx4 v234, s[8:11], s41 offen offset:1024  lds
 v_mfma_f32_16x16x32_bf16 v[156:159], a[60:63], v[220:223], v[156:159]
 ds_read_b64_tr_b16 v[198:199], v226 offset:6144
 v_cvt_pk_bf16_f32 v3, v18, v19
 v_mfma_f32_16x16x32_bf16 v[152:155], a[56:59], v[220:223], 0
 ds_read_b64_tr_b16 v[200:201], v226 offset:8192
 v_mfma_f32_16x16x32_bf16 v[152:155], a[40:43], v[216:219], v[152:155]
 ds_read_b64_tr_b16 v[202:203], v226 offset:10240
 v_mfma_f32_16x16x32_bf16 v[152:155], a[24:27], v[212:215], v[152:155]
 buffer_load_dwordx4 v234, s[8:11], s42 offen offset:2048  lds
 v_mfma_f32_16x16x32_bf16 v[152:155], a[8:11], v[208:211], v[152:155]
 ds_read_b64_tr_b16 v[204:205], v226 offset:12288
 ds_read_b64_tr_b16 v[206:207], v226 offset:14336
 v_mfma_f32_16x16x32_bf16 v[148:151], a[4:7], v[208:211], 0
 v_mfma_f32_16x16x32_bf16 v[148:151], a[20:23], v[212:215], v[148:151]
 v_mfma_f32_16x16x32_bf16 v[148:151], a[36:39], v[216:219], v[148:151]
 buffer_store_dwordx4 v[0:3], v255, s[4:7], s44 offen sc1
 v_mfma_f32_16x16x32_bf16 v[148:151], a[52:55], v[220:223], v[148:151]
 v_cvt_pk_bf16_f32 v4, v4, v5
 v_mfma_f32_16x16x32_bf16 v[144:147], a[48:51], v[220:223], 0
 v_mfma_f32_16x16x32_bf16 v[144:147], a[32:35], v[216:219], v[144:147]
 v_mfma_f32_16x16x32_bf16 v[144:147], a[16:19], v[212:215], v[144:147]
 buffer_load_dwordx4 v234, s[8:11], s43 offen offset:3072  lds
 v_mfma_f32_16x16x32_bf16 v[144:147], a[0:3], v[208:211], v[144:147]
 s_waitcnt lgkmcnt(0)
 ds_read_b64_tr_b16 v[208:209], v227 offset:0
 v_cvt_pk_bf16_f32 v5, v6, v7
 v_mfma_f32_16x16x32_bf16 v[160:163], a[0:3], v[192:195], 0
 ds_read_b64_tr_b16 v[210:211], v227 offset:2048
 v_mfma_f32_16x16x32_bf16 v[160:163], a[16:19], v[196:199], v[160:163]
 ds_read_b64_tr_b16 v[212:213], v227 offset:4096
 v_mfma_f32_16x16x32_bf16 v[160:163], a[32:35], v[200:203], v[160:163]
 v_mfma_f32_16x16x32_bf16 v[160:163], a[48:51], v[204:207], v[160:163]
 ds_read_b64_tr_b16 v[214:215], v227 offset:6144
 v_cvt_pk_bf16_f32 v6, v20, v21
 v_mfma_f32_16x16x32_bf16 v[164:167], a[52:55], v[204:207], 0
 ds_read_b64_tr_b16 v[216:217], v227 offset:8192
 v_mfma_f32_16x16x32_bf16 v[164:167], a[36:39], v[200:203], v[164:167]
 ds_read_b64_tr_b16 v[218:219], v227 offset:10240
 v_mfma_f32_16x16x32_bf16 v[164:167], a[20:23], v[196:199], v[164:167]
 v_mfma_f32_16x16x32_bf16 v[164:167], a[4:7], v[192:195], v[164:167]
 ds_read_b64_tr_b16 v[220:221], v227 offset:12288
 ds_read_b64_tr_b16 v[222:223], v227 offset:14336
 v_mfma_f32_16x16x32_bf16 v[168:171], a[8:11], v[192:195], 0
 v_cvt_pk_bf16_f32 v7, v22, v23
 v_mfma_f32_16x16x32_bf16 v[168:171], a[24:27], v[196:199], v[168:171]
 v_mfma_f32_16x16x32_bf16 v[168:171], a[40:43], v[200:203], v[168:171]
 s_xor_b32 s25, s53, 2097280
 v_mfma_f32_16x16x32_bf16 v[168:171], a[56:59], v[204:207], v[168:171]
 s_add_u32 m0, s55, 32768
 v_mfma_f32_16x16x32_bf16 v[172:175], a[60:63], v[204:207], 0
 s_waitcnt vmcnt(20)
 v_add_u32 v234, s25, v233
 v_mfma_f32_16x16x32_bf16 v[172:175], a[44:47], v[200:203], v[172:175]
 s_barrier
 v_mfma_f32_16x16x32_bf16 v[172:175], a[28:31], v[196:199], v[172:175]
 buffer_store_dwordx4 v[4:7], v255, s[4:7], s45 offen sc1
 v_mfma_f32_16x16x32_bf16 v[172:175], a[12:15], v[192:195], v[172:175]
 s_waitcnt lgkmcnt(0)
 ds_read_b64_tr_b16 v[192:193], v244 offset:0
 v_cvt_pk_bf16_f32 v8, v8, v9
 v_mfma_f32_16x16x32_bf16 v[188:191], a[12:15], v[208:211], 0
 ds_read_b64_tr_b16 v[194:195], v244 offset:2048
 v_mfma_f32_16x16x32_bf16 v[188:191], a[28:31], v[212:215], v[188:191]
 ds_read_b64_tr_b16 v[196:197], v244 offset:4096
 v_mfma_f32_16x16x32_bf16 v[188:191], a[44:47], v[216:219], v[188:191]
 buffer_load_dwordx4 v234, s[8:11], s40 offen  lds
 v_mfma_f32_16x16x32_bf16 v[188:191], a[60:63], v[220:223], v[188:191]
 ds_read_b64_tr_b16 v[198:199], v244 offset:6144
 v_cvt_pk_bf16_f32 v9, v10, v11
 v_mfma_f32_16x16x32_bf16 v[184:187], a[56:59], v[220:223], 0
 ds_read_b64_tr_b16 v[200:201], v244 offset:8192
 v_mfma_f32_16x16x32_bf16 v[184:187], a[40:43], v[216:219], v[184:187]
 ds_read_b64_tr_b16 v[202:203], v244 offset:10240
 v_mfma_f32_16x16x32_bf16 v[184:187], a[24:27], v[212:215], v[184:187]
 buffer_load_dwordx4 v234, s[8:11], s41 offen offset:1024  lds
 v_mfma_f32_16x16x32_bf16 v[184:187], a[8:11], v[208:211], v[184:187]
 ds_read_b64_tr_b16 v[204:205], v244 offset:12288
 ds_read_b64_tr_b16 v[206:207], v244 offset:14336
 v_mfma_f32_16x16x32_bf16 v[180:183], a[4:7], v[208:211], 0
 v_cvt_pk_bf16_f32 v10, v24, v25
 v_mfma_f32_16x16x32_bf16 v[180:183], a[20:23], v[212:215], v[180:183]
 v_mfma_f32_16x16x32_bf16 v[180:183], a[36:39], v[216:219], v[180:183]
 buffer_load_dwordx4 v234, s[8:11], s42 offen offset:2048  lds
 v_mfma_f32_16x16x32_bf16 v[180:183], a[52:55], v[220:223], v[180:183]
 v_cvt_pk_bf16_f32 v11, v26, v27
 v_mfma_f32_16x16x32_bf16 v[176:179], a[48:51], v[220:223], 0
 v_mfma_f32_16x16x32_bf16 v[176:179], a[32:35], v[216:219], v[176:179]
 v_mfma_f32_16x16x32_bf16 v[176:179], a[16:19], v[212:215], v[176:179]
 buffer_load_dwordx4 v234, s[8:11], s43 offen offset:3072  lds
 v_mfma_f32_16x16x32_bf16 v[176:179], a[0:3], v[208:211], v[176:179]
 s_waitcnt lgkmcnt(0)
 ds_read_b64_tr_b16 v[208:209], v245 offset:0
 v_mfma_f32_16x16x32_bf16 v[128:131], a[64:67], v[192:195], v[128:131]
 ds_read_b64_tr_b16 v[210:211], v245 offset:2048
 v_mfma_f32_16x16x32_bf16 v[128:131], a[80:83], v[196:199], v[128:131]
 ds_read_b64_tr_b16 v[212:213], v245 offset:4096
 v_mfma_f32_16x16x32_bf16 v[128:131], a[96:99], v[200:203], v[128:131]
 s_lshl_b32 s23, s22, 17
 buffer_store_dwordx4 v[8:11], v255, s[4:7], s46 offen sc1
 v_mfma_f32_16x16x32_bf16 v[128:131], a[112:115], v[204:207], v[128:131]
 s_lshl_b32 s24, s20, 14
 ds_read_b64_tr_b16 v[214:215], v245 offset:6144
 v_cvt_pk_bf16_f32 v12, v12, v13
 v_mfma_f32_16x16x32_bf16 v[132:135], a[116:119], v[204:207], v[132:135]
 s_sub_u32 s26, s24, s23
 ds_read_b64_tr_b16 v[216:217], v245 offset:8192
 v_mfma_f32_16x16x32_bf16 v[132:135], a[100:103], v[200:203], v[132:135]
 s_add_u32 s23, s24, s23
 ds_read_b64_tr_b16 v[218:219], v245 offset:10240
 v_mfma_f32_16x16x32_bf16 v[132:135], a[84:87], v[196:199], v[132:135]
 s_add_u32 s32, s23, 0
 v_mfma_f32_16x16x32_bf16 v[132:135], a[68:71], v[192:195], v[132:135]
 s_add_u32 s33, s23, 7168
 ds_read_b64_tr_b16 v[220:221], v245 offset:12288
 ds_read_b64_tr_b16 v[222:223], v245 offset:14336
 v_mfma_f32_16x16x32_bf16 v[136:139], a[72:75], v[192:195], v[136:139]
 s_add_u32 s34, s23, 63488
 v_cvt_pk_bf16_f32 v13, v14, v15
 v_mfma_f32_16x16x32_bf16 v[136:139], a[88:91], v[196:199], v[136:139]
 s_add_u32 s35, s23, 70656
 v_mfma_f32_16x16x32_bf16 v[136:139], a[104:107], v[200:203], v[136:139]
 s_add_u32 s36, s26, 1966080
 v_mfma_f32_16x16x32_bf16 v[136:139], a[120:123], v[204:207], v[136:139]
 s_add_u32 s37, s26, 1973248
 v_cvt_pk_bf16_f32 v14, v28, v29
 v_mfma_f32_16x16x32_bf16 v[140:143], a[124:127], v[204:207], v[140:143]
 s_add_u32 s38, s26, 2029568
 v_mfma_f32_16x16x32_bf16 v[140:143], a[108:111], v[200:203], v[140:143]
 s_add_u32 s39, s26, 2036736
 v_mfma_f32_16x16x32_bf16 v[140:143], a[92:95], v[196:199], v[140:143]
 s_xor_b32 s25, s53, 3145856
 v_mfma_f32_16x16x32_bf16 v[140:143], a[76:79], v[192:195], v[140:143]
 s_waitcnt lgkmcnt(0)
 s_add_u32 m0, s55, 49152
 ds_read_b64_tr_b16 v[192:193], v246 offset:0
 v_cvt_pk_bf16_f32 v15, v30, v31
 v_mfma_f32_16x16x32_bf16 v[156:159], a[76:79], v[208:211], v[156:159]
 ds_read_b64_tr_b16 v[194:195], v246 offset:2048
 v_add_u32 v234, s25, v233
 v_mfma_f32_16x16x32_bf16 v[156:159], a[92:95], v[212:215], v[156:159]
 ds_read_b64_tr_b16 v[196:197], v246 offset:4096
 v_mfma_f32_16x16x32_bf16 v[156:159], a[108:111], v[216:219], v[156:159]
 buffer_load_dwordx4 v234, s[8:11], s40 offen  lds
 v_mfma_f32_16x16x32_bf16 v[156:159], a[124:127], v[220:223], v[156:159]
 ds_read_b64_tr_b16 v[198:199], v246 offset:6144
 v_mfma_f32_16x16x32_bf16 v[152:155], a[120:123], v[220:223], v[152:155]
 ds_read_b64_tr_b16 v[200:201], v246 offset:8192
 v_mfma_f32_16x16x32_bf16 v[152:155], a[104:107], v[216:219], v[152:155]
 ds_read_b64_tr_b16 v[202:203], v246 offset:10240
 v_mfma_f32_16x16x32_bf16 v[152:155], a[88:91], v[212:215], v[152:155]
 buffer_store_dwordx4 v[12:15], v255, s[4:7], s47 offen sc1
 v_mfma_f32_16x16x32_bf16 v[152:155], a[72:75], v[208:211], v[152:155]
 ds_read_b64_tr_b16 v[204:205], v246 offset:12288
 ds_read_b64_tr_b16 v[206:207], v246 offset:14336
 v_mfma_f32_16x16x32_bf16 v[148:151], a[68:71], v[208:211], v[148:151]
 v_cvt_pk_bf16_f32 v32, v32, v33
 v_mfma_f32_16x16x32_bf16 v[148:151], a[84:87], v[212:215], v[148:151]
 v_mfma_f32_16x16x32_bf16 v[148:151], a[100:103], v[216:219], v[148:151]
 buffer_load_dwordx4 v234, s[8:11], s41 offen offset:1024  lds
 v_mfma_f32_16x16x32_bf16 v[148:151], a[116:119], v[220:223], v[148:151]
 v_cvt_pk_bf16_f32 v33, v34, v35
 v_mfma_f32_16x16x32_bf16 v[144:147], a[112:115], v[220:223], v[144:147]
 v_mfma_f32_16x16x32_bf16 v[144:147], a[96:99], v[216:219], v[144:147]
 v_mfma_f32_16x16x32_bf16 v[144:147], a[80:83], v[212:215], v[144:147]
 buffer_load_dwordx4 v234, s[8:11], s42 offen offset:2048  lds
 v_mfma_f32_16x16x32_bf16 v[144:147], a[64:67], v[208:211], v[144:147]
 s_waitcnt lgkmcnt(0)
 ds_read_b64_tr_b16 v[208:209], v247 offset:0
 v_cvt_pk_bf16_f32 v34, v48, v49
 v_mfma_f32_16x16x32_bf16 v[160:163], a[64:67], v[192:195], v[160:163]
 ds_read_b64_tr_b16 v[210:211], v247 offset:2048
 v_mfma_f32_16x16x32_bf16 v[160:163], a[80:83], v[196:199], v[160:163]
 ds_read_b64_tr_b16 v[212:213], v247 offset:4096
 v_mfma_f32_16x16x32_bf16 v[160:163], a[96:99], v[200:203], v[160:163]
 buffer_load_dwordx4 v234, s[8:11], s43 offen offset:3072  lds
 v_mfma_f32_16x16x32_bf16 v[160:163], a[112:115], v[204:207], v[160:163]
 ds_read_b64_tr_b16 v[214:215], v247 offset:6144
 v_cvt_pk_bf16_f32 v35, v50, v51
 v_mfma_f32_16x16x32_bf16 v[164:167], a[116:119], v[204:207], v[164:167]
 ds_read_b64_tr_b16 v[216:217], v247 offset:8192
 v_mfma_f32_16x16x32_bf16 v[164:167], a[100:103], v[200:203], v[164:167]
 ds_read_b64_tr_b16 v[218:219], v247 offset:10240
 v_mfma_f32_16x16x32_bf16 v[164:167], a[84:87], v[196:199], v[164:167]
 v_mfma_f32_16x16x32_bf16 v[164:167], a[68:71], v[192:195], v[164:167]
 ds_read_b64_tr_b16 v[220:221], v247 offset:12288
 ds_read_b64_tr_b16 v[222:223], v247 offset:14336
 v_mfma_f32_16x16x32_bf16 v[168:171], a[72:75], v[192:195], v[168:171]
 v_mfma_f32_16x16x32_bf16 v[168:171], a[88:91], v[196:199], v[168:171]
 v_mfma_f32_16x16x32_bf16 v[168:171], a[104:107], v[200:203], v[168:171]
 s_mov_b32 s8, s68
 buffer_store_dwordx4 v[32:35], v255, s[4:7], s44 offen offset:1024 sc1
 v_mfma_f32_16x16x32_bf16 v[168:171], a[120:123], v[204:207], v[168:171]
 s_mov_b32 s9, s69
 v_cvt_pk_bf16_f32 v36, v36, v37
 v_mfma_f32_16x16x32_bf16 v[172:175], a[124:127], v[204:207], v[172:175]
 s_xor_b32 s25, s52, 0
 s_waitcnt vmcnt(18)
 v_mfma_f32_16x16x32_bf16 v[172:175], a[108:111], v[200:203], v[172:175]
 s_add_u32 m0, s55, 0
 s_barrier
 v_cmp_gt_u32 vcc, 1, v235
 s_nop 1
 s_cbranch_vccnz Lspin4
Lback5:
 v_mfma_f32_16x16x32_bf16 v[172:175], a[92:95], v[196:199], v[172:175]
 v_mfma_f32_16x16x32_bf16 v[172:175], a[76:79], v[192:195], v[172:175]
 s_waitcnt lgkmcnt(0)
 ds_read_b64_tr_b16 v[192:193], v244 offset:16384
 v_cvt_pk_bf16_f32 v37, v38, v39
 v_mfma_f32_16x16x32_bf16 v[188:191], a[76:79], v[208:211], v[188:191]
 ds_read_b64_tr_b16 v[194:195], v244 offset:18432
 v_add_u32 v234, s25, v233
 v_mfma_f32_16x16x32_bf16 v[188:191], a[92:95], v[212:215], v[188:191]
 ds_read_b64_tr_b16 v[196:197], v244 offset:20480
 v_mfma_f32_16x16x32_bf16 v[188:191], a[108:111], v[216:219], v[188:191]
 buffer_load_dwordx4 v234, s[8:11], s40 offen  lds
 v_mfma_f32_16x16x32_bf16 v[188:191], a[124:127], v[220:223], v[188:191]
 ds_read_b64_tr_b16 v[198:199], v244 offset:22528
 v_cvt_pk_bf16_f32 v38, v52, v53
 v_mfma_f32_16x16x32_bf16 v[184:187], a[120:123], v[220:223], v[184:187]
 ds_read_b64_tr_b16 v[200:201], v244 offset:24576
 v_mfma_f32_16x16x32_bf16 v[184:187], a[104:107], v[216:219], v[184:187]
 ds_read_b64_tr_b16 v[202:203], v244 offset:26624
 v_mfma_f32_16x16x32_bf16 v[184:187], a[88:91], v[212:215], v[184:187]
 buffer_load_dwordx4 v234, s[8:11], s41 offen offset:1024  lds
 v_mfma_f32_16x16x32_bf16 v[184:187], a[72:75], v[208:211], v[184:187]
 ds_read_b64_tr_b16 v[204:205], v244 offset:28672
 ds_read_b64_tr_b16 v[206:207], v244 offset:30720
 v_mfma_f32_16x16x32_bf16 v[180:183], a[68:71], v[208:211], v[180:183]
 v_cvt_pk_bf16_f32 v39, v54, v55
 v_mfma_f32_16x16x32_bf16 v[180:183], a[84:87], v[212:215], v[180:183]
 v_mfma_f32_16x16x32_bf16 v[180:183], a[100:103], v[216:219], v[180:183]
 buffer_load_dwordx4 v234, s[8:11], s42 offen offset:2048  lds
 v_mfma_f32_16x16x32_bf16 v[180:183], a[116:119], v[220:223], v[180:183]
 v_mfma_f32_16x16x32_bf16 v[176:179], a[112:115], v[220:223], v[176:179]
 v_mfma_f32_16x16x32_bf16 v[176:179], a[96:99], v[216:219], v[176:179]
 v_mfma_f32_16x16x32_bf16 v[176:179], a[80:83], v[212:215], v[176:179]
 buffer_store_dwordx4 v[36:39], v255, s[4:7], s45 offen offset:1024 sc1
 v_mfma_f32_16x16x32_bf16 v[176:179], a[64:67], v[208:211], v[176:179]
 s_waitcnt lgkmcnt(0)
 ds_read_b64_tr_b16 v[208:209], v245 offset:16384
 v_cvt_pk_bf16_f32 v40, v40, v41
 v_mfma_f32_16x16x32_bf16 v[128:131], a[128:131], v[192:195], v[128:131]
 ds_read_b64_tr_b16 v[210:211], v245 offset:18432
 v_mfma_f32_16x16x32_bf16 v[128:131], a[144:147], v[196:199], v[128:131]
 ds_read_b64_tr_b16 v[212:213], v245 offset:20480
 v_mfma_f32_16x16x32_bf16 v[128:131], a[160:163], v[200:203], v[128:131]
 buffer_load_dwordx4 v234, s[8:11], s43 offen offset:3072  lds
 v_mfma_f32_16x16x32_bf16 v[128:131], a[176:179], v[204:207], v[128:131]
 s_add_u32 m0, s54, 65536
 ds_read_b64_tr_b16 v[214:215], v245 offset:22528
 v_cvt_pk_bf16_f32 v41, v42, v43
 v_mfma_f32_16x16x32_bf16 v[132:135], a[180:183], v[204:207], v[132:135]
 ds_read_b64_tr_b16 v[216:217], v245 offset:24576
 v_mfma_f32_16x16x32_bf16 v[132:135], a[164:167], v[200:203], v[132:135]
 ds_read_b64_tr_b16 v[218:219], v245 offset:26624
 v_mfma_f32_16x16x32_bf16 v[132:135], a[148:151], v[196:199], v[132:135]
 buffer_load_dwordx4 v232, s[4:7], s32 offen sc1 lds
 v_mfma_f32_16x16x32_bf16 v[132:135], a[132:135], v[192:195], v[132:135]
 ds_read_b64_tr_b16 v[220:221], v245 offset:28672
 ds_read_b64_tr_b16 v[222:223], v245 offset:30720
 v_mfma_f32_16x16x32_bf16 v[136:139], a[136:139], v[192:195], v[136:139]
 v_cvt_pk_bf16_f32 v42, v56, v57
 v_mfma_f32_16x16x32_bf16 v[136:139], a[152:155], v[196:199], v[136:139]
 v_mfma_f32_16x16x32_bf16 v[136:139], a[168:171], v[200:203], v[136:139]
 buffer_load_dwordx4 v232, s[4:7], s33 offen offset:1024 sc1 lds
 v_mfma_f32_16x16x32_bf16 v[136:139], a[184:187], v[204:207], v[136:139]
 v_cvt_pk_bf16_f32 v43, v58, v59
 v_mfma_f32_16x16x32_bf16 v[140:143], a[188:191], v[204:207], v[140:143]
 v_mfma_f32_16x16x32_bf16 v[140:143], a[172:175], v[200:203], v[140:143]
 v_mfma_f32_16x16x32_bf16 v[140:143], a[156:159], v[196:199], v[140:143]
 buffer_load_dwordx4 v232, s[4:7], s34 offen offset:2048 sc1 lds
 v_mfma_f32_16x16x32_bf16 v[140:143], a[140:143], v[192:195], v[140:143]
 s_waitcnt lgkmcnt(0)
 ds_read_b64_tr_b16 v[192:193], v246 offset:16384
 v_mfma_f32_16x16x32_bf16 v[156:159], a[140:143], v[208:211], v[156:159]
 ds_read_b64_tr_b16 v[194:195], v246 offset:18432
 v_mfma_f32_16x16x32_bf16 v[156:159], a[156:159], v[212:215], v[156:159]
 ds_read_b64_tr_b16 v[196:197], v246 offset:20480
 v_mfma_f32_16x16x32_bf16 v[156:159], a[172:175], v[216:219], v[156:159]
 buffer_store_dwordx4 v[40:43], v255, s[4:7], s46 offen offset:1024 sc1
 v_mfma_f32_16x16x32_bf16 v[156:159], a[188:191], v[220:223], v[156:159]
 ds_read_b64_tr_b16 v[198:199], v246 offset:22528
 v_cvt_pk_bf16_f32 v44, v44, v45
 v_mfma_f32_16x16x32_bf16 v[152:155], a[184:187], v[220:223], v[152:155]
 ds_read_b64_tr_b16 v[200:201], v246 offset:24576
 v_mfma_f32_16x16x32_bf16 v[152:155], a[168:171], v[216:219], v[152:155]
 ds_read_b64_tr_b16 v[202:203], v246 offset:26624
 v_mfma_f32_16x16x32_bf16 v[152:155], a[152:155], v[212:215], v[152:155]
 buffer_load_dwordx4 v232, s[4:7], s35 offen offset:3072 sc1 lds
 v_mfma_f32_16x16x32_bf16 v[152:155], a[136:139], v[208:211], v[152:155]
 s_add_u32 m0, s54, 69632
 ds_read_b64_tr_b16 v[204:205], v246 offset:28672
 ds_read_b64_tr_b16 v[206:207], v246 offset:30720
 v_mfma_f32_16x16x32_bf16 v[148:151], a[132:135], v[208:211], v[148:151]
 v_cvt_pk_bf16_f32 v45, v46, v47
 v_mfma_f32_16x16x32_bf16 v[148:151], a[148:151], v[212:215], v[148:151]
 v_mfma_f32_16x16x32_bf16 v[148:151], a[164:167], v[216:219], v[148:151]
 buffer_load_dwordx4 v232, s[4:7], s36 offen sc1 lds
 v_mfma_f32_16x16x32_bf16 v[148:151], a[180:183], v[220:223], v[148:151]
 v_cvt_pk_bf16_f32 v46, v60, v61
 v_mfma_f32_16x16x32_bf16 v[144:147], a[176:179], v[220:223], v[144:147]
 v_mfma_f32_16x16x32_bf16 v[144:147], a[160:163], v[216:219], v[144:147]
 v_mfma_f32_16x16x32_bf16 v[144:147], a[144:147], v[212:215], v[144:147]
 buffer_load_dwordx4 v232, s[4:7], s37 offen offset:1024 sc1 lds
 v_mfma_f32_16x16x32_bf16 v[144:147], a[128:131], v[208:211], v[144:147]
 s_waitcnt lgkmcnt(0)
 ds_read_b64_tr_b16 v[208:209], v247 offset:16384
 v_cvt_pk_bf16_f32 v47, v62, v63
 v_mfma_f32_16x16x32_bf16 v[160:163], a[128:131], v[192:195], v[160:163]
 ds_read_b64_tr_b16 v[210:211], v247 offset:18432
 v_mfma_f32_16x16x32_bf16 v[160:163], a[144:147], v[196:199], v[160:163]
 ds_read_b64_tr_b16 v[212:213], v247 offset:20480
 v_mfma_f32_16x16x32_bf16 v[160:163], a[160:163], v[200:203], v[160:163]
 buffer_load_dwordx4 v232, s[4:7], s38 offen offset:2048 sc1 lds
 v_mfma_f32_16x16x32_bf16 v[160:163], a[176:179], v[204:207], v[160:163]
 ds_read_b64_tr_b16 v[214:215], v247 offset:22528
 v_mfma_f32_16x16x32_bf16 v[164:167], a[180:183], v[204:207], v[164:167]
 ds_read_b64_tr_b16 v[216:217], v247 offset:24576
 v_mfma_f32_16x16x32_bf16 v[164:167], a[164:167], v[200:203], v[164:167]
 ds_read_b64_tr_b16 v[218:219], v247 offset:26624
 v_mfma_f32_16x16x32_bf16 v[164:167], a[148:151], v[196:199], v[164:167]
 buffer_store_dwordx4 v[44:47], v255, s[4:7], s47 offen offset:1024 sc1
 v_mfma_f32_16x16x32_bf16 v[164:167], a[132:135], v[192:195], v[164:167]
 ds_read_b64_tr_b16 v[220:221], v247 offset:28672
 ds_read_b64_tr_b16 v[222:223], v247 offset:30720
 v_mfma_f32_16x16x32_bf16 v[168:171], a[136:139], v[192:195], v[168:171]
 v_cvt_pk_bf16_f32 v64, v64, v65
 v_mfma_f32_16x16x32_bf16 v[168:171], a[152:155], v[196:199], v[168:171]
 v_mfma_f32_16x16x32_bf16 v[168:171], a[168:171], v[200:203], v[168:171]
 buffer_load_dwordx4 v232, s[4:7], s39 offen offset:3072 sc1 lds
 v_mfma_f32_16x16x32_bf16 v[168:171], a[184:187], v[204:207], v[168:171]
 v_cvt_pk_bf16_f32 v65, v66, v67
 v_xor_b32 v232, 128, v232
 v_mfma_f32_16x16x32_bf16 v[172:175], a[188:191], v[204:207], v[172:175]
 v_mfma_f32_16x16x32_bf16 v[172:175], a[172:175], v[200:203], v[172:175]
 s_barrier
 v_mfma_f32_16x16x32_bf16 v[172:175], a[156:159], v[196:199], v[172:175]
 v_mfma_f32_16x16x32_bf16 v[172:175], a[140:143], v[192:195], v[172:175]
 s_waitcnt lgkmcnt(0)
 ds_read_b64_tr_b16 v[192:193], v244 offset:32768
 v_cvt_pk_bf16_f32 v66, v80, v81
 v_mfma_f32_16x16x32_bf16 v[188:191], a[140:143], v[208:211], v[188:191]
 ds_read_b64_tr_b16 v[194:195], v244 offset:34816
 v_mfma_f32_16x16x32_bf16 v[188:191], a[156:159], v[212:215], v[188:191]
 ds_read_b64_tr_b16 v[196:197], v244 offset:36864
 v_mfma_f32_16x16x32_bf16 v[188:191], a[172:175], v[216:219], v[188:191]
Lw1_3:
 s_cbranch_execz Lw1_back
 v_mfma_f32_16x16x32_bf16 v[188:191], a[188:191], v[220:223], v[188:191]
 ds_read_b64_tr_b16 v[198:199], v244 offset:38912
 v_cvt_pk_bf16_f32 v67, v82, v83
 v_mfma_f32_16x16x32_bf16 v[184:187], a[184:187], v[220:223], v[184:187]
 ds_read_b64_tr_b16 v[200:201], v244 offset:40960
 v_mfma_f32_16x16x32_bf16 v[184:187], a[168:171], v[216:219], v[184:187]
 ds_read_b64_tr_b16 v[202:203], v244 offset:43008
 v_mfma_f32_16x16x32_bf16 v[184:187], a[152:155], v[212:215], v[184:187]
 v_mfma_f32_16x16x32_bf16 v[184:187], a[136:139], v[208:211], v[184:187]
 ds_read_b64_tr_b16 v[204:205], v244 offset:45056
 ds_read_b64_tr_b16 v[206:207], v244 offset:47104
 v_mfma_f32_16x16x32_bf16 v[180:183], a[132:135], v[208:211], v[180:183]
 v_mfma_f32_16x16x32_bf16 v[180:183], a[148:151], v[212:215], v[180:183]
 v_mfma_f32_16x16x32_bf16 v[180:183], a[164:167], v[216:219], v[180:183]
 buffer_store_dwordx4 v[64:67], v255, s[4:7], s44 offen offset:2048 sc1
 v_mfma_f32_16x16x32_bf16 v[180:183], a[180:183], v[220:223], v[180:183]
 v_cvt_pk_bf16_f32 v68, v68, v69
 v_mfma_f32_16x16x32_bf16 v[176:179], a[176:179], v[220:223], v[176:179]
 v_mfma_f32_16x16x32_bf16 v[176:179], a[160:163], v[216:219], v[176:179]
 v_mfma_f32_16x16x32_bf16 v[176:179], a[144:147], v[212:215], v[176:179]
 v_mfma_f32_16x16x32_bf16 v[176:179], a[128:131], v[208:211], v[176:179]
 s_waitcnt lgkmcnt(0)
 ds_read_b64_tr_b16 v[208:209], v245 offset:32768
 v_cvt_pk_bf16_f32 v69, v70, v71
 v_mfma_f32_16x16x32_bf16 v[128:131], a[192:195], v[192:195], v[128:131]
 ds_read_b64_tr_b16 v[210:211], v245 offset:34816
 v_mfma_f32_16x16x32_bf16 v[128:131], a[208:211], v[196:199], v[128:131]
 ds_read_b64_tr_b16 v[212:213], v245 offset:36864
 v_mfma_f32_16x16x32_bf16 v[128:131], a[224:227], v[200:203], v[128:131]
 v_mfma_f32_16x16x32_bf16 v[128:131], a[240:243], v[204:207], v[128:131]
 ds_read_b64_tr_b16 v[214:215], v245 offset:38912
 v_cvt_pk_bf16_f32 v70, v84, v85
 v_mfma_f32_16x16x32_bf16 v[132:135], a[244:247], v[204:207], v[132:135]
 ds_read_b64_tr_b16 v[216:217], v245 offset:40960
 v_mfma_f32_16x16x32_bf16 v[132:135], a[228:231], v[200:203], v[132:135]
 ds_read_b64_tr_b16 v[218:219], v245 offset:43008
 v_mfma_f32_16x16x32_bf16 v[132:135], a[212:215], v[196:199], v[132:135]
 v_mfma_f32_16x16x32_bf16 v[132:135], a[196:199], v[192:195], v[132:135]
 ds_read_b64_tr_b16 v[220:221], v245 offset:45056
 ds_read_b64_tr_b16 v[222:223], v245 offset:47104
 v_mfma_f32_16x16x32_bf16 v[136:139], a[200:203], v[192:195], v[136:139]
 v_cvt_pk_bf16_f32 v71, v86, v87
 v_mfma_f32_16x16x32_bf16 v[136:139], a[216:219], v[196:199], v[136:139]
 v_mfma_f32_16x16x32_bf16 v[136:139], a[232:235], v[200:203], v[136:139]
 v_mfma_f32_16x16x32_bf16 v[136:139], a[248:251], v[204:207], v[136:139]
 v_mfma_f32_16x16x32_bf16 v[140:143], a[252:255], v[204:207], v[140:143]
 v_mfma_f32_16x16x32_bf16 v[140:143], a[236:239], v[200:203], v[140:143]
 v_mfma_f32_16x16x32_bf16 v[140:143], a[220:223], v[196:199], v[140:143]
 buffer_store_dwordx4 v[68:71], v255, s[4:7], s45 offen offset:2048 sc1
 v_mfma_f32_16x16x32_bf16 v[140:143], a[204:207], v[192:195], v[140:143]
 s_waitcnt lgkmcnt(0)
 ds_read_b64_tr_b16 v[192:193], v246 offset:32768
 v_cvt_pk_bf16_f32 v72, v72, v73
 v_mfma_f32_16x16x32_bf16 v[156:159], a[204:207], v[208:211], v[156:159]
 ds_read_b64_tr_b16 v[194:195], v246 offset:34816
 v_mfma_f32_16x16x32_bf16 v[156:159], a[220:223], v[212:215], v[156:159]
 ds_read_b64_tr_b16 v[196:197], v246 offset:36864
 v_mfma_f32_16x16x32_bf16 v[156:159], a[236:239], v[216:219], v[156:159]
 v_mfma_f32_16x16x32_bf16 v[156:159], a[252:255], v[220:223], v[156:159]
 ds_read_b64_tr_b16 v[198:199], v246 offset:38912
 v_cvt_pk_bf16_f32 v73, v74, v75
 v_mfma_f32_16x16x32_bf16 v[152:155], a[248:251], v[220:223], v[152:155]
 ds_read_b64_tr_b16 v[200:201], v246 offset:40960
 v_mfma_f32_16x16x32_bf16 v[152:155], a[232:235], v[216:219], v[152:155]
 ds_read_b64_tr_b16 v[202:203], v246 offset:43008
 v_mfma_f32_16x16x32_bf16 v[152:155], a[216:219], v[212:215], v[152:155]
 v_mfma_f32_16x16x32_bf16 v[152:155], a[200:203], v[208:211], v[152:155]
 ds_read_b64_tr_b16 v[204:205], v246 offset:45056
 ds_read_b64_tr_b16 v[206:207], v246 offset:47104
 v_mfma_f32_16x16x32_bf16 v[148:151], a[196:199], v[208:211], v[148:151]
 v_cvt_pk_bf16_f32 v74, v88, v89
 v_mfma_f32_16x16x32_bf16 v[148:151], a[212:215], v[212:215], v[148:151]
 v_mfma_f32_16x16x32_bf16 v[148:151], a[228:231], v[216:219], v[148:151]
 v_mfma_f32_16x16x32_bf16 v[148:151], a[244:247], v[220:223], v[148:151]
 v_cvt_pk_bf16_f32 v75, v90, v91
 v_mfma_f32_16x16x32_bf16 v[144:147], a[240:243], v[220:223], v[144:147]
 v_mfma_f32_16x16x32_bf16 v[144:147], a[224:227], v[216:219], v[144:147]
 v_mfma_f32_16x16x32_bf16 v[144:147], a[208:211], v[212:215], v[144:147]
 v_mfma_f32_16x16x32_bf16 v[144:147], a[192:195], v[208:211], v[144:147]
 s_waitcnt lgkmcnt(0)
 ds_read_b64_tr_b16 v[208:209], v247 offset:32768
 v_mfma_f32_16x16x32_bf16 v[160:163], a[192:195], v[192:195], v[160:163]
 ds_read_b64_tr_b16 v[210:211], v247 offset:34816
 v_mfma_f32_16x16x32_bf16 v[160:163], a[208:211], v[196:199], v[160:163]
 ds_read_b64_tr_b16 v[212:213], v247 offset:36864
 v_mfma_f32_16x16x32_bf16 v[160:163], a[224:227], v[200:203], v[160:163]
 buffer_store_dwordx4 v[72:75], v255, s[4:7], s46 offen offset:2048 sc1
 v_mfma_f32_16x16x32_bf16 v[160:163], a[240:243], v[204:207], v[160:163]
 ds_read_b64_tr_b16 v[214:215], v247 offset:38912
 v_cvt_pk_bf16_f32 v76, v76, v77
 v_mfma_f32_16x16x32_bf16 v[164:167], a[244:247], v[204:207], v[164:167]
 ds_read_b64_tr_b16 v[216:217], v247 offset:40960
 v_mfma_f32_16x16x32_bf16 v[164:167], a[228:231], v[200:203], v[164:167]
 ds_read_b64_tr_b16 v[218:219], v247 offset:43008
 v_mfma_f32_16x16x32_bf16 v[164:167], a[212:215], v[196:199], v[164:167]
 v_mfma_f32_16x16x32_bf16 v[164:167], a[196:199], v[192:195], v[164:167]
 ds_read_b64_tr_b16 v[220:221], v247 offset:45056
 ds_read_b64_tr_b16 v[222:223], v247 offset:47104
 v_mfma_f32_16x16x32_bf16 v[168:171], a[200:203], v[192:195], v[168:171]
 v_cvt_pk_bf16_f32 v77, v78, v79
 v_mfma_f32_16x16x32_bf16 v[168:171], a[216:219], v[196:199], v[168:171]
 v_mfma_f32_16x16x32_bf16 v[168:171], a[232:235], v[200:203], v[168:171]
 v_mfma_f32_16x16x32_bf16 v[168:171], a[248:251], v[204:207], v[168:171]
 v_cvt_pk_bf16_f32 v78, v92, v93
 v_mfma_f32_16x16x32_bf16 v[172:175], a[252:255], v[204:207], v[172:175]
 s_add_u32 m0, s54, 0
 s_waitcnt vmcnt(35)
 v_mfma_f32_16x16x32_bf16 v[172:175], a[236:239], v[200:203], v[172:175]
 s_barrier
 v_mfma_f32_16x16x32_bf16 v[172:175], a[220:223], v[196:199], v[172:175]
 v_mfma_f32_16x16x32_bf16 v[172:175], a[204:207], v[192:195], v[172:175]
 s_waitcnt lgkmcnt(0)
 ds_read_b64_tr_b16 v[192:193], v244 offset:49152
 v_cvt_pk_bf16_f32 v79, v94, v95
 v_mfma_f32_16x16x32_bf16 v[188:191], a[204:207], v[208:211], v[188:191]
 ds_read_b64_tr_b16 v[194:195], v244 offset:51200
 v_mfma_f32_16x16x32_bf16 v[188:191], a[220:223], v[212:215], v[188:191]
 ds_read_b64_tr_b16 v[196:197], v244 offset:53248
 v_mfma_f32_16x16x32_bf16 v[188:191], a[236:239], v[216:219], v[188:191]
 buffer_load_dwordx4 v232, s[4:7], s32 offen sc1 lds
 v_mfma_f32_16x16x32_bf16 v[188:191], a[252:255], v[220:223], v[188:191]
 ds_read_b64_tr_b16 v[198:199], v244 offset:55296
 v_mfma_f32_16x16x32_bf16 v[184:187], a[248:251], v[220:223], v[184:187]
 ds_read_b64_tr_b16 v[200:201], v244 offset:57344
 v_mfma_f32_16x16x32_bf16 v[184:187], a[232:235], v[216:219], v[184:187]
 ds_read_b64_tr_b16 v[202:203], v244 offset:59392
 v_mfma_f32_16x16x32_bf16 v[184:187], a[216:219], v[212:215], v[184:187]
 buffer_store_dwordx4 v[76:79], v255, s[4:7], s47 offen offset:2048 sc1
 v_mfma_f32_16x16x32_bf16 v[184:187], a[200:203], v[208:211], v[184:187]
 ds_read_b64_tr_b16 v[204:205], v244 offset:61440
 ds_read_b64_tr_b16 v[206:207], v244 offset:63488
 v_mfma_f32_16x16x32_bf16 v[180:183], a[196:199], v[208:211], v[180:183]
 v_mfma_f32_16x16x32_bf16 v[180:183], a[212:215], v[212:215], v[180:183]
 v_mfma_f32_16x16x32_bf16 v[180:183], a[228:231], v[216:219], v[180:183]
 buffer_load_dwordx4 v232, s[4:7], s33 offen offset:1024 sc1 lds
 v_mfma_f32_16x16x32_bf16 v[180:183], a[244:247], v[220:223], v[180:183]
 v_mfma_f32_16x16x32_bf16 v[176:179], a[240:243], v[220:223], v[176:179]
 v_mfma_f32_16x16x32_bf16 v[176:179], a[224:227], v[216:219], v[176:179]
 v_mfma_f32_16x16x32_bf16 v[176:179], a[208:211], v[212:215], v[176:179]
 buffer_load_dwordx4 v232, s[4:7], s34 offen offset:2048 sc1 lds
 v_mfma_f32_16x16x32_bf16 v[176:179], a[192:195], v[208:211], v[176:179]
 s_waitcnt lgkmcnt(0)
 ds_read_b64_tr_b16 v[208:209], v245 offset:49152
 v_mfma_f32_16x16x32_bf16 v[0:3], a[0:3], v[192:195], 0
 ds_read_b64_tr_b16 v[210:211], v245 offset:51200
 v_mfma_f32_16x16x32_bf16 v[0:3], a[16:19], v[196:199], v[0:3]
 ds_read_b64_tr_b16 v[212:213], v245 offset:53248
 v_mfma_f32_16x16x32_bf16 v[0:3], a[32:35], v[200:203], v[0:3]
 buffer_load_dwordx4 v232, s[4:7], s35 offen offset:3072 sc1 lds
 v_mfma_f32_16x16x32_bf16 v[0:3], a[48:51], v[204:207], v[0:3]
 s_add_u32 m0, s54, 4096
 ds_read_b64_tr_b16 v[214:215], v245 offset:55296
 v_mfma_f32_16x16x32_bf16 v[4:7], a[52:55], v[204:207], 0
 ds_read_b64_tr_b16 v[216:217], v245 offset:57344
 v_mfma_f32_16x16x32_bf16 v[4:7], a[36:39], v[200:203], v[4:7]
 ds_read_b64_tr_b16 v[218:219], v245 offset:59392
 v_mfma_f32_16x16x32_bf16 v[4:7], a[20:23], v[196:199], v[4:7]
 buffer_load_dwordx4 v232, s[4:7], s36 offen sc1 lds
 v_mfma_f32_16x16x32_bf16 v[4:7], a[4:7], v[192:195], v[4:7]
 ds_read_b64_tr_b16 v[220:221], v245 offset:61440
 ds_read_b64_tr_b16 v[222:223], v245 offset:63488
 v_mfma_f32_16x16x32_bf16 v[8:11], a[8:11], v[192:195], 0
 v_cvt_pk_bf16_f32 v96, v96, v97
 v_mfma_f32_16x16x32_bf16 v[8:11], a[24:27], v[196:199], v[8:11]
 v_mfma_f32_16x16x32_bf16 v[8:11], a[40:43], v[200:203], v[8:11]
 buffer_load_dwordx4 v232, s[4:7], s37 offen offset:1024 sc1 lds
 v_mfma_f32_16x16x32_bf16 v[8:11], a[56:59], v[204:207], v[8:11]
 v_cvt_pk_bf16_f32 v97, v98, v99
 v_mfma_f32_16x16x32_bf16 v[12:15], a[60:63], v[204:207], 0
 v_mfma_f32_16x16x32_bf16 v[12:15], a[44:47], v[200:203], v[12:15]
 v_mfma_f32_16x16x32_bf16 v[12:15], a[28:31], v[196:199], v[12:15]
 buffer_load_dwordx4 v232, s[4:7], s38 offen offset:2048 sc1 lds
 v_mfma_f32_16x16x32_bf16 v[12:15], a[12:15], v[192:195], v[12:15]
 s_waitcnt lgkmcnt(0)
 ds_read_b64_tr_b16 v[192:193], v246 offset:49152
 v_cvt_pk_bf16_f32 v98, v112, v113
 v_mfma_f32_16x16x32_bf16 v[28:31], a[12:15], v[208:211], 0
 ds_read_b64_tr_b16 v[194:195], v246 offset:51200
 v_mfma_f32_16x16x32_bf16 v[28:31], a[28:31], v[212:215], v[28:31]
 ds_read_b64_tr_b16 v[196:197], v246 offset:53248
 v_mfma_f32_16x16x32_bf16 v[28:31], a[44:47], v[216:219], v[28:31]
 buffer_load_dwordx4 v232, s[4:7], s39 offen offset:3072 sc1 lds
 v_mfma_f32_16x16x32_bf16 v[28:31], a[60:63], v[220:223], v[28:31]
 ds_read_b64_tr_b16 v[198:199], v246 offset:55296
 v_cvt_pk_bf16_f32 v99, v114, v115
 v_mfma_f32_16x16x32_bf16 v[24:27], a[56:59], v[220:223], 0
 ds_read_b64_tr_b16 v[200:201], v246 offset:57344
 v_xor_b32 v232, 384, v232
 v_mfma_f32_16x16x32_bf16 v[24:27], a[40:43], v[216:219], v[24:27]
 ds_read_b64_tr_b16 v[202:203], v246 offset:59392
 v_mfma_f32_16x16x32_bf16 v[24:27], a[24:27], v[212:215], v[24:27]
 v_mfma_f32_16x16x32_bf16 v[24:27], a[8:11], v[208:211], v[24:27]
 ds_read_b64_tr_b16 v[204:205], v246 offset:61440
 ds_read_b64_tr_b16 v[206:207], v246 offset:63488
 v_mfma_f32_16x16x32_bf16 v[20:23], a[4:7], v[208:211], 0
 v_mfma_f32_16x16x32_bf16 v[20:23], a[20:23], v[212:215], v[20:23]
 v_mfma_f32_16x16x32_bf16 v[20:23], a[36:39], v[216:219], v[20:23]
 buffer_store_dwordx4 v[96:99], v255, s[4:7], s44 offen offset:3072 sc1
 v_mfma_f32_16x16x32_bf16 v[20:23], a[52:55], v[220:223], v[20:23]
 v_cvt_pk_bf16_f32 v100, v100, v101
 v_mfma_f32_16x16x32_bf16 v[16:19], a[48:51], v[220:223], 0
 v_mfma_f32_16x16x32_bf16 v[16:19], a[32:35], v[216:219], v[16:19]
 v_mfma_f32_16x16x32_bf16 v[16:19], a[16:19], v[212:215], v[16:19]
 v_mfma_f32_16x16x32_bf16 v[16:19], a[0:3], v[208:211], v[16:19]
 s_waitcnt lgkmcnt(0)
 ds_read_b64_tr_b16 v[208:209], v247 offset:49152
 v_cvt_pk_bf16_f32 v101, v102, v103
 v_mfma_f32_16x16x32_bf16 v[32:35], a[0:3], v[192:195], 0
 ds_read_b64_tr_b16 v[210:211], v247 offset:51200
 v_mfma_f32_16x16x32_bf16 v[32:35], a[16:19], v[196:199], v[32:35]
 ds_read_b64_tr_b16 v[212:213], v247 offset:53248
 v_mfma_f32_16x16x32_bf16 v[32:35], a[32:35], v[200:203], v[32:35]
 v_mfma_f32_16x16x32_bf16 v[32:35], a[48:51], v[204:207], v[32:35]
 ds_read_b64_tr_b16 v[214:215], v247 offset:55296
 v_cvt_pk_bf16_f32 v102, v116, v117
 v_mfma_f32_16x16x32_bf16 v[36:39], a[52:55], v[204:207], 0
 ds_read_b64_tr_b16 v[216:217], v247 offset:57344
 v_mfma_f32_16x16x32_bf16 v[36:39], a[36:39], v[200:203], v[36:39]
 ds_read_b64_tr_b16 v[218:219], v247 offset:59392
 v_mfma_f32_16x16x32_bf16 v[36:39], a[20:23], v[196:199], v[36:39]
 v_mfma_f32_16x16x32_bf16 v[36:39], a[4:7], v[192:195], v[36:39]
 ds_read_b64_tr_b16 v[220:221], v247 offset:61440
 ds_read_b64_tr_b16 v[222:223], v247 offset:63488
 v_mfma_f32_16x16x32_bf16 v[40:43], a[8:11], v[192:195], 0
 v_cvt_pk_bf16_f32 v103, v118, v119
 v_mfma_f32_16x16x32_bf16 v[40:43], a[24:27], v[196:199], v[40:43]
 v_mfma_f32_16x16x32_bf16 v[40:43], a[40:43], v[200:203], v[40:43]
 v_mfma_f32_16x16x32_bf16 v[40:43], a[56:59], v[204:207], v[40:43]
 v_mfma_f32_16x16x32_bf16 v[44:47], a[60:63], v[204:207], 0
 s_waitcnt vmcnt(40)
 v_mfma_f32_16x16x32_bf16 v[44:47], a[44:47], v[200:203], v[44:47]
 s_barrier
 v_mfma_f32_16x16x32_bf16 v[44:47], a[28:31], v[196:199], v[44:47]
 buffer_store_dwordx4 v[100:103], v255, s[4:7], s45 offen offset:3072 sc1
 v_mfma_f32_16x16x32_bf16 v[44:47], a[12:15], v[192:195], v[44:47]
 s_waitcnt lgkmcnt(0)
 ds_read_b64_tr_b16 v[192:193], v224 offset:16384
 v_cvt_pk_bf16_f32 v104, v104, v105
 v_mfma_f32_16x16x32_bf16 v[60:63], a[12:15], v[208:211], 0
 ds_read_b64_tr_b16 v[194:195], v224 offset:18432
 v_mfma_f32_16x16x32_bf16 v[60:63], a[28:31], v[212:215], v[60:63]
 ds_read_b64_tr_b16 v[196:197], v224 offset:20480
 v_mfma_f32_16x16x32_bf16 v[60:63], a[44:47], v[216:219], v[60:63]
 v_mfma_f32_16x16x32_bf16 v[60:63], a[60:63], v[220:223], v[60:63]
 ds_read_b64_tr_b16 v[198:199], v224 offset:22528
 v_cvt_pk_bf16_f32 v105, v106, v107
 v_mfma_f32_16x16x32_bf16 v[56:59], a[56:59], v[220:223], 0
 ds_read_b64_tr_b16 v[200:201], v224 offset:24576
 v_mfma_f32_16x16x32_bf16 v[56:59], a[40:43], v[216:219], v[56:59]
 ds_read_b64_tr_b16 v[202:203], v224 offset:26624
 v_mfma_f32_16x16x32_bf16 v[56:59], a[24:27], v[212:215], v[56:59]
 v_mfma_f32_16x16x32_bf16 v[56:59], a[8:11], v[208:211], v[56:59]
 ds_read_b64_tr_b16 v[204:205], v224 offset:28672
 ds_read_b64_tr_b16 v[206:207], v224 offset:30720
 v_mfma_f32_16x16x32_bf16 v[52:55], a[4:7], v[208:211], 0
 v_cvt_pk_bf16_f32 v106, v120, v121
 v_mfma_f32_16x16x32_bf16 v[52:55], a[20:23], v[212:215], v[52:55]
 v_mfma_f32_16x16x32_bf16 v[52:55], a[36:39], v[216:219], v[52:55]
 v_mfma_f32_16x16x32_bf16 v[52:55], a[52:55], v[220:223], v[52:55]
 v_cvt_pk_bf16_f32 v107, v122, v123
 v_mfma_f32_16x16x32_bf16 v[48:51], a[48:51], v[220:223], 0
 v_mfma_f32_16x16x32_bf16 v[48:51], a[32:35], v[216:219], v[48:51]
 v_mfma_f32_16x16x32_bf16 v[48:51], a[16:19], v[212:215], v[48:51]
 v_mfma_f32_16x16x32_bf16 v[48:51], a[0:3], v[208:211], v[48:51]
 s_waitcnt lgkmcnt(0)
 ds_read_b64_tr_b16 v[208:209], v225 offset:16384
 v_mfma_f32_16x16x32_bf16 v[0:3], a[64:67], v[192:195], v[0:3]
 ds_read_b64_tr_b16 v[210:211], v225 offset:18432
 v_mfma_f32_16x16x32_bf16 v[0:3], a[80:83], v[196:199], v[0:3]
 ds_read_b64_tr_b16 v[212:213], v225 offset:20480
 v_mfma_f32_16x16x32_bf16 v[0:3], a[96:99], v[200:203], v[0:3]
 buffer_store_dwordx4 v[104:107], v255, s[4:7], s46 offen offset:3072 sc1
 v_mfma_f32_16x16x32_bf16 v[0:3], a[112:115], v[204:207], v[0:3]
 ds_read_b64_tr_b16 v[214:215], v225 offset:22528
 v_cvt_pk_bf16_f32 v108, v108, v109
 v_mfma_f32_16x16x32_bf16 v[4:7], a[116:119], v[204:207], v[4:7]
 ds_read_b64_tr_b16 v[216:217], v225 offset:24576
 v_mfma_f32_16x16x32_bf16 v[4:7], a[100:103], v[200:203], v[4:7]
 ds_read_b64_tr_b16 v[218:219], v225 offset:26624
 v_mfma_f32_16x16x32_bf16 v[4:7], a[84:87], v[196:199], v[4:7]
 v_mfma_f32_16x16x32_bf16 v[4:7], a[68:71], v[192:195], v[4:7]
 s_waitcnt vmcnt(15)
 ds_read_b128 a[0:3], v230 offset:0
 ds_read_b64_tr_b16 v[220:221], v225 offset:28672
 v_mfma_f32_16x16x32_bf16 v[8:11], a[72:75], v[192:195], v[8:11]
 ds_read_b64_tr_b16 v[222:223], v225 offset:30720
 v_cvt_pk_bf16_f32 v109, v110, v111
 v_mfma_f32_16x16x32_bf16 v[8:11], a[88:91], v[196:199], v[8:11]
 ds_read_b128 a[16:19], v231 offset:0
 v_mfma_f32_16x16x32_bf16 v[8:11], a[104:107], v[200:203], v[8:11]
 v_mfma_f32_16x16x32_bf16 v[8:11], a[120:123], v[204:207], v[8:11]
 ds_read_b128 a[4:7], v230 offset:2048
 v_cvt_pk_bf16_f32 v110, v124, v125
 v_mfma_f32_16x16x32_bf16 v[12:15], a[124:127], v[204:207], v[12:15]
 v_mfma_f32_16x16x32_bf16 v[12:15], a[108:111], v[200:203], v[12:15]
 ds_read_b128 a[20:23], v231 offset:2048
 v_mfma_f32_16x16x32_bf16 v[12:15], a[92:95], v[196:199], v[12:15]
 v_mfma_f32_16x16x32_bf16 v[12:15], a[76:79], v[192:195], v[12:15]
 s_waitcnt lgkmcnt(6)
 ds_read_b128 a[8:11], v230 offset:4096
 ds_read_b64_tr_b16 v[192:193], v226 offset:16384
 v_mfma_f32_16x16x32_bf16 v[28:31], a[76:79], v[208:211], v[28:31]
 ds_read_b64_tr_b16 v[194:195], v226 offset:18432
 v_cvt_pk_bf16_f32 v111, v126, v127
 v_mfma_f32_16x16x32_bf16 v[28:31], a[92:95], v[212:215], v[28:31]
 ds_read_b128 a[24:27], v231 offset:4096
 ds_read_b64_tr_b16 v[196:197], v226 offset:20480
 v_mfma_f32_16x16x32_bf16 v[28:31], a[108:111], v[216:219], v[28:31]
 s_waitcnt lgkmcnt(8)
 v_mfma_f32_16x16x32_bf16 v[28:31], a[124:127], v[220:223], v[28:31]
 ds_read_b128 a[12:15], v230 offset:6144
 ds_read_b64_tr_b16 v[198:199], v226 offset:22528
 v_mfma_f32_16x16x32_bf16 v[24:27], a[120:123], v[220:223], v[24:27]
 ds_read_b64_tr_b16 v[200:201], v226 offset:24576
 v_mfma_f32_16x16x32_bf16 v[24:27], a[104:107], v[216:219], v[24:27]
 ds_read_b128 a[28:31], v231 offset:6144
 ds_read_b64_tr_b16 v[202:203], v226 offset:26624
 v_mfma_f32_16x16x32_bf16 v[24:27], a[88:91], v[212:215], v[24:27]
 buffer_store_dwordx4 v[108:111], v255, s[4:7], s47 offen offset:3072 sc1
 v_mfma_f32_16x16x32_bf16 v[24:27], a[72:75], v[208:211], v[24:27]
 ds_read_b64_tr_b16 v[204:205], v226 offset:28672
 ds_read_b64_tr_b16 v[206:207], v226 offset:30720
 v_mfma_f32_16x16x32_bf16 v[20:23], a[68:71], v[208:211], v[20:23]
 v_cvt_pk_bf16_f32 v128, v128, v129
 v_mfma_f32_16x16x32_bf16 v[20:23], a[84:87], v[212:215], v[20:23]
 v_mfma_f32_16x16x32_bf16 v[20:23], a[100:103], v[216:219], v[20:23]
 v_mfma_f32_16x16x32_bf16 v[20:23], a[116:119], v[220:223], v[20:23]
 v_cvt_pk_bf16_f32 v129, v130, v131
 v_mfma_f32_16x16x32_bf16 v[16:19], a[112:115], v[220:223], v[16:19]
 v_mfma_f32_16x16x32_bf16 v[16:19], a[96:99], v[216:219], v[16:19]
 v_mfma_f32_16x16x32_bf16 v[16:19], a[80:83], v[212:215], v[16:19]
 v_mfma_f32_16x16x32_bf16 v[16:19], a[64:67], v[208:211], v[16:19]
 s_waitcnt lgkmcnt(9)
 ds_read_b64_tr_b16 v[208:209], v227 offset:16384
 v_cvt_pk_bf16_f32 v130, v132, v133
 v_mfma_f32_16x16x32_bf16 v[32:35], a[64:67], v[192:195], v[32:35]
 s_waitcnt lgkmcnt(5)
 ds_read_b64_tr_b16 v[210:211], v227 offset:18432
 v_mfma_f32_16x16x32_bf16 v[32:35], a[80:83], v[196:199], v[32:35]
 s_waitcnt lgkmcnt(2)
 ds_read_b64_tr_b16 v[212:213], v227 offset:20480
 v_mfma_f32_16x16x32_bf16 v[32:35], a[96:99], v[200:203], v[32:35]
 v_mfma_f32_16x16x32_bf16 v[32:35], a[112:115], v[204:207], v[32:35]
 ds_read_b64_tr_b16 v[214:215], v227 offset:22528
 v_cvt_pk_bf16_f32 v131, v134, v135
 v_mfma_f32_16x16x32_bf16 v[36:39], a[116:119], v[204:207], v[36:39]
 ds_read_b64_tr_b16 v[216:217], v227 offset:24576
 v_mfma_f32_16x16x32_bf16 v[36:39], a[100:103], v[200:203], v[36:39]
 ds_read_b64_tr_b16 v[218:219], v227 offset:26624
 v_mfma_f32_16x16x32_bf16 v[36:39], a[84:87], v[196:199], v[36:39]
 v_mfma_f32_16x16x32_bf16 v[36:39], a[68:71], v[192:195], v[36:39]
 ds_read_b64_tr_b16 v[220:221], v227 offset:28672
 ds_read_b64_tr_b16 v[222:223], v227 offset:30720
 v_mfma_f32_16x16x32_bf16 v[40:43], a[72:75], v[192:195], v[40:43]
 v_mfma_f32_16x16x32_bf16 v[40:43], a[88:91], v[196:199], v[40:43]
 v_mfma_f32_16x16x32_bf16 v[40:43], a[104:107], v[200:203], v[40:43]
 buffer_store_dwordx4 v[128:131], v255, s[4:7], s48 offen sc1
 v_mfma_f32_16x16x32_bf16 v[40:43], a[120:123], v[204:207], v[40:43]
 v_cvt_pk_bf16_f32 v136, v136, v137
 v_mfma_f32_16x16x32_bf16 v[44:47], a[124:127], v[204:207], v[44:47]
 s_add_u32 m0, s54, 32768
 v_mfma_f32_16x16x32_bf16 v[44:47], a[108:111], v[200:203], v[44:47]
 s_barrier
 v_mfma_f32_16x16x32_bf16 v[44:47], a[92:95], v[196:199], v[44:47]
 v_mfma_f32_16x16x32_bf16 v[44:47], a[76:79], v[192:195], v[44:47]
 s_waitcnt lgkmcnt(0)
 ds_read_b64_tr_b16 v[192:193], v224 offset:32768
 v_cvt_pk_bf16_f32 v137, v138, v139
 v_mfma_f32_16x16x32_bf16 v[60:63], a[76:79], v[208:211], v[60:63]
 ds_read_b64_tr_b16 v[194:195], v224 offset:34816
 v_mfma_f32_16x16x32_bf16 v[60:63], a[92:95], v[212:215], v[60:63]
 ds_read_b64_tr_b16 v[196:197], v224 offset:36864
 v_mfma_f32_16x16x32_bf16 v[60:63], a[108:111], v[216:219], v[60:63]
 buffer_load_dwordx4 v232, s[4:7], s32 offen sc1 lds
 v_mfma_f32_16x16x32_bf16 v[60:63], a[124:127], v[220:223], v[60:63]
 ds_read_b64_tr_b16 v[198:199], v224 offset:38912
 v_cvt_pk_bf16_f32 v138, v140, v141
 v_mfma_f32_16x16x32_bf16 v[56:59], a[120:123], v[220:223], v[56:59]
 ds_read_b64_tr_b16 v[200:201], v224 offset:40960
 v_mfma_f32_16x16x32_bf16 v[56:59], a[104:107], v[216:219], v[56:59]
 ds_read_b64_tr_b16 v[202:203], v224 offset:43008
 v_mfma_f32_16x16x32_bf16 v[56:59], a[88:91], v[212:215], v[56:59]
 buffer_load_dwordx4 v232, s[4:7], s33 offen offset:1024 sc1 lds
 v_mfma_f32_16x16x32_bf16 v[56:59], a[72:75], v[208:211], v[56:59]
 ds_read_b64_tr_b16 v[204:205], v224 offset:45056
 ds_read_b64_tr_b16 v[206:207], v224 offset:47104
 v_mfma_f32_16x16x32_bf16 v[52:55], a[68:71], v[208:211], v[52:55]
 v_cvt_pk_bf16_f32 v139, v142, v143
 v_mfma_f32_16x16x32_bf16 v[52:55], a[84:87], v[212:215], v[52:55]
 v_mfma_f32_16x16x32_bf16 v[52:55], a[100:103], v[216:219], v[52:55]
 buffer_load_dwordx4 v232, s[4:7], s34 offen offset:2048 sc1 lds
 v_mfma_f32_16x16x32_bf16 v[52:55], a[116:119], v[220:223], v[52:55]
 v_mfma_f32_16x16x32_bf16 v[48:51], a[112:115], v[220:223], v[48:51]
 v_mfma_f32_16x16x32_bf16 v[48:51], a[96:99], v[216:219], v[48:51]
 v_mfma_f32_16x16x32_bf16 v[48:51], a[80:83], v[212:215], v[48:51]
 buffer_store_dwordx4 v[136:139], v255, s[4:7], s48 offen offset:1024 sc1
 v_mfma_f32_16x16x32_bf16 v[48:51], a[64:67], v[208:211], v[48:51]
 s_waitcnt lgkmcnt(0)
 ds_read_b64_tr_b16 v[208:209], v225 offset:32768
 v_cvt_pk_bf16_f32 v144, v144, v145
 v_mfma_f32_16x16x32_bf16 v[0:3], a[128:131], v[192:195], v[0:3]
 ds_read_b64_tr_b16 v[210:211], v225 offset:34816
 v_mfma_f32_16x16x32_bf16 v[0:3], a[144:147], v[196:199], v[0:3]
 s_waitcnt vmcnt(9)
 ds_read_b128 a[32:35], v228 offset:0
 ds_read_b64_tr_b16 v[212:213], v225 offset:36864
 v_mfma_f32_16x16x32_bf16 v[0:3], a[160:163], v[200:203], v[0:3]
 buffer_load_dwordx4 v232, s[4:7], s35 offen offset:3072 sc1 lds
 v_mfma_f32_16x16x32_bf16 v[0:3], a[176:179], v[204:207], v[0:3]
 s_add_u32 m0, s54, 36864
 ds_read_b128 a[48:51], v229 offset:0
 ds_read_b64_tr_b16 v[214:215], v225 offset:38912
 v_mfma_f32_16x16x32_bf16 v[4:7], a[180:183], v[204:207], v[4:7]
 ds_read_b64_tr_b16 v[216:217], v225 offset:40960
 v_cvt_pk_bf16_f32 v145, v146, v147
 v_mfma_f32_16x16x32_bf16 v[4:7], a[164:167], v[200:203], v[4:7]
 ds_read_b128 a[36:39], v228 offset:2048
 ds_read_b64_tr_b16 v[218:219], v225 offset:43008
 v_mfma_f32_16x16x32_bf16 v[4:7], a[148:151], v[196:199], v[4:7]
 buffer_load_dwordx4 v232, s[4:7], s36 offen sc1 lds
 v_mfma_f32_16x16x32_bf16 v[4:7], a[132:135], v[192:195], v[4:7]
 ds_read_b128 a[52:55], v229 offset:2048
 ds_read_b64_tr_b16 v[220:221], v225 offset:45056
 v_mfma_f32_16x16x32_bf16 v[8:11], a[136:139], v[192:195], v[8:11]
 ds_read_b64_tr_b16 v[222:223], v225 offset:47104
 v_cvt_pk_bf16_f32 v146, v148, v149
 v_mfma_f32_16x16x32_bf16 v[8:11], a[152:155], v[196:199], v[8:11]
 ds_read_b128 a[40:43], v228 offset:4096
 v_mfma_f32_16x16x32_bf16 v[8:11], a[168:171], v[200:203], v[8:11]
 buffer_load_dwordx4 v232, s[4:7], s37 offen offset:1024 sc1 lds
 v_mfma_f32_16x16x32_bf16 v[8:11], a[184:187], v[204:207], v[8:11]
 ds_read_b128 a[56:59], v229 offset:4096
 v_cvt_pk_bf16_f32 v147, v150, v151
 v_mfma_f32_16x16x32_bf16 v[12:15], a[188:191], v[204:207], v[12:15]
 v_mfma_f32_16x16x32_bf16 v[12:15], a[172:175], v[200:203], v[12:15]
 ds_read_b128 a[44:47], v228 offset:6144
 v_mfma_f32_16x16x32_bf16 v[12:15], a[156:159], v[196:199], v[12:15]
 buffer_load_dwordx4 v232, s[4:7], s38 offen offset:2048 sc1 lds
 v_mfma_f32_16x16x32_bf16 v[12:15], a[140:143], v[192:195], v[12:15]
 s_waitcnt lgkmcnt(13)
 ds_read_b128 a[60:63], v229 offset:6144
 ds_read_b64_tr_b16 v[192:193], v226 offset:32768
 v_mfma_f32_16x16x32_bf16 v[28:31], a[140:143], v[208:211], v[28:31]
 s_waitcnt lgkmcnt(10)
 ds_read_b64_tr_b16 v[194:195], v226 offset:34816
 v_mfma_f32_16x16x32_bf16 v[28:31], a[156:159], v[212:215], v[28:31]
 s_waitcnt lgkmcnt(9)
 ds_read_b64_tr_b16 v[196:197], v226 offset:36864
 v_mfma_f32_16x16x32_bf16 v[28:31], a[172:175], v[216:219], v[28:31]
 s_waitcnt lgkmcnt(7)
 buffer_store_dwordx4 v[144:147], v255, s[4:7], s48 offen offset:2048 sc1
 v_mfma_f32_16x16x32_bf16 v[28:31], a[188:191], v[220:223], v[28:31]
 ds_read_b64_tr_b16 v[198:199], v226 offset:38912
 v_cvt_pk_bf16_f32 v152, v152, v153
 v_mfma_f32_16x16x32_bf16 v[24:27], a[184:187], v[220:223], v[24:27]
 ds_read_b64_tr_b16 v[200:201], v226 offset:40960
 v_mfma_f32_16x16x32_bf16 v[24:27], a[168:171], v[216:219], v[24:27]
 ds_read_b64_tr_b16 v[202:203], v226 offset:43008
 v_mfma_f32_16x16x32_bf16 v[24:27], a[152:155], v[212:215], v[24:27]
 buffer_load_dwordx4 v232, s[4:7], s39 offen offset:3072 sc1 lds
 v_mfma_f32_16x16x32_bf16 v[24:27], a[136:139], v[208:211], v[24:27]
 ds_read_b64_tr_b16 v[204:205], v226 offset:45056
 ds_read_b64_tr_b16 v[206:207], v226 offset:47104
 v_mfma_f32_16x16x32_bf16 v[20:23], a[132:135], v[208:211], v[20:23]
 v_cvt_pk_bf16_f32 v153, v154, v155
 v_xor_b32 v232, 128, v232
 v_mfma_f32_16x16x32_bf16 v[20:23], a[148:151], v[212:215], v[20:23]
 v_mfma_f32_16x16x32_bf16 v[20:23], a[164:167], v[216:219], v[20:23]
 v_mfma_f32_16x16x32_bf16 v[20:23], a[180:183], v[220:223], v[20:23]
 v_cvt_pk_bf16_f32 v154, v156, v157
 v_mfma_f32_16x16x32_bf16 v[16:19], a[176:179], v[220:223], v[16:19]
 v_mfma_f32_16x16x32_bf16 v[16:19], a[160:163], v[216:219], v[16:19]
 v_mfma_f32_16x16x32_bf16 v[16:19], a[144:147], v[212:215], v[16:19]
 v_mfma_f32_16x16x32_bf16 v[16:19], a[128:131], v[208:211], v[16:19]
 s_waitcnt lgkmcnt(0)
 ds_read_b64_tr_b16 v[208:209], v227 offset:32768
 v_cvt_pk_bf16_f32 v155, v158, v159
 v_mfma_f32_16x16x32_bf16 v[32:35], a[128:131], v[192:195], v[32:35]
 ds_read_b64_tr_b16 v[210:211], v227 offset:34816
 v_mfma_f32_16x16x32_bf16 v[32:35], a[144:147], v[196:199], v[32:35]
 ds_read_b64_tr_b16 v[212:213], v227 offset:36864
 v_mfma_f32_16x16x32_bf16 v[32:35], a[160:163], v[200:203], v[32:35]
 v_mfma_f32_16x16x32_bf16 v[32:35], a[176:179], v[204:207], v[32:35]
 ds_read_b64_tr_b16 v[214:215], v227 offset:38912
 v_mfma_f32_16x16x32_bf16 v[36:39], a[180:183], v[204:207], v[36:39]
 ds_read_b64_tr_b16 v[216:217], v227 offset:40960
 v_mfma_f32_16x16x32_bf16 v[36:39], a[164:167], v[200:203], v[36:39]
 ds_read_b64_tr_b16 v[218:219], v227 offset:43008
 v_mfma_f32_16x16x32_bf16 v[36:39], a[148:151], v[196:199], v[36:39]
 buffer_store_dwordx4 v[152:155], v255, s[4:7], s48 offen offset:3072 sc1
 v_mfma_f32_16x16x32_bf16 v[36:39], a[132:135], v[192:195], v[36:39]
 ds_read_b64_tr_b16 v[220:221], v227 offset:45056
 ds_read_b64_tr_b16 v[222:223], v227 offset:47104
 v_mfma_f32_16x16x32_bf16 v[40:43], a[136:139], v[192:195], v[40:43]
 v_cvt_pk_bf16_f32 v160, v160, v161
 v_mfma_f32_16x16x32_bf16 v[40:43], a[152:155], v[196:199], v[40:43]
 v_mfma_f32_16x16x32_bf16 v[40:43], a[168:171], v[200:203], v[40:43]
 s_xor_b32 s25, s52, 524288
 v_mfma_f32_16x16x32_bf16 v[40:43], a[184:187], v[204:207], v[40:43]
 s_add_u32 m0, s55, 16384
 v_cvt_pk_bf16_f32 v161, v162, v163
 v_mfma_f32_16x16x32_bf16 v[44:47], a[188:191], v[204:207], v[44:47]
 v_add_u32 v234, s25, v233
 v_mfma_f32_16x16x32_bf16 v[44:47], a[172:175], v[200:203], v[44:47]
 s_barrier
 v_mfma_f32_16x16x32_bf16 v[44:47], a[156:159], v[196:199], v[44:47]
 buffer_load_dwordx4 v234, s[8:11], s40 offen  lds
 v_mfma_f32_16x16x32_bf16 v[44:47], a[140:143], v[192:195], v[44:47]
 s_waitcnt lgkmcnt(0)
 ds_read_b64_tr_b16 v[192:193], v224 offset:49152
 v_cvt_pk_bf16_f32 v162, v164, v165
 v_mfma_f32_16x16x32_bf16 v[60:63], a[140:143], v[208:211], v[60:63]
 ds_read_b64_tr_b16 v[194:195], v224 offset:51200
 v_mfma_f32_16x16x32_bf16 v[60:63], a[156:159], v[212:215], v[60:63]
 ds_read_b64_tr_b16 v[196:197], v224 offset:53248
 v_mfma_f32_16x16x32_bf16 v[60:63], a[172:175], v[216:219], v[60:63]
 buffer_load_dwordx4 v234, s[8:11], s41 offen offset:1024  lds
 v_mfma_f32_16x16x32_bf16 v[60:63], a[188:191], v[220:223], v[60:63]
 ds_read_b64_tr_b16 v[198:199], v224 offset:55296
 v_cvt_pk_bf16_f32 v163, v166, v167
 v_mfma_f32_16x16x32_bf16 v[56:59], a[184:187], v[220:223], v[56:59]
 ds_read_b64_tr_b16 v[200:201], v224 offset:57344
 v_mfma_f32_16x16x32_bf16 v[56:59], a[168:171], v[216:219], v[56:59]
 ds_read_b64_tr_b16 v[202:203], v224 offset:59392
 v_mfma_f32_16x16x32_bf16 v[56:59], a[152:155], v[212:215], v[56:59]
 buffer_load_dwordx4 v234, s[8:11], s42 offen offset:2048  lds
 v_mfma_f32_16x16x32_bf16 v[56:59], a[136:139], v[208:211], v[56:59]
Lw3_0:
 s_cbranch_execz Lw3_4
 ds_read_b64_tr_b16 v[204:205], v224 offset:61440
 ds_read_b64_tr_b16 v[206:207], v224 offset:63488
 v_mfma_f32_16x16x32_bf16 v[52:55], a[132:135], v[208:211], v[52:55]
 v_mfma_f32_16x16x32_bf16 v[52:55], a[148:151], v[212:215], v[52:55]
 v_mfma_f32_16x16x32_bf16 v[52:55], a[164:167], v[216:219], v[52:55]
 buffer_store_dwordx4 v[160:163], v255, s[4:7], s49 offen sc1
 v_mfma_f32_16x16x32_bf16 v[52:55], a[180:183], v[220:223], v[52:55]
 v_cvt_pk_bf16_f32 v168, v168, v169
 v_mfma_f32_16x16x32_bf16 v[48:51], a[176:179], v[220:223], v[48:51]
 v_mfma_f32_16x16x32_bf16 v[48:51], a[160:163], v[216:219], v[48:51]
 v_mfma_f32_16x16x32_bf16 v[48:51], a[144:147], v[212:215], v[48:51]
 buffer_load_dwordx4 v234, s[8:11], s43 offen offset:3072  lds
 v_mfma_f32_16x16x32_bf16 v[48:51], a[128:131], v[208:211], v[48:51]
 s_waitcnt lgkmcnt(0)
 s_add_u32 m0, s54, 65536
 ds_read_b64_tr_b16 v[208:209], v225 offset:49152
 v_cvt_pk_bf16_f32 v169, v170, v171
 v_mfma_f32_16x16x32_bf16 v[0:3], a[192:195], v[192:195], v[0:3]
 ds_read_b64_tr_b16 v[210:211], v225 offset:51200
 v_mfma_f32_16x16x32_bf16 v[0:3], a[208:211], v[196:199], v[0:3]
 ds_read_b64_tr_b16 v[212:213], v225 offset:53248
 v_mfma_f32_16x16x32_bf16 v[0:3], a[224:227], v[200:203], v[0:3]
 buffer_load_dwordx4 v232, s[4:7], s32 offen sc1 lds
 v_mfma_f32_16x16x32_bf16 v[0:3], a[240:243], v[204:207], v[0:3]
 ds_read_b64_tr_b16 v[214:215], v225 offset:55296
 v_cvt_pk_bf16_f32 v170, v172, v173
 v_mfma_f32_16x16x32_bf16 v[4:7], a[244:247], v[204:207], v[4:7]
 ds_read_b64_tr_b16 v[216:217], v225 offset:57344
 v_mfma_f32_16x16x32_bf16 v[4:7], a[228:231], v[200:203], v[4:7]
 ds_read_b64_tr_b16 v[218:219], v225 offset:59392
 v_mfma_f32_16x16x32_bf16 v[4:7], a[212:215], v[196:199], v[4:7]
 buffer_load_dwordx4 v232, s[4:7], s33 offen offset:1024 sc1 lds
 v_mfma_f32_16x16x32_bf16 v[4:7], a[196:199], v[192:195], v[4:7]
 ds_read_b64_tr_b16 v[220:221], v225 offset:61440
 ds_read_b64_tr_b16 v[222:223], v225 offset:63488
 v_mfma_f32_16x16x32_bf16 v[8:11], a[200:203], v[192:195], v[8:11]
 v_cvt_pk_bf16_f32 v171, v174, v175
 v_mfma_f32_16x16x32_bf16 v[8:11], a[216:219], v[196:199], v[8:11]
 v_mfma_f32_16x16x32_bf16 v[8:11], a[232:235], v[200:203], v[8:11]
 buffer_load_dwordx4 v232, s[4:7], s34 offen offset:2048 sc1 lds
 v_mfma_f32_16x16x32_bf16 v[8:11], a[248:251], v[204:207], v[8:11]
 v_mfma_f32_16x16x32_bf16 v[12:15], a[252:255], v[204:207], v[12:15]
 v_mfma_f32_16x16x32_bf16 v[12:15], a[236:239], v[200:203], v[12:15]
 v_mfma_f32_16x16x32_bf16 v[12:15], a[220:223], v[196:199], v[12:15]
 buffer_store_dwordx4 v[168:171], v255, s[4:7], s49 offen offset:1024 sc1
 v_mfma_f32_16x16x32_bf16 v[12:15], a[204:207], v[192:195], v[12:15]
 s_waitcnt lgkmcnt(0)
 ds_read_b64_tr_b16 v[192:193], v226 offset:49152
 v_cvt_pk_bf16_f32 v176, v176, v177
 v_mfma_f32_16x16x32_bf16 v[28:31], a[204:207], v[208:211], v[28:31]
 ds_read_b64_tr_b16 v[194:195], v226 offset:51200
 v_mfma_f32_16x16x32_bf16 v[28:31], a[220:223], v[212:215], v[28:31]
 ds_read_b64_tr_b16 v[196:197], v226 offset:53248
 v_mfma_f32_16x16x32_bf16 v[28:31], a[236:239], v[216:219], v[28:31]
 buffer_load_dwordx4 v232, s[4:7], s35 offen offset:3072 sc1 lds
 v_mfma_f32_16x16x32_bf16 v[28:31], a[252:255], v[220:223], v[28:31]
 s_add_u32 m0, s54, 69632
 ds_read_b64_tr_b16 v[198:199], v226 offset:55296
 v_cvt_pk_bf16_f32 v177, v178, v179
 v_mfma_f32_16x16x32_bf16 v[24:27], a[248:251], v[220:223], v[24:27]
 ds_read_b64_tr_b16 v[200:201], v226 offset:57344
 v_mfma_f32_16x16x32_bf16 v[24:27], a[232:235], v[216:219], v[24:27]
 ds_read_b64_tr_b16 v[202:203], v226 offset:59392
 v_mfma_f32_16x16x32_bf16 v[24:27], a[216:219], v[212:215], v[24:27]
 buffer_load_dwordx4 v232, s[4:7], s36 offen sc1 lds
 v_mfma_f32_16x16x32_bf16 v[24:27], a[200:203], v[208:211], v[24:27]
 ds_read_b64_tr_b16 v[204:205], v226 offset:61440
 ds_read_b64_tr_b16 v[206:207], v226 offset:63488
 v_mfma_f32_16x16x32_bf16 v[20:23], a[196:199], v[208:211], v[20:23]
 v_cvt_pk_bf16_f32 v178, v180, v181
 v_mfma_f32_16x16x32_bf16 v[20:23], a[212:215], v[212:215], v[20:23]
 v_mfma_f32_16x16x32_bf16 v[20:23], a[228:231], v[216:219], v[20:23]
 buffer_load_dwordx4 v232, s[4:7], s37 offen offset:1024 sc1 lds
 v_mfma_f32_16x16x32_bf16 v[20:23], a[244:247], v[220:223], v[20:23]
 v_cvt_pk_bf16_f32 v179, v182, v183
 v_mfma_f32_16x16x32_bf16 v[16:19], a[240:243], v[220:223], v[16:19]
 v_mfma_f32_16x16x32_bf16 v[16:19], a[224:227], v[216:219], v[16:19]
 v_mfma_f32_16x16x32_bf16 v[16:19], a[208:211], v[212:215], v[16:19]
 buffer_load_dwordx4 v232, s[4:7], s38 offen offset:2048 sc1 lds
 v_mfma_f32_16x16x32_bf16 v[16:19], a[192:195], v[208:211], v[16:19]
 s_waitcnt lgkmcnt(0)
 ds_read_b64_tr_b16 v[208:209], v227 offset:49152
 v_mfma_f32_16x16x32_bf16 v[32:35], a[192:195], v[192:195], v[32:35]
 ds_read_b64_tr_b16 v[210:211], v227 offset:51200
 v_mfma_f32_16x16x32_bf16 v[32:35], a[208:211], v[196:199], v[32:35]
 ds_read_b64_tr_b16 v[212:213], v227 offset:53248
 v_mfma_f32_16x16x32_bf16 v[32:35], a[224:227], v[200:203], v[32:35]
 buffer_store_dwordx4 v[176:179], v255, s[4:7], s49 offen offset:2048 sc1
 v_mfma_f32_16x16x32_bf16 v[32:35], a[240:243], v[204:207], v[32:35]
 ds_read_b64_tr_b16 v[214:215], v227 offset:55296
 v_cvt_pk_bf16_f32 v184, v184, v185
 v_mfma_f32_16x16x32_bf16 v[36:39], a[244:247], v[204:207], v[36:39]
 ds_read_b64_tr_b16 v[216:217], v227 offset:57344
 v_mfma_f32_16x16x32_bf16 v[36:39], a[228:231], v[200:203], v[36:39]
 ds_read_b64_tr_b16 v[218:219], v227 offset:59392
 v_mfma_f32_16x16x32_bf16 v[36:39], a[212:215], v[196:199], v[36:39]
 buffer_load_dwordx4 v232, s[4:7], s39 offen offset:3072 sc1 lds
 v_mfma_f32_16x16x32_bf16 v[36:39], a[196:199], v[192:195], v[36:39]
 ds_read_b64_tr_b16 v[220:221], v227 offset:61440
 ds_read_b64_tr_b16 v[222:223], v227 offset:63488
 v_mfma_f32_16x16x32_bf16 v[40:43], a[200:203], v[192:195], v[40:43]
 v_cvt_pk_bf16_f32 v185, v186, v187
 v_xor_b32 v232, 896, v232
 v_mfma_f32_16x16x32_bf16 v[40:43], a[216:219], v[196:199], v[40:43]
 v_mfma_f32_16x16x32_bf16 v[40:43], a[232:235], v[200:203], v[40:43]
 s_xor_b32 s25, s52, 1048576
 v_mfma_f32_16x16x32_bf16 v[40:43], a[248:251], v[204:207], v[40:43]
 s_add_u32 m0, s55, 32768
 v_cvt_pk_bf16_f32 v186, v188, v189
 v_mfma_f32_16x16x32_bf16 v[44:47], a[252:255], v[204:207], v[44:47]
 v_add_u32 v234, s25, v233
 v_mfma_f32_16x16x32_bf16 v[44:47], a[236:239], v[200:203], v[44:47]
 s_barrier
 v_mfma_f32_16x16x32_bf16 v[44:47], a[220:223], v[196:199], v[44:47]
 buffer_load_dwordx4 v234, s[8:11], s40 offen  lds
 v_mfma_f32_16x16x32_bf16 v[44:47], a[204:207], v[192:195], v[44:47]
 s_waitcnt lgkmcnt(0)
 ds_read_b64_tr_b16 v[192:193], v224 offset:0
 v_cvt_pk_bf16_f32 v187, v190, v191
 v_mfma_f32_16x16x32_bf16 v[60:63], a[204:207], v[208:211], v[60:63]
 ds_read_b64_tr_b16 v[194:195], v224 offset:2048
 v_mfma_f32_16x16x32_bf16 v[60:63], a[220:223], v[212:215], v[60:63]
 ds_read_b64_tr_b16 v[196:197], v224 offset:8192
 v_mfma_f32_16x16x32_bf16 v[60:63], a[236:239], v[216:219], v[60:63]
 buffer_load_dwordx4 v234, s[8:11], s41 offen offset:1024  lds
 v_mfma_f32_16x16x32_bf16 v[60:63], a[252:255], v[220:223], v[60:63]
 ds_read_b64_tr_b16 v[198:199], v224 offset:10240
 v_mfma_f32_16x16x32_bf16 v[56:59], a[248:251], v[220:223], v[56:59]
 v_mfma_f32_16x16x32_bf16 v[56:59], a[232:235], v[216:219], v[56:59]
 v_mfma_f32_16x16x32_bf16 v[56:59], a[216:219], v[212:215], v[56:59]
 buffer_store_dwordx4 v[184:187], v255, s[4:7], s49 offen offset:3072 sc1
 v_mfma_f32_16x16x32_bf16 v[56:59], a[200:203], v[208:211], v[56:59]
 ds_read_b64_tr_b16 v[200:201], v225 offset:0
 v_mfma_f32_16x16x32_bf16 v[52:55], a[196:199], v[208:211], v[52:55]
 ds_read_b64_tr_b16 v[202:203], v225 offset:2048
 v_mfma_f32_16x16x32_bf16 v[52:55], a[212:215], v[212:215], v[52:55]
 ds_read_b64_tr_b16 v[204:205], v225 offset:8192
 v_mfma_f32_16x16x32_bf16 v[52:55], a[228:231], v[216:219], v[52:55]
 buffer_load_dwordx4 v234, s[8:11], s42 offen offset:2048  lds
 v_mfma_f32_16x16x32_bf16 v[52:55], a[244:247], v[220:223], v[52:55]
 ds_read_b64_tr_b16 v[206:207], v225 offset:10240
 v_mfma_f32_16x16x32_bf16 v[48:51], a[240:243], v[220:223], v[48:51]
 v_mfma_f32_16x16x32_bf16 v[48:51], a[224:227], v[216:219], v[48:51]
 v_mfma_f32_16x16x32_bf16 v[48:51], a[208:211], v[212:215], v[48:51]
 buffer_load_dwordx4 v234, s[8:11], s43 offen offset:3072  lds
 v_mfma_f32_16x16x32_bf16 v[48:51], a[192:195], v[208:211], v[48:51]
 s_waitcnt lgkmcnt(4)
 ds_read_b64_tr_b16 v[208:209], v226 offset:0
 v_mfma_f32_16x16x32_bf16 v[64:67], v[192:195], a[0:3], 0
 ds_read_b64_tr_b16 v[210:211], v226 offset:2048
 v_mfma_f32_16x16x32_bf16 v[64:67], v[196:199], a[16:19], v[64:67]
 ds_read_b64_tr_b16 v[212:213], v226 offset:8192
 v_mfma_f32_16x16x32_bf16 v[68:71], v[196:199], a[20:23], 0
 s_add_u32 m0, s54, 0
 v_mfma_f32_16x16x32_bf16 v[68:71], v[192:195], a[4:7], v[68:71]
 ds_read_b64_tr_b16 v[214:215], v226 offset:10240
 v_mfma_f32_16x16x32_bf16 v[72:75], v[192:195], a[8:11], 0
 v_mfma_f32_16x16x32_bf16 v[72:75], v[196:199], a[24:27], v[72:75]
 v_mfma_f32_16x16x32_bf16 v[76:79], v[196:199], a[28:31], 0
 buffer_load_dwordx4 v232, s[4:7], s32 offen sc1 lds
 v_mfma_f32_16x16x32_bf16 v[76:79], v[192:195], a[12:15], v[76:79]
 s_waitcnt lgkmcnt(4)
 ds_read_b64_tr_b16 v[216:217], v227 offset:0
 v_cvt_pk_bf16_f32 v0, v0, v1
 v_mfma_f32_16x16x32_bf16 v[92:95], v[200:203], a[12:15], 0
 ds_read_b64_tr_b16 v[218:219], v227 offset:2048
 v_mfma_f32_16x16x32_bf16 v[92:95], v[204:207], a[28:31], v[92:95]
 ds_read_b64_tr_b16 v[220:221], v227 offset:8192
 v_mfma_f32_16x16x32_bf16 v[88:91], v[204:207], a[24:27], 0
 buffer_load_dwordx4 v232, s[4:7], s33 offen offset:1024 sc1 lds
 v_mfma_f32_16x16x32_bf16 v[88:91], v[200:203], a[8:11], v[88:91]
 ds_read_b64_tr_b16 v[222:223], v227 offset:10240
 v_cvt_pk_bf16_f32 v1, v2, v3
 v_mfma_f32_16x16x32_bf16 v[84:87], v[200:203], a[4:7], 0
 v_mfma_f32_16x16x32_bf16 v[84:87], v[204:207], a[20:23], v[84:87]
 v_mfma_f32_16x16x32_bf16 v[80:83], v[204:207], a[16:19], 0
 buffer_load_dwordx4 v232, s[4:7], s34 offen offset:2048 sc1 lds
 v_mfma_f32_16x16x32_bf16 v[80:83], v[200:203], a[0:3], v[80:83]
 s_waitcnt lgkmcnt(4)
 ds_read_b64_tr_b16 v[192:193], v224 offset:4096
 v_mfma_f32_16x16x32_bf16 v[96:99], v[208:211], a[0:3], 0
 ds_read_b64_tr_b16 v[194:195], v224 offset:6144
 v_cvt_pk_bf16_f32 v2, v4, v5
 v_mfma_f32_16x16x32_bf16 v[96:99], v[212:215], a[16:19], v[96:99]
 ds_read_b64_tr_b16 v[196:197], v224 offset:12288
 v_mfma_f32_16x16x32_bf16 v[100:103], v[212:215], a[20:23], 0
 buffer_load_dwordx4 v232, s[4:7], s35 offen offset:3072 sc1 lds
 v_mfma_f32_16x16x32_bf16 v[100:103], v[208:211], a[4:7], v[100:103]
 s_add_u32 m0, s54, 4096
 ds_read_b64_tr_b16 v[198:199], v224 offset:14336
 v_mfma_f32_16x16x32_bf16 v[104:107], v[208:211], a[8:11], 0
 v_mfma_f32_16x16x32_bf16 v[104:107], v[212:215], a[24:27], v[104:107]
 v_mfma_f32_16x16x32_bf16 v[108:111], v[212:215], a[28:31], 0
 buffer_load_dwordx4 v232, s[4:7], s36 offen sc1 lds
 v_mfma_f32_16x16x32_bf16 v[108:111], v[208:211], a[12:15], v[108:111]
 s_waitcnt lgkmcnt(4)
 ds_read_b64_tr_b16 v[200:201], v225 offset:4096
 v_cvt_pk_bf16_f32 v3, v6, v7
 v_mfma_f32_16x16x32_bf16 v[124:127], v[216:219], a[12:15], 0
 ds_read_b64_tr_b16 v[202:203], v225 offset:6144
 v_mfma_f32_16x16x32_bf16 v[124:127], v[220:223], a[28:31], v[124:127]
 ds_read_b64_tr_b16 v[204:205], v225 offset:12288
 v_mfma_f32_16x16x32_bf16 v[120:123], v[220:223], a[24:27], 0
 buffer_load_dwordx4 v232, s[4:7], s37 offen offset:1024 sc1 lds
 v_mfma_f32_16x16x32_bf16 v[120:123], v[216:219], a[8:11], v[120:123]
 ds_read_b64_tr_b16 v[206:207], v225 offset:14336
 v_mfma_f32_16x16x32_bf16 v[116:119], v[216:219], a[4:7], 0
 v_mfma_f32_16x16x32_bf16 v[116:119], v[220:223], a[20:23], v[116:119]
 v_mfma_f32_16x16x32_bf16 v[112:115], v[220:223], a[16:19], 0
 buffer_store_dwordx4 v[0:3], v255, s[4:7], s50 offen sc1
 v_mfma_f32_16x16x32_bf16 v[112:115], v[216:219], a[0:3], v[112:115]
 s_waitcnt lgkmcnt(4)
 ds_read_b64_tr_b16 v[208:209], v226 offset:4096
 v_mfma_f32_16x16x32_bf16 v[128:131], v[192:195], a[0:3], 0
 ds_read_b64_tr_b16 v[210:211], v226 offset:6144
 v_mfma_f32_16x16x32_bf16 v[128:131], v[196:199], a[16:19], v[128:131]
 s_waitcnt vmcnt(28)
 ds_read_b128 a[64:67], v228 offset:32768
 ds_read_b64_tr_b16 v[212:213], v226 offset:12288
 v_mfma_f32_16x16x32_bf16 v[132:135], v[196:199], a[20:23], 0
 buffer_load_dwordx4 v232, s[4:7], s38 offen offset:2048 sc1 lds
 v_mfma_f32_16x16x32_bf16 v[132:135], v[192:195], a[4:7], v[132:135]
 ds_read_b128 a[80:83], v229 offset:32768
 ds_read_b64_tr_b16 v[214:215], v226 offset:14336
 v_mfma_f32_16x16x32_bf16 v[136:139], v[192:195], a[8:11], 0
 v_cvt_pk_bf16_f32 v8, v8, v9
 v_mfma_f32_16x16x32_bf16 v[136:139], v[196:199], a[24:27], v[136:139]
 ds_read_b128 a[68:71], v228 offset:34816
 v_mfma_f32_16x16x32_bf16 v[140:143], v[196:199], a[28:31], 0
 buffer_load_dwordx4 v232, s[4:7], s39 offen offset:3072 sc1 lds
 v_mfma_f32_16x16x32_bf16 v[140:143], v[192:195], a[12:15], v[140:143]
 s_waitcnt lgkmcnt(7)
 ds_read_b128 a[84:87], v229 offset:34816
 ds_read_b64_tr_b16 v[216:217], v227 offset:4096
 v_xor_b32 v232, 128, v232
 v_mfma_f32_16x16x32_bf16 v[156:159], v[200:203], a[12:15], 0
 ds_read_b64_tr_b16 v[218:219], v227 offset:6144
 v_cvt_pk_bf16_f32 v9, v10, v11
 v_mfma_f32_16x16x32_bf16 v[156:159], v[204:207], a[28:31], v[156:159]
 ds_read_b128 a[72:75], v228 offset:36864
 ds_read_b64_tr_b16 v[220:221], v227 offset:12288
 v_mfma_f32_16x16x32_bf16 v[152:155], v[204:207], a[24:27], 0
 s_xor_b32 s25, s52, 1572864
 v_mfma_f32_16x16x32_bf16 v[152:155], v[200:203], a[8:11], v[152:155]
 s_add_u32 m0, s55, 49152
 ds_read_b128 a[88:91], v229 offset:36864
 ds_read_b64_tr_b16 v[222:223], v227 offset:14336
 v_mfma_f32_16x16x32_bf16 v[148:151], v[200:203], a[4:7], 0
 s_waitcnt vmcnt(24)
 v_cvt_pk_bf16_f32 v10, v12, v13
 v_add_u32 v234, s25, v233
 v_mfma_f32_16x16x32_bf16 v[148:151], v[204:207], a[20:23], v[148:151]
 s_barrier
 ds_read_b128 a[76:79], v228 offset:38912
 v_mfma_f32_16x16x32_bf16 v[144:147], v[204:207], a[16:19], 0
 buffer_load_dwordx4 v234, s[8:11], s40 offen  lds
 v_mfma_f32_16x16x32_bf16 v[144:147], v[200:203], a[0:3], v[144:147]
 s_waitcnt lgkmcnt(13)
 ds_read_b128 a[92:95], v229 offset:38912
 ds_read_b64_tr_b16 v[192:193], v224 offset:16384
 v_mfma_f32_16x16x32_bf16 v[160:163], v[208:211], a[0:3], 0
 s_waitcnt lgkmcnt(11)
 ds_read_b64_tr_b16 v[194:195], v224 offset:18432
 v_mfma_f32_16x16x32_bf16 v[160:163], v[212:215], a[16:19], v[160:163]
 ds_read_b64_tr_b16 v[196:197], v224 offset:24576
 v_cvt_pk_bf16_f32 v11, v14, v15
 v_mfma_f32_16x16x32_bf16 v[164:167], v[212:215], a[20:23], 0
 buffer_load_dwordx4 v234, s[8:11], s41 offen offset:1024  lds
 v_mfma_f32_16x16x32_bf16 v[164:167], v[208:211], a[4:7], v[164:167]
 ds_read_b64_tr_b16 v[198:199], v224 offset:26624
 v_mfma_f32_16x16x32_bf16 v[168:171], v[208:211], a[8:11], 0
 v_mfma_f32_16x16x32_bf16 v[168:171], v[212:215], a[24:27], v[168:171]
 v_mfma_f32_16x16x32_bf16 v[172:175], v[212:215], a[28:31], 0
 buffer_load_dwordx4 v234, s[8:11], s42 offen offset:2048  lds
 v_mfma_f32_16x16x32_bf16 v[172:175], v[208:211], a[12:15], v[172:175]
 s_waitcnt lgkmcnt(10)
 ds_read_b64_tr_b16 v[200:201], v225 offset:16384
 v_mfma_f32_16x16x32_bf16 v[188:191], v[216:219], a[12:15], 0
 s_waitcnt lgkmcnt(7)
 ds_read_b64_tr_b16 v[202:203], v225 offset:18432
 v_mfma_f32_16x16x32_bf16 v[188:191], v[220:223], a[28:31], v[188:191]
 ds_read_b64_tr_b16 v[204:205], v225 offset:24576
 v_mfma_f32_16x16x32_bf16 v[184:187], v[220:223], a[24:27], 0
 buffer_store_dwordx4 v[8:11], v255, s[4:7], s50 offen offset:1024 sc1
 v_mfma_f32_16x16x32_bf16 v[184:187], v[216:219], a[8:11], v[184:187]
 ds_read_b64_tr_b16 v[206:207], v225 offset:26624
 v_mfma_f32_16x16x32_bf16 v[180:183], v[216:219], a[4:7], 0
 v_cvt_pk_bf16_f32 v16, v16, v17
 v_mfma_f32_16x16x32_bf16 v[180:183], v[220:223], a[20:23], v[180:183]
 v_mfma_f32_16x16x32_bf16 v[176:179], v[220:223], a[16:19], 0
 buffer_load_dwordx4 v234, s[8:11], s43 offen offset:3072  lds
 v_mfma_f32_16x16x32_bf16 v[176:179], v[216:219], a[0:3], v[176:179]
 s_waitcnt lgkmcnt(4)
 ds_read_b64_tr_b16 v[208:209], v226 offset:16384
 v_mfma_f32_16x16x32_bf16 v[64:67], v[192:195], a[32:35], v[64:67]
 ds_read_b64_tr_b16 v[210:211], v226 offset:18432
 v_mfma_f32_16x16x32_bf16 v[64:67], v[196:199], a[48:51], v[64:67]
 ds_read_b64_tr_b16 v[212:213], v226 offset:24576
 v_cvt_pk_bf16_f32 v17, v18, v19
 v_mfma_f32_16x16x32_bf16 v[68:71], v[196:199], a[52:55], v[68:71]
 v_mfma_f32_16x16x32_bf16 v[68:71], v[192:195], a[36:39], v[68:71]
 ds_read_b64_tr_b16 v[214:215], v226 offset:26624
 v_mfma_f32_16x16x32_bf16 v[72:75], v[192:195], a[40:43], v[72:75]
 v_mfma_f32_16x16x32_bf16 v[72:75], v[196:199], a[56:59], v[72:75]
 v_mfma_f32_16x16x32_bf16 v[76:79], v[196:199], a[60:63], v[76:79]
 v_mfma_f32_16x16x32_bf16 v[76:79], v[192:195], a[44:47], v[76:79]
 s_waitcnt lgkmcnt(4)
 ds_read_b64_tr_b16 v[216:217], v227 offset:16384
 v_cvt_pk_bf16_f32 v18, v20, v21
 v_mfma_f32_16x16x32_bf16 v[92:95], v[200:203], a[44:47], v[92:95]
 ds_read_b64_tr_b16 v[218:219], v227 offset:18432
 v_mfma_f32_16x16x32_bf16 v[92:95], v[204:207], a[60:63], v[92:95]
 ds_read_b64_tr_b16 v[220:221], v227 offset:24576
 v_mfma_f32_16x16x32_bf16 v[88:91], v[204:207], a[56:59], v[88:91]
 v_mfma_f32_16x16x32_bf16 v[88:91], v[200:203], a[40:43], v[88:91]
 ds_read_b64_tr_b16 v[222:223], v227 offset:26624
 v_mfma_f32_16x16x32_bf16 v[84:87], v[200:203], a[36:39], v[84:87]
 v_cvt_pk_bf16_f32 v19, v22, v23
 v_mfma_f32_16x16x32_bf16 v[84:87], v[204:207], a[52:55], v[84:87]
 v_mfma_f32_16x16x32_bf16 v[80:83], v[204:207], a[48:51], v[80:83]
 v_mfma_f32_16x16x32_bf16 v[80:83], v[200:203], a[32:35], v[80:83]
 s_waitcnt lgkmcnt(4)
 s_add_u32 m0, s54, 32768
 ds_read_b64_tr_b16 v[192:193], v224 offset:20480
 v_mfma_f32_16x16x32_bf16 v[96:99], v[208:211], a[32:35], v[96:99]
 ds_read_b64_tr_b16 v[194:195], v224 offset:22528
 v_mfma_f32_16x16x32_bf16 v[96:99], v[212:215], a[48:51], v[96:99]
 ds_read_b64_tr_b16 v[196:197], v224 offset:28672
 v_mfma_f32_16x16x32_bf16 v[100:103], v[212:215], a[52:55], v[100:103]
 v_mfma_f32_16x16x32_bf16 v[100:103], v[208:211], a[36:39], v[100:103]
 ds_read_b64_tr_b16 v[198:199], v224 offset:30720
 v_mfma_f32_16x16x32_bf16 v[104:107], v[208:211], a[40:43], v[104:107]
 v_mfma_f32_16x16x32_bf16 v[104:107], v[212:215], a[56:59], v[104:107]
 v_mfma_f32_16x16x32_bf16 v[108:111], v[212:215], a[60:63], v[108:111]
 buffer_store_dwordx4 v[16:19], v255, s[4:7], s50 offen offset:2048 sc1
 v_mfma_f32_16x16x32_bf16 v[108:111], v[208:211], a[44:47], v[108:111]
 s_waitcnt lgkmcnt(4)
 ds_read_b64_tr_b16 v[200:201], v225 offset:20480
 v_cvt_pk_bf16_f32 v24, v24, v25
 v_mfma_f32_16x16x32_bf16 v[124:127], v[216:219], a[44:47], v[124:127]
 ds_read_b64_tr_b16 v[202:203], v225 offset:22528
 v_mfma_f32_16x16x32_bf16 v[124:127], v[220:223], a[60:63], v[124:127]
 ds_read_b64_tr_b16 v[204:205], v225 offset:28672
 v_mfma_f32_16x16x32_bf16 v[120:123], v[220:223], a[56:59], v[120:123]
 buffer_load_dwordx4 v232, s[4:7], s32 offen sc1 lds
 v_mfma_f32_16x16x32_bf16 v[120:123], v[216:219], a[40:43], v[120:123]
 ds_read_b64_tr_b16 v[206:207], v225 offset:30720
 v_mfma_f32_16x16x32_bf16 v[116:119], v[216:219], a[36:39], v[116:119]
 v_mfma_f32_16x16x32_bf16 v[116:119], v[220:223], a[52:55], v[116:119]
 v_cvt_pk_bf16_f32 v25, v26, v27
 v_mfma_f32_16x16x32_bf16 v[112:115], v[220:223], a[48:51], v[112:115]
 buffer_load_dwordx4 v232, s[4:7], s33 offen offset:1024 sc1 lds
 v_mfma_f32_16x16x32_bf16 v[112:115], v[216:219], a[32:35], v[112:115]
 s_waitcnt lgkmcnt(4)
 ds_read_b64_tr_b16 v[208:209], v226 offset:20480
 v_mfma_f32_16x16x32_bf16 v[128:131], v[192:195], a[32:35], v[128:131]
 ds_read_b64_tr_b16 v[210:211], v226 offset:22528
 v_mfma_f32_16x16x32_bf16 v[128:131], v[196:199], a[48:51], v[128:131]
 ds_read_b64_tr_b16 v[212:213], v226 offset:28672
 v_mfma_f32_16x16x32_bf16 v[132:135], v[196:199], a[52:55], v[132:135]
 buffer_load_dwordx4 v232, s[4:7], s34 offen offset:2048 sc1 lds
 v_mfma_f32_16x16x32_bf16 v[132:135], v[192:195], a[36:39], v[132:135]
 ds_read_b64_tr_b16 v[214:215], v226 offset:30720
 v_cvt_pk_bf16_f32 v26, v28, v29
 v_mfma_f32_16x16x32_bf16 v[136:139], v[192:195], a[40:43], v[136:139]
 v_mfma_f32_16x16x32_bf16 v[136:139], v[196:199], a[56:59], v[136:139]
 v_mfma_f32_16x16x32_bf16 v[140:143], v[196:199], a[60:63], v[140:143]
 buffer_load_dwordx4 v232, s[4:7], s35 offen offset:3072 sc1 lds
 v_mfma_f32_16x16x32_bf16 v[140:143], v[192:195], a[44:47], v[140:143]
 s_waitcnt lgkmcnt(4)
 s_add_u32 m0, s54, 36864
 ds_read_b64_tr_b16 v[216:217], v227 offset:20480
 v_mfma_f32_16x16x32_bf16 v[156:159], v[200:203], a[44:47], v[156:159]
 ds_read_b64_tr_b16 v[218:219], v227 offset:22528
 v_cvt_pk_bf16_f32 v27, v30, v31
 v_mfma_f32_16x16x32_bf16 v[156:159], v[204:207], a[60:63], v[156:159]
 ds_read_b64_tr_b16 v[220:221], v227 offset:28672
 v_mfma_f32_16x16x32_bf16 v[152:155], v[204:207], a[56:59], v[152:155]
 buffer_load_dwordx4 v232, s[4:7], s36 offen sc1 lds
 v_mfma_f32_16x16x32_bf16 v[152:155], v[200:203], a[40:43], v[152:155]
 ds_read_b64_tr_b16 v[222:223], v227 offset:30720
 v_mfma_f32_16x16x32_bf16 v[148:151], v[200:203], a[36:39], v[148:151]
 s_waitcnt vmcnt(20)
 v_mfma_f32_16x16x32_bf16 v[148:151], v[204:207], a[52:55], v[148:151]
 s_barrier
 ds_read_b128 a[96:99], v230 offset:0
 v_mfma_f32_16x16x32_bf16 v[144:147], v[204:207], a[48:51], v[144:147]
 buffer_store_dwordx4 v[24:27], v255, s[4:7], s50 offen offset:3072 sc1
 v_mfma_f32_16x16x32_bf16 v[144:147], v[200:203], a[32:35], v[144:147]
 s_waitcnt lgkmcnt(5)
 ds_read_b128 a[112:115], v231 offset:0
 ds_read_b64_tr_b16 v[192:193], v224 offset:32768
 v_mfma_f32_16x16x32_bf16 v[160:163], v[208:211], a[32:35], v[160:163]
 ds_read_b64_tr_b16 v[194:195], v224 offset:34816
 v_mfma_f32_16x16x32_bf16 v[160:163], v[212:215], a[48:51], v[160:163]
 ds_read_b128 a[100:103], v230 offset:2048
 ds_read_b64_tr_b16 v[196:197], v224 offset:40960
 v_mfma_f32_16x16x32_bf16 v[164:167], v[212:215], a[52:55], v[164:167]
 buffer_load_dwordx4 v232, s[4:7], s37 offen offset:1024 sc1 lds
 v_mfma_f32_16x16x32_bf16 v[164:167], v[208:211], a[36:39], v[164:167]
 ds_read_b128 a[116:119], v231 offset:2048
 ds_read_b64_tr_b16 v[198:199], v224 offset:43008
 v_mfma_f32_16x16x32_bf16 v[168:171], v[208:211], a[40:43], v[168:171]
 v_cvt_pk_bf16_f32 v32, v32, v33
 v_mfma_f32_16x16x32_bf16 v[168:171], v[212:215], a[56:59], v[168:171]
 ds_read_b128 a[104:107], v230 offset:4096
 v_mfma_f32_16x16x32_bf16 v[172:175], v[212:215], a[60:63], v[172:175]
 buffer_load_dwordx4 v232, s[4:7], s38 offen offset:2048 sc1 lds
 v_mfma_f32_16x16x32_bf16 v[172:175], v[208:211], a[44:47], v[172:175]
 s_waitcnt lgkmcnt(9)
 ds_read_b128 a[120:123], v231 offset:4096
 ds_read_b64_tr_b16 v[200:201], v225 offset:32768
 v_mfma_f32_16x16x32_bf16 v[188:191], v[216:219], a[44:47], v[188:191]
 ds_read_b64_tr_b16 v[202:203], v225 offset:34816
 v_cvt_pk_bf16_f32 v33, v34, v35
 v_mfma_f32_16x16x32_bf16 v[188:191], v[220:223], a[60:63], v[188:191]
 ds_read_b128 a[108:111], v230 offset:6144
 ds_read_b64_tr_b16 v[204:205], v225 offset:40960
 v_mfma_f32_16x16x32_bf16 v[184:187], v[220:223], a[56:59], v[184:187]
 buffer_load_dwordx4 v232, s[4:7], s39 offen offset:3072 sc1 lds
 v_mfma_f32_16x16x32_bf16 v[184:187], v[216:219], a[40:43], v[184:187]
 s_xor_b32 s25, s52, 2097152
 ds_read_b128 a[124:127], v231 offset:6144
 ds_read_b64_tr_b16 v[206:207], v225 offset:43008
 v_mfma_f32_16x16x32_bf16 v[180:183], v[216:219], a[36:39], v[180:183]
 s_add_u32 m0, s55, 0
 v_xor_b32 v232, 384, v232
 v_mfma_f32_16x16x32_bf16 v[180:183], v[220:223], a[52:55], v[180:183]
 v_cvt_pk_bf16_f32 v34, v36, v37
 v_add_u32 v234, s25, v233
 v_mfma_f32_16x16x32_bf16 v[176:179], v[220:223], a[48:51], v[176:179]
 buffer_load_dwordx4 v234, s[8:11], s40 offen  lds
 v_mfma_f32_16x16x32_bf16 v[176:179], v[216:219], a[32:35], v[176:179]
 s_waitcnt lgkmcnt(12)
 ds_read_b64_tr_b16 v[208:209], v226 offset:32768
 v_mfma_f32_16x16x32_bf16 v[64:67], v[192:195], a[64:67], v[64:67]
 s_waitcnt lgkmcnt(9)
 ds_read_b64_tr_b16 v[210:211], v226 offset:34816
 v_mfma_f32_16x16x32_bf16 v[64:67], v[196:199], a[80:83], v[64:67]
 ds_read_b64_tr_b16 v[212:213], v226 offset:40960
 v_mfma_f32_16x16x32_bf16 v[68:71], v[196:199], a[84:87], v[68:71]
 buffer_load_dwordx4 v234, s[8:11], s41 offen offset:1024  lds
 v_mfma_f32_16x16x32_bf16 v[68:71], v[192:195], a[68:71], v[68:71]
 ds_read_b64_tr_b16 v[214:215], v226 offset:43008
 v_cvt_pk_bf16_f32 v35, v38, v39
 v_mfma_f32_16x16x32_bf16 v[72:75], v[192:195], a[72:75], v[72:75]
 v_mfma_f32_16x16x32_bf16 v[72:75], v[196:199], a[88:91], v[72:75]
 v_mfma_f32_16x16x32_bf16 v[76:79], v[196:199], a[92:95], v[76:79]
 buffer_load_dwordx4 v234, s[8:11], s42 offen offset:2048  lds
 v_mfma_f32_16x16x32_bf16 v[76:79], v[192:195], a[76:79], v[76:79]
 s_waitcnt lgkmcnt(8)
 ds_read_b64_tr_b16 v[216:217], v227 offset:32768
 v_mfma_f32_16x16x32_bf16 v[92:95], v[200:203], a[76:79], v[92:95]
 s_waitcnt lgkmcnt(5)
 s_lshl_b32 s23, s21, 10
 ds_read_b64_tr_b16 v[218:219], v227 offset:34816
 v_mfma_f32_16x16x32_bf16 v[92:95], v[204:207], a[92:95], v[92:95]
 s_add_u32 s23, s23, 83361792
 ds_read_b64_tr_b16 v[220:221], v227 offset:40960
 v_mfma_f32_16x16x32_bf16 v[88:91], v[204:207], a[88:91], v[88:91]
 s_lshl_b32 s26, s22, 7
 buffer_store_dwordx4 v[32:35], v255, s[4:7], s51 offen sc1
 v_mfma_f32_16x16x32_bf16 v[88:91], v[200:203], a[72:75], v[88:91]
 s_add_u32 s26, s26, s23
 ds_read_b64_tr_b16 v[222:223], v227 offset:43008
 v_mfma_f32_16x16x32_bf16 v[84:87], v[200:203], a[68:71], v[84:87]
 v_mfma_f32_16x16x32_bf16 v[84:87], v[204:207], a[84:87], v[84:87]
 v_and_b32 v236, 112, v255
 v_lshl_add_u32 v236, v236, 3, s23
 v_mfma_f32_16x16x32_bf16 v[80:83], v[204:207], a[80:83], v[80:83]
 buffer_load_dwordx4 v234, s[8:11], s43 offen offset:3072  lds
 v_mfma_f32_16x16x32_bf16 v[80:83], v[200:203], a[64:67], v[80:83]
 s_waitcnt lgkmcnt(4)
 ds_read_b64_tr_b16 v[192:193], v224 offset:36864
 v_cvt_pk_bf16_f32 v40, v40, v41
 v_mfma_f32_16x16x32_bf16 v[96:99], v[208:211], a[64:67], v[96:99]
 ds_read_b64_tr_b16 v[194:195], v224 offset:38912
 v_mfma_f32_16x16x32_bf16 v[96:99], v[212:215], a[80:83], v[96:99]
 ds_read_b64_tr_b16 v[196:197], v224 offset:45056
 v_mfma_f32_16x16x32_bf16 v[100:103], v[212:215], a[84:87], v[100:103]
 v_mfma_f32_16x16x32_bf16 v[100:103], v[208:211], a[68:71], v[100:103]
 ds_read_b64_tr_b16 v[198:199], v224 offset:47104
 v_cvt_pk_bf16_f32 v41, v42, v43
 v_mfma_f32_16x16x32_bf16 v[104:107], v[208:211], a[72:75], v[104:107]
 v_mfma_f32_16x16x32_bf16 v[104:107], v[212:215], a[88:91], v[104:107]
 v_mfma_f32_16x16x32_bf16 v[108:111], v[212:215], a[92:95], v[108:111]
 v_mfma_f32_16x16x32_bf16 v[108:111], v[208:211], a[76:79], v[108:111]
 s_waitcnt lgkmcnt(4)
 ds_read_b64_tr_b16 v[200:201], v225 offset:36864
 v_mfma_f32_16x16x32_bf16 v[124:127], v[216:219], a[76:79], v[124:127]
 ds_read_b64_tr_b16 v[202:203], v225 offset:38912
 v_mfma_f32_16x16x32_bf16 v[124:127], v[220:223], a[92:95], v[124:127]
 ds_read_b64_tr_b16 v[204:205], v225 offset:45056
 v_cvt_pk_bf16_f32 v42, v44, v45
 v_mfma_f32_16x16x32_bf16 v[120:123], v[220:223], a[88:91], v[120:123]
 v_mfma_f32_16x16x32_bf16 v[120:123], v[216:219], a[72:75], v[120:123]
 ds_read_b64_tr_b16 v[206:207], v225 offset:47104
 v_mfma_f32_16x16x32_bf16 v[116:119], v[216:219], a[68:71], v[116:119]
 s_add_u32 m0, s54, 65536
 v_mfma_f32_16x16x32_bf16 v[116:119], v[220:223], a[84:87], v[116:119]
 v_mfma_f32_16x16x32_bf16 v[112:115], v[220:223], a[80:83], v[112:115]
 v_mfma_f32_16x16x32_bf16 v[112:115], v[216:219], a[64:67], v[112:115]
 s_waitcnt lgkmcnt(4)
 ds_read_b64_tr_b16 v[208:209], v226 offset:36864
 v_cvt_pk_bf16_f32 v43, v46, v47
 v_mfma_f32_16x16x32_bf16 v[128:131], v[192:195], a[64:67], v[128:131]
 ds_read_b64_tr_b16 v[210:211], v226 offset:38912
 v_mfma_f32_16x16x32_bf16 v[128:131], v[196:199], a[80:83], v[128:131]
 ds_read_b64_tr_b16 v[212:213], v226 offset:45056
 v_mfma_f32_16x16x32_bf16 v[132:135], v[196:199], a[84:87], v[132:135]
 buffer_load_dwordx4 v232, s[4:7], s32 offen sc1 lds
 v_mfma_f32_16x16x32_bf16 v[132:135], v[192:195], a[68:71], v[132:135]
 ds_read_b64_tr_b16 v[214:215], v226 offset:47104
 v_mfma_f32_16x16x32_bf16 v[136:139], v[192:195], a[72:75], v[136:139]
 v_mfma_f32_16x16x32_bf16 v[136:139], v[196:199], a[88:91], v[136:139]
 v_mfma_f32_16x16x32_bf16 v[140:143], v[196:199], a[92:95], v[140:143]
 buffer_store_dwordx4 v[40:43], v255, s[4:7], s51 offen offset:1024 sc1
 v_mfma_f32_16x16x32_bf16 v[140:143], v[192:195], a[76:79], v[140:143]
 s_waitcnt lgkmcnt(4)
 ds_read_b64_tr_b16 v[216:217], v227 offset:36864
 v_mfma_f32_16x16x32_bf16 v[156:159], v[200:203], a[76:79], v[156:159]
 ds_read_b64_tr_b16 v[218:219], v227 offset:38912
 v_mfma_f32_16x16x32_bf16 v[156:159], v[204:207], a[92:95], v[156:159]
 ds_read_b64_tr_b16 v[220:221], v227 offset:45056
 v_cvt_pk_bf16_f32 v48, v48, v49
 v_mfma_f32_16x16x32_bf16 v[152:155], v[204:207], a[88:91], v[152:155]
 buffer_load_dwordx4 v232, s[4:7], s33 offen offset:1024 sc1 lds
 v_mfma_f32_16x16x32_bf16 v[152:155], v[200:203], a[72:75], v[152:155]
 ds_read_b64_tr_b16 v[222:223], v227 offset:47104
 v_mfma_f32_16x16x32_bf16 v[148:151], v[200:203], a[68:71], v[148:151]
 s_waitcnt vmcnt(18)
 v_mfma_f32_16x16x32_bf16 v[148:151], v[204:207], a[84:87], v[148:151]
 s_barrier
 v_mfma_f32_16x16x32_bf16 v[144:147], v[204:207], a[80:83], v[144:147]
Lw3_1:
 s_cbranch_execz Lw3_5
 buffer_load_dwordx4 v232, s[4:7], s34 offen offset:2048 sc1 lds
 v_mfma_f32_16x16x32_bf16 v[144:147], v[200:203], a[64:67], v[144:147]
 s_waitcnt lgkmcnt(4)
 ds_read_b64_tr_b16 v[192:193], v224 offset:49152
 v_cvt_pk_bf16_f32 v49, v50, v51
 v_mfma_f32_16x16x32_bf16 v[160:163], v[208:211], a[64:67], v[160:163]
 ds_read_b64_tr_b16 v[194:195], v224 offset:51200
 v_mfma_f32_16x16x32_bf16 v[160:163], v[212:215], a[80:83], v[160:163]
 ds_read_b64_tr_b16 v[196:197], v224 offset:57344
 v_mfma_f32_16x16x32_bf16 v[164:167], v[212:215], a[84:87], v[164:167]
 buffer_load_dwordx4 v232, s[4:7], s35 offen offset:3072 sc1 lds
 v_mfma_f32_16x16x32_bf16 v[164:167], v[208:211], a[68:71], v[164:167]
 s_add_u32 m0, s54, 69632
 ds_read_b64_tr_b16 v[198:199], v224 offset:59392
 v_mov_b32 v243, 536870912
 v_mfma_f32_16x16x32_bf16 v[168:171], v[208:211], a[72:75], v[168:171]
 v_cvt_pk_bf16_f32 v50, v52, v53
 v_lshlrev_b32 v249, 3, v255
 v_mfma_f32_16x16x32_bf16 v[168:171], v[212:215], a[88:91], v[168:171]
 v_cmp_gt_u32 vcc, 4096, v249
 s_nop 0
 v_mfma_f32_16x16x32_bf16 v[172:175], v[212:215], a[92:95], v[172:175]
 buffer_load_dwordx4 v232, s[4:7], s36 offen sc1 lds
 v_mfma_f32_16x16x32_bf16 v[172:175], v[208:211], a[76:79], v[172:175]
 s_waitcnt lgkmcnt(4)
 ds_read_b64_tr_b16 v[200:201], v225 offset:49152
 v_cndmask_b32 v242, v243, v249, vcc
 v_mfma_f32_16x16x32_bf16 v[188:191], v[216:219], a[76:79], v[188:191]
 ds_read_b64_tr_b16 v[202:203], v225 offset:51200
 v_mfma_f32_16x16x32_bf16 v[188:191], v[220:223], a[92:95], v[188:191]
 ds_read_b64_tr_b16 v[204:205], v225 offset:57344
 v_cvt_pk_bf16_f32 v51, v54, v55
 v_mfma_f32_16x16x32_bf16 v[184:187], v[220:223], a[88:91], v[184:187]
 buffer_load_dwordx4 v232, s[4:7], s37 offen offset:1024 sc1 lds
 v_mfma_f32_16x16x32_bf16 v[184:187], v[216:219], a[72:75], v[184:187]
 ds_read_b128 a[128:131], v228 offset:0
 ds_read_b64_tr_b16 v[206:207], v225 offset:59392
 v_mfma_f32_16x16x32_bf16 v[180:183], v[216:219], a[68:71], v[180:183]
 v_mfma_f32_16x16x32_bf16 v[180:183], v[220:223], a[84:87], v[180:183]
 ds_read_b128 a[144:147], v229 offset:0
 v_mfma_f32_16x16x32_bf16 v[176:179], v[220:223], a[80:83], v[176:179]
 buffer_load_dwordx4 v232, s[4:7], s38 offen offset:2048 sc1 lds
 v_mfma_f32_16x16x32_bf16 v[176:179], v[216:219], a[64:67], v[176:179]
 s_waitcnt lgkmcnt(6)
 ds_read_b128 a[132:135], v228 offset:2048
 ds_read_b64_tr_b16 v[208:209], v226 offset:49152
 v_mfma_f32_16x16x32_bf16 v[64:67], v[192:195], a[96:99], v[64:67]
 ds_read_b64_tr_b16 v[210:211], v226 offset:51200
 v_mfma_f32_16x16x32_bf16 v[64:67], v[196:199], a[112:115], v[64:67]
 ds_read_b128 a[148:151], v229 offset:2048
 ds_read_b64_tr_b16 v[212:213], v226 offset:57344
 v_mfma_f32_16x16x32_bf16 v[68:71], v[196:199], a[116:119], v[68:71]
 s_lshl_b32 s30, s20, 4
 buffer_store_dwordx4 v[48:51], v255, s[4:7], s51 offen offset:2048 sc1
 v_mfma_f32_16x16x32_bf16 v[68:71], v[192:195], a[100:103], v[68:71]
 s_lshl_b32 s31, s22, 6
 ds_read_b128 a[136:139], v228 offset:4096
 ds_read_b64_tr_b16 v[214:215], v226 offset:59392
 v_mfma_f32_16x16x32_bf16 v[72:75], v[192:195], a[104:107], v[72:75]
 v_cvt_pk_bf16_f32 v56, v56, v57
 v_add_u32 v240, 0x10000, v255
 v_mfma_f32_16x16x32_bf16 v[72:75], v[196:199], a[120:123], v[72:75]
 ds_read_b128 a[152:155], v229 offset:4096
 v_add_u32 v241, 0x10000, v255
 v_mfma_f32_16x16x32_bf16 v[76:79], v[196:199], a[124:127], v[76:79]
 buffer_load_dwordx4 v232, s[4:7], s39 offen offset:3072 sc1 lds
 v_mfma_f32_16x16x32_bf16 v[76:79], v[192:195], a[108:111], v[76:79]
 s_waitcnt lgkmcnt(11)
 s_xor_b32 s25, s52, 2621440
 ds_read_b128 a[140:143], v228 offset:6144
 ds_read_b64_tr_b16 v[216:217], v227 offset:49152
 v_mfma_f32_16x16x32_bf16 v[92:95], v[200:203], a[108:111], v[92:95]
 s_waitcnt lgkmcnt(11)
 s_add_u32 m0, s55, 16384
 ds_read_b64_tr_b16 v[218:219], v227 offset:51200
 v_xor_b32 v232, 128, v232
 v_mfma_f32_16x16x32_bf16 v[92:95], v[204:207], a[124:127], v[92:95]
 ds_read_b128 a[156:159], v229 offset:6144
 ds_read_b64_tr_b16 v[220:221], v227 offset:57344
 v_add_u32 v234, s25, v233
 v_mfma_f32_16x16x32_bf16 v[88:91], v[204:207], a[120:123], v[88:91]
 buffer_load_dwordx4 v234, s[8:11], s40 offen  lds
 v_mfma_f32_16x16x32_bf16 v[88:91], v[200:203], a[104:107], v[88:91]
 ds_read_b64_tr_b16 v[222:223], v227 offset:59392
 v_cvt_pk_bf16_f32 v57, v58, v59
 v_mfma_f32_16x16x32_bf16 v[84:87], v[200:203], a[100:103], v[84:87]
 v_mov_b32 v244, 0x3f803f80
 v_mov_b32 v245, 0x3f803f80
 v_mfma_f32_16x16x32_bf16 v[84:87], v[204:207], a[116:119], v[84:87]
 v_mov_b32 v246, 0x3f803f80
 v_mov_b32 v247, 0x3f803f80
 v_mfma_f32_16x16x32_bf16 v[80:83], v[204:207], a[112:115], v[80:83]
 buffer_load_dwordx4 v234, s[8:11], s41 offen offset:1024  lds
 v_mfma_f32_16x16x32_bf16 v[80:83], v[200:203], a[96:99], v[80:83]
 s_waitcnt lgkmcnt(11)
 ds_read_b64_tr_b16 v[192:193], v224 offset:53248
 v_cvt_pk_bf16_f32 v58, v60, v61
 v_mfma_f32_16x16x32_bf16 v[96:99], v[208:211], a[96:99], v[96:99]
 s_waitcnt lgkmcnt(8)
 ds_read_b64_tr_b16 v[194:195], v224 offset:55296
 v_add_u32 v249, 0, v255
 v_mfma_f32_16x16x32_bf16 v[96:99], v[212:215], a[112:115], v[96:99]
 ds_read_b64_tr_b16 v[196:197], v224 offset:61440
 v_add_u32 v250, 4096, v255
 v_mfma_f32_16x16x32_bf16 v[100:103], v[212:215], a[116:119], v[100:103]
 buffer_load_dwordx4 v234, s[8:11], s42 offen offset:2048  lds
 v_mfma_f32_16x16x32_bf16 v[100:103], v[208:211], a[100:103], v[100:103]
 ds_read_b64_tr_b16 v[198:199], v224 offset:63488
 v_add_u32 v251, 8192, v255
 v_mfma_f32_16x16x32_bf16 v[104:107], v[208:211], a[104:107], v[104:107]
 v_add_u32 v252, 12288, v255
 v_bfe_u32 v248, v255, 4, 4
 v_mfma_f32_16x16x32_bf16 v[104:107], v[212:215], a[120:123], v[104:107]
 v_cvt_pk_bf16_f32 v59, v62, v63
 v_lshrrev_b32 v237, 8, v255
 v_mfma_f32_16x16x32_bf16 v[108:111], v[212:215], a[124:127], v[108:111]
 buffer_load_dwordx4 v234, s[8:11], s43 offen offset:3072  lds
 v_mfma_f32_16x16x32_bf16 v[108:111], v[208:211], a[108:111], v[108:111]
 s_waitcnt lgkmcnt(7)
 ds_read_b64_tr_b16 v[200:201], v225 offset:53248
 v_lshlrev_b32 v237, 2, v237
 v_mfma_f32_16x16x32_bf16 v[124:127], v[216:219], a[108:111], v[124:127]
 s_waitcnt lgkmcnt(5)
 ds_read_b64_tr_b16 v[202:203], v225 offset:55296
 v_sub_u32 v248, v248, v237
 v_mfma_f32_16x16x32_bf16 v[124:127], v[220:223], a[124:127], v[124:127]
 ds_read_b64_tr_b16 v[204:205], v225 offset:61440
 v_add_u32 v248, s30, v248
 v_mfma_f32_16x16x32_bf16 v[120:123], v[220:223], a[120:123], v[120:123]
 v_mfma_f32_16x16x32_bf16 v[120:123], v[216:219], a[104:107], v[120:123]
 ds_read_b64_tr_b16 v[206:207], v225 offset:63488
 v_add_u32 v237, s31, v248
 v_mfma_f32_16x16x32_bf16 v[116:119], v[216:219], a[100:103], v[116:119]
 v_mfma_f32_16x16x32_bf16 v[116:119], v[220:223], a[116:119], v[116:119]
 v_mfma_f32_16x16x32_bf16 v[112:115], v[220:223], a[112:115], v[112:115]
 buffer_store_dwordx4 v[56:59], v255, s[4:7], s51 offen offset:3072 sc1
 v_mfma_f32_16x16x32_bf16 v[112:115], v[216:219], a[96:99], v[112:115]
 s_waitcnt lgkmcnt(4)
 ds_read_b64_tr_b16 v[208:209], v226 offset:53248
 v_mfma_f32_16x16x32_bf16 v[128:131], v[192:195], a[96:99], v[128:131]
 ds_read_b64_tr_b16 v[210:211], v226 offset:55296
 v_mfma_f32_16x16x32_bf16 v[128:131], v[196:199], a[112:115], v[128:131]
 ds_read_b64_tr_b16 v[212:213], v226 offset:61440
 v_mfma_f32_16x16x32_bf16 v[132:135], v[196:199], a[116:119], v[132:135]
 v_mfma_f32_16x16x32_bf16 v[132:135], v[192:195], a[100:103], v[132:135]
 ds_read_b64_tr_b16 v[214:215], v226 offset:63488
 v_mfma_f32_16x16x32_bf16 v[136:139], v[192:195], a[104:107], v[136:139]
 v_mfma_f32_16x16x32_bf16 v[136:139], v[196:199], a[120:123], v[136:139]
 v_mfma_f32_16x16x32_bf16 v[140:143], v[196:199], a[124:127], v[140:143]
 v_mfma_f32_16x16x32_bf16 v[140:143], v[192:195], a[108:111], v[140:143]
 s_waitcnt lgkmcnt(4)
 ds_read_b64_tr_b16 v[216:217], v227 offset:53248
 v_mfma_f32_16x16x32_bf16 v[156:159], v[200:203], a[108:111], v[156:159]
 s_add_u32 m0, s54, 0
 ds_read_b64_tr_b16 v[218:219], v227 offset:55296
 v_mfma_f32_16x16x32_bf16 v[156:159], v[204:207], a[124:127], v[156:159]
 ds_read_b64_tr_b16 v[220:221], v227 offset:61440
 v_mfma_f32_16x16x32_bf16 v[152:155], v[204:207], a[120:123], v[152:155]
 v_mfma_f32_16x16x32_bf16 v[152:155], v[200:203], a[104:107], v[152:155]
 ds_read_b64_tr_b16 v[222:223], v227 offset:63488
 v_mfma_f32_16x16x32_bf16 v[148:151], v[200:203], a[100:103], v[148:151]
 s_waitcnt vmcnt(15)
 v_mfma_f32_16x16x32_bf16 v[148:151], v[204:207], a[116:119], v[148:151]
 s_barrier
 v_mfma_f32_16x16x32_bf16 v[144:147], v[204:207], a[112:115], v[144:147]
 buffer_load_dwordx4 v232, s[4:7], s32 offen sc1 lds
 v_mfma_f32_16x16x32_bf16 v[144:147], v[200:203], a[96:99], v[144:147]
 s_waitcnt lgkmcnt(4)
 ds_read_b64_tr_b16 v[192:193], v224 offset:0
 v_mfma_f32_16x16x32_bf16 v[160:163], v[208:211], a[96:99], v[160:163]
 ds_read_b64_tr_b16 v[194:195], v224 offset:2048
 v_mfma_f32_16x16x32_bf16 v[160:163], v[212:215], a[112:115], v[160:163]
 ds_read_b64_tr_b16 v[196:197], v224 offset:8192
 v_mfma_f32_16x16x32_bf16 v[164:167], v[212:215], a[116:119], v[164:167]
 buffer_load_dwordx4 v232, s[4:7], s33 offen offset:1024 sc1 lds
 v_mfma_f32_16x16x32_bf16 v[164:167], v[208:211], a[100:103], v[164:167]
 ds_read_b64_tr_b16 v[198:199], v224 offset:10240
 v_mfma_f32_16x16x32_bf16 v[168:171], v[208:211], a[104:107], v[168:171]
 v_mfma_f32_16x16x32_bf16 v[168:171], v[212:215], a[120:123], v[168:171]
 v_mfma_f32_16x16x32_bf16 v[172:175], v[212:215], a[124:127], v[172:175]
 buffer_load_dwordx4 v232, s[4:7], s34 offen offset:2048 sc1 lds
 v_mfma_f32_16x16x32_bf16 v[172:175], v[208:211], a[108:111], v[172:175]
 s_waitcnt lgkmcnt(4)
 ds_read_b64_tr_b16 v[200:201], v225 offset:0
 v_mfma_f32_16x16x32_bf16 v[188:191], v[216:219], a[108:111], v[188:191]
 ds_read_b64_tr_b16 v[202:203], v225 offset:2048
 v_mfma_f32_16x16x32_bf16 v[188:191], v[220:223], a[124:127], v[188:191]
 ds_read_b64_tr_b16 v[204:205], v225 offset:8192
 v_mfma_f32_16x16x32_bf16 v[184:187], v[220:223], a[120:123], v[184:187]
 buffer_load_dwordx4 v232, s[4:7], s35 offen offset:3072 sc1 lds
 v_mfma_f32_16x16x32_bf16 v[184:187], v[216:219], a[104:107], v[184:187]
 s_add_u32 m0, s54, 4096
 ds_read_b64_tr_b16 v[206:207], v225 offset:10240
 v_mfma_f32_16x16x32_bf16 v[180:183], v[216:219], a[100:103], v[180:183]
 v_mfma_f32_16x16x32_bf16 v[180:183], v[220:223], a[116:119], v[180:183]
 v_mfma_f32_16x16x32_bf16 v[176:179], v[220:223], a[112:115], v[176:179]
 buffer_load_dwordx4 v232, s[4:7], s36 offen sc1 lds
 v_mfma_f32_16x16x32_bf16 v[176:179], v[216:219], a[96:99], v[176:179]
 s_waitcnt lgkmcnt(4)
 ds_read_b64_tr_b16 v[208:209], v226 offset:0
 v_mfma_f32_16x16x32_bf16 v[64:67], v[192:195], a[128:131], v[64:67]
 ds_read_b64_tr_b16 v[210:211], v226 offset:2048
 v_mfma_f32_16x16x32_bf16 v[64:67], v[196:199], a[144:147], v[64:67]
 ds_read_b64_tr_b16 v[212:213], v226 offset:8192
 v_mfma_f32_16x16x32_bf16 v[68:71], v[196:199], a[148:151], v[68:71]
 s_lshl_b32 s23, s21, 20
 buffer_load_dwordx4 v232, s[4:7], s37 offen offset:1024 sc1 lds
 v_mfma_f32_16x16x32_bf16 v[68:71], v[192:195], a[132:135], v[68:71]
 s_add_u32 s23, s23, 2031616
 ds_read_b64_tr_b16 v[214:215], v226 offset:10240
 v_mfma_f32_16x16x32_bf16 v[72:75], v[192:195], a[136:139], v[72:75]
 s_lshl_b32 s24, s22, 16
 v_accvgpr_write_b32 a0, 0
 v_mfma_f32_16x16x32_bf16 v[72:75], v[196:199], a[152:155], v[72:75]
 s_sub_u32 s14, 1114112, s24
 v_accvgpr_write_b32 a1, 0
 v_mfma_f32_16x16x32_bf16 v[76:79], v[196:199], a[156:159], v[76:79]
 buffer_load_dwordx4 v232, s[4:7], s38 offen offset:2048 sc1 lds
 v_mfma_f32_16x16x32_bf16 v[76:79], v[192:195], a[140:143], v[76:79]
 s_waitcnt lgkmcnt(4)
 ds_read_b128 a[160:163], v228 offset:32768
 ds_read_b64_tr_b16 v[216:217], v227 offset:0
 v_mfma_f32_16x16x32_bf16 v[92:95], v[200:203], a[140:143], v[92:95]
 s_add_u32 s12, s90, s23
 s_addc_u32 s13, s91, 0
 ds_read_b64_tr_b16 v[218:219], v227 offset:2048
 v_mfma_f32_16x16x32_bf16 v[92:95], v[204:207], a[156:159], v[92:95]
 ds_read_b128 a[176:179], v229 offset:32768
 ds_read_b64_tr_b16 v[220:221], v227 offset:8192
 v_mfma_f32_16x16x32_bf16 v[88:91], v[204:207], a[152:155], v[88:91]
 s_lshl_b32 s92, s20, 13
 buffer_load_dwordx4 v232, s[4:7], s39 offen offset:3072 sc1 lds
 v_mfma_f32_16x16x32_bf16 v[88:91], v[200:203], a[136:139], v[88:91]
 s_xor_b32 s25, s52, 3145728
 ds_read_b128 a[164:167], v228 offset:34816
 ds_read_b64_tr_b16 v[222:223], v227 offset:10240
 v_mfma_f32_16x16x32_bf16 v[84:87], v[200:203], a[132:135], v[84:87]
 s_add_u32 m0, s55, 32768
 v_xor_b32 v232, 896, v232
 v_accvgpr_write_b32 a2, 0
 v_mfma_f32_16x16x32_bf16 v[84:87], v[204:207], a[148:151], v[84:87]
 s_add_u32 s92, s92, 65536
 ds_read_b128 a[180:183], v229 offset:34816
 v_add_u32 v234, s25, v233
 v_mfma_f32_16x16x32_bf16 v[80:83], v[204:207], a[144:147], v[80:83]
 buffer_load_dwordx4 v234, s[8:11], s40 offen  lds
 v_mfma_f32_16x16x32_bf16 v[80:83], v[200:203], a[128:131], v[80:83]
 s_waitcnt lgkmcnt(8)
 ds_read_b128 a[168:171], v228 offset:36864
 ds_read_b64_tr_b16 v[192:193], v224 offset:4096
 v_mfma_f32_16x16x32_bf16 v[96:99], v[208:211], a[128:131], v[96:99]
 ds_read_b64_tr_b16 v[194:195], v224 offset:6144
 v_accvgpr_write_b32 a3, 0
 v_mfma_f32_16x16x32_bf16 v[96:99], v[212:215], a[144:147], v[96:99]
 ds_read_b128 a[184:187], v229 offset:36864
 ds_read_b64_tr_b16 v[196:197], v224 offset:12288
 v_mfma_f32_16x16x32_bf16 v[100:103], v[212:215], a[148:151], v[100:103]
 buffer_load_dwordx4 v234, s[8:11], s41 offen offset:1024  lds
 v_mfma_f32_16x16x32_bf16 v[100:103], v[208:211], a[132:135], v[100:103]
 ds_read_b128 a[172:175], v228 offset:38912
 ds_read_b64_tr_b16 v[198:199], v224 offset:14336
 v_mfma_f32_16x16x32_bf16 v[104:107], v[208:211], a[136:139], v[104:107]
 v_accvgpr_write_b32 a4, 0
 v_accvgpr_write_b32 a5, 0
 v_mfma_f32_16x16x32_bf16 v[104:107], v[212:215], a[152:155], v[104:107]
 ds_read_b128 a[188:191], v229 offset:38912
 v_accvgpr_write_b32 a6, 0
 v_mfma_f32_16x16x32_bf16 v[108:111], v[212:215], a[156:159], v[108:111]
 buffer_load_dwordx4 v234, s[8:11], s42 offen offset:2048  lds
 v_mfma_f32_16x16x32_bf16 v[108:111], v[208:211], a[140:143], v[108:111]
 s_waitcnt lgkmcnt(13)
 ds_read_b64_tr_b16 v[200:201], v225 offset:4096
 v_accvgpr_write_b32 a7, 0
 v_mfma_f32_16x16x32_bf16 v[124:127], v[216:219], a[140:143], v[124:127]
 s_waitcnt lgkmcnt(10)
 ds_read_b64_tr_b16 v[202:203], v225 offset:6144
 v_accvgpr_write_b32 a8, 0
 v_mfma_f32_16x16x32_bf16 v[124:127], v[220:223], a[156:159], v[124:127]
 ds_read_b64_tr_b16 v[204:205], v225 offset:12288
 v_accvgpr_write_b32 a9, 0
 v_mfma_f32_16x16x32_bf16 v[120:123], v[220:223], a[152:155], v[120:123]
 buffer_load_dwordx4 v234, s[8:11], s43 offen offset:3072  lds
 v_mfma_f32_16x16x32_bf16 v[120:123], v[216:219], a[136:139], v[120:123]
 ds_read_b64_tr_b16 v[206:207], v225 offset:14336
 v_accvgpr_write_b32 a10, 0
 v_mfma_f32_16x16x32_bf16 v[116:119], v[216:219], a[132:135], v[116:119]
 v_accvgpr_write_b32 a11, 0
 v_accvgpr_write_b32 a12, 0
 v_mfma_f32_16x16x32_bf16 v[116:119], v[220:223], a[148:151], v[116:119]
 v_accvgpr_write_b32 a13, 0
 v_accvgpr_write_b32 a14, 0
 v_mfma_f32_16x16x32_bf16 v[112:115], v[220:223], a[144:147], v[112:115]
 v_mfma_f32_16x16x32_bf16 v[112:115], v[216:219], a[128:131], v[112:115]
 s_waitcnt lgkmcnt(9)
 ds_read_b64_tr_b16 v[208:209], v226 offset:4096
 v_accvgpr_write_b32 a15, 0
 v_mfma_f32_16x16x32_bf16 v[128:131], v[192:195], a[128:131], v[128:131]
 s_waitcnt lgkmcnt(6)
 ds_read_b64_tr_b16 v[210:211], v226 offset:6144
 v_accvgpr_write_b32 a16, 0
 v_mfma_f32_16x16x32_bf16 v[128:131], v[196:199], a[144:147], v[128:131]
 ds_read_b64_tr_b16 v[212:213], v226 offset:12288
 v_accvgpr_write_b32 a17, 0
 v_mfma_f32_16x16x32_bf16 v[132:135], v[196:199], a[148:151], v[132:135]
 v_mfma_f32_16x16x32_bf16 v[132:135], v[192:195], a[132:135], v[132:135]
 ds_read_b64_tr_b16 v[214:215], v226 offset:14336
 v_accvgpr_write_b32 a18, 0
 v_mfma_f32_16x16x32_bf16 v[136:139], v[192:195], a[136:139], v[136:139]
 v_accvgpr_write_b32 a19, 0
 v_accvgpr_write_b32 a20, 0
 v_mfma_f32_16x16x32_bf16 v[136:139], v[196:199], a[152:155], v[136:139]
 v_accvgpr_write_b32 a21, 0
 v_accvgpr_write_b32 a22, 0
 v_mfma_f32_16x16x32_bf16 v[140:143], v[196:199], a[156:159], v[140:143]
 v_mfma_f32_16x16x32_bf16 v[140:143], v[192:195], a[140:143], v[140:143]
 s_waitcnt lgkmcnt(4)
 ds_read_b64_tr_b16 v[216:217], v227 offset:4096
 v_accvgpr_write_b32 a23, 0
 v_mfma_f32_16x16x32_bf16 v[156:159], v[200:203], a[140:143], v[156:159]
 ds_read_b64_tr_b16 v[218:219], v227 offset:6144
 v_accvgpr_write_b32 a24, 0
 v_mfma_f32_16x16x32_bf16 v[156:159], v[204:207], a[156:159], v[156:159]
 ds_read_b64_tr_b16 v[220:221], v227 offset:12288
 v_accvgpr_write_b32 a25, 0
 v_mfma_f32_16x16x32_bf16 v[152:155], v[204:207], a[152:155], v[152:155]
 s_xor_b32 s25, s52, 3670016
 v_mfma_f32_16x16x32_bf16 v[152:155], v[200:203], a[136:139], v[152:155]
 s_add_u32 m0, s55, 49152
 ds_read_b64_tr_b16 v[222:223], v227 offset:14336
 v_accvgpr_write_b32 a26, 0
 v_mfma_f32_16x16x32_bf16 v[148:151], v[200:203], a[132:135], v[148:151]
 s_waitcnt vmcnt(12)
 v_add_u32 v234, s25, v233
 v_accvgpr_write_b32 a27, 0
 v_mfma_f32_16x16x32_bf16 v[148:151], v[204:207], a[148:151], v[148:151]
 s_barrier
 buffer_store_dword v253, v254, s[4:7], s26 offen sc1
 v_mfma_f32_16x16x32_bf16 v[144:147], v[204:207], a[144:147], v[144:147]
 buffer_load_dwordx4 v234, s[8:11], s40 offen  lds
 v_mfma_f32_16x16x32_bf16 v[144:147], v[200:203], a[128:131], v[144:147]
 s_waitcnt lgkmcnt(4)
 ds_read_b64_tr_b16 v[192:193], v224 offset:16384
 v_accvgpr_write_b32 a28, 0
 v_mfma_f32_16x16x32_bf16 v[160:163], v[208:211], a[128:131], v[160:163]
 ds_read_b64_tr_b16 v[194:195], v224 offset:18432
 v_accvgpr_write_b32 a29, 0
 v_mfma_f32_16x16x32_bf16 v[160:163], v[212:215], a[144:147], v[160:163]
 ds_read_b64_tr_b16 v[196:197], v224 offset:24576
 v_accvgpr_write_b32 a30, 0
 v_mfma_f32_16x16x32_bf16 v[164:167], v[212:215], a[148:151], v[164:167]
 buffer_load_dwordx4 v234, s[8:11], s41 offen offset:1024  lds
 v_mfma_f32_16x16x32_bf16 v[164:167], v[208:211], a[132:135], v[164:167]
 ds_read_b64_tr_b16 v[198:199], v224 offset:26624
 v_accvgpr_write_b32 a31, 0
 v_mfma_f32_16x16x32_bf16 v[168:171], v[208:211], a[136:139], v[168:171]
 v_accvgpr_write_b32 a32, 0
 v_mfma_f32_16x16x32_bf16 v[168:171], v[212:215], a[152:155], v[168:171]
 v_accvgpr_write_b32 a33, 0
 v_mfma_f32_16x16x32_bf16 v[172:175], v[212:215], a[156:159], v[172:175]
 buffer_load_dwordx4 v234, s[8:11], s42 offen offset:2048  lds
 v_mfma_f32_16x16x32_bf16 v[172:175], v[208:211], a[140:143], v[172:175]
 s_waitcnt lgkmcnt(4)
 ds_read_b64_tr_b16 v[200:201], v225 offset:16384
 v_accvgpr_write_b32 a34, 0
 v_mfma_f32_16x16x32_bf16 v[188:191], v[216:219], a[140:143], v[188:191]
 ds_read_b64_tr_b16 v[202:203], v225 offset:18432
 v_accvgpr_write_b32 a35, 0
 v_mfma_f32_16x16x32_bf16 v[188:191], v[220:223], a[156:159], v[188:191]
 ds_read_b64_tr_b16 v[204:205], v225 offset:24576
 v_mfma_f32_16x16x32_bf16 v[184:187], v[220:223], a[152:155], v[184:187]
 buffer_load_dwordx4 v234, s[8:11], s43 offen offset:3072  lds
 v_mfma_f32_16x16x32_bf16 v[184:187], v[216:219], a[136:139], v[184:187]
 ds_read_b64_tr_b16 v[206:207], v225 offset:26624
 v_accvgpr_write_b32 a36, 0
 v_mfma_f32_16x16x32_bf16 v[180:183], v[216:219], a[132:135], v[180:183]
 v_accvgpr_write_b32 a37, 0
 v_mfma_f32_16x16x32_bf16 v[180:183], v[220:223], a[148:151], v[180:183]
 v_accvgpr_write_b32 a38, 0
 v_mfma_f32_16x16x32_bf16 v[176:179], v[220:223], a[144:147], v[176:179]
 v_mfma_f32_16x16x32_bf16 v[176:179], v[216:219], a[128:131], v[176:179]
 s_waitcnt lgkmcnt(4)
 ds_read_b64_tr_b16 v[208:209], v226 offset:16384
 v_accvgpr_write_b32 a39, 0
 v_mfma_f32_16x16x32_bf16 v[64:67], v[192:195], a[160:163], v[64:67]
 ds_read_b64_tr_b16 v[210:211], v226 offset:18432
 v_accvgpr_write_b32 a40, 0
 v_mfma_f32_16x16x32_bf16 v[64:67], v[196:199], a[176:179], v[64:67]
 ds_read_b64_tr_b16 v[212:213], v226 offset:24576
 v_accvgpr_write_b32 a41, 0
 v_mfma_f32_16x16x32_bf16 v[68:71], v[196:199], a[180:183], v[68:71]
 v_mfma_f32_16x16x32_bf16 v[68:71], v[192:195], a[164:167], v[68:71]
 ds_read_b64_tr_b16 v[214:215], v226 offset:26624
 v_accvgpr_write_b32 a42, 0
 v_mfma_f32_16x16x32_bf16 v[72:75], v[192:195], a[168:171], v[72:75]
 v_accvgpr_write_b32 a43, 0
 v_mfma_f32_16x16x32_bf16 v[72:75], v[196:199], a[184:187], v[72:75]
 v_mfma_f32_16x16x32_bf16 v[76:79], v[196:199], a[188:191], v[76:79]
 v_mfma_f32_16x16x32_bf16 v[76:79], v[192:195], a[172:175], v[76:79]
 s_waitcnt lgkmcnt(4)
 ds_read_b64_tr_b16 v[216:217], v227 offset:16384
 v_accvgpr_write_b32 a44, 0
 v_mfma_f32_16x16x32_bf16 v[92:95], v[200:203], a[172:175], v[92:95]
 ds_read_b64_tr_b16 v[218:219], v227 offset:18432
 v_accvgpr_write_b32 a45, 0
 v_mfma_f32_16x16x32_bf16 v[92:95], v[204:207], a[188:191], v[92:95]
 ds_read_b64_tr_b16 v[220:221], v227 offset:24576
 v_accvgpr_write_b32 a46, 0
 v_mfma_f32_16x16x32_bf16 v[88:91], v[204:207], a[184:187], v[88:91]
 v_mfma_f32_16x16x32_bf16 v[88:91], v[200:203], a[168:171], v[88:91]
 ds_read_b64_tr_b16 v[222:223], v227 offset:26624
 v_accvgpr_write_b32 a47, 0
 v_mfma_f32_16x16x32_bf16 v[84:87], v[200:203], a[164:167], v[84:87]
 v_accvgpr_write_b32 a48, 0
 v_mfma_f32_16x16x32_bf16 v[84:87], v[204:207], a[180:183], v[84:87]
 ds_read_b128 a[192:195], v230 offset:0
 v_accvgpr_write_b32 a49, 0
 v_mfma_f32_16x16x32_bf16 v[80:83], v[204:207], a[176:179], v[80:83]
 v_mfma_f32_16x16x32_bf16 v[80:83], v[200:203], a[160:163], v[80:83]
 s_waitcnt lgkmcnt(5)
 ds_read_b128 a[208:211], v231 offset:0
 ds_read_b64_tr_b16 v[192:193], v224 offset:20480
 v_mfma_f32_16x16x32_bf16 v[96:99], v[208:211], a[160:163], v[96:99]
 ds_read_b64_tr_b16 v[194:195], v224 offset:22528
 v_accvgpr_write_b32 a50, 0
 s_getpc_b64 s[28:29]
Lpc8:
 s_add_u32 s28, s28, Lround2-Lpc8
 s_addc_u32 s29, s29, 0
 v_mfma_f32_16x16x32_bf16 v[96:99], v[212:215], a[176:179], v[96:99]
 s_bfe_u32 s30, s2, 0x30003
 ds_read_b128 a[196:199], v230 offset:2048
 ds_read_b64_tr_b16 v[196:197], v224 offset:28672
 v_mfma_f32_16x16x32_bf16 v[100:103], v[212:215], a[180:183], v[100:103]
 s_lshl_b32 s30, s30, 2
 v_mfma_f32_16x16x32_bf16 v[100:103], v[208:211], a[164:167], v[100:103]
 s_add_u32 s30, s30, s20
 ds_read_b128 a[212:215], v231 offset:2048
 ds_read_b64_tr_b16 v[198:199], v224 offset:30720
 v_mfma_f32_16x16x32_bf16 v[104:107], v[208:211], a[168:171], v[104:107]
 s_mul_i32 s30, s30, 2048
 v_accvgpr_write_b32 a51, 0
 v_accvgpr_write_b32 a52, 0
 v_mfma_f32_16x16x32_bf16 v[104:107], v[212:215], a[184:187], v[104:107]
 ds_read_b128 a[200:203], v230 offset:4096
 v_accvgpr_write_b32 a53, 0
 v_mfma_f32_16x16x32_bf16 v[108:111], v[212:215], a[188:191], v[108:111]
 v_mfma_f32_16x16x32_bf16 v[108:111], v[208:211], a[172:175], v[108:111]
 s_waitcnt lgkmcnt(9)
 ds_read_b128 a[216:219], v231 offset:4096
 ds_read_b64_tr_b16 v[200:201], v225 offset:20480
 v_mfma_f32_16x16x32_bf16 v[124:127], v[216:219], a[172:175], v[124:127]
 ds_read_b64_tr_b16 v[202:203], v225 offset:22528
 v_accvgpr_write_b32 a54, 0
 v_mfma_f32_16x16x32_bf16 v[124:127], v[220:223], a[188:191], v[124:127]
 ds_read_b128 a[204:207], v230 offset:6144
 ds_read_b64_tr_b16 v[204:205], v225 offset:28672
 v_mfma_f32_16x16x32_bf16 v[120:123], v[220:223], a[184:187], v[120:123]
 v_mfma_f32_16x16x32_bf16 v[120:123], v[216:219], a[168:171], v[120:123]
 ds_read_b128 a[220:223], v231 offset:6144
 ds_read_b64_tr_b16 v[206:207], v225 offset:30720
 v_mfma_f32_16x16x32_bf16 v[116:119], v[216:219], a[164:167], v[116:119]
 v_accvgpr_write_b32 a55, 0
 v_accvgpr_write_b32 a56, 0
 v_mfma_f32_16x16x32_bf16 v[116:119], v[220:223], a[180:183], v[116:119]
 v_accvgpr_write_b32 a57, 0
 v_accvgpr_write_b32 a58, 0
 v_mfma_f32_16x16x32_bf16 v[112:115], v[220:223], a[176:179], v[112:115]
 v_mfma_f32_16x16x32_bf16 v[112:115], v[216:219], a[160:163], v[112:115]
 s_waitcnt lgkmcnt(12)
 ds_read_b64_tr_b16 v[208:209], v226 offset:20480
 v_accvgpr_write_b32 a59, 0
 v_mfma_f32_16x16x32_bf16 v[128:131], v[192:195], a[160:163], v[128:131]
 s_waitcnt lgkmcnt(9)
 ds_read_b64_tr_b16 v[210:211], v226 offset:22528
 v_accvgpr_write_b32 a60, 0
 v_mfma_f32_16x16x32_bf16 v[128:131], v[196:199], a[176:179], v[128:131]
 ds_read_b64_tr_b16 v[212:213], v226 offset:28672
 v_accvgpr_write_b32 a61, 0
 v_mfma_f32_16x16x32_bf16 v[132:135], v[196:199], a[180:183], v[132:135]
 v_mfma_f32_16x16x32_bf16 v[132:135], v[192:195], a[164:167], v[132:135]
 ds_read_b64_tr_b16 v[214:215], v226 offset:30720
 v_accvgpr_write_b32 a62, 0
 v_mfma_f32_16x16x32_bf16 v[136:139], v[192:195], a[168:171], v[136:139]
 v_accvgpr_write_b32 a63, 0
 v_accvgpr_write_b32 a64, 0
 v_mfma_f32_16x16x32_bf16 v[136:139], v[196:199], a[184:187], v[136:139]
 v_accvgpr_write_b32 a65, 0
 v_and_b32 v234, 240, v255
 v_mfma_f32_16x16x32_bf16 v[140:143], v[196:199], a[188:191], v[140:143]
 v_mfma_f32_16x16x32_bf16 v[140:143], v[192:195], a[172:175], v[140:143]
 s_waitcnt lgkmcnt(8)
 ds_read_b64_tr_b16 v[216:217], v227 offset:20480
 v_accvgpr_write_b32 a66, 0
 v_mfma_f32_16x16x32_bf16 v[156:159], v[200:203], a[172:175], v[156:159]
 s_waitcnt lgkmcnt(5)
 ds_read_b64_tr_b16 v[218:219], v227 offset:22528
 v_accvgpr_write_b32 a67, 0
 v_mfma_f32_16x16x32_bf16 v[156:159], v[204:207], a[188:191], v[156:159]
 ds_read_b64_tr_b16 v[220:221], v227 offset:28672
 v_lshl_add_u32 v234, v234, 3, s30
 v_mfma_f32_16x16x32_bf16 v[152:155], v[204:207], a[184:187], v[152:155]
 global_load_dword v234, v234, s[28:29]
 v_mfma_f32_16x16x32_bf16 v[152:155], v[200:203], a[168:171], v[152:155]
 ds_read_b64_tr_b16 v[222:223], v227 offset:30720
 v_accvgpr_write_b32 a68, 0
 v_mfma_f32_16x16x32_bf16 v[148:151], v[200:203], a[164:167], v[148:151]
 s_waitcnt vmcnt(6)
 v_accvgpr_write_b32 a69, 0
 v_mfma_f32_16x16x32_bf16 v[148:151], v[204:207], a[180:183], v[148:151]
 s_barrier
 v_accvgpr_write_b32 a70, 0
 v_mfma_f32_16x16x32_bf16 v[144:147], v[204:207], a[176:179], v[144:147]
 v_mfma_f32_16x16x32_bf16 v[144:147], v[200:203], a[160:163], v[144:147]
 s_waitcnt lgkmcnt(4)
 ds_read_b64_tr_b16 v[192:193], v224 offset:32768
 v_accvgpr_write_b32 a71, 0
 v_mfma_f32_16x16x32_bf16 v[160:163], v[208:211], a[160:163], v[160:163]
 ds_read_b64_tr_b16 v[194:195], v224 offset:34816
 v_accvgpr_write_b32 a72, 0
 v_mfma_f32_16x16x32_bf16 v[160:163], v[212:215], a[176:179], v[160:163]
 ds_read_b64_tr_b16 v[196:197], v224 offset:40960
 v_accvgpr_write_b32 a73, 0
 v_mfma_f32_16x16x32_bf16 v[164:167], v[212:215], a[180:183], v[164:167]
 v_mfma_f32_16x16x32_bf16 v[164:167], v[208:211], a[164:167], v[164:167]
 ds_read_b64_tr_b16 v[198:199], v224 offset:43008
 v_accvgpr_write_b32 a74, 0
 v_mfma_f32_16x16x32_bf16 v[168:171], v[208:211], a[168:171], v[168:171]
 v_accvgpr_write_b32 a75, 0
 v_mfma_f32_16x16x32_bf16 v[168:171], v[212:215], a[184:187], v[168:171]
 v_mfma_f32_16x16x32_bf16 v[172:175], v[212:215], a[188:191], v[172:175]
 v_mfma_f32_16x16x32_bf16 v[172:175], v[208:211], a[172:175], v[172:175]
 s_waitcnt lgkmcnt(4)
 ds_read_b64_tr_b16 v[200:201], v225 offset:32768
 v_accvgpr_write_b32 a76, 0
 v_mfma_f32_16x16x32_bf16 v[188:191], v[216:219], a[172:175], v[188:191]
 ds_read_b64_tr_b16 v[202:203], v225 offset:34816
 v_accvgpr_write_b32 a77, 0
 v_mfma_f32_16x16x32_bf16 v[188:191], v[220:223], a[188:191], v[188:191]
 ds_read_b64_tr_b16 v[204:205], v225 offset:40960
 v_accvgpr_write_b32 a78, 0
 v_mfma_f32_16x16x32_bf16 v[184:187], v[220:223], a[184:187], v[184:187]
 v_mfma_f32_16x16x32_bf16 v[184:187], v[216:219], a[168:171], v[184:187]
 ds_read_b64_tr_b16 v[206:207], v225 offset:43008
 v_accvgpr_write_b32 a79, 0
 v_mfma_f32_16x16x32_bf16 v[180:183], v[216:219], a[164:167], v[180:183]
Lw3_2:
 s_cbranch_execz Lw3_6
 v_accvgpr_write_b32 a80, 0
 v_mfma_f32_16x16x32_bf16 v[180:183], v[220:223], a[180:183], v[180:183]
 v_accvgpr_write_b32 a81, 0
 v_mfma_f32_16x16x32_bf16 v[176:179], v[220:223], a[176:179], v[176:179]
 v_mfma_f32_16x16x32_bf16 v[176:179], v[216:219], a[160:163], v[176:179]
 s_waitcnt lgkmcnt(4)
 ds_read_b64_tr_b16 v[208:209], v226 offset:32768
 v_accvgpr_write_b32 a82, 0
 v_mfma_f32_16x16x32_bf16 v[64:67], v[192:195], a[192:195], v[64:67]
 ds_read_b64_tr_b16 v[210:211], v226 offset:34816
 v_accvgpr_write_b32 a83, 0
 v_mfma_f32_16x16x32_bf16 v[64:67], v[196:199], a[208:211], v[64:67]
 ds_read_b128 a[224:227], v228 offset:0
 ds_read_b64_tr_b16 v[212:213], v226 offset:40960
 v_mfma_f32_16x16x32_bf16 v[68:71], v[196:199], a[212:215], v[68:71]
 v_mfma_f32_16x16x32_bf16 v[68:71], v[192:195], a[196:199], v[68:71]
 ds_read_b128 a[240:243], v229 offset:0
 ds_read_b64_tr_b16 v[214:215], v226 offset:43008
 v_mfma_f32_16x16x32_bf16 v[72:75], v[192:195], a[200:203], v[72:75]
 v_accvgpr_write_b32 a84, 0
 v_accvgpr_write_b32 a85, 0
 v_mfma_f32_16x16x32_bf16 v[72:75], v[196:199], a[216:219], v[72:75]
 ds_read_b128 a[228:231], v228 offset:2048
 v_accvgpr_write_b32 a86, 0
 v_mfma_f32_16x16x32_bf16 v[76:79], v[196:199], a[220:223], v[76:79]
 v_mfma_f32_16x16x32_bf16 v[76:79], v[192:195], a[204:207], v[76:79]
 s_waitcnt lgkmcnt(7)
 ds_read_b128 a[244:247], v229 offset:2048
 ds_read_b64_tr_b16 v[216:217], v227 offset:32768
 v_mfma_f32_16x16x32_bf16 v[92:95], v[200:203], a[204:207], v[92:95]
 ds_read_b64_tr_b16 v[218:219], v227 offset:34816
 v_accvgpr_write_b32 a87, 0
 v_mfma_f32_16x16x32_bf16 v[92:95], v[204:207], a[220:223], v[92:95]
 ds_read_b128 a[232:235], v228 offset:4096
 ds_read_b64_tr_b16 v[220:221], v227 offset:40960
 v_mfma_f32_16x16x32_bf16 v[88:91], v[204:207], a[216:219], v[88:91]
 buffer_load_dword v235, v236, s[4:7], 0 offen sc1
 v_mfma_f32_16x16x32_bf16 v[88:91], v[200:203], a[200:203], v[88:91]
 ds_read_b128 a[248:251], v229 offset:4096
 ds_read_b64_tr_b16 v[222:223], v227 offset:43008
 v_mfma_f32_16x16x32_bf16 v[84:87], v[200:203], a[196:199], v[84:87]
 v_accvgpr_write_b32 a88, 0
 v_accvgpr_write_b32 a89, 0
 v_mfma_f32_16x16x32_bf16 v[84:87], v[204:207], a[212:215], v[84:87]
 ds_read_b128 a[236:239], v228 offset:6144
 v_accvgpr_write_b32 a90, 0
 v_mfma_f32_16x16x32_bf16 v[80:83], v[204:207], a[208:211], v[80:83]
 v_mfma_f32_16x16x32_bf16 v[80:83], v[200:203], a[192:195], v[80:83]
 s_waitcnt lgkmcnt(13)
 ds_read_b128 a[252:255], v229 offset:6144
 ds_read_b64_tr_b16 v[192:193], v224 offset:36864
 v_mfma_f32_16x16x32_bf16 v[96:99], v[208:211], a[192:195], v[96:99]
 s_waitcnt lgkmcnt(11)
 ds_read_b64_tr_b16 v[194:195], v224 offset:38912
 v_accvgpr_write_b32 a91, 0
 v_mfma_f32_16x16x32_bf16 v[96:99], v[212:215], a[208:211], v[96:99]
 ds_read_b64_tr_b16 v[196:197], v224 offset:45056
 v_accvgpr_write_b32 a92, 0
 v_mfma_f32_16x16x32_bf16 v[100:103], v[212:215], a[212:215], v[100:103]
 v_mfma_f32_16x16x32_bf16 v[100:103], v[208:211], a[196:199], v[100:103]
 ds_read_b64_tr_b16 v[198:199], v224 offset:47104
 v_accvgpr_write_b32 a93, 0
 v_mfma_f32_16x16x32_bf16 v[104:107], v[208:211], a[200:203], v[104:107]
 v_accvgpr_write_b32 a94, 0
 v_accvgpr_write_b32 a95, 0
 v_mfma_f32_16x16x32_bf16 v[104:107], v[212:215], a[216:219], v[104:107]
 v_accvgpr_write_b32 a96, 0
 v_accvgpr_write_b32 a97, 0
 v_mfma_f32_16x16x32_bf16 v[108:111], v[212:215], a[220:223], v[108:111]
 v_mfma_f32_16x16x32_bf16 v[108:111], v[208:211], a[204:207], v[108:111]
 s_waitcnt lgkmcnt(10)
 ds_read_b64_tr_b16 v[200:201], v225 offset:36864
 v_accvgpr_write_b32 a98, 0
 v_mfma_f32_16x16x32_bf16 v[124:127], v[216:219], a[204:207], v[124:127]
 s_waitcnt lgkmcnt(7)
 ds_read_b64_tr_b16 v[202:203], v225 offset:38912
 v_accvgpr_write_b32 a99, 0
 v_mfma_f32_16x16x32_bf16 v[124:127], v[220:223], a[220:223], v[124:127]
 ds_read_b64_tr_b16 v[204:205], v225 offset:45056
 v_mfma_f32_16x16x32_bf16 v[120:123], v[220:223], a[216:219], v[120:123]
 v_mfma_f32_16x16x32_bf16 v[120:123], v[216:219], a[200:203], v[120:123]
 ds_read_b64_tr_b16 v[206:207], v225 offset:47104
 v_accvgpr_write_b32 a100, 0
 v_mfma_f32_16x16x32_bf16 v[116:119], v[216:219], a[196:199], v[116:119]
 v_accvgpr_write_b32 a101, 0
 v_mfma_f32_16x16x32_bf16 v[116:119], v[220:223], a[212:215], v[116:119]
 v_accvgpr_write_b32 a102, 0
 v_mfma_f32_16x16x32_bf16 v[112:115], v[220:223], a[208:211], v[112:115]
 v_mfma_f32_16x16x32_bf16 v[112:115], v[216:219], a[192:195], v[112:115]
 s_waitcnt lgkmcnt(4)
 ds_read_b64_tr_b16 v[208:209], v226 offset:36864
 v_accvgpr_write_b32 a103, 0
 v_mfma_f32_16x16x32_bf16 v[128:131], v[192:195], a[192:195], v[128:131]
 ds_read_b64_tr_b16 v[210:211], v226 offset:38912
 v_accvgpr_write_b32 a104, 0
 v_mfma_f32_16x16x32_bf16 v[128:131], v[196:199], a[208:211], v[128:131]
 ds_read_b64_tr_b16 v[212:213], v226 offset:45056
 v_accvgpr_write_b32 a105, 0
 v_mfma_f32_16x16x32_bf16 v[132:135], v[196:199], a[212:215], v[132:135]
 v_mfma_f32_16x16x32_bf16 v[132:135], v[192:195], a[196:199], v[132:135]
 ds_read_b64_tr_b16 v[214:215], v226 offset:47104
 v_accvgpr_write_b32 a106, 0
 v_mfma_f32_16x16x32_bf16 v[136:139], v[192:195], a[200:203], v[136:139]
 v_accvgpr_write_b32 a107, 0
 v_mfma_f32_16x16x32_bf16 v[136:139], v[196:199], a[216:219], v[136:139]
 v_mfma_f32_16x16x32_bf16 v[140:143], v[196:199], a[220:223], v[140:143]
 v_mfma_f32_16x16x32_bf16 v[140:143], v[192:195], a[204:207], v[140:143]
 s_waitcnt lgkmcnt(4)
 ds_read_b64_tr_b16 v[216:217], v227 offset:36864
 v_accvgpr_write_b32 a108, 0
 v_mfma_f32_16x16x32_bf16 v[156:159], v[200:203], a[204:207], v[156:159]
 ds_read_b64_tr_b16 v[218:219], v227 offset:38912
 v_accvgpr_write_b32 a109, 0
 v_mfma_f32_16x16x32_bf16 v[156:159], v[204:207], a[220:223], v[156:159]
 ds_read_b64_tr_b16 v[220:221], v227 offset:45056
 v_accvgpr_write_b32 a110, 0
 v_mfma_f32_16x16x32_bf16 v[152:155], v[204:207], a[216:219], v[152:155]
 v_mfma_f32_16x16x32_bf16 v[152:155], v[200:203], a[200:203], v[152:155]
 ds_read_b64_tr_b16 v[222:223], v227 offset:47104
 v_accvgpr_write_b32 a111, 0
 v_mfma_f32_16x16x32_bf16 v[148:151], v[200:203], a[196:199], v[148:151]
 s_waitcnt vmcnt(0)
 v_accvgpr_write_b32 a112, 0
 v_mfma_f32_16x16x32_bf16 v[148:151], v[204:207], a[212:215], v[148:151]
 s_barrier
 v_accvgpr_write_b32 a113, 0
 v_cmp_gt_u32 vcc, 1, v235
 s_nop 1
 s_cbranch_vccnz Lspin6
Lback7:
 v_mfma_f32_16x16x32_bf16 v[144:147], v[204:207], a[208:211], v[144:147]
 s_and_b32 m0, s92, 0x1ffff
 v_mfma_f32_16x16x32_bf16 v[144:147], v[200:203], a[192:195], v[144:147]
 s_waitcnt lgkmcnt(4)
 ds_read_b64_tr_b16 v[192:193], v224 offset:49152
 v_accvgpr_write_b32 a114, 0
 v_mfma_f32_16x16x32_bf16 v[160:163], v[208:211], a[192:195], v[160:163]
 ds_read_b64_tr_b16 v[194:195], v224 offset:51200
 v_accvgpr_write_b32 a115, 0
 v_mfma_f32_16x16x32_bf16 v[160:163], v[212:215], a[208:211], v[160:163]
 ds_read_b64_tr_b16 v[196:197], v224 offset:57344
 v_mfma_f32_16x16x32_bf16 v[164:167], v[212:215], a[212:215], v[164:167]
 buffer_load_dwordx4 v255, s[12:15], s92 offen sc1 lds
 v_mfma_f32_16x16x32_bf16 v[164:167], v[208:211], a[196:199], v[164:167]
 ds_read_b64_tr_b16 v[198:199], v224 offset:59392
 v_accvgpr_write_b32 a116, 0
 v_mfma_f32_16x16x32_bf16 v[168:171], v[208:211], a[200:203], v[168:171]
 v_accvgpr_write_b32 a117, 0
 v_subrev_u32 v0, 0, v237
 v_mfma_f32_16x16x32_bf16 v[168:171], v[212:215], a[216:219], v[168:171]
 v_accvgpr_write_b32 a118, 0
 v_ashrrev_i32 v0, 31, v0
 v_mfma_f32_16x16x32_bf16 v[172:175], v[212:215], a[220:223], v[172:175]
 buffer_load_dwordx4 v255, s[12:15], s92 offen offset:1024 sc1 lds
 v_mfma_f32_16x16x32_bf16 v[172:175], v[208:211], a[204:207], v[172:175]
 s_waitcnt lgkmcnt(4)
 ds_read_b64_tr_b16 v[200:201], v225 offset:49152
 v_accvgpr_write_b32 a119, 0
 v_mfma_f32_16x16x32_bf16 v[188:191], v[216:219], a[204:207], v[188:191]
 ds_read_b64_tr_b16 v[202:203], v225 offset:51200
 v_accvgpr_write_b32 a120, 0
 v_mfma_f32_16x16x32_bf16 v[188:191], v[220:223], a[220:223], v[188:191]
 ds_read_b64_tr_b16 v[204:205], v225 offset:57344
 v_accvgpr_write_b32 a121, 0
 v_mfma_f32_16x16x32_bf16 v[184:187], v[220:223], a[216:219], v[184:187]
 buffer_load_dwordx4 v255, s[12:15], s92 offen offset:2048 sc1 lds
 v_mfma_f32_16x16x32_bf16 v[184:187], v[216:219], a[200:203], v[184:187]
 ds_read_b64_tr_b16 v[206:207], v225 offset:59392
 v_accvgpr_write_b32 a122, 0
 v_mfma_f32_16x16x32_bf16 v[180:183], v[216:219], a[196:199], v[180:183]
 v_accvgpr_write_b32 a123, 0
 v_and_b32 v0, 0xf149f2ca, v0
 v_mfma_f32_16x16x32_bf16 v[180:183], v[220:223], a[212:215], v[180:183]
 v_subrev_u32 v1, 1, v237
 v_ashrrev_i32 v1, 31, v1
 v_mfma_f32_16x16x32_bf16 v[176:179], v[220:223], a[208:211], v[176:179]
 buffer_load_dwordx4 v255, s[12:15], s92 offen offset:3072 sc1 lds
 v_mfma_f32_16x16x32_bf16 v[176:179], v[216:219], a[192:195], v[176:179]
 s_waitcnt lgkmcnt(4)
 s_add_u32 s92, s92, 4096
 ds_read_b64_tr_b16 v[208:209], v226 offset:49152
 v_accvgpr_write_b32 a124, 0
 v_mfma_f32_16x16x32_bf16 v[64:67], v[192:195], a[224:227], v[64:67]
 s_and_b32 m0, s92, 0x1ffff
 ds_read_b64_tr_b16 v[210:211], v226 offset:51200
 v_accvgpr_write_b32 a125, 0
 v_mfma_f32_16x16x32_bf16 v[64:67], v[196:199], a[240:243], v[64:67]
 ds_read_b64_tr_b16 v[212:213], v226 offset:57344
 v_accvgpr_write_b32 a126, 0
 v_mfma_f32_16x16x32_bf16 v[68:71], v[196:199], a[244:247], v[68:71]
 buffer_load_dwordx4 v255, s[12:15], s92 offen sc1 lds
 v_mfma_f32_16x16x32_bf16 v[68:71], v[192:195], a[228:231], v[68:71]
 ds_read_b64_tr_b16 v[214:215], v226 offset:59392
 v_accvgpr_write_b32 a127, 0
 v_mfma_f32_16x16x32_bf16 v[72:75], v[192:195], a[232:235], v[72:75]
 v_and_b32 v1, 0xf149f2ca, v1
 v_subrev_u32 v2, 2, v237
 v_mfma_f32_16x16x32_bf16 v[72:75], v[196:199], a[248:251], v[72:75]
 v_ashrrev_i32 v2, 31, v2
 v_and_b32 v2, 0xf149f2ca, v2
 v_mfma_f32_16x16x32_bf16 v[76:79], v[196:199], a[252:255], v[76:79]
 buffer_load_dwordx4 v255, s[12:15], s92 offen offset:1024 sc1 lds
 v_mfma_f32_16x16x32_bf16 v[76:79], v[192:195], a[236:239], v[76:79]
 s_waitcnt lgkmcnt(4)
 ds_read_b64_tr_b16 v[216:217], v227 offset:49152
 v_subrev_u32 v3, 3, v237
 v_mfma_f32_16x16x32_bf16 v[92:95], v[200:203], a[236:239], v[92:95]
 ds_read_b64_tr_b16 v[218:219], v227 offset:51200
 v_ashrrev_i32 v3, 31, v3
 v_mfma_f32_16x16x32_bf16 v[92:95], v[204:207], a[252:255], v[92:95]
 ds_read_b64_tr_b16 v[220:221], v227 offset:57344
 v_and_b32 v3, 0xf149f2ca, v3
 v_mfma_f32_16x16x32_bf16 v[88:91], v[204:207], a[248:251], v[88:91]
 buffer_load_dwordx4 v255, s[12:15], s92 offen offset:2048 sc1 lds
 v_mfma_f32_16x16x32_bf16 v[88:91], v[200:203], a[232:235], v[88:91]
 ds_read_b64_tr_b16 v[222:223], v227 offset:59392
 v_mfma_f32_16x16x32_bf16 v[84:87], v[200:203], a[228:231], v[84:87]
 v_mfma_f32_16x16x32_bf16 v[84:87], v[204:207], a[244:247], v[84:87]
 v_mfma_f32_16x16x32_bf16 v[80:83], v[204:207], a[240:243], v[80:83]
 buffer_load_dwordx4 v255, s[12:15], s92 offen offset:3072 sc1 lds
 v_mfma_f32_16x16x32_bf16 v[80:83], v[200:203], a[224:227], v[80:83]
 s_waitcnt lgkmcnt(4)
 s_add_u32 s92, s92, 28672
 ds_read_b64_tr_b16 v[192:193], v224 offset:53248
 v_mfma_f32_16x16x32_bf16 v[96:99], v[208:211], a[224:227], v[96:99]
 s_and_b32 m0, s92, 0x1ffff
 ds_read_b64_tr_b16 v[194:195], v224 offset:55296
 v_mfma_f32_16x16x32_bf16 v[96:99], v[212:215], a[240:243], v[96:99]
 ds_read_b64_tr_b16 v[196:197], v224 offset:61440
 v_mfma_f32_16x16x32_bf16 v[100:103], v[212:215], a[244:247], v[100:103]
 buffer_load_dwordx4 v255, s[12:15], s92 offen sc1 lds
 v_mfma_f32_16x16x32_bf16 v[100:103], v[208:211], a[228:231], v[100:103]
 ds_read_b64_tr_b16 v[198:199], v224 offset:63488
 v_mfma_f32_16x16x32_bf16 v[104:107], v[208:211], a[232:235], v[104:107]
 v_cvt_pk_bf16_f32 v64, v64, v65
 v_cvt_pk_bf16_f32 v65, v66, v67
 v_mfma_f32_16x16x32_bf16 v[104:107], v[212:215], a[248:251], v[104:107]
 v_cvt_pk_bf16_f32 v66, v80, v81
 v_cvt_pk_bf16_f32 v67, v82, v83
 v_mfma_f32_16x16x32_bf16 v[108:111], v[212:215], a[252:255], v[108:111]
 buffer_load_dwordx4 v255, s[12:15], s92 offen offset:1024 sc1 lds
 v_accvgpr_write_b32 a128, v64
 v_mfma_f32_16x16x32_bf16 v[108:111], v[208:211], a[236:239], v[108:111]
 s_waitcnt lgkmcnt(4)
 ds_read_b64_tr_b16 v[200:201], v225 offset:53248
 v_accvgpr_write_b32 a129, v65
 v_mfma_f32_16x16x32_bf16 v[124:127], v[216:219], a[236:239], v[124:127]
 ds_read_b64_tr_b16 v[202:203], v225 offset:55296
 v_accvgpr_write_b32 a130, v66
 v_mfma_f32_16x16x32_bf16 v[124:127], v[220:223], a[252:255], v[124:127]
 ds_read_b64_tr_b16 v[204:205], v225 offset:61440
 v_accvgpr_write_b32 a131, v67
 v_mfma_f32_16x16x32_bf16 v[120:123], v[220:223], a[248:251], v[120:123]
 buffer_load_dwordx4 v255, s[12:15], s92 offen offset:2048 sc1 lds
 v_cvt_pk_bf16_f32 v68, v68, v69
 v_mfma_f32_16x16x32_bf16 v[120:123], v[216:219], a[232:235], v[120:123]
 ds_read_b64_tr_b16 v[206:207], v225 offset:63488
 v_cvt_pk_bf16_f32 v69, v70, v71
 v_mfma_f32_16x16x32_bf16 v[116:119], v[216:219], a[228:231], v[116:119]
 v_cvt_pk_bf16_f32 v70, v84, v85
 v_cvt_pk_bf16_f32 v71, v86, v87
 v_mfma_f32_16x16x32_bf16 v[116:119], v[220:223], a[244:247], v[116:119]
 v_accvgpr_write_b32 a144, v68
 v_accvgpr_write_b32 a145, v69
 v_mfma_f32_16x16x32_bf16 v[112:115], v[220:223], a[240:243], v[112:115]
 buffer_load_dwordx4 v255, s[12:15], s92 offen offset:3072 sc1 lds
 v_accvgpr_write_b32 a146, v70
 v_mfma_f32_16x16x32_bf16 v[112:115], v[216:219], a[224:227], v[112:115]
 s_waitcnt lgkmcnt(4)
 s_add_u32 s92, s92, 4096
 ds_read_b64_tr_b16 v[208:209], v226 offset:53248
 v_accvgpr_write_b32 a147, v71
 v_mfma_f32_16x16x32_bf16 v[128:131], v[192:195], a[224:227], v[128:131]
 s_and_b32 m0, s92, 0x1ffff
 ds_read_b64_tr_b16 v[210:211], v226 offset:55296
 v_cvt_pk_bf16_f32 v72, v72, v73
 v_mfma_f32_16x16x32_bf16 v[128:131], v[196:199], a[240:243], v[128:131]
 ds_read_b64_tr_b16 v[212:213], v226 offset:61440
 v_cvt_pk_bf16_f32 v73, v74, v75
 v_mfma_f32_16x16x32_bf16 v[132:135], v[196:199], a[244:247], v[132:135]
 buffer_load_dwordx4 v255, s[12:15], s92 offen sc1 lds
 v_cvt_pk_bf16_f32 v74, v88, v89
 v_mfma_f32_16x16x32_bf16 v[132:135], v[192:195], a[228:231], v[132:135]
 ds_read_b64_tr_b16 v[214:215], v226 offset:63488
 v_cvt_pk_bf16_f32 v75, v90, v91
 v_mfma_f32_16x16x32_bf16 v[136:139], v[192:195], a[232:235], v[136:139]
 v_accvgpr_write_b32 a160, v72
 v_accvgpr_write_b32 a161, v73
 v_mfma_f32_16x16x32_bf16 v[136:139], v[196:199], a[248:251], v[136:139]
 v_accvgpr_write_b32 a162, v74
 v_accvgpr_write_b32 a163, v75
 v_mfma_f32_16x16x32_bf16 v[140:143], v[196:199], a[252:255], v[140:143]
 buffer_load_dwordx4 v255, s[12:15], s92 offen offset:1024 sc1 lds
 v_cvt_pk_bf16_f32 v76, v76, v77
 v_mfma_f32_16x16x32_bf16 v[140:143], v[192:195], a[236:239], v[140:143]
 s_waitcnt lgkmcnt(4)
 ds_read_b64_tr_b16 v[216:217], v227 offset:53248
 v_cvt_pk_bf16_f32 v77, v78, v79
 v_mfma_f32_16x16x32_bf16 v[156:159], v[200:203], a[236:239], v[156:159]
 ds_read_b64_tr_b16 v[218:219], v227 offset:55296
 v_cvt_pk_bf16_f32 v78, v92, v93
 v_mfma_f32_16x16x32_bf16 v[156:159], v[204:207], a[252:255], v[156:159]
 ds_read_b64_tr_b16 v[220:221], v227 offset:61440
 v_cvt_pk_bf16_f32 v79, v94, v95
 v_mfma_f32_16x16x32_bf16 v[152:155], v[204:207], a[248:251], v[152:155]
 buffer_load_dwordx4 v255, s[12:15], s92 offen offset:2048 sc1 lds
 v_accvgpr_write_b32 a176, v76
 v_mfma_f32_16x16x32_bf16 v[152:155], v[200:203], a[232:235], v[152:155]
 ds_read_b64_tr_b16 v[222:223], v227 offset:63488
 v_accvgpr_write_b32 a177, v77
 v_mfma_f32_16x16x32_bf16 v[148:151], v[200:203], a[228:231], v[148:151]
 v_accvgpr_write_b32 a178, v78
 v_accvgpr_write_b32 a179, v79
 v_mfma_f32_16x16x32_bf16 v[148:151], v[204:207], a[244:247], v[148:151]
 v_cvt_pk_bf16_f32 v96, v96, v97
 v_cvt_pk_bf16_f32 v97, v98, v99
 v_mfma_f32_16x16x32_bf16 v[144:147], v[204:207], a[240:243], v[144:147]
 buffer_load_dwordx4 v255, s[12:15], s92 offen offset:3072 sc1 lds
 v_cvt_pk_bf16_f32 v98, v112, v113
 v_mfma_f32_16x16x32_bf16 v[144:147], v[200:203], a[224:227], v[144:147]
 s_waitcnt lgkmcnt(4)
 s_add_u32 s92, s92, 28672
 v_cvt_pk_bf16_f32 v99, v114, v115
 v_accvgpr_write_b32 a132, v96
 v_mfma_f32_16x16x32_bf16 v[160:163], v[208:211], a[224:227], v[160:163]
 s_lshl_b32 s94, s20, 12
 v_accvgpr_write_b32 a133, v97
 v_accvgpr_write_b32 a134, v98
 v_mfma_f32_16x16x32_bf16 v[160:163], v[212:215], a[240:243], v[160:163]
 s_sub_u32 s92, s92, s94
 v_accvgpr_write_b32 a135, v99
 v_cvt_pk_bf16_f32 v100, v100, v101
 v_mfma_f32_16x16x32_bf16 v[164:167], v[212:215], a[244:247], v[164:167]
 s_and_b32 m0, s92, 0x1ffff
 v_cvt_pk_bf16_f32 v101, v102, v103
 v_cvt_pk_bf16_f32 v102, v116, v117
 v_mfma_f32_16x16x32_bf16 v[164:167], v[208:211], a[228:231], v[164:167]
 v_cvt_pk_bf16_f32 v103, v118, v119
 v_accvgpr_write_b32 a148, v100
 v_mfma_f32_16x16x32_bf16 v[168:171], v[208:211], a[232:235], v[168:171]
 v_accvgpr_write_b32 a149, v101
 v_accvgpr_write_b32 a150, v102
 v_mfma_f32_16x16x32_bf16 v[168:171], v[212:215], a[248:251], v[168:171]
 v_accvgpr_write_b32 a151, v103
 v_cvt_pk_bf16_f32 v104, v104, v105
 v_mfma_f32_16x16x32_bf16 v[172:175], v[212:215], a[252:255], v[172:175]
 v_cvt_pk_bf16_f32 v105, v106, v107
 v_cvt_pk_bf16_f32 v106, v120, v121
 v_mfma_f32_16x16x32_bf16 v[172:175], v[208:211], a[236:239], v[172:175]
 s_waitcnt lgkmcnt(0)
 v_cvt_pk_bf16_f32 v107, v122, v123
 v_accvgpr_write_b32 a164, v104
 v_mfma_f32_16x16x32_bf16 v[188:191], v[216:219], a[236:239], v[188:191]
 v_accvgpr_write_b32 a165, v105
 v_accvgpr_write_b32 a166, v106
 v_mfma_f32_16x16x32_bf16 v[188:191], v[220:223], a[252:255], v[188:191]
 v_accvgpr_write_b32 a167, v107
 v_cvt_pk_bf16_f32 v108, v108, v109
 v_mfma_f32_16x16x32_bf16 v[184:187], v[220:223], a[248:251], v[184:187]
 v_cvt_pk_bf16_f32 v109, v110, v111
 v_cvt_pk_bf16_f32 v110, v124, v125
 v_mfma_f32_16x16x32_bf16 v[184:187], v[216:219], a[232:235], v[184:187]
 v_cvt_pk_bf16_f32 v111, v126, v127
 v_accvgpr_write_b32 a180, v108
 v_mfma_f32_16x16x32_bf16 v[180:183], v[216:219], a[228:231], v[180:183]
 v_accvgpr_write_b32 a181, v109
 v_accvgpr_write_b32 a182, v110
 v_mfma_f32_16x16x32_bf16 v[180:183], v[220:223], a[244:247], v[180:183]
 s_waitcnt vmcnt(8)
 v_accvgpr_write_b32 a183, v111
 v_cvt_pk_bf16_f32 v128, v128, v129
 v_mfma_f32_16x16x32_bf16 v[176:179], v[220:223], a[240:243], v[176:179]
 s_barrier
 v_cvt_pk_bf16_f32 v129, v130, v131
 v_cvt_pk_bf16_f32 v130, v144, v145
 v_mfma_f32_16x16x32_bf16 v[176:179], v[216:219], a[224:227], v[176:179]
 v_cvt_pk_bf16_f32 v131, v146, v147
 v_accvgpr_write_b32 a136, v128
 ds_read_b128 a[192:195], v240 offset:0
 ds_read_b128 a[196:199], v240 offset:1024
 ds_read_b128 a[200:203], v240 offset:2048
 ds_read_b128 a[204:207], v240 offset:3072
 ds_read_b128 a[208:211], v240 offset:4096
 ds_read_b128 a[212:215], v240 offset:5120
 ds_read_b128 a[216:219], v240 offset:6144
 ds_read_b128 a[220:223], v240 offset:7168
 v_accvgpr_write_b32 a137, v129
 v_accvgpr_write_b32 a138, v130
 v_accvgpr_write_b32 a139, v131
 v_cvt_pk_bf16_f32 v132, v132, v133
 v_cvt_pk_bf16_f32 v133, v134, v135
 v_cvt_pk_bf16_f32 v134, v148, v149
 v_cvt_pk_bf16_f32 v135, v150, v151
 v_accvgpr_write_b32 a152, v132
 v_accvgpr_write_b32 a153, v133
 v_accvgpr_write_b32 a154, v134
 v_accvgpr_write_b32 a155, v135
 v_cvt_pk_bf16_f32 v136, v136, v137
 v_cvt_pk_bf16_f32 v137, v138, v139
 v_cvt_pk_bf16_f32 v138, v152, v153
 v_cvt_pk_bf16_f32 v139, v154, v155
 v_accvgpr_write_b32 a168, v136
 v_accvgpr_write_b32 a169, v137
 v_accvgpr_write_b32 a170, v138
 v_accvgpr_write_b32 a171, v139
 v_cvt_pk_bf16_f32 v140, v140, v141
 v_cvt_pk_bf16_f32 v141, v142, v143
 v_cvt_pk_bf16_f32 v142, v156, v157
 v_cvt_pk_bf16_f32 v143, v158, v159
 v_accvgpr_write_b32 a184, v140
 v_accvgpr_write_b32 a185, v141
 v_accvgpr_write_b32 a186, v142
 v_accvgpr_write_b32 a187, v143
 v_cvt_pk_bf16_f32 v160, v160, v161
 v_cvt_pk_bf16_f32 v161, v162, v163
 v_cvt_pk_bf16_f32 v162, v176, v177
 v_cvt_pk_bf16_f32 v163, v178, v179
 v_accvgpr_write_b32 a140, v160
 v_accvgpr_write_b32 a141, v161
 v_accvgpr_write_b32 a142, v162
 v_accvgpr_write_b32 a143, v163
 v_cvt_pk_bf16_f32 v164, v164, v165
 v_cvt_pk_bf16_f32 v165, v166, v167
 v_cvt_pk_bf16_f32 v166, v180, v181
 v_cvt_pk_bf16_f32 v167, v182, v183
 v_accvgpr_write_b32 a156, v164
 v_accvgpr_write_b32 a157, v165
 v_accvgpr_write_b32 a158, v166
 v_accvgpr_write_b32 a159, v167
 v_cvt_pk_bf16_f32 v168, v168, v169
 v_cvt_pk_bf16_f32 v169, v170, v171
 v_cvt_pk_bf16_f32 v170, v184, v185
 v_cvt_pk_bf16_f32 v171, v186, v187
 v_accvgpr_write_b32 a172, v168
 v_accvgpr_write_b32 a173, v169
 v_accvgpr_write_b32 a174, v170
 v_accvgpr_write_b32 a175, v171
 v_cvt_pk_bf16_f32 v172, v172, v173
 v_cvt_pk_bf16_f32 v173, v174, v175
 v_cvt_pk_bf16_f32 v174, v188, v189
 v_cvt_pk_bf16_f32 v175, v190, v191
 v_accvgpr_write_b32 a188, v172
 v_accvgpr_write_b32 a189, v173
 v_accvgpr_write_b32 a190, v174
 v_accvgpr_write_b32 a191, v175
 s_waitcnt lgkmcnt(4)
 v_mfma_f32_16x16x32_bf16 v[0:3], a[192:195], a[128:131], v[0:3]
 s_mov_b32 s27, 0x0b0b0909
 ds_read_b128 a[224:227], v240 offset:8192
 v_mov_b32 v224, 0
 v_mfma_f32_16x16x32_bf16 v[0:3], a[196:199], a[132:135], v[0:3]
 s_lshl_b32 s23, s21, 14
 ds_read_b128 a[228:231], v240 offset:9216
 v_mov_b32 v225, 0
 v_mfma_f32_16x16x32_bf16 v[0:3], a[200:203], a[136:139], v[0:3]
 s_lshl_b32 s24, s20, 10
 ds_read_b128 a[232:235], v240 offset:10240
 v_mov_b32 v226, 0
 v_mfma_f32_16x16x32_bf16 v[0:3], a[204:207], a[140:143], v[0:3]
 s_add_u32 s23, s23, s24
 ds_read_b128 a[236:239], v240 offset:11264
 v_mov_b32 v227, 0
 v_mfma_f32_16x16x32_bf16 v[4:7], a[192:195], a[144:147], 0
 s_lshl_b32 s24, s22, 20
 buffer_load_dwordx4 v255, s[12:15], s92 offen sc1 lds
 v_mov_b32 v228, 0
 v_mfma_f32_16x16x32_bf16 v[4:7], a[196:199], a[148:151], v[4:7]
 s_add_u32 s25, s23, s24
 v_mov_b32 v229, 0
 v_mov_b32 v230, 0
 v_mfma_f32_16x16x32_bf16 v[4:7], a[200:203], a[152:155], v[4:7]
 s_sub_u32 s26, s23, s24
 v_mov_b32 v231, 0
 v_mov_b32 v232, 0
 v_mfma_f32_16x16x32_bf16 v[4:7], a[204:207], a[156:159], v[4:7]
 s_add_u32 s98, s25, 35651584
 buffer_load_dwordx4 v255, s[12:15], s92 offen offset:1024 sc1 lds
 v_mov_b32 v233, 0
 v_mfma_f32_16x16x32_bf16 v[8:11], a[192:195], a[160:163], 0
 s_add_u32 s99, s25, 36175872
 v_mov_b32 v234, 0
 v_mov_b32 v235, 0
 v_mfma_f32_16x16x32_bf16 v[8:11], a[196:199], a[164:167], v[8:11]
 s_add_u32 s100, s26, 51380224
 v_mov_b32 v236, 0
 v_mov_b32 v237, 0
 v_mfma_f32_16x16x32_bf16 v[8:11], a[200:203], a[168:171], v[8:11]
 s_add_u32 s101, s26, 51904512
 buffer_load_dwordx4 v255, s[12:15], s92 offen offset:2048 sc1 lds
 v_mov_b32 v238, 0
 v_mfma_f32_16x16x32_bf16 v[8:11], a[204:207], a[172:175], v[8:11]
 s_mov_b32 s30, s22
 v_mov_b32 v239, 0
 v_sub_u32 v192, -1, v248
 v_mfma_f32_16x16x32_bf16 v[12:15], a[192:195], a[176:179], 0
 s_lshl_b32 s31, s22, 1
 v_sub_u32 v204, 0, v248
 v_perm_b32 v192, v204, v192, s27
 v_mfma_f32_16x16x32_bf16 v[12:15], a[196:199], a[180:183], v[12:15]
 s_sub_u32 s31, 14, s31
 buffer_load_dwordx4 v255, s[12:15], s92 offen offset:3072 sc1 lds
 v_sub_u32 v193, 1, v248
 v_mfma_f32_16x16x32_bf16 v[12:15], a[200:203], a[184:187], v[12:15]
 s_add_u32 s92, s92, s94
 v_sub_u32 v204, 2, v248
 v_perm_b32 v193, v204, v193, s27
 v_mfma_f32_16x16x32_bf16 v[12:15], a[204:207], a[188:191], v[12:15]
 s_waitcnt lgkmcnt(4)
 s_add_u32 s92, s92, 16384
 buffer_load_dword v243, v243, s[4:7], 0 offen
 v_sub_u32 v194, 15, v248
 v_mfma_f32_16x16x32_bf16 v[16:19], a[208:211], a[128:131], 0
 s_and_b32 m0, s92, 0x1ffff
 ds_read_b128 a[240:243], v240 offset:12288
 v_sub_u32 v204, 16, v248
 v_mfma_f32_16x16x32_bf16 v[16:19], a[212:215], a[132:135], v[16:19]
 s_sub_u32 s32, 255, s2
 ds_read_b128 a[244:247], v240 offset:13312
 v_perm_b32 v194, v204, v194, s27
 v_mfma_f32_16x16x32_bf16 v[16:19], a[216:219], a[136:139], v[16:19]
 s_mul_i32 s32, s32, 4096
 ds_read_b128 a[248:251], v240 offset:14336
 v_sub_u32 v195, 17, v248
 v_mfma_f32_16x16x32_bf16 v[16:19], a[220:223], a[140:143], v[16:19]
 s_mov_b32 s33, 917504
 ds_read_b128 a[252:255], v240 offset:15360
 v_sub_u32 v204, 18, v248
 v_mfma_f32_16x16x32_bf16 v[20:23], a[208:211], a[144:147], 0
 s_lshl_b32 s23, s20, 22
 buffer_load_dwordx4 v255, s[12:15], s92 offen sc1 lds
 v_perm_b32 v195, v204, v195, s27
 v_mfma_f32_16x16x32_bf16 v[20:23], a[212:215], a[148:151], v[20:23]
 s_mov_b32 s10, 2097152
 v_max3_f32 v209, v0, v1, v2
 v_max3_f32 v213, v4, v5, v6
 v_max3_f32 v217, v8, v9, v10
 v_max3_f32 v221, v12, v13, v14
 v_max_f32 v209, v209, v3
 v_mfma_f32_16x16x32_bf16 v[20:23], a[216:219], a[152:155], v[20:23]
 s_mov_b32 s18, 2097152
 v_max_f32 v213, v213, v7
 v_max_f32 v217, v217, v11
 v_max_f32 v221, v221, v15
 v_mov_b32 v210, v209
 v_mov_b32 v214, v213
 v_mfma_f32_16x16x32_bf16 v[20:23], a[220:223], a[156:159], v[20:23]
 s_add_u32 s8, s80, s23
 v_mov_b32 v218, v217
 v_mov_b32 v222, v221
 v_permlane16_swap_b32 v209, v210
 v_permlane16_swap_b32 v213, v214
 v_permlane16_swap_b32 v217, v218
 v_mfma_f32_16x16x32_bf16 v[24:27], a[208:211], a[160:163], 0
 s_addc_u32 s9, s81, 0
 v_permlane16_swap_b32 v221, v222
 v_max_f32 v209, v209, v210
 v_max_f32 v213, v213, v214
 v_max_f32 v217, v217, v218
 v_max_f32 v221, v221, v222
 v_mfma_f32_16x16x32_bf16 v[24:27], a[212:215], a[164:167], v[24:27]
 s_cmp_eq_u32 s20, 2
 v_mov_b32 v210, v209
Lw3_3:
 s_cbranch_execz Lw3_back
 v_mov_b32 v214, v213
 v_mov_b32 v218, v217
 v_mov_b32 v222, v221
 v_permlane32_swap_b32 v209, v210
 v_mfma_f32_16x16x32_bf16 v[24:27], a[216:219], a[168:171], v[24:27]
 s_cselect_b32 s8, s74, s8
 buffer_load_dwordx4 v255, s[12:15], s92 offen offset:1024 sc1 lds
 v_permlane32_swap_b32 v213, v214
 v_permlane32_swap_b32 v217, v218
 v_permlane32_swap_b32 v221, v222
 v_max_f32 v209, v209, v210
 v_mfma_f32_16x16x32_bf16 v[24:27], a[220:223], a[172:175], v[24:27]
 s_cselect_b32 s9, s75, s9
 v_max_f32 v213, v213, v214
 v_max_f32 v217, v217, v218
 v_max_f32 v221, v221, v222
 v_sub_f32 v208, 0, v209
 v_sub_f32 v212, 0, v213
 v_mfma_f32_16x16x32_bf16 v[28:31], a[208:211], a[176:179], 0
 s_add_u32 s16, s8, 2097152
 v_sub_f32 v216, 0, v217
 v_sub_f32 v220, 0, v221
 v_sub_f32 v210, 0, v209
 v_sub_f32 v214, 0, v213
 v_sub_f32 v218, 0, v217
 v_mfma_f32_16x16x32_bf16 v[28:31], a[212:215], a[180:183], v[28:31]
 s_addc_u32 s17, s9, 0
 v_sub_f32 v222, 0, v221
 v_sub_f32 v211, 0, v209
 v_sub_f32 v215, 0, v213
 v_sub_f32 v219, 0, v217
 v_sub_f32 v223, 0, v221
 v_mfma_f32_16x16x32_bf16 v[28:31], a[216:219], a[184:187], v[28:31]
 s_cmp_eq_u32 s20, 3
 v_sub_f32 v209, 0, v209
 v_sub_f32 v213, 0, v213
 v_sub_f32 v217, 0, v217
 v_sub_f32 v221, 0, v221
 v_mfma_f32_16x16x32_bf16 v[28:31], a[220:223], a[188:191], v[28:31]
 s_waitcnt lgkmcnt(4)
 s_cselect_b32 s8, s78, s8
 s_nop 0
 v_mfma_f32_16x16x32_bf16 v[32:35], a[224:227], a[128:131], v[208:211]
 s_cselect_b32 s9, s79, s9
 v_add_f32 v0, v0, v208
 v_add_f32 v1, v1, v208
 v_mfma_f32_16x16x32_bf16 v[32:35], a[228:231], a[132:135], v[32:35]
 s_cselect_b32 s10, 1835008, s10
 v_add_f32 v2, v2, v208
 v_add_f32 v3, v3, v208
 v_mfma_f32_16x16x32_bf16 v[32:35], a[232:235], a[136:139], v[32:35]
 s_cselect_b32 s16, s64, s16
 v_add_f32 v4, v4, v212
 v_add_f32 v5, v5, v212
 v_mfma_f32_16x16x32_bf16 v[32:35], a[236:239], a[140:143], v[32:35]
 s_cselect_b32 s17, s65, s17
 v_add_f32 v6, v6, v212
 v_add_f32 v7, v7, v212
 v_mfma_f32_16x16x32_bf16 v[36:39], a[224:227], a[144:147], v[212:215]
 v_add_f32 v8, v8, v216
 v_add_f32 v9, v9, v216
 v_mfma_f32_16x16x32_bf16 v[36:39], a[228:231], a[148:151], v[36:39]
 v_add_f32 v10, v10, v216
 v_add_f32 v11, v11, v216
 v_mfma_f32_16x16x32_bf16 v[36:39], a[232:235], a[152:155], v[36:39]
 v_add_f32 v12, v12, v220
 v_add_f32 v13, v13, v220
 v_mfma_f32_16x16x32_bf16 v[36:39], a[236:239], a[156:159], v[36:39]
 v_add_f32 v14, v14, v220
 v_add_f32 v15, v15, v220
 v_mfma_f32_16x16x32_bf16 v[40:43], a[224:227], a[160:163], v[216:219]
 v_exp_f32 v0, v0
 v_mfma_f32_16x16x32_bf16 v[40:43], a[228:231], a[164:167], v[40:43]
 v_exp_f32 v1, v1
 v_mfma_f32_16x16x32_bf16 v[40:43], a[232:235], a[168:171], v[40:43]
 v_exp_f32 v2, v2
 v_mfma_f32_16x16x32_bf16 v[40:43], a[236:239], a[172:175], v[40:43]
 v_cvt_pk_bf16_f32 v128, v0, v1
 v_mfma_f32_16x16x32_bf16 v[44:47], a[224:227], a[176:179], v[220:223]
 v_exp_f32 v3, v3
 v_mfma_f32_16x16x32_bf16 v[44:47], a[228:231], a[180:183], v[44:47]
 s_waitcnt vmcnt(7)
 v_exp_f32 v4, v4
 v_mfma_f32_16x16x32_bf16 v[44:47], a[232:235], a[184:187], v[44:47]
 s_barrier
 v_cvt_pk_bf16_f32 v129, v2, v3
 v_mfma_f32_16x16x32_bf16 v[44:47], a[236:239], a[188:191], v[44:47]
 s_waitcnt lgkmcnt(0)
 ds_read_b128 a[192:195], v240 offset:32768
 v_mfma_f32_16x16x32_bf16 v[48:51], a[240:243], a[128:131], v[208:211]
 ds_read_b128 a[196:199], v240 offset:33792
 v_mfma_f32_16x16x32_bf16 v[48:51], a[244:247], a[132:135], v[48:51]
 ds_read_b128 a[200:203], v240 offset:34816
 v_mfma_f32_16x16x32_bf16 v[48:51], a[248:251], a[136:139], v[48:51]
 ds_read_b128 a[204:207], v240 offset:35840
 v_mfma_f32_16x16x32_bf16 v[48:51], a[252:255], a[140:143], v[48:51]
 ds_read_b128 a[208:211], v240 offset:36864
 v_mfma_f32_16x16x32_bf16 v[52:55], a[240:243], a[144:147], v[212:215]
 ds_read_b128 a[212:215], v240 offset:37888
 v_mfma_f32_16x16x32_bf16 v[52:55], a[244:247], a[148:151], v[52:55]
 ds_read_b128 a[216:219], v240 offset:38912
 v_mfma_f32_16x16x32_bf16 v[52:55], a[248:251], a[152:155], v[52:55]
 ds_read_b128 a[220:223], v240 offset:39936
 v_mfma_f32_16x16x32_bf16 v[52:55], a[252:255], a[156:159], v[52:55]
 v_exp_f32 v5, v5
 v_mfma_f32_16x16x32_bf16 v[56:59], a[240:243], a[160:163], v[216:219]
 v_add_f32 v16, v16, v208
 v_add_f32 v17, v17, v208
 v_mfma_f32_16x16x32_bf16 v[56:59], a[244:247], a[164:167], v[56:59]
 v_add_f32 v18, v18, v208
 v_add_f32 v19, v19, v208
 v_mfma_f32_16x16x32_bf16 v[56:59], a[248:251], a[168:171], v[56:59]
 v_add_f32 v20, v20, v212
 v_add_f32 v21, v21, v212
 v_mfma_f32_16x16x32_bf16 v[56:59], a[252:255], a[172:175], v[56:59]
 v_add_f32 v22, v22, v212
 v_add_f32 v23, v23, v212
 v_mfma_f32_16x16x32_bf16 v[60:63], a[240:243], a[176:179], v[220:223]
 v_add_f32 v24, v24, v216
 v_add_f32 v25, v25, v216
 v_mfma_f32_16x16x32_bf16 v[60:63], a[244:247], a[180:183], v[60:63]
 v_add_f32 v26, v26, v216
 v_add_f32 v27, v27, v216
 v_mfma_f32_16x16x32_bf16 v[60:63], a[248:251], a[184:187], v[60:63]
 v_add_f32 v28, v28, v220
 v_add_f32 v29, v29, v220
 v_mfma_f32_16x16x32_bf16 v[60:63], a[252:255], a[188:191], v[60:63]
 v_add_f32 v30, v30, v220
 v_add_f32 v31, v31, v220
 v_exp_f32 v6, v6
 v_cvt_pk_bf16_f32 v136, v4, v5
 v_exp_f32 v7, v7
 v_exp_f32 v8, v8
 v_cvt_pk_bf16_f32 v137, v6, v7
 v_exp_f32 v9, v9
 v_exp_f32 v10, v10
 v_cvt_pk_bf16_f32 v144, v8, v9
 v_exp_f32 v11, v11
 v_exp_f32 v12, v12
 v_cvt_pk_bf16_f32 v145, v10, v11
 v_exp_f32 v13, v13
 v_exp_f32 v14, v14
 v_cvt_pk_bf16_f32 v152, v12, v13
 v_exp_f32 v15, v15
 v_exp_f32 v16, v16
 v_cvt_pk_bf16_f32 v153, v14, v15
 v_exp_f32 v17, v17
 v_exp_f32 v18, v18
 v_cvt_pk_bf16_f32 v130, v16, v17
 v_exp_f32 v19, v19
 v_exp_f32 v20, v20
 v_cvt_pk_bf16_f32 v131, v18, v19
 v_exp_f32 v21, v21
 v_exp_f32 v22, v22
 v_cvt_pk_bf16_f32 v138, v20, v21
 v_exp_f32 v23, v23
 v_exp_f32 v24, v24
 v_cvt_pk_bf16_f32 v139, v22, v23
 v_exp_f32 v25, v25
 v_exp_f32 v26, v26
 v_cvt_pk_bf16_f32 v146, v24, v25
 v_exp_f32 v27, v27
 v_exp_f32 v28, v28
 v_cvt_pk_bf16_f32 v147, v26, v27
 v_exp_f32 v29, v29
 v_exp_f32 v30, v30
 v_cvt_pk_bf16_f32 v154, v28, v29
 v_exp_f32 v31, v31
 v_sub_u32 v196, 31, v248
 v_cvt_pk_bf16_f32 v155, v30, v31
 v_sub_u32 v204, 32, v248
 v_perm_b32 v196, v204, v196, s27
 v_sub_u32 v197, 33, v248
 v_sub_u32 v204, 34, v248
 v_perm_b32 v197, v204, v197, s27
 v_sub_u32 v198, 47, v248
 v_sub_u32 v204, 48, v248
 v_perm_b32 v198, v204, v198, s27
 v_sub_u32 v199, 49, v248
 v_sub_u32 v204, 50, v248
 v_perm_b32 v199, v204, v199, s27
 v_bfe_u32 v206, v255, 4, 1
 v_mul_u32_u24 v206, 0xaaaa, v206
 v_add_u32 v206, 0x4444, v206
 s_waitcnt lgkmcnt(4)
 s_cmp_eq_u32 s22, 0
 s_cbranch_scc1 L43
 s_nop 0
 s_nop 0
L44:
 v_mfma_f32_16x16x32_bf16 v[64:67], a[192:195], a[128:131], v[208:211]
 v_exp_f32 v32, v32
 v_mfma_f32_16x16x32_bf16 v[64:67], a[196:199], a[132:135], v[64:67]
 v_exp_f32 v33, v33
 v_mfma_f32_16x16x32_bf16 v[64:67], a[200:203], a[136:139], v[64:67]
 buffer_load_dwordx4 v255, s[12:15], s92 offen offset:2048 sc1 lds
 v_mfma_f32_16x16x32_bf16 v[64:67], a[204:207], a[140:143], v[64:67]
 ds_read_b128 a[224:227], v240 offset:40960
 ds_read_b128 a[228:231], v240 offset:41984
 v_mfma_f32_16x16x32_bf16 v[68:71], a[204:207], a[156:159], v[212:215]
 v_exp_f32 v34, v34
 v_mfma_f32_16x16x32_bf16 v[68:71], a[200:203], a[152:155], v[68:71]
 v_xor_b32 v241, 0x10000, v241
 v_cvt_pk_bf16_f32 v132, v32, v33
 v_mfma_f32_16x16x32_bf16 v[68:71], a[196:199], a[148:151], v[68:71]
 v_exp_f32 v35, v35
 v_mfma_f32_16x16x32_bf16 v[68:71], a[192:195], a[144:147], v[68:71]
 ds_read_b128 a[232:235], v240 offset:43008
 v_cvt_pk_bf16_f32 v133, v34, v35
 v_mfma_f32_16x16x32_bf16 v[72:75], a[192:195], a[160:163], v[216:219]
 v_exp_f32 v36, v36
 v_mfma_f32_16x16x32_bf16 v[72:75], a[196:199], a[164:167], v[72:75]
 v_mfma_f32_16x16x32_bf16 v[72:75], a[200:203], a[168:171], v[72:75]
 v_exp_f32 v37, v37
 v_mfma_f32_16x16x32_bf16 v[72:75], a[204:207], a[172:175], v[72:75]
 ds_read_b128 a[236:239], v240 offset:44032
 v_cvt_pk_bf16_f32 v140, v36, v37
 v_mfma_f32_16x16x32_bf16 v[76:79], a[204:207], a[188:191], v[220:223]
 v_exp_f32 v38, v38
 v_mfma_f32_16x16x32_bf16 v[76:79], a[200:203], a[184:187], v[76:79]
 v_exp_f32 v39, v39
 v_mfma_f32_16x16x32_bf16 v[76:79], a[196:199], a[180:183], v[76:79]
 ds_read_b128 a[240:243], v240 offset:45056
 v_cvt_pk_bf16_f32 v141, v38, v39
 v_mfma_f32_16x16x32_bf16 v[76:79], a[192:195], a[176:179], v[76:79]
 s_waitcnt lgkmcnt(5)
 v_exp_f32 v40, v40
 v_mfma_f32_16x16x32_bf16 v[92:95], a[208:211], a[176:179], v[220:223]
 v_mfma_f32_16x16x32_bf16 v[92:95], a[212:215], a[180:183], v[92:95]
 buffer_load_dwordx4 v255, s[12:15], s92 offen offset:3072 sc1 lds
 v_mfma_f32_16x16x32_bf16 v[92:95], a[216:219], a[184:187], v[92:95]
 s_add_u32 s92, s92, 4096
 v_exp_f32 v41, v41
 v_mfma_f32_16x16x32_bf16 v[92:95], a[220:223], a[188:191], v[92:95]
 s_and_b32 m0, s92, 0x1ffff
 ds_read_b128 a[244:247], v240 offset:46080
 v_cvt_pk_bf16_f32 v148, v40, v41
 v_mfma_f32_16x16x32_bf16 v[88:91], a[220:223], a[172:175], v[216:219]
 v_exp_f32 v42, v42
 v_mfma_f32_16x16x32_bf16 v[88:91], a[216:219], a[168:171], v[88:91]
 v_mfma_f32_16x16x32_bf16 v[88:91], a[212:215], a[164:167], v[88:91]
 v_exp_f32 v43, v43
 v_mfma_f32_16x16x32_bf16 v[88:91], a[208:211], a[160:163], v[88:91]
 ds_read_b128 a[248:251], v240 offset:47104
 v_cvt_pk_bf16_f32 v149, v42, v43
 v_mfma_f32_16x16x32_bf16 v[84:87], a[208:211], a[144:147], v[212:215]
 v_exp_f32 v44, v44
 v_mfma_f32_16x16x32_bf16 v[84:87], a[212:215], a[148:151], v[84:87]
 v_exp_f32 v45, v45
 v_mfma_f32_16x16x32_bf16 v[84:87], a[216:219], a[152:155], v[84:87]
 ds_read_b128 a[252:255], v240 offset:48128
 v_cvt_pk_bf16_f32 v156, v44, v45
 v_mfma_f32_16x16x32_bf16 v[84:87], a[220:223], a[156:159], v[84:87]
 v_exp_f32 v46, v46
 v_mfma_f32_16x16x32_bf16 v[80:83], a[220:223], a[140:143], v[208:211]
 v_mfma_f32_16x16x32_bf16 v[80:83], a[216:219], a[136:139], v[80:83]
 v_exp_f32 v47, v47
 v_mfma_f32_16x16x32_bf16 v[80:83], a[212:215], a[132:135], v[80:83]
 ds_read_b128 a[192:195], v240 offset:16384
 v_cvt_pk_bf16_f32 v157, v46, v47
 v_mfma_f32_16x16x32_bf16 v[80:83], a[208:211], a[128:131], v[80:83]
 s_waitcnt lgkmcnt(5)
 v_exp_f32 v48, v48
 v_mfma_f32_16x16x32_bf16 v[96:99], a[224:227], a[128:131], v[208:211]
 buffer_load_dwordx4 v255, s[12:15], s92 offen sc1 lds
 v_mfma_f32_16x16x32_bf16 v[96:99], a[228:231], a[132:135], v[96:99]
 v_mfma_f32_16x16x32_bf16 v[96:99], a[232:235], a[136:139], v[96:99]
 v_exp_f32 v49, v49
 v_mfma_f32_16x16x32_bf16 v[96:99], a[236:239], a[140:143], v[96:99]
 ds_read_b128 a[196:199], v240 offset:17408
 v_cvt_pk_bf16_f32 v134, v48, v49
 v_mfma_f32_16x16x32_bf16 v[100:103], a[236:239], a[156:159], v[212:215]
 v_exp_f32 v50, v50
 v_mfma_f32_16x16x32_bf16 v[100:103], a[232:235], a[152:155], v[100:103]
 v_mfma_f32_16x16x32_bf16 v[100:103], a[228:231], a[148:151], v[100:103]
 v_exp_f32 v51, v51
 v_mfma_f32_16x16x32_bf16 v[100:103], a[224:227], a[144:147], v[100:103]
 v_exp_f32 v52, v52
 v_mfma_f32_16x16x32_bf16 v[104:107], a[224:227], a[160:163], v[216:219]
 ds_read_b128 a[200:203], v240 offset:18432
 v_cvt_pk_bf16_f32 v135, v50, v51
 v_mfma_f32_16x16x32_bf16 v[104:107], a[228:231], a[164:167], v[104:107]
 v_exp_f32 v53, v53
 v_mfma_f32_16x16x32_bf16 v[104:107], a[232:235], a[168:171], v[104:107]
 ds_read_b128 a[204:207], v240 offset:19456
 v_cvt_pk_bf16_f32 v142, v52, v53
 v_mfma_f32_16x16x32_bf16 v[104:107], a[236:239], a[172:175], v[104:107]
 v_exp_f32 v54, v54
 v_mfma_f32_16x16x32_bf16 v[108:111], a[236:239], a[188:191], v[220:223]
 v_mfma_f32_16x16x32_bf16 v[108:111], a[232:235], a[184:187], v[108:111]
 v_exp_f32 v55, v55
 v_mfma_f32_16x16x32_bf16 v[108:111], a[228:231], a[180:183], v[108:111]
 ds_read_b128 a[208:211], v240 offset:20480
 v_cvt_pk_bf16_f32 v143, v54, v55
 v_mfma_f32_16x16x32_bf16 v[108:111], a[224:227], a[176:179], v[108:111]
 s_waitcnt lgkmcnt(5)
 v_exp_f32 v56, v56
 v_mfma_f32_16x16x32_bf16 v[124:127], a[240:243], a[176:179], v[220:223]
 buffer_load_dwordx4 v255, s[12:15], s92 offen offset:1024 sc1 lds
 v_mfma_f32_16x16x32_bf16 v[124:127], a[244:247], a[180:183], v[124:127]
 v_mfma_f32_16x16x32_bf16 v[124:127], a[248:251], a[184:187], v[124:127]
 v_exp_f32 v57, v57
 v_mfma_f32_16x16x32_bf16 v[124:127], a[252:255], a[188:191], v[124:127]
 v_exp_f32 v58, v58
 v_mfma_f32_16x16x32_bf16 v[120:123], a[252:255], a[172:175], v[216:219]
 ds_read_b128 a[212:215], v240 offset:21504
 v_cvt_pk_bf16_f32 v150, v56, v57
 v_mfma_f32_16x16x32_bf16 v[120:123], a[248:251], a[168:171], v[120:123]
 v_exp_f32 v59, v59
 v_mfma_f32_16x16x32_bf16 v[120:123], a[244:247], a[164:167], v[120:123]
 ds_read_b128 a[216:219], v240 offset:22528
 v_cvt_pk_bf16_f32 v151, v58, v59
 v_mfma_f32_16x16x32_bf16 v[120:123], a[240:243], a[160:163], v[120:123]
 v_exp_f32 v60, v60
 v_mfma_f32_16x16x32_bf16 v[116:119], a[240:243], a[144:147], v[212:215]
 v_mfma_f32_16x16x32_bf16 v[116:119], a[244:247], a[148:151], v[116:119]
 v_exp_f32 v61, v61
 v_mfma_f32_16x16x32_bf16 v[116:119], a[248:251], a[152:155], v[116:119]
 ds_read_b128 a[220:223], v240 offset:23552
 v_cvt_pk_bf16_f32 v158, v60, v61
 v_mfma_f32_16x16x32_bf16 v[116:119], a[252:255], a[156:159], v[116:119]
 v_exp_f32 v62, v62
 v_mfma_f32_16x16x32_bf16 v[112:115], a[252:255], a[140:143], v[208:211]
 v_mfma_f32_16x16x32_bf16 v[112:115], a[248:251], a[136:139], v[112:115]
 v_exp_f32 v63, v63
 v_mfma_f32_16x16x32_bf16 v[112:115], a[244:247], a[132:135], v[112:115]
 ds_read_b128 a[224:227], v240 offset:24576
 v_cvt_pk_bf16_f32 v159, v62, v63
 v_mfma_f32_16x16x32_bf16 v[112:115], a[240:243], a[128:131], v[112:115]
 s_waitcnt lgkmcnt(7)
 buffer_load_dwordx4 v255, s[12:15], s92 offen offset:2048 sc1 lds
 v_mfma_f32_16x16x32_bf16 a[0:3], a[192:195], v[128:131], a[0:3]
 v_mfma_f32_16x16x32_bf16 a[0:3], a[196:199], v[132:135], a[0:3]
 v_exp_f32 v64, v64
 v_mfma_f32_16x16x32_bf16 a[4:7], a[192:195], v[136:139], a[4:7]
 v_exp_f32 v65, v65
 v_mfma_f32_16x16x32_bf16 a[4:7], a[196:199], v[140:143], a[4:7]
 ds_read_b128 a[228:231], v240 offset:25600
 v_cvt_pk_bf16_f32 v160, v64, v65
 v_mfma_f32_16x16x32_bf16 a[8:11], a[192:195], v[144:147], a[8:11]
 v_exp_f32 v66, v66
 v_mfma_f32_16x16x32_bf16 a[8:11], a[196:199], v[148:151], a[8:11]
 v_mfma_f32_16x16x32_bf16 a[12:15], a[192:195], v[152:155], a[12:15]
 v_exp_f32 v67, v67
 v_mfma_f32_16x16x32_bf16 a[12:15], a[196:199], v[156:159], a[12:15]
 s_waitcnt lgkmcnt(6)
 ds_read_b128 a[232:235], v240 offset:26624
 v_cvt_pk_bf16_f32 v161, v66, v67
 v_mfma_f32_16x16x32_bf16 a[28:31], a[200:203], v[152:155], a[28:31]
 v_exp_f32 v68, v68
 v_mfma_f32_16x16x32_bf16 a[28:31], a[204:207], v[156:159], a[28:31]
 v_mfma_f32_16x16x32_bf16 a[24:27], a[204:207], v[148:151], a[24:27]
 v_exp_f32 v69, v69
 v_mfma_f32_16x16x32_bf16 a[24:27], a[200:203], v[144:147], a[24:27]
 ds_read_b128 a[236:239], v240 offset:27648
 v_cvt_pk_bf16_f32 v168, v68, v69
 v_mfma_f32_16x16x32_bf16 a[20:23], a[200:203], v[136:139], a[20:23]
 v_exp_f32 v70, v70
 v_mfma_f32_16x16x32_bf16 a[20:23], a[204:207], v[140:143], a[20:23]
 v_exp_f32 v71, v71
 v_mfma_f32_16x16x32_bf16 a[16:19], a[204:207], v[132:135], a[16:19]
 buffer_load_dwordx4 v255, s[12:15], s92 offen offset:3072 sc1 lds
 v_mfma_f32_16x16x32_bf16 a[16:19], a[200:203], v[128:131], a[16:19]
 s_add_u32 s92, s92, 28672
 ds_read_b128 a[240:243], v240 offset:28672
 v_cvt_pk_bf16_f32 v169, v70, v71
 v_smfmac_f32_16x16x64_bf16 v[224:227], v[244:247], v[128:135], v206
 s_waitcnt lgkmcnt(7)
 v_mfma_f32_16x16x32_bf16 a[32:35], a[208:211], v[128:131], a[32:35]
 s_and_b32 m0, s92, 0x1ffff
 v_exp_f32 v72, v72
 v_mfma_f32_16x16x32_bf16 a[32:35], a[212:215], v[132:135], a[32:35]
 v_mfma_f32_16x16x32_bf16 a[36:39], a[212:215], v[140:143], a[36:39]
 v_exp_f32 v73, v73
 v_mfma_f32_16x16x32_bf16 a[36:39], a[208:211], v[136:139], a[36:39]
 ds_read_b128 a[244:247], v240 offset:29696
 v_cvt_pk_bf16_f32 v176, v72, v73
 v_mfma_f32_16x16x32_bf16 a[40:43], a[208:211], v[144:147], a[40:43]
 v_exp_f32 v74, v74
 v_mfma_f32_16x16x32_bf16 a[40:43], a[212:215], v[148:151], a[40:43]
 v_mfma_f32_16x16x32_bf16 a[44:47], a[212:215], v[156:159], a[44:47]
 v_exp_f32 v75, v75
 v_mfma_f32_16x16x32_bf16 a[44:47], a[208:211], v[152:155], a[44:47]
 s_waitcnt lgkmcnt(6)
 ds_read_b128 a[248:251], v240 offset:30720
 v_cvt_pk_bf16_f32 v177, v74, v75
 v_mfma_f32_16x16x32_bf16 a[60:63], a[216:219], v[152:155], a[60:63]
 v_exp_f32 v76, v76
 v_mfma_f32_16x16x32_bf16 a[60:63], a[220:223], v[156:159], a[60:63]
 v_exp_f32 v77, v77
 v_mfma_f32_16x16x32_bf16 a[56:59], a[220:223], v[148:151], a[56:59]
 ds_read_b128 a[252:255], v240 offset:31744
 v_cvt_pk_bf16_f32 v184, v76, v77
 v_mfma_f32_16x16x32_bf16 a[56:59], a[216:219], v[144:147], a[56:59]
 v_exp_f32 v78, v78
 v_mfma_f32_16x16x32_bf16 a[52:55], a[216:219], v[136:139], a[52:55]
 v_mfma_f32_16x16x32_bf16 a[52:55], a[220:223], v[140:143], a[52:55]
 v_exp_f32 v79, v79
 v_mfma_f32_16x16x32_bf16 a[48:51], a[220:223], v[132:135], a[48:51]
 s_waitcnt vmcnt(9)
 v_cvt_pk_bf16_f32 v185, v78, v79
 v_mfma_f32_16x16x32_bf16 a[48:51], a[216:219], v[128:131], a[48:51]
 s_barrier
 v_exp_f32 v80, v80
 v_smfmac_f32_16x16x64_bf16 v[228:231], v[244:247], v[136:143], v206
 s_waitcnt lgkmcnt(6)
 ds_read_b128 a[192:195], v241 offset:0
 v_mfma_f32_16x16x32_bf16 a[64:67], a[224:227], v[128:131], a[64:67]
 buffer_load_dwordx4 v255, s[12:15], s92 offen sc1 lds
 v_mfma_f32_16x16x32_bf16 a[64:67], a[228:231], v[132:135], a[64:67]
 buffer_load_dword v243, v242, s[8:11], s32 offen
 v_mfma_f32_16x16x32_bf16 a[68:71], a[228:231], v[140:143], a[68:71]
 s_sub_u32 s30, s30, 1
 ds_read_b128 a[196:199], v241 offset:1024
 v_mfma_f32_16x16x32_bf16 a[68:71], a[224:227], v[136:139], a[68:71]
 v_exp_f32 v81, v81
 v_mfma_f32_16x16x32_bf16 a[72:75], a[224:227], v[144:147], a[72:75]
 v_cvt_pk_bf16_f32 v162, v80, v81
 v_mfma_f32_16x16x32_bf16 a[72:75], a[228:231], v[148:151], a[72:75]
 v_exp_f32 v82, v82
 v_mfma_f32_16x16x32_bf16 a[76:79], a[228:231], v[156:159], a[76:79]
 ds_read_b128 a[200:203], v241 offset:2048
 v_mfma_f32_16x16x32_bf16 a[76:79], a[224:227], v[152:155], a[76:79]
 s_waitcnt lgkmcnt(7)
 v_exp_f32 v83, v83
 v_mfma_f32_16x16x32_bf16 a[92:95], a[232:235], v[152:155], a[92:95]
 v_exp_f32 v84, v84
 v_mfma_f32_16x16x32_bf16 a[92:95], a[236:239], v[156:159], a[92:95]
 v_cvt_pk_bf16_f32 v163, v82, v83
 v_mfma_f32_16x16x32_bf16 a[88:91], a[236:239], v[148:151], a[88:91]
 v_exp_f32 v85, v85
 v_mfma_f32_16x16x32_bf16 a[88:91], a[232:235], v[144:147], a[88:91]
 ds_read_b128 a[204:207], v241 offset:3072
 v_cvt_pk_bf16_f32 v170, v84, v85
 v_mfma_f32_16x16x32_bf16 a[84:87], a[232:235], v[136:139], a[84:87]
 v_exp_f32 v86, v86
 v_mfma_f32_16x16x32_bf16 a[84:87], a[236:239], v[140:143], a[84:87]
 v_mfma_f32_16x16x32_bf16 a[80:83], a[236:239], v[132:135], a[80:83]
 v_exp_f32 v87, v87
 v_mfma_f32_16x16x32_bf16 a[80:83], a[232:235], v[128:131], a[80:83]
 ds_read_b128 a[208:211], v241 offset:4096
 v_cvt_pk_bf16_f32 v171, v86, v87
 v_smfmac_f32_16x16x64_bf16 v[232:235], v[244:247], v[144:151], v206
 s_waitcnt lgkmcnt(7)
 v_mfma_f32_16x16x32_bf16 a[96:99], a[240:243], v[128:131], a[96:99]
 buffer_load_dwordx4 v255, s[12:15], s92 offen offset:1024 sc1 lds
 v_mfma_f32_16x16x32_bf16 a[96:99], a[244:247], v[132:135], a[96:99]
 v_exp_f32 v88, v88
 v_mfma_f32_16x16x32_bf16 a[100:103], a[244:247], v[140:143], a[100:103]
 ds_read_b128 a[212:215], v241 offset:5120
 v_mfma_f32_16x16x32_bf16 a[100:103], a[240:243], v[136:139], a[100:103]
 v_exp_f32 v89, v89
 v_mfma_f32_16x16x32_bf16 a[104:107], a[240:243], v[144:147], a[104:107]
 v_exp_f32 v90, v90
 v_mfma_f32_16x16x32_bf16 a[104:107], a[244:247], v[148:151], a[104:107]
 v_cvt_pk_bf16_f32 v178, v88, v89
 v_mfma_f32_16x16x32_bf16 a[108:111], a[244:247], v[156:159], a[108:111]
 v_exp_f32 v91, v91
 v_mfma_f32_16x16x32_bf16 a[108:111], a[240:243], v[152:155], a[108:111]
 s_waitcnt lgkmcnt(6)
 ds_read_b128 a[216:219], v241 offset:6144
 v_cvt_pk_bf16_f32 v179, v90, v91
 v_mfma_f32_16x16x32_bf16 a[124:127], a[248:251], v[152:155], a[124:127]
 v_exp_f32 v92, v92
 v_mfma_f32_16x16x32_bf16 a[124:127], a[252:255], v[156:159], a[124:127]
 v_mfma_f32_16x16x32_bf16 a[120:123], a[252:255], v[148:151], a[120:123]
 v_exp_f32 v93, v93
 v_mfma_f32_16x16x32_bf16 a[120:123], a[248:251], v[144:147], a[120:123]
 ds_read_b128 a[220:223], v241 offset:7168
 v_cvt_pk_bf16_f32 v186, v92, v93
 v_mfma_f32_16x16x32_bf16 a[116:119], a[248:251], v[136:139], a[116:119]
 v_exp_f32 v94, v94
 v_mfma_f32_16x16x32_bf16 a[116:119], a[252:255], v[140:143], a[116:119]
 v_mfma_f32_16x16x32_bf16 a[112:115], a[252:255], v[132:135], a[112:115]
 v_exp_f32 v95, v95
 v_mfma_f32_16x16x32_bf16 a[112:115], a[248:251], v[128:131], a[112:115]
 s_waitcnt lgkmcnt(4)
 v_cvt_pk_bf16_f32 v187, v94, v95
 v_smfmac_f32_16x16x64_bf16 v[236:239], v[244:247], v[152:159], v206
 v_mfma_f32_16x16x32_bf16 v[0:3], a[192:195], a[128:131], v[208:211]
 v_exp_f32 v96, v96
 v_mfma_f32_16x16x32_bf16 v[0:3], a[196:199], a[132:135], v[0:3]
 v_exp_f32 v97, v97
 v_mfma_f32_16x16x32_bf16 v[0:3], a[200:203], a[136:139], v[0:3]
 buffer_load_dwordx4 v255, s[12:15], s92 offen offset:2048 sc1 lds
 v_mfma_f32_16x16x32_bf16 v[0:3], a[204:207], a[140:143], v[0:3]
 ds_read_b128 a[224:227], v241 offset:8192
 ds_read_b128 a[228:231], v241 offset:9216
 v_mfma_f32_16x16x32_bf16 v[4:7], a[204:207], a[156:159], v[212:215]
 v_exp_f32 v98, v98
 v_mfma_f32_16x16x32_bf16 v[4:7], a[200:203], a[152:155], v[4:7]
 v_cvt_pk_bf16_f32 v164, v96, v97
 v_mfma_f32_16x16x32_bf16 v[4:7], a[196:199], a[148:151], v[4:7]
 v_exp_f32 v99, v99
 v_mfma_f32_16x16x32_bf16 v[4:7], a[192:195], a[144:147], v[4:7]
 ds_read_b128 a[232:235], v241 offset:10240
 v_cvt_pk_bf16_f32 v165, v98, v99
 v_mfma_f32_16x16x32_bf16 v[8:11], a[192:195], a[160:163], v[216:219]
 v_exp_f32 v100, v100
 v_mfma_f32_16x16x32_bf16 v[8:11], a[196:199], a[164:167], v[8:11]
 v_mfma_f32_16x16x32_bf16 v[8:11], a[200:203], a[168:171], v[8:11]
 v_exp_f32 v101, v101
 v_mfma_f32_16x16x32_bf16 v[8:11], a[204:207], a[172:175], v[8:11]
 ds_read_b128 a[236:239], v241 offset:11264
 v_cvt_pk_bf16_f32 v172, v100, v101
 v_mfma_f32_16x16x32_bf16 v[12:15], a[204:207], a[188:191], v[220:223]
 v_exp_f32 v102, v102
 v_mfma_f32_16x16x32_bf16 v[12:15], a[200:203], a[184:187], v[12:15]
 v_exp_f32 v103, v103
 v_mfma_f32_16x16x32_bf16 v[12:15], a[196:199], a[180:183], v[12:15]
 ds_read_b128 a[240:243], v241 offset:12288
 v_cvt_pk_bf16_f32 v173, v102, v103
 v_mfma_f32_16x16x32_bf16 v[12:15], a[192:195], a[176:179], v[12:15]
 s_waitcnt lgkmcnt(5)
 v_exp_f32 v104, v104
 v_mfma_f32_16x16x32_bf16 v[28:31], a[208:211], a[176:179], v[220:223]
 v_mfma_f32_16x16x32_bf16 v[28:31], a[212:215], a[180:183], v[28:31]
 buffer_load_dwordx4 v255, s[12:15], s92 offen offset:3072 sc1 lds
 v_mfma_f32_16x16x32_bf16 v[28:31], a[216:219], a[184:187], v[28:31]
 s_add_u32 s92, s92, 4096
 v_exp_f32 v105, v105
 v_mfma_f32_16x16x32_bf16 v[28:31], a[220:223], a[188:191], v[28:31]
 s_and_b32 m0, s92, 0x1ffff
 ds_read_b128 a[244:247], v241 offset:13312
 v_cvt_pk_bf16_f32 v180, v104, v105
 v_mfma_f32_16x16x32_bf16 v[24:27], a[220:223], a[172:175], v[216:219]
 v_exp_f32 v106, v106
 v_mfma_f32_16x16x32_bf16 v[24:27], a[216:219], a[168:171], v[24:27]
 v_mfma_f32_16x16x32_bf16 v[24:27], a[212:215], a[164:167], v[24:27]
 v_exp_f32 v107, v107
 v_mfma_f32_16x16x32_bf16 v[24:27], a[208:211], a[160:163], v[24:27]
 ds_read_b128 a[248:251], v241 offset:14336
 v_cvt_pk_bf16_f32 v181, v106, v107
 v_mfma_f32_16x16x32_bf16 v[20:23], a[208:211], a[144:147], v[212:215]
 v_exp_f32 v108, v108
 v_mfma_f32_16x16x32_bf16 v[20:23], a[212:215], a[148:151], v[20:23]
 v_exp_f32 v109, v109
 v_mfma_f32_16x16x32_bf16 v[20:23], a[216:219], a[152:155], v[20:23]
 ds_read_b128 a[252:255], v241 offset:15360
 v_cvt_pk_bf16_f32 v188, v108, v109
 v_mfma_f32_16x16x32_bf16 v[20:23], a[220:223], a[156:159], v[20:23]
 v_exp_f32 v110, v110
 v_mfma_f32_16x16x32_bf16 v[16:19], a[220:223], a[140:143], v[208:211]
 v_mfma_f32_16x16x32_bf16 v[16:19], a[216:219], a[136:139], v[16:19]
 v_exp_f32 v111, v111
 v_mfma_f32_16x16x32_bf16 v[16:19], a[212:215], a[132:135], v[16:19]
 ds_read_b128 a[192:195], v240 offset:49152
 v_cvt_pk_bf16_f32 v189, v110, v111
 v_mfma_f32_16x16x32_bf16 v[16:19], a[208:211], a[128:131], v[16:19]
 s_waitcnt lgkmcnt(5)
 v_exp_f32 v112, v112
 v_mfma_f32_16x16x32_bf16 v[32:35], a[224:227], a[128:131], v[208:211]
 buffer_load_dwordx4 v255, s[12:15], s92 offen sc1 lds
 v_mfma_f32_16x16x32_bf16 v[32:35], a[228:231], a[132:135], v[32:35]
 v_mfma_f32_16x16x32_bf16 v[32:35], a[232:235], a[136:139], v[32:35]
 v_exp_f32 v113, v113
 v_mfma_f32_16x16x32_bf16 v[32:35], a[236:239], a[140:143], v[32:35]
 ds_read_b128 a[196:199], v240 offset:50176
 v_cvt_pk_bf16_f32 v166, v112, v113
 v_mfma_f32_16x16x32_bf16 v[36:39], a[236:239], a[156:159], v[212:215]
 v_exp_f32 v114, v114
 v_mfma_f32_16x16x32_bf16 v[36:39], a[232:235], a[152:155], v[36:39]
 v_mfma_f32_16x16x32_bf16 v[36:39], a[228:231], a[148:151], v[36:39]
 v_exp_f32 v115, v115
 v_mfma_f32_16x16x32_bf16 v[36:39], a[224:227], a[144:147], v[36:39]
 v_exp_f32 v116, v116
 v_mfma_f32_16x16x32_bf16 v[40:43], a[224:227], a[160:163], v[216:219]
 ds_read_b128 a[200:203], v240 offset:51200
 v_cvt_pk_bf16_f32 v167, v114, v115
 v_mfma_f32_16x16x32_bf16 v[40:43], a[228:231], a[164:167], v[40:43]
 v_exp_f32 v117, v117
 v_mfma_f32_16x16x32_bf16 v[40:43], a[232:235], a[168:171], v[40:43]
 ds_read_b128 a[204:207], v240 offset:52224
 v_cvt_pk_bf16_f32 v174, v116, v117
 v_mfma_f32_16x16x32_bf16 v[40:43], a[236:239], a[172:175], v[40:43]
 v_exp_f32 v118, v118
 v_mfma_f32_16x16x32_bf16 v[44:47], a[236:239], a[188:191], v[220:223]
 v_mfma_f32_16x16x32_bf16 v[44:47], a[232:235], a[184:187], v[44:47]
 v_exp_f32 v119, v119
 v_mfma_f32_16x16x32_bf16 v[44:47], a[228:231], a[180:183], v[44:47]
 ds_read_b128 a[208:211], v240 offset:53248
 v_cvt_pk_bf16_f32 v175, v118, v119
 v_mfma_f32_16x16x32_bf16 v[44:47], a[224:227], a[176:179], v[44:47]
 s_waitcnt lgkmcnt(5)
 v_exp_f32 v120, v120
 v_mfma_f32_16x16x32_bf16 v[60:63], a[240:243], a[176:179], v[220:223]
 buffer_load_dwordx4 v255, s[12:15], s92 offen offset:1024 sc1 lds
 v_mfma_f32_16x16x32_bf16 v[60:63], a[244:247], a[180:183], v[60:63]
 v_mfma_f32_16x16x32_bf16 v[60:63], a[248:251], a[184:187], v[60:63]
 v_exp_f32 v121, v121
 v_mfma_f32_16x16x32_bf16 v[60:63], a[252:255], a[188:191], v[60:63]
 v_exp_f32 v122, v122
 v_mfma_f32_16x16x32_bf16 v[56:59], a[252:255], a[172:175], v[216:219]
 ds_read_b128 a[212:215], v240 offset:54272
 v_cvt_pk_bf16_f32 v182, v120, v121
 v_mfma_f32_16x16x32_bf16 v[56:59], a[248:251], a[168:171], v[56:59]
 v_exp_f32 v123, v123
 v_mfma_f32_16x16x32_bf16 v[56:59], a[244:247], a[164:167], v[56:59]
 ds_read_b128 a[216:219], v240 offset:55296
 v_cvt_pk_bf16_f32 v183, v122, v123
 v_mfma_f32_16x16x32_bf16 v[56:59], a[240:243], a[160:163], v[56:59]
 v_exp_f32 v124, v124
 v_mfma_f32_16x16x32_bf16 v[52:55], a[240:243], a[144:147], v[212:215]
 v_mfma_f32_16x16x32_bf16 v[52:55], a[244:247], a[148:151], v[52:55]
 v_exp_f32 v125, v125
 v_mfma_f32_16x16x32_bf16 v[52:55], a[248:251], a[152:155], v[52:55]
 ds_read_b128 a[220:223], v240 offset:56320
 v_cvt_pk_bf16_f32 v190, v124, v125
 v_mfma_f32_16x16x32_bf16 v[52:55], a[252:255], a[156:159], v[52:55]
 v_exp_f32 v126, v126
 v_mfma_f32_16x16x32_bf16 v[48:51], a[252:255], a[140:143], v[208:211]
 v_mfma_f32_16x16x32_bf16 v[48:51], a[248:251], a[136:139], v[48:51]
 v_exp_f32 v127, v127
 v_mfma_f32_16x16x32_bf16 v[48:51], a[244:247], a[132:135], v[48:51]
 ds_read_b128 a[224:227], v240 offset:57344
 v_cvt_pk_bf16_f32 v191, v126, v127
 v_mfma_f32_16x16x32_bf16 v[48:51], a[240:243], a[128:131], v[48:51]
 s_waitcnt lgkmcnt(7)
 buffer_load_dwordx4 v255, s[12:15], s92 offen offset:2048 sc1 lds
 v_mfma_f32_16x16x32_bf16 a[0:3], a[192:195], v[160:163], a[0:3]
 v_mfma_f32_16x16x32_bf16 a[0:3], a[196:199], v[164:167], a[0:3]
 v_exp_f32 v0, v0
 v_mfma_f32_16x16x32_bf16 a[4:7], a[192:195], v[168:171], a[4:7]
 v_exp_f32 v1, v1
 v_mfma_f32_16x16x32_bf16 a[4:7], a[196:199], v[172:175], a[4:7]
Lw3_4:
 s_cbranch_execz Lw3_back
 ds_read_b128 a[228:231], v240 offset:58368
 v_cvt_pk_bf16_f32 v128, v0, v1
 v_mfma_f32_16x16x32_bf16 a[8:11], a[192:195], v[176:179], a[8:11]
 v_exp_f32 v2, v2
 v_mfma_f32_16x16x32_bf16 a[8:11], a[196:199], v[180:183], a[8:11]
 v_mfma_f32_16x16x32_bf16 a[12:15], a[192:195], v[184:187], a[12:15]
 v_exp_f32 v3, v3
 v_mfma_f32_16x16x32_bf16 a[12:15], a[196:199], v[188:191], a[12:15]
 s_waitcnt lgkmcnt(6)
 ds_read_b128 a[232:235], v240 offset:59392
 v_cvt_pk_bf16_f32 v129, v2, v3
 v_mfma_f32_16x16x32_bf16 a[28:31], a[200:203], v[184:187], a[28:31]
 v_exp_f32 v4, v4
 v_mfma_f32_16x16x32_bf16 a[28:31], a[204:207], v[188:191], a[28:31]
 v_mfma_f32_16x16x32_bf16 a[24:27], a[204:207], v[180:183], a[24:27]
 v_exp_f32 v5, v5
 v_mfma_f32_16x16x32_bf16 a[24:27], a[200:203], v[176:179], a[24:27]
 ds_read_b128 a[236:239], v240 offset:60416
 v_cvt_pk_bf16_f32 v136, v4, v5
 v_mfma_f32_16x16x32_bf16 a[20:23], a[200:203], v[168:171], a[20:23]
 v_exp_f32 v6, v6
 v_mfma_f32_16x16x32_bf16 a[20:23], a[204:207], v[172:175], a[20:23]
 v_exp_f32 v7, v7
 v_mfma_f32_16x16x32_bf16 a[16:19], a[204:207], v[164:167], a[16:19]
 buffer_load_dwordx4 v255, s[12:15], s92 offen offset:3072 sc1 lds
 v_mfma_f32_16x16x32_bf16 a[16:19], a[200:203], v[160:163], a[16:19]
 s_add_u32 s92, s92, 28672
 ds_read_b128 a[240:243], v240 offset:61440
 v_cvt_pk_bf16_f32 v137, v6, v7
 v_smfmac_f32_16x16x64_bf16 v[224:227], v[244:247], v[160:167], v206
 s_waitcnt lgkmcnt(7)
 v_mfma_f32_16x16x32_bf16 a[32:35], a[208:211], v[160:163], a[32:35]
 s_and_b32 m0, s92, 0x1ffff
 v_exp_f32 v8, v8
 v_mfma_f32_16x16x32_bf16 a[32:35], a[212:215], v[164:167], a[32:35]
 v_mfma_f32_16x16x32_bf16 a[36:39], a[212:215], v[172:175], a[36:39]
 v_exp_f32 v9, v9
 v_mfma_f32_16x16x32_bf16 a[36:39], a[208:211], v[168:171], a[36:39]
 ds_read_b128 a[244:247], v240 offset:62464
 v_cvt_pk_bf16_f32 v144, v8, v9
 v_mfma_f32_16x16x32_bf16 a[40:43], a[208:211], v[176:179], a[40:43]
 v_exp_f32 v10, v10
 v_mfma_f32_16x16x32_bf16 a[40:43], a[212:215], v[180:183], a[40:43]
 v_mfma_f32_16x16x32_bf16 a[44:47], a[212:215], v[188:191], a[44:47]
 v_exp_f32 v11, v11
 v_mfma_f32_16x16x32_bf16 a[44:47], a[208:211], v[184:187], a[44:47]
 s_waitcnt lgkmcnt(6)
 ds_read_b128 a[248:251], v240 offset:63488
 v_cvt_pk_bf16_f32 v145, v10, v11
 v_mfma_f32_16x16x32_bf16 a[60:63], a[216:219], v[184:187], a[60:63]
 v_exp_f32 v12, v12
 v_mfma_f32_16x16x32_bf16 a[60:63], a[220:223], v[188:191], a[60:63]
 v_exp_f32 v13, v13
 v_mfma_f32_16x16x32_bf16 a[56:59], a[220:223], v[180:183], a[56:59]
 ds_read_b128 a[252:255], v240 offset:64512
 v_cvt_pk_bf16_f32 v152, v12, v13
 v_mfma_f32_16x16x32_bf16 a[56:59], a[216:219], v[176:179], a[56:59]
 v_exp_f32 v14, v14
 v_mfma_f32_16x16x32_bf16 a[52:55], a[216:219], v[168:171], a[52:55]
 v_xor_b32 v240, 0x10000, v240
 v_mfma_f32_16x16x32_bf16 a[52:55], a[220:223], v[172:175], a[52:55]
 v_exp_f32 v15, v15
 v_mfma_f32_16x16x32_bf16 a[48:51], a[220:223], v[164:167], a[48:51]
 s_waitcnt vmcnt(9)
 v_cvt_pk_bf16_f32 v153, v14, v15
 v_mfma_f32_16x16x32_bf16 a[48:51], a[216:219], v[160:163], a[48:51]
 s_barrier
 v_exp_f32 v16, v16
 v_smfmac_f32_16x16x64_bf16 v[228:231], v[244:247], v[168:175], v206
 s_waitcnt lgkmcnt(6)
 ds_read_b128 a[192:195], v241 offset:32768
 v_mfma_f32_16x16x32_bf16 a[64:67], a[224:227], v[160:163], a[64:67]
 buffer_load_dwordx4 v255, s[12:15], s92 offen sc1 lds
 v_mfma_f32_16x16x32_bf16 a[64:67], a[228:231], v[164:167], a[64:67]
 buffer_load_dword v243, v242, s[16:19], s32 offen
 v_mfma_f32_16x16x32_bf16 a[68:71], a[228:231], v[172:175], a[68:71]
 s_add_u32 s32, s32, s33
 ds_read_b128 a[196:199], v241 offset:33792
 v_mfma_f32_16x16x32_bf16 a[68:71], a[224:227], v[168:171], a[68:71]
 s_sub_u32 s33, s33, 131072
 v_exp_f32 v17, v17
 v_mfma_f32_16x16x32_bf16 a[72:75], a[224:227], v[176:179], a[72:75]
 v_cvt_pk_bf16_f32 v130, v16, v17
 v_mfma_f32_16x16x32_bf16 a[72:75], a[228:231], v[180:183], a[72:75]
 v_exp_f32 v18, v18
 v_mfma_f32_16x16x32_bf16 a[76:79], a[228:231], v[188:191], a[76:79]
 ds_read_b128 a[200:203], v241 offset:34816
 v_mfma_f32_16x16x32_bf16 a[76:79], a[224:227], v[184:187], a[76:79]
 s_waitcnt lgkmcnt(7)
 v_exp_f32 v19, v19
 v_mfma_f32_16x16x32_bf16 a[92:95], a[232:235], v[184:187], a[92:95]
 v_exp_f32 v20, v20
 v_mfma_f32_16x16x32_bf16 a[92:95], a[236:239], v[188:191], a[92:95]
 v_cvt_pk_bf16_f32 v131, v18, v19
 v_mfma_f32_16x16x32_bf16 a[88:91], a[236:239], v[180:183], a[88:91]
 v_exp_f32 v21, v21
 v_mfma_f32_16x16x32_bf16 a[88:91], a[232:235], v[176:179], a[88:91]
 ds_read_b128 a[204:207], v241 offset:35840
 v_cvt_pk_bf16_f32 v138, v20, v21
 v_mfma_f32_16x16x32_bf16 a[84:87], a[232:235], v[168:171], a[84:87]
 v_exp_f32 v22, v22
 v_mfma_f32_16x16x32_bf16 a[84:87], a[236:239], v[172:175], a[84:87]
 v_mfma_f32_16x16x32_bf16 a[80:83], a[236:239], v[164:167], a[80:83]
 v_exp_f32 v23, v23
 v_mfma_f32_16x16x32_bf16 a[80:83], a[232:235], v[160:163], a[80:83]
 ds_read_b128 a[208:211], v241 offset:36864
 v_cvt_pk_bf16_f32 v139, v22, v23
 v_smfmac_f32_16x16x64_bf16 v[232:235], v[244:247], v[176:183], v206
 s_waitcnt lgkmcnt(7)
 v_mfma_f32_16x16x32_bf16 a[96:99], a[240:243], v[160:163], a[96:99]
 buffer_load_dwordx4 v255, s[12:15], s92 offen offset:1024 sc1 lds
 v_mfma_f32_16x16x32_bf16 a[96:99], a[244:247], v[164:167], a[96:99]
 v_exp_f32 v24, v24
 v_mfma_f32_16x16x32_bf16 a[100:103], a[244:247], v[172:175], a[100:103]
 ds_read_b128 a[212:215], v241 offset:37888
 v_mfma_f32_16x16x32_bf16 a[100:103], a[240:243], v[168:171], a[100:103]
 v_exp_f32 v25, v25
 v_mfma_f32_16x16x32_bf16 a[104:107], a[240:243], v[176:179], a[104:107]
 v_exp_f32 v26, v26
 v_mfma_f32_16x16x32_bf16 a[104:107], a[244:247], v[180:183], a[104:107]
 v_cvt_pk_bf16_f32 v146, v24, v25
 v_mfma_f32_16x16x32_bf16 a[108:111], a[244:247], v[188:191], a[108:111]
 v_exp_f32 v27, v27
 v_mfma_f32_16x16x32_bf16 a[108:111], a[240:243], v[184:187], a[108:111]
 s_waitcnt lgkmcnt(6)
 ds_read_b128 a[216:219], v241 offset:38912
 v_cvt_pk_bf16_f32 v147, v26, v27
 v_mfma_f32_16x16x32_bf16 a[124:127], a[248:251], v[184:187], a[124:127]
 v_exp_f32 v28, v28
 v_mfma_f32_16x16x32_bf16 a[124:127], a[252:255], v[188:191], a[124:127]
 v_mfma_f32_16x16x32_bf16 a[120:123], a[252:255], v[180:183], a[120:123]
 v_exp_f32 v29, v29
 v_mfma_f32_16x16x32_bf16 a[120:123], a[248:251], v[176:179], a[120:123]
 ds_read_b128 a[220:223], v241 offset:39936
 v_cvt_pk_bf16_f32 v154, v28, v29
 v_mfma_f32_16x16x32_bf16 a[116:119], a[248:251], v[168:171], a[116:119]
 v_exp_f32 v30, v30
 v_mfma_f32_16x16x32_bf16 a[116:119], a[252:255], v[172:175], a[116:119]
 v_mfma_f32_16x16x32_bf16 a[112:115], a[252:255], v[164:167], a[112:115]
 s_waitcnt lgkmcnt(4)
 v_exp_f32 v31, v31
 v_mfma_f32_16x16x32_bf16 a[112:115], a[248:251], v[160:163], a[112:115]
 s_cmp_lg_u32 s30, 0
 v_cvt_pk_bf16_f32 v155, v30, v31
 v_smfmac_f32_16x16x64_bf16 v[236:239], v[244:247], v[184:191], v206
 s_cbranch_scc1 L44
L43:
 v_mfma_f32_16x16x32_bf16 v[68:71], a[192:195], a[144:147], v[212:215]
 v_exp_f32 v32, v32
 v_mfma_f32_16x16x32_bf16 v[68:71], a[196:199], a[148:151], v[68:71]
 v_exp_f32 v33, v33
 v_mfma_f32_16x16x32_bf16 v[68:71], a[200:203], a[152:155], v[68:71]
 buffer_load_dwordx4 v255, s[12:15], s92 offen offset:2048 sc1 lds
 v_mfma_f32_16x16x32_bf16 v[68:71], a[204:207], a[156:159], v[68:71]
 s_mov_b32 s8, s84
 ds_read_b128 a[224:227], v240 offset:40960
 v_exp_f32 v34, v34
 v_mfma_f32_16x16x32_bf16 v[72:75], a[204:207], a[172:175], v[216:219]
 s_mov_b32 s9, s85
 v_and_b32 v131, v131, v195
 v_and_b32 v130, v130, v194
 v_and_b32 v129, v129, v193
 v_and_b32 v128, v128, v192
 v_mfma_f32_16x16x32_bf16 v[72:75], a[200:203], a[168:171], v[72:75]
 s_mov_b32 s10, 917504
 v_exp_f32 v35, v35
 v_mfma_f32_16x16x32_bf16 v[72:75], a[196:199], a[164:167], v[72:75]
 s_sub_u32 s23, 255, s2
 ds_read_b128 a[228:231], v240 offset:41984
 v_exp_f32 v36, v36
 v_mfma_f32_16x16x32_bf16 v[72:75], a[192:195], a[160:163], v[72:75]
 s_lshl_b32 s24, s20, 8
 v_exp_f32 v37, v37
 v_mfma_f32_16x16x32_bf16 v[76:79], a[192:195], a[176:179], v[220:223]
 s_add_u32 s23, s23, s24
 ds_read_b128 a[232:235], v240 offset:43008
 v_cvt_pk_bf16_f32 v132, v32, v33
 v_mfma_f32_16x16x32_bf16 v[76:79], a[196:199], a[180:183], v[76:79]
 s_mul_i32 s32, s23, 4096
 v_exp_f32 v38, v38
 v_mfma_f32_16x16x32_bf16 v[76:79], a[200:203], a[184:187], v[76:79]
 s_mov_b32 s16, s82
 v_exp_f32 v39, v39
 v_mfma_f32_16x16x32_bf16 v[76:79], a[204:207], a[188:191], v[76:79]
 s_waitcnt lgkmcnt(3)
 ds_read_b128 a[236:239], v240 offset:44032
 ds_read_b128 a[240:243], v240 offset:45056
 v_mfma_f32_16x16x32_bf16 v[84:87], a[208:211], a[144:147], v[212:215]
 s_mov_b32 s17, s83
 v_exp_f32 v40, v40
 v_mfma_f32_16x16x32_bf16 v[84:87], a[212:215], a[148:151], v[84:87]
 s_mov_b32 s18, 4096
 v_exp_f32 v41, v41
 v_mfma_f32_16x16x32_bf16 v[84:87], a[216:219], a[152:155], v[84:87]
 s_lshl_b32 s33, s20, 10
 buffer_load_dwordx4 v255, s[12:15], s92 offen offset:3072 sc1 lds
 v_mfma_f32_16x16x32_bf16 v[84:87], a[220:223], a[156:159], v[84:87]
 s_add_u32 s92, s92, 4096
 v_exp_f32 v42, v42
 v_mfma_f32_16x16x32_bf16 v[88:91], a[220:223], a[172:175], v[216:219]
 s_and_b32 m0, s92, 0x1ffff
 v_cvt_pk_bf16_f32 v140, v36, v37
 v_cvt_pk_bf16_f32 v133, v34, v35
 v_mfma_f32_16x16x32_bf16 v[88:91], a[216:219], a[168:171], v[88:91]
 s_lshl_b32 s25, s2, 2
 v_exp_f32 v43, v43
 v_mfma_f32_16x16x32_bf16 v[88:91], a[212:215], a[164:167], v[88:91]
 s_add_u32 s25, s25, s20
 ds_read_b128 a[244:247], v240 offset:46080
 v_exp_f32 v44, v44
 v_mfma_f32_16x16x32_bf16 v[88:91], a[208:211], a[160:163], v[88:91]
 s_lshl_b32 s25, s25, 13
 v_exp_f32 v45, v45
 v_mfma_f32_16x16x32_bf16 v[92:95], a[208:211], a[176:179], v[220:223]
 s_add_u32 s95, s25, 85983232
 ds_read_b128 a[248:251], v240 offset:47104
 v_cvt_pk_bf16_f32 v141, v38, v39
 v_mfma_f32_16x16x32_bf16 v[92:95], a[212:215], a[180:183], v[92:95]
 s_add_u32 s25, s95, 2048
 v_exp_f32 v46, v46
 v_mfma_f32_16x16x32_bf16 v[92:95], a[216:219], a[184:187], v[92:95]
 v_exp_f32 v47, v47
 v_mfma_f32_16x16x32_bf16 v[92:95], a[220:223], a[188:191], v[92:95]
 s_waitcnt lgkmcnt(3)
 ds_read_b128 a[252:255], v240 offset:48128
 v_cvt_pk_bf16_f32 v148, v40, v41
 v_mfma_f32_16x16x32_bf16 v[100:103], a[224:227], a[144:147], v[212:215]
 v_exp_f32 v48, v48
 v_mfma_f32_16x16x32_bf16 v[100:103], a[228:231], a[148:151], v[100:103]
 v_exp_f32 v49, v49
 v_mfma_f32_16x16x32_bf16 v[100:103], a[232:235], a[152:155], v[100:103]
 v_exp_f32 v50, v50
 v_mfma_f32_16x16x32_bf16 v[100:103], a[236:239], a[156:159], v[100:103]
 buffer_load_dwordx4 v255, s[12:15], s92 offen sc1 lds
 ds_read_b128 a[192:195], v240 offset:16384
 v_mfma_f32_16x16x32_bf16 v[104:107], a[236:239], a[172:175], v[216:219]
 v_cvt_pk_bf16_f32 v156, v44, v45
 v_cvt_pk_bf16_f32 v149, v42, v43
 v_mfma_f32_16x16x32_bf16 v[104:107], a[232:235], a[168:171], v[104:107]
 v_exp_f32 v51, v51
 v_mfma_f32_16x16x32_bf16 v[104:107], a[228:231], a[164:167], v[104:107]
 ds_read_b128 a[196:199], v240 offset:17408
 v_exp_f32 v52, v52
 v_mfma_f32_16x16x32_bf16 v[104:107], a[224:227], a[160:163], v[104:107]
 v_exp_f32 v53, v53
 v_mfma_f32_16x16x32_bf16 v[108:111], a[224:227], a[176:179], v[220:223]
 ds_read_b128 a[200:203], v240 offset:18432
 v_cvt_pk_bf16_f32 v157, v46, v47
 v_mfma_f32_16x16x32_bf16 v[108:111], a[228:231], a[180:183], v[108:111]
 v_exp_f32 v54, v54
 v_mfma_f32_16x16x32_bf16 v[108:111], a[232:235], a[184:187], v[108:111]
 v_exp_f32 v55, v55
 v_mfma_f32_16x16x32_bf16 v[108:111], a[236:239], a[188:191], v[108:111]
 s_waitcnt lgkmcnt(3)
 ds_read_b128 a[204:207], v240 offset:19456
 v_cvt_pk_bf16_f32 v134, v48, v49
 v_mfma_f32_16x16x32_bf16 v[116:119], a[240:243], a[144:147], v[212:215]
 v_exp_f32 v56, v56
 v_mfma_f32_16x16x32_bf16 v[116:119], a[244:247], a[148:151], v[116:119]
 v_exp_f32 v57, v57
 v_mfma_f32_16x16x32_bf16 v[116:119], a[248:251], a[152:155], v[116:119]
 v_exp_f32 v58, v58
 v_mfma_f32_16x16x32_bf16 v[116:119], a[252:255], a[156:159], v[116:119]
 ds_read_b128 a[208:211], v240 offset:20480
 v_cvt_pk_bf16_f32 v135, v50, v51
 v_mfma_f32_16x16x32_bf16 v[120:123], a[252:255], a[172:175], v[216:219]
 buffer_load_dwordx4 v255, s[12:15], s92 offen offset:1024 sc1 lds
 v_mfma_f32_16x16x32_bf16 v[120:123], a[248:251], a[168:171], v[120:123]
 v_exp_f32 v59, v59
 v_mfma_f32_16x16x32_bf16 v[120:123], a[244:247], a[164:167], v[120:123]
 ds_read_b128 a[212:215], v240 offset:21504
 v_cvt_pk_bf16_f32 v142, v52, v53
 v_exp_f32 v60, v60
 v_mfma_f32_16x16x32_bf16 v[120:123], a[240:243], a[160:163], v[120:123]
 v_exp_f32 v61, v61
 v_mfma_f32_16x16x32_bf16 v[124:127], a[240:243], a[176:179], v[220:223]
 ds_read_b128 a[216:219], v240 offset:22528
 v_cvt_pk_bf16_f32 v143, v54, v55
 v_mfma_f32_16x16x32_bf16 v[124:127], a[244:247], a[180:183], v[124:127]
 v_exp_f32 v62, v62
 v_mfma_f32_16x16x32_bf16 v[124:127], a[248:251], a[184:187], v[124:127]
 v_and_b32 v135, v135, v199
 v_and_b32 v134, v134, v198
 v_and_b32 v133, v133, v197
 v_and_b32 v132, v132, v196
 v_exp_f32 v63, v63
 v_mfma_f32_16x16x32_bf16 v[124:127], a[252:255], a[188:191], v[124:127]
 s_waitcnt lgkmcnt(5)
 ds_read_b128 a[220:223], v240 offset:23552
 v_cvt_pk_bf16_f32 v150, v56, v57
 v_mfma_f32_16x16x32_bf16 a[0:3], a[192:195], v[128:131], a[0:3]
 ds_read_b128 a[224:227], v240 offset:24576
 v_cvt_pk_bf16_f32 v151, v58, v59
 v_mfma_f32_16x16x32_bf16 a[0:3], a[196:199], v[132:135], a[0:3]
 v_exp_f32 v68, v68
 v_mfma_f32_16x16x32_bf16 a[4:7], a[192:195], v[136:139], a[4:7]
 v_cvt_pk_bf16_f32 v159, v62, v63
 v_cvt_pk_bf16_f32 v158, v60, v61
 v_mfma_f32_16x16x32_bf16 a[4:7], a[196:199], v[140:143], a[4:7]
 v_exp_f32 v69, v69
 v_mfma_f32_16x16x32_bf16 a[8:11], a[192:195], v[144:147], a[8:11]
 buffer_load_dwordx4 v255, s[12:15], s92 offen offset:2048 sc1 lds
 v_mfma_f32_16x16x32_bf16 a[8:11], a[196:199], v[148:151], a[8:11]
 ds_read_b128 a[228:231], v240 offset:25600
 v_cvt_pk_bf16_f32 v168, v68, v69
 v_mfma_f32_16x16x32_bf16 a[12:15], a[192:195], v[152:155], a[12:15]
 v_exp_f32 v70, v70
 v_mfma_f32_16x16x32_bf16 a[12:15], a[196:199], v[156:159], a[12:15]
 s_waitcnt lgkmcnt(6)
 ds_read_b128 a[232:235], v240 offset:26624
 v_xor_b32 v241, 0x10000, v241
 v_mfma_f32_16x16x32_bf16 a[28:31], a[200:203], v[152:155], a[28:31]
 v_exp_f32 v71, v71
 v_mfma_f32_16x16x32_bf16 a[28:31], a[204:207], v[156:159], a[28:31]
 v_cvt_pk_bf16_f32 v169, v70, v71
 v_mov_b32 v200, -1
 v_mfma_f32_16x16x32_bf16 a[24:27], a[204:207], v[148:151], a[24:27]
 v_exp_f32 v72, v72
 v_mfma_f32_16x16x32_bf16 a[24:27], a[200:203], v[144:147], a[24:27]
 ds_read_b128 a[236:239], v240 offset:27648
 v_mov_b32 v201, -1
 v_mfma_f32_16x16x32_bf16 a[20:23], a[200:203], v[136:139], a[20:23]
 v_exp_f32 v73, v73
 v_mfma_f32_16x16x32_bf16 a[20:23], a[204:207], v[140:143], a[20:23]
 v_cvt_pk_bf16_f32 v176, v72, v73
 v_mov_b32 v202, -1
 v_mfma_f32_16x16x32_bf16 a[16:19], a[204:207], v[132:135], a[16:19]
 v_exp_f32 v74, v74
 v_mfma_f32_16x16x32_bf16 a[16:19], a[200:203], v[128:131], a[16:19]
 ds_read_b128 a[240:243], v240 offset:28672
 v_mov_b32 v203, -1
 v_smfmac_f32_16x16x64_bf16 v[224:227], v[244:247], v[128:135], v206
 s_waitcnt lgkmcnt(7)
 v_mfma_f32_16x16x32_bf16 a[32:35], a[208:211], v[128:131], a[32:35]
 buffer_load_dwordx4 v255, s[12:15], s92 offen offset:3072 sc1 lds
 v_mfma_f32_16x16x32_bf16 a[32:35], a[212:215], v[132:135], a[32:35]
 s_add_u32 s92, s92, 28672
 v_exp_f32 v75, v75
 v_mfma_f32_16x16x32_bf16 a[36:39], a[212:215], v[140:143], a[36:39]
 s_and_b32 m0, s92, 0x1ffff
 ds_read_b128 a[244:247], v240 offset:29696
 v_cvt_pk_bf16_f32 v177, v74, v75
 v_mfma_f32_16x16x32_bf16 a[36:39], a[208:211], v[136:139], a[36:39]
 v_mfma_f32_16x16x32_bf16 a[40:43], a[208:211], v[144:147], a[40:43]
 v_exp_f32 v76, v76
 v_mfma_f32_16x16x32_bf16 a[40:43], a[212:215], v[148:151], a[40:43]
 v_mfma_f32_16x16x32_bf16 a[44:47], a[212:215], v[156:159], a[44:47]
 v_exp_f32 v77, v77
 v_mfma_f32_16x16x32_bf16 a[44:47], a[208:211], v[152:155], a[44:47]
 s_waitcnt lgkmcnt(6)
 ds_read_b128 a[248:251], v240 offset:30720
 v_cvt_pk_bf16_f32 v184, v76, v77
 v_mfma_f32_16x16x32_bf16 a[60:63], a[216:219], v[152:155], a[60:63]
 v_exp_f32 v78, v78
 v_mfma_f32_16x16x32_bf16 a[60:63], a[220:223], v[156:159], a[60:63]
 v_mfma_f32_16x16x32_bf16 a[56:59], a[220:223], v[148:151], a[56:59]
 v_exp_f32 v79, v79
 v_mfma_f32_16x16x32_bf16 a[56:59], a[216:219], v[144:147], a[56:59]
 ds_read_b128 a[252:255], v240 offset:31744
 v_cvt_pk_bf16_f32 v185, v78, v79
 v_mfma_f32_16x16x32_bf16 a[52:55], a[216:219], v[136:139], a[52:55]
 v_exp_f32 v84, v84
 v_mfma_f32_16x16x32_bf16 a[52:55], a[220:223], v[140:143], a[52:55]
 v_mfma_f32_16x16x32_bf16 a[48:51], a[220:223], v[132:135], a[48:51]
 s_waitcnt vmcnt(9)
 v_exp_f32 v85, v85
 v_mfma_f32_16x16x32_bf16 a[48:51], a[216:219], v[128:131], a[48:51]
 s_barrier
 v_cvt_pk_bf16_f32 v170, v84, v85
 v_smfmac_f32_16x16x64_bf16 v[228:231], v[244:247], v[136:143], v206
 s_waitcnt lgkmcnt(6)
 ds_read_b128 a[192:195], v241 offset:0
 v_mfma_f32_16x16x32_bf16 a[64:67], a[224:227], v[128:131], a[64:67]
 buffer_load_dwordx4 v255, s[12:15], s92 offen sc1 lds
 v_mfma_f32_16x16x32_bf16 a[64:67], a[228:231], v[132:135], a[64:67]
 buffer_load_dword v243, v242, s[8:11], s32 offen
 v_mfma_f32_16x16x32_bf16 a[68:71], a[228:231], v[140:143], a[68:71]
 buffer_load_dword v243, v255, s[16:19], s33 offen
 v_mfma_f32_16x16x32_bf16 a[68:71], a[224:227], v[136:139], a[68:71]
 v_exp_f32 v86, v86
 v_mfma_f32_16x16x32_bf16 a[72:75], a[224:227], v[144:147], a[72:75]
 ds_read_b128 a[196:199], v241 offset:1024
 v_mfma_f32_16x16x32_bf16 a[72:75], a[228:231], v[148:151], a[72:75]
 buffer_store_dwordx4 v[200:203], v255, s[4:7], s95 offen sc1
 v_mfma_f32_16x16x32_bf16 a[76:79], a[228:231], v[156:159], a[76:79]
 v_exp_f32 v87, v87
 v_mfma_f32_16x16x32_bf16 a[76:79], a[224:227], v[152:155], a[76:79]
 s_waitcnt lgkmcnt(6)
 ds_read_b128 a[200:203], v241 offset:2048
 v_cvt_pk_bf16_f32 v171, v86, v87
 v_mfma_f32_16x16x32_bf16 a[92:95], a[232:235], v[152:155], a[92:95]
 v_mfma_f32_16x16x32_bf16 a[92:95], a[236:239], v[156:159], a[92:95]
 buffer_store_dwordx4 v[200:203], v255, s[4:7], s95 offen offset:1024 sc1
 v_mfma_f32_16x16x32_bf16 a[88:91], a[236:239], v[148:151], a[88:91]
 v_exp_f32 v88, v88
 v_mfma_f32_16x16x32_bf16 a[88:91], a[232:235], v[144:147], a[88:91]
 ds_read_b128 a[204:207], v241 offset:3072
 v_mfma_f32_16x16x32_bf16 a[84:87], a[232:235], v[136:139], a[84:87]
 v_exp_f32 v89, v89
 v_mfma_f32_16x16x32_bf16 a[84:87], a[236:239], v[140:143], a[84:87]
 buffer_store_dwordx4 v[200:203], v255, s[4:7], s25 offen sc1
 v_mfma_f32_16x16x32_bf16 a[80:83], a[236:239], v[132:135], a[80:83]
 v_cvt_pk_bf16_f32 v178, v88, v89
 v_mfma_f32_16x16x32_bf16 a[80:83], a[232:235], v[128:131], a[80:83]
 v_exp_f32 v90, v90
 v_smfmac_f32_16x16x64_bf16 v[232:235], v[244:247], v[144:151], v206
 s_waitcnt lgkmcnt(6)
 ds_read_b128 a[208:211], v241 offset:4096
 v_mfma_f32_16x16x32_bf16 a[96:99], a[240:243], v[128:131], a[96:99]
 buffer_load_dwordx4 v255, s[12:15], s92 offen offset:1024 sc1 lds
 v_mfma_f32_16x16x32_bf16 a[96:99], a[244:247], v[132:135], a[96:99]
 buffer_store_dwordx4 v[200:203], v255, s[4:7], s25 offen offset:1024 sc1
 v_mfma_f32_16x16x32_bf16 a[100:103], a[244:247], v[140:143], a[100:103]
 ds_read_b128 a[212:215], v241 offset:5120
 v_mfma_f32_16x16x32_bf16 a[100:103], a[240:243], v[136:139], a[100:103]
 v_exp_f32 v91, v91
 v_mfma_f32_16x16x32_bf16 a[104:107], a[240:243], v[144:147], a[104:107]
 buffer_store_dwordx4 v[200:203], v255, s[4:7], s25 offen offset:2048 sc1
 v_mfma_f32_16x16x32_bf16 a[104:107], a[244:247], v[148:151], a[104:107]
 v_cvt_pk_bf16_f32 v179, v90, v91
 v_mfma_f32_16x16x32_bf16 a[108:111], a[244:247], v[156:159], a[108:111]
 v_exp_f32 v92, v92
 v_mfma_f32_16x16x32_bf16 a[108:111], a[240:243], v[152:155], a[108:111]
 s_waitcnt lgkmcnt(6)
 ds_read_b128 a[216:219], v241 offset:6144
 v_mfma_f32_16x16x32_bf16 a[124:127], a[248:251], v[152:155], a[124:127]
 buffer_store_dwordx4 v[200:203], v255, s[4:7], s25 offen offset:3072 sc1
 v_mfma_f32_16x16x32_bf16 a[124:127], a[252:255], v[156:159], a[124:127]
 v_exp_f32 v93, v93
 v_mfma_f32_16x16x32_bf16 a[120:123], a[252:255], v[148:151], a[120:123]
 ds_read_b128 a[220:223], v241 offset:7168
 v_cvt_pk_bf16_f32 v186, v92, v93
 v_mfma_f32_16x16x32_bf16 a[120:123], a[248:251], v[144:147], a[120:123]
 v_exp_f32 v94, v94
 v_mfma_f32_16x16x32_bf16 a[116:119], a[248:251], v[136:139], a[116:119]
 v_mfma_f32_16x16x32_bf16 a[116:119], a[252:255], v[140:143], a[116:119]
 v_exp_f32 v95, v95
 v_mfma_f32_16x16x32_bf16 a[112:115], a[252:255], v[132:135], a[112:115]
 v_cvt_pk_bf16_f32 v187, v94, v95
 v_mfma_f32_16x16x32_bf16 a[112:115], a[248:251], v[128:131], a[112:115]
 s_waitcnt lgkmcnt(4)
 v_smfmac_f32_16x16x64_bf16 v[236:239], v[244:247], v[152:159], v206
 v_mfma_f32_16x16x32_bf16 v[8:11], a[192:195], a[160:163], v[216:219]
 v_exp_f32 v100, v100
 v_mfma_f32_16x16x32_bf16 v[8:11], a[196:199], a[164:167], v[8:11]
 v_exp_f32 v101, v101
 v_mfma_f32_16x16x32_bf16 v[8:11], a[200:203], a[168:171], v[8:11]
 buffer_load_dwordx4 v255, s[12:15], s92 offen offset:2048 sc1 lds
 v_mfma_f32_16x16x32_bf16 v[8:11], a[204:207], a[172:175], v[8:11]
 s_bfe_u32 s62, s2, 0x20001
 ds_read_b128 a[224:227], v241 offset:8192
 v_exp_f32 v102, v102
 v_mfma_f32_16x16x32_bf16 v[12:15], a[204:207], a[188:191], v[220:223]
 s_and_b32 s30, s62, 1
 v_and_b32 v171, v171, v195
 v_and_b32 v170, v170, v194
 v_and_b32 v169, v169, v193
 v_and_b32 v168, v168, v192
 v_exp_f32 v103, v103
 v_mfma_f32_16x16x32_bf16 v[12:15], a[200:203], a[184:187], v[12:15]
 s_lshl_b32 s30, s30, 6
 ds_read_b128 a[228:231], v241 offset:9216
 v_exp_f32 v104, v104
 v_mfma_f32_16x16x32_bf16 v[12:15], a[196:199], a[180:183], v[12:15]
 s_and_b32 s60, s2, 1
 v_exp_f32 v105, v105
 v_add_f32 v224, v224, v225
 v_mfma_f32_16x16x32_bf16 v[12:15], a[192:195], a[176:179], v[12:15]
 s_waitcnt lgkmcnt(2)
 ds_read_b128 a[232:235], v241 offset:10240
 ds_read_b128 a[236:239], v241 offset:11264
 v_mfma_f32_16x16x32_bf16 v[28:31], a[208:211], a[176:179], v[220:223]
 s_bfe_u32 s23, s2, 0x30003
 v_exp_f32 v106, v106
 v_mfma_f32_16x16x32_bf16 v[28:31], a[212:215], a[180:183], v[28:31]
 s_lshl_b32 s23, s23, 1
 v_exp_f32 v107, v107
 v_mfma_f32_16x16x32_bf16 v[28:31], a[216:219], a[184:187], v[28:31]
 s_add_u32 s60, s60, s23
 buffer_load_dwordx4 v255, s[12:15], s92 offen offset:3072 sc1 lds
 v_mfma_f32_16x16x32_bf16 v[28:31], a[220:223], a[188:191], v[28:31]
 s_add_u32 s92, s92, 4096
 ds_read_b128 a[240:243], v241 offset:12288
 v_exp_f32 v108, v108
 v_mfma_f32_16x16x32_bf16 v[24:27], a[220:223], a[172:175], v[216:219]
 s_and_b32 m0, s92, 0x1ffff
 v_cvt_pk_bf16_f32 v172, v100, v101
 v_exp_f32 v109, v109
 v_mfma_f32_16x16x32_bf16 v[24:27], a[216:219], a[168:171], v[24:27]
 s_lshr_b32 s61, s2, 6
 ds_read_b128 a[244:247], v241 offset:13312
 v_exp_f32 v110, v110
 v_mfma_f32_16x16x32_bf16 v[24:27], a[212:215], a[164:167], v[24:27]
 s_and_b32 s34, s22, 1
 v_exp_f32 v111, v111
 v_mfma_f32_16x16x32_bf16 v[24:27], a[208:211], a[160:163], v[24:27]
 s_waitcnt lgkmcnt(2)
 ds_read_b128 a[248:251], v241 offset:14336
 v_cvt_pk_bf16_f32 v173, v102, v103
 v_mfma_f32_16x16x32_bf16 v[40:43], a[224:227], a[160:163], v[216:219]
 s_lshl_b32 s34, s34, 16
 v_exp_f32 v116, v116
 v_mfma_f32_16x16x32_bf16 v[40:43], a[228:231], a[164:167], v[40:43]
 s_lshl_b32 s24, s20, 13
 ds_read_b128 a[252:255], v241 offset:15360
 v_cvt_pk_bf16_f32 v180, v104, v105
 v_exp_f32 v117, v117
 v_mfma_f32_16x16x32_bf16 v[40:43], a[232:235], a[168:171], v[40:43]
 s_add_u32 s35, s24, 0x20000
 v_exp_f32 v118, v118
 v_mfma_f32_16x16x32_bf16 v[40:43], a[236:239], a[172:175], v[40:43]
 s_lshl_b32 s24, s20, 12
 buffer_load_dwordx4 v255, s[12:15], s92 offen sc1 lds
 ds_read_b128 a[192:195], v240 offset:49152
 v_mfma_f32_16x16x32_bf16 v[44:47], a[236:239], a[188:191], v[220:223]
 s_add_u32 s47, s24, 0x20000
 v_cvt_pk_bf16_f32 v181, v106, v107
 v_exp_f32 v119, v119
 v_mfma_f32_16x16x32_bf16 v[44:47], a[232:235], a[184:187], v[44:47]
 s_add_u32 s37, s34, s24
 ds_read_b128 a[196:199], v240 offset:50176
 v_exp_f32 v120, v120
 v_mfma_f32_16x16x32_bf16 v[44:47], a[228:231], a[180:183], v[44:47]
 s_xor_b32 s36, s37, 0x10000
 v_exp_f32 v121, v121
 v_mfma_f32_16x16x32_bf16 v[44:47], a[224:227], a[176:179], v[44:47]
 s_waitcnt lgkmcnt(3)
 ds_read_b128 a[200:203], v240 offset:51200
 v_cvt_pk_bf16_f32 v188, v108, v109
 v_mfma_f32_16x16x32_bf16 v[60:63], a[240:243], a[176:179], v[220:223]
 s_lshl_b32 s23, s62, 20
 v_exp_f32 v122, v122
 v_mfma_f32_16x16x32_bf16 v[60:63], a[244:247], a[180:183], v[60:63]
 s_lshl_b32 s24, s20, 15
 ds_read_b128 a[204:207], v240 offset:52224
 v_cvt_pk_bf16_f32 v189, v110, v111
 v_exp_f32 v123, v123
 v_mfma_f32_16x16x32_bf16 v[60:63], a[248:251], a[184:187], v[60:63]
 s_waitcnt lgkmcnt(3)
 v_exp_f32 v124, v124
 v_mfma_f32_16x16x32_bf16 v[60:63], a[252:255], a[188:191], v[60:63]
 s_add_u32 s23, s23, s24
 buffer_load_dwordx4 v255, s[12:15], s92 offen offset:1024 sc1 lds
 ds_read_b128 a[208:211], v240 offset:53248
 v_mfma_f32_16x16x32_bf16 v[56:59], a[252:255], a[172:175], v[216:219]
 s_lshl_b32 s25, s61, 8
 v_cvt_pk_bf16_f32 v174, v116, v117
 v_exp_f32 v125, v125
 v_mfma_f32_16x16x32_bf16 v[56:59], a[248:251], a[168:171], v[56:59]
 s_add_u32 s23, s23, s25
 ds_read_b128 a[212:215], v240 offset:54272
 v_cvt_pk_bf16_f32 v175, v118, v119
 v_exp_f32 v126, v126
 v_mfma_f32_16x16x32_bf16 v[56:59], a[244:247], a[164:167], v[56:59]
 s_lshr_b32 s26, s62, 1
 v_and_b32 v175, v175, v199
 v_and_b32 v174, v174, v198
 v_and_b32 v173, v173, v197
 v_and_b32 v172, v172, v196
 v_exp_f32 v127, v127
 v_mfma_f32_16x16x32_bf16 v[56:59], a[240:243], a[160:163], v[56:59]
 s_lshl_b32 s26, s26, 7
 ds_read_b128 a[216:219], v240 offset:55296
 v_cvt_pk_bf16_f32 v182, v120, v121
 v_mfma_f32_16x16x32_bf16 a[4:7], a[192:195], v[168:171], a[4:7]
 s_waitcnt lgkmcnt(5)
 ds_read_b128 a[220:223], v240 offset:56320
 v_cvt_pk_bf16_f32 v183, v122, v123
 v_mfma_f32_16x16x32_bf16 a[4:7], a[196:199], v[172:175], a[4:7]
 s_add_u32 s58, s23, s26
 v_exp_f32 v8, v8
 v_mfma_f32_16x16x32_bf16 a[8:11], a[192:195], v[176:179], a[8:11]
 s_xor_b32 s59, s58, 128
 v_cvt_pk_bf16_f32 v191, v126, v127
 v_cvt_pk_bf16_f32 v190, v124, v125
 v_mfma_f32_16x16x32_bf16 a[8:11], a[196:199], v[180:183], a[8:11]
 s_lshl_b32 s24, s20, 14
 ds_read_b128 a[224:227], v240 offset:57344
 v_exp_f32 v9, v9
 v_mfma_f32_16x16x32_bf16 a[12:15], a[192:195], v[184:187], a[12:15]
 s_add_u32 s24, s24, s25
 buffer_load_dwordx4 v255, s[12:15], s92 offen offset:2048 sc1 lds
 v_mfma_f32_16x16x32_bf16 a[12:15], a[196:199], v[188:191], a[12:15]
 s_lshl_b32 s26, s62, 6
 ds_read_b128 a[228:231], v240 offset:58368
 ds_read_b128 a[232:235], v240 offset:59392
 v_smfmac_f32_16x16x64_bf16 v[228:231], v[244:247], v[168:175], v206
 s_waitcnt lgkmcnt(7)
 v_cvt_pk_bf16_f32 v144, v8, v9
 v_mfma_f32_16x16x32_bf16 a[20:23], a[200:203], v[168:171], a[20:23]
 s_add_u32 s24, s24, s26
 ds_read_b128 a[236:239], v240 offset:60416
 v_rcp_f32 v226, v224
 v_mfma_f32_16x16x32_bf16 a[20:23], a[204:207], v[172:175], a[20:23]
 s_lshl_b32 s23, s60, 16
 v_exp_f32 v10, v10
 v_accvgpr_read_b32 v0, a0
 v_mfma_f32_16x16x32_bf16 a[24:27], a[204:207], v[180:183], a[24:27]
 s_add_u32 s63, s24, s23
 v_accvgpr_read_b32 v1, a1
 v_accvgpr_read_b32 v2, a2
 v_accvgpr_read_b32 v3, a3
 v_mfma_f32_16x16x32_bf16 a[24:27], a[200:203], v[176:179], a[24:27]
 s_sub_u32 s24, s24, s23
 v_exp_f32 v11, v11
 v_accvgpr_read_b32 v64, a16
 v_mfma_f32_16x16x32_bf16 a[28:31], a[200:203], v[184:187], a[28:31]
 s_add_u32 s94, s24, 2031616
 ds_read_b128 a[240:243], v240 offset:61440
 v_cvt_pk_bf16_f32 v145, v10, v11
 v_accvgpr_read_b32 v65, a17
 v_mfma_f32_16x16x32_bf16 a[28:31], a[204:207], v[188:191], a[28:31]
 s_waitcnt lgkmcnt(7)
 buffer_load_dwordx4 v255, s[12:15], s92 offen offset:3072 sc1 lds
 v_mfma_f32_16x16x32_bf16 a[36:39], a[208:211], v[168:171], a[36:39]
 s_add_u32 s92, s92, 28672
 ds_read_b128 a[244:247], v240 offset:62464
 v_accvgpr_read_b32 v66, a18
 v_accvgpr_read_b32 v67, a19
 v_mfma_f32_16x16x32_bf16 a[36:39], a[212:215], v[172:175], a[36:39]
Lw3_5:
 s_cbranch_execz Lw3_back
 s_and_b32 m0, s92, 0x1ffff
 v_exp_f32 v12, v12
 v_mul_f32 v0, v0, v226
 v_mfma_f32_16x16x32_bf16 a[40:43], a[212:215], v[180:183], a[40:43]
 s_lshl_b32 s23, s22, 5
 v_mul_f32 v1, v1, v226
 v_mul_f32 v2, v2, v226
 v_mul_f32 v3, v3, v226
 v_mfma_f32_16x16x32_bf16 a[40:43], a[208:211], v[176:179], a[40:43]
 s_add_u32 s23, s23, s21
 v_mul_f32 v64, v64, v226
 v_mul_f32 v65, v65, v226
 v_mul_f32 v66, v66, v226
 v_mfma_f32_16x16x32_bf16 a[44:47], a[208:211], v[184:187], a[44:47]
 s_lshl_b32 s23, s23, 7
 v_exp_f32 v13, v13
 v_mul_f32 v67, v67, v226
 v_mfma_f32_16x16x32_bf16 a[44:47], a[212:215], v[188:191], a[44:47]
 s_lshl_b32 s26, s20, 15
 ds_read_b128 a[248:251], v240 offset:63488
 v_cvt_pk_bf16_f32 v152, v12, v13
 v_cvt_pk_bf16_f32 v0, v0, v1
 v_smfmac_f32_16x16x64_bf16 v[232:235], v[244:247], v[176:183], v206
 s_waitcnt lgkmcnt(7)
 v_cvt_pk_bf16_f32 v1, v2, v3
 v_cvt_pk_bf16_f32 v2, v64, v65
 v_mfma_f32_16x16x32_bf16 a[52:55], a[216:219], v[168:171], a[52:55]
 s_add_u32 s26, s26, 83656704
 v_exp_f32 v14, v14
 v_cvt_pk_bf16_f32 v3, v66, v67
 v_mfma_f32_16x16x32_bf16 a[52:55], a[220:223], v[172:175], a[52:55]
 s_add_u32 s54, s23, s26
 ds_read_b128 a[252:255], v240 offset:64512
 buffer_store_dwordx4 v[0:3], v249, s[4:7], s98 offen sc1
 v_accvgpr_read_b32 v16, a32
 v_mfma_f32_16x16x32_bf16 a[56:59], a[220:223], v[180:183], a[56:59]
 s_waitcnt vmcnt(16)
 v_xor_b32 v240, 0x10000, v240
 v_accvgpr_read_b32 v17, a33
 v_accvgpr_read_b32 v18, a34
 v_mfma_f32_16x16x32_bf16 a[56:59], a[216:219], v[176:179], a[56:59]
 s_barrier
 v_exp_f32 v15, v15
 v_accvgpr_read_b32 v19, a35
 v_mfma_f32_16x16x32_bf16 a[60:63], a[216:219], v[184:187], a[60:63]
 s_lshr_b32 s23, s60, 1
 ds_read_b128 a[192:195], v241 offset:32768
 v_cvt_pk_bf16_f32 v153, v14, v15
 v_accvgpr_read_b32 v80, a48
 v_mfma_f32_16x16x32_bf16 a[60:63], a[220:223], v[188:191], a[60:63]
 s_waitcnt lgkmcnt(7)
 buffer_load_dwordx4 v255, s[12:15], s92 offen sc1 lds
 v_mfma_f32_16x16x32_bf16 a[68:71], a[224:227], v[168:171], a[68:71]
 s_lshl_b32 s23, s23, 2
 ds_read_b128 a[196:199], v241 offset:33792
 v_accvgpr_read_b32 v81, a49
 v_accvgpr_read_b32 v82, a50
 v_mfma_f32_16x16x32_bf16 a[68:71], a[228:231], v[172:175], a[68:71]
 s_add_u32 s23, s23, s62
 v_exp_f32 v24, v24
 v_accvgpr_read_b32 v83, a51
 v_mfma_f32_16x16x32_bf16 a[72:75], a[228:231], v[180:183], a[72:75]
 s_lshl_b32 s23, s23, 10
 v_mul_f32 v16, v16, v226
 v_mul_f32 v17, v17, v226
 v_mul_f32 v18, v18, v226
 v_mfma_f32_16x16x32_bf16 a[72:75], a[224:227], v[176:179], a[72:75]
 s_add_u32 s55, s23, s26
 v_exp_f32 v25, v25
 v_mul_f32 v19, v19, v226
 v_mfma_f32_16x16x32_bf16 a[76:79], a[224:227], v[184:187], a[76:79]
 s_lshl_b32 s23, s62, 17
 ds_read_b128 a[200:203], v241 offset:34816
 v_cvt_pk_bf16_f32 v146, v24, v25
 v_mul_f32 v80, v80, v226
 v_mfma_f32_16x16x32_bf16 a[76:79], a[228:231], v[188:191], a[76:79]
 s_waitcnt lgkmcnt(7)
 v_mul_f32 v81, v81, v226
 v_mul_f32 v82, v82, v226
 v_mul_f32 v83, v83, v226
 v_mfma_f32_16x16x32_bf16 a[84:87], a[232:235], v[168:171], a[84:87]
 s_lshl_b32 s24, s20, 10
 v_exp_f32 v26, v26
 v_cvt_pk_bf16_f32 v16, v16, v17
 v_mfma_f32_16x16x32_bf16 a[84:87], a[236:239], v[172:175], a[84:87]
 s_add_u32 s23, s23, s24
 ds_read_b128 a[204:207], v241 offset:35840
 v_cvt_pk_bf16_f32 v17, v18, v19
 v_cvt_pk_bf16_f32 v18, v80, v81
 v_mfma_f32_16x16x32_bf16 a[88:91], a[236:239], v[180:183], a[88:91]
 s_lshl_b32 s24, s60, 19
 v_exp_f32 v27, v27
 v_cvt_pk_bf16_f32 v19, v82, v83
 v_mfma_f32_16x16x32_bf16 a[88:91], a[232:235], v[176:179], a[88:91]
 s_add_u32 s38, s23, s24
 v_cvt_pk_bf16_f32 v147, v26, v27
 buffer_store_dwordx4 v[16:19], v250, s[4:7], s98 offen sc1
 v_accvgpr_read_b32 v32, a64
 v_mfma_f32_16x16x32_bf16 a[92:95], a[232:235], v[184:187], a[92:95]
 s_sub_u32 s45, s23, s24
 ds_read_b128 a[208:211], v241 offset:36864
 v_accvgpr_read_b32 v33, a65
 v_accvgpr_read_b32 v34, a66
 v_mfma_f32_16x16x32_bf16 a[92:95], a[236:239], v[188:191], a[92:95]
 s_add_u32 s38, s38, 35651584
 v_exp_f32 v28, v28
 v_accvgpr_read_b32 v35, a67
 v_smfmac_f32_16x16x64_bf16 v[236:239], v[244:247], v[184:191], v206
 s_waitcnt lgkmcnt(7)
 v_accvgpr_read_b32 v96, a80
 v_accvgpr_read_b32 v97, a81
 v_mfma_f32_16x16x32_bf16 a[100:103], a[240:243], v[168:171], a[100:103]
 s_add_u32 s45, s45, 51904512
 buffer_load_dwordx4 v255, s[12:15], s92 offen offset:1024 sc1 lds
 v_mfma_f32_16x16x32_bf16 a[100:103], a[244:247], v[172:175], a[100:103]
 s_mov_b32 s8, s74
 ds_read_b128 a[212:215], v241 offset:37888
 v_accvgpr_read_b32 v98, a82
 v_accvgpr_read_b32 v99, a83
 v_mfma_f32_16x16x32_bf16 a[104:107], a[244:247], v[180:183], a[104:107]
 s_mov_b32 s9, s75
 v_mul_f32 v32, v32, v226
 v_mul_f32 v33, v33, v226
 v_mul_f32 v34, v34, v226
 v_mfma_f32_16x16x32_bf16 a[104:107], a[240:243], v[176:179], a[104:107]
 s_mov_b32 s10, 4194304
 v_exp_f32 v29, v29
 v_mul_f32 v35, v35, v226
 v_mfma_f32_16x16x32_bf16 a[108:111], a[240:243], v[184:187], a[108:111]
 s_mov_b32 s16, s64
 ds_read_b128 a[216:219], v241 offset:38912
 v_cvt_pk_bf16_f32 v154, v28, v29
 v_mul_f32 v96, v96, v226
 v_mfma_f32_16x16x32_bf16 a[108:111], a[244:247], v[188:191], a[108:111]
 s_waitcnt lgkmcnt(7)
 v_exp_f32 v30, v30
 v_mul_f32 v97, v97, v226
 v_mfma_f32_16x16x32_bf16 a[116:119], a[248:251], v[168:171], a[116:119]
 s_mov_b32 s17, s65
 ds_read_b128 a[220:223], v241 offset:39936
 v_mul_f32 v98, v98, v226
 v_mul_f32 v99, v99, v226
 v_mfma_f32_16x16x32_bf16 a[116:119], a[252:255], v[172:175], a[116:119]
 s_mov_b32 s18, 2097152
 v_cvt_pk_bf16_f32 v32, v32, v33
 v_cvt_pk_bf16_f32 v33, v34, v35
 v_cvt_pk_bf16_f32 v34, v96, v97
 v_mfma_f32_16x16x32_bf16 a[120:123], a[252:255], v[180:183], a[120:123]
 v_exp_f32 v31, v31
 v_cvt_pk_bf16_f32 v35, v98, v99
 v_mfma_f32_16x16x32_bf16 a[120:123], a[248:251], v[176:179], a[120:123]
 v_cvt_pk_bf16_f32 v155, v30, v31
 buffer_store_dwordx4 v[32:35], v251, s[4:7], s98 offen sc1
 v_accvgpr_read_b32 v48, a96
 v_mfma_f32_16x16x32_bf16 a[124:127], a[248:251], v[184:187], a[124:127]
 s_waitcnt lgkmcnt(4)
 v_accvgpr_read_b32 v49, a97
 v_accvgpr_read_b32 v50, a98
 v_accvgpr_read_b32 v51, a99
 v_mfma_f32_16x16x32_bf16 a[124:127], a[252:255], v[188:191], a[124:127]
 v_accvgpr_read_b32 v112, a112
 v_accvgpr_read_b32 v113, a113
 v_accvgpr_read_b32 v114, a114
 v_accvgpr_read_b32 v115, a115
 v_mul_f32 v48, v48, v226
 v_mul_f32 v49, v49, v226
 v_mul_f32 v50, v50, v226
 v_mul_f32 v51, v51, v226
 v_mul_f32 v112, v112, v226
 v_mul_f32 v113, v113, v226
 v_mul_f32 v114, v114, v226
 v_mul_f32 v115, v115, v226
 v_cvt_pk_bf16_f32 v48, v48, v49
 v_cvt_pk_bf16_f32 v49, v50, v51
 v_cvt_pk_bf16_f32 v50, v112, v113
 v_cvt_pk_bf16_f32 v51, v114, v115
 buffer_store_dwordx4 v[48:51], v252, s[4:7], s98 offen sc1
 v_lshrrev_b32 v204, 7, v255
 v_and_b32 v205, 6, v204
 v_lshlrev_b32 v205, 4, v205
 v_and_b32 v200, 0x70, v255
 v_xor_b32 v205, v205, v200
 v_xor_b32 v205, s30, v205
 v_lshl_add_u32 v200, v204, 10, v205
 v_add_u32 v201, 7168, v200
 v_add_u32 v202, 14336, v200
 v_add_u32 v203, 21504, v200
 v_and_b32 v161, 112, v255
 v_lshl_add_u32 v161, v161, 3, s55
 s_getpc_b64 s[28:29]
Lpc9:
 s_add_u32 s28, s28, Lround2-Lpc9
 s_addc_u32 s29, s29, 0
 s_bfe_u32 s23, s2, 0x30003
 s_lshl_b32 s23, s23, 2
 s_add_u32 s23, s23, s20
 s_mul_i32 s23, s23, 2048
 v_and_b32 v162, 240, v255
 v_lshl_add_u32 v162, v162, 3, s23
 v_add_f32 v228, v228, v229
 v_rcp_f32 v230, v228
 v_accvgpr_read_b32 v4, a4
 v_accvgpr_read_b32 v5, a5
 v_accvgpr_read_b32 v6, a6
 v_accvgpr_read_b32 v7, a7
 v_accvgpr_read_b32 v68, a20
 v_accvgpr_read_b32 v69, a21
 v_accvgpr_read_b32 v70, a22
 v_accvgpr_read_b32 v71, a23
 v_pk_mul_f32 v[4:5], v[4:5], v[230:231] op_sel_hi:[1,0]
 v_pk_mul_f32 v[6:7], v[6:7], v[230:231] op_sel_hi:[1,0]
 v_pk_mul_f32 v[68:69], v[68:69], v[230:231] op_sel_hi:[1,0]
 v_pk_mul_f32 v[70:71], v[70:71], v[230:231] op_sel_hi:[1,0]
 v_cvt_pk_bf16_f32 v4, v4, v5
 v_cvt_pk_bf16_f32 v5, v6, v7
 v_cvt_pk_bf16_f32 v6, v68, v69
 v_cvt_pk_bf16_f32 v7, v70, v71
 buffer_store_dwordx4 v[4:7], v249, s[4:7], s99 offen sc1
 v_accvgpr_read_b32 v20, a36
 v_accvgpr_read_b32 v21, a37
 v_accvgpr_read_b32 v22, a38
 v_accvgpr_read_b32 v23, a39
 v_accvgpr_read_b32 v84, a52
 v_accvgpr_read_b32 v85, a53
 v_accvgpr_read_b32 v86, a54
 v_accvgpr_read_b32 v87, a55
 v_pk_mul_f32 v[20:21], v[20:21], v[230:231] op_sel_hi:[1,0]
 v_pk_mul_f32 v[22:23], v[22:23], v[230:231] op_sel_hi:[1,0]
 v_pk_mul_f32 v[84:85], v[84:85], v[230:231] op_sel_hi:[1,0]
 v_pk_mul_f32 v[86:87], v[86:87], v[230:231] op_sel_hi:[1,0]
 v_cvt_pk_bf16_f32 v20, v20, v21
 v_cvt_pk_bf16_f32 v21, v22, v23
 v_cvt_pk_bf16_f32 v22, v84, v85
 v_cvt_pk_bf16_f32 v23, v86, v87
 buffer_store_dwordx4 v[20:23], v250, s[4:7], s99 offen sc1
 v_accvgpr_read_b32 v36, a68
 v_accvgpr_read_b32 v37, a69
 v_accvgpr_read_b32 v38, a70
 v_accvgpr_read_b32 v39, a71
 v_accvgpr_read_b32 v100, a84
 v_accvgpr_read_b32 v101, a85
 v_accvgpr_read_b32 v102, a86
 v_accvgpr_read_b32 v103, a87
 v_pk_mul_f32 v[36:37], v[36:37], v[230:231] op_sel_hi:[1,0]
 v_pk_mul_f32 v[38:39], v[38:39], v[230:231] op_sel_hi:[1,0]
 v_pk_mul_f32 v[100:101], v[100:101], v[230:231] op_sel_hi:[1,0]
 v_pk_mul_f32 v[102:103], v[102:103], v[230:231] op_sel_hi:[1,0]
 v_cvt_pk_bf16_f32 v36, v36, v37
 v_cvt_pk_bf16_f32 v37, v38, v39
 v_cvt_pk_bf16_f32 v38, v100, v101
 v_cvt_pk_bf16_f32 v39, v102, v103
 buffer_store_dwordx4 v[36:39], v251, s[4:7], s99 offen sc1
 v_accvgpr_read_b32 v52, a100
 v_accvgpr_read_b32 v53, a101
 v_accvgpr_read_b32 v54, a102
 v_accvgpr_read_b32 v55, a103
 v_accvgpr_read_b32 v116, a116
 v_accvgpr_read_b32 v117, a117
 v_accvgpr_read_b32 v118, a118
 v_accvgpr_read_b32 v119, a119
 v_pk_mul_f32 v[52:53], v[52:53], v[230:231] op_sel_hi:[1,0]
 v_pk_mul_f32 v[54:55], v[54:55], v[230:231] op_sel_hi:[1,0]
 v_pk_mul_f32 v[116:117], v[116:117], v[230:231] op_sel_hi:[1,0]
 v_pk_mul_f32 v[118:119], v[118:119], v[230:231] op_sel_hi:[1,0]
 v_cvt_pk_bf16_f32 v52, v52, v53
 v_cvt_pk_bf16_f32 v53, v54, v55
 v_cvt_pk_bf16_f32 v54, v116, v117
 v_cvt_pk_bf16_f32 v55, v118, v119
 buffer_store_dwordx4 v[52:55], v252, s[4:7], s99 offen sc1
 v_max_u32 v204, v224, v228
 v_cmp_le_u32 vcc, 0x5f800000, v204
 v_min_u32 v163, 1, v255
 v_lshlrev_b32 v163, 29, v163
 s_cmp_eq_u64 vcc, 0
 s_cselect_b32 s30, s54, 536870912
 s_lshl_b32 s23, s61, 16
 s_add_u32 s23, s23, s38
 s_and_b32 s23, s23, 0xffff0000
 s_add_u32 s16, s90, s23
 s_addc_u32 s17, s91, 0
 s_lshl_b32 s23, s61, 3
 s_and_b32 s23, s23, 16
 s_add_u32 s23, s23, s60
 s_cmp_lt_u32 s23, 12
 s_cselect_b32 s18, 0x10000, 0
 s_lshl_b32 s23, s20, 12
 v_lshrrev_b32 v204, 9, v255
 v_lshl_add_u32 v242, v255, 3, s23
 s_mov_b32 s32, 14
 v_lshl_add_u32 v242, v204, 20, v242
 s_cmp_eq_u32 s31, 0
 s_cbranch_scc1 L21
 s_nop 0
 s_nop 0
 s_nop 0
L22:
 v_mfma_f32_16x16x32_bf16 v[72:75], a[192:195], a[160:163], v[216:219]
 v_exp_f32 v40, v40
 v_mfma_f32_16x16x32_bf16 v[72:75], a[196:199], a[164:167], v[72:75]
 v_exp_f32 v41, v41
 v_mfma_f32_16x16x32_bf16 v[72:75], a[200:203], a[168:171], v[72:75]
 buffer_load_dwordx4 v255, s[12:15], s92 offen offset:2048 sc1 lds
 v_mfma_f32_16x16x32_bf16 v[72:75], a[204:207], a[172:175], v[72:75]
 ds_read_b128 a[224:227], v240 offset:40960
 ds_read_b128 a[228:231], v240 offset:41984
 v_mfma_f32_16x16x32_bf16 v[76:79], a[204:207], a[188:191], v[220:223]
 v_exp_f32 v42, v42
 v_mfma_f32_16x16x32_bf16 v[76:79], a[200:203], a[184:187], v[76:79]
 ds_read_b128 a[232:235], v240 offset:43008
 ds_read_b128 a[236:239], v240 offset:44032
 v_mfma_f32_16x16x32_bf16 v[76:79], a[196:199], a[180:183], v[76:79]
 v_exp_f32 v43, v43
 v_mfma_f32_16x16x32_bf16 v[76:79], a[192:195], a[176:179], v[76:79]
 s_waitcnt lgkmcnt(4)
 v_exp_f32 v44, v44
 v_mfma_f32_16x16x32_bf16 v[92:95], a[208:211], a[176:179], v[220:223]
 ds_read_b128 a[240:243], v240 offset:45056
 v_cvt_pk_bf16_f32 v148, v40, v41
 v_mfma_f32_16x16x32_bf16 v[92:95], a[212:215], a[180:183], v[92:95]
 buffer_load_dwordx4 v255, s[12:15], s92 offen offset:3072 sc1 lds
 v_mfma_f32_16x16x32_bf16 v[92:95], a[216:219], a[184:187], v[92:95]
 s_add_u32 s92, s92, 4096
 v_exp_f32 v45, v45
 v_mfma_f32_16x16x32_bf16 v[92:95], a[220:223], a[188:191], v[92:95]
 s_and_b32 m0, s92, 0x1ffff
 ds_read_b128 a[244:247], v240 offset:46080
 ds_read_b128 a[248:251], v240 offset:47104
 v_mfma_f32_16x16x32_bf16 v[88:91], a[220:223], a[172:175], v[216:219]
 v_exp_f32 v46, v46
 v_mfma_f32_16x16x32_bf16 v[88:91], a[216:219], a[168:171], v[88:91]
 v_exp_f32 v47, v47
 v_mfma_f32_16x16x32_bf16 v[88:91], a[212:215], a[164:167], v[88:91]
 ds_read_b128 a[252:255], v240 offset:48128
 v_cvt_pk_bf16_f32 v149, v42, v43
 v_mfma_f32_16x16x32_bf16 v[88:91], a[208:211], a[160:163], v[88:91]
 s_waitcnt lgkmcnt(4)
 v_exp_f32 v56, v56
 v_mfma_f32_16x16x32_bf16 v[104:107], a[224:227], a[160:163], v[216:219]
 buffer_load_dwordx4 v255, s[12:15], s92 offen sc1 lds
 v_mfma_f32_16x16x32_bf16 v[104:107], a[228:231], a[164:167], v[104:107]
 ds_read_b128 a[192:195], v240 offset:16384
 v_cvt_pk_bf16_f32 v156, v44, v45
 v_mfma_f32_16x16x32_bf16 v[104:107], a[232:235], a[168:171], v[104:107]
 v_exp_f32 v57, v57
 v_mfma_f32_16x16x32_bf16 v[104:107], a[236:239], a[172:175], v[104:107]
 v_exp_f32 v58, v58
 v_mfma_f32_16x16x32_bf16 v[108:111], a[236:239], a[188:191], v[220:223]
 ds_read_b128 a[196:199], v240 offset:17408
 ds_read_b128 a[200:203], v240 offset:18432
 v_mfma_f32_16x16x32_bf16 v[108:111], a[232:235], a[184:187], v[108:111]
 v_exp_f32 v59, v59
 v_mfma_f32_16x16x32_bf16 v[108:111], a[228:231], a[180:183], v[108:111]
 ds_read_b128 a[204:207], v240 offset:19456
 v_cvt_pk_bf16_f32 v157, v46, v47
 v_mfma_f32_16x16x32_bf16 v[108:111], a[224:227], a[176:179], v[108:111]
 s_waitcnt lgkmcnt(4)
 buffer_load_dwordx4 v255, s[12:15], s92 offen offset:1024 sc1 lds
 v_mfma_f32_16x16x32_bf16 v[124:127], a[240:243], a[176:179], v[220:223]
 v_exp_f32 v60, v60
 v_mfma_f32_16x16x32_bf16 v[124:127], a[244:247], a[180:183], v[124:127]
 v_exp_f32 v61, v61
 v_mfma_f32_16x16x32_bf16 v[124:127], a[248:251], a[184:187], v[124:127]
 ds_read_b128 a[208:211], v240 offset:20480
 v_cvt_pk_bf16_f32 v150, v56, v57
 v_mfma_f32_16x16x32_bf16 v[124:127], a[252:255], a[188:191], v[124:127]
 v_exp_f32 v62, v62
 v_mfma_f32_16x16x32_bf16 v[120:123], a[252:255], a[172:175], v[216:219]
 ds_read_b128 a[212:215], v240 offset:21504
 v_cvt_pk_bf16_f32 v151, v58, v59
 v_mfma_f32_16x16x32_bf16 v[120:123], a[248:251], a[168:171], v[120:123]
 v_exp_f32 v63, v63
 v_mfma_f32_16x16x32_bf16 v[120:123], a[244:247], a[164:167], v[120:123]
 buffer_load_dwordx4 v255, s[12:15], s92 offen offset:2048 sc1 lds
 v_mfma_f32_16x16x32_bf16 v[120:123], a[240:243], a[160:163], v[120:123]
 s_waitcnt lgkmcnt(2)
 ds_read_b128 a[216:219], v240 offset:22528
 v_cvt_pk_bf16_f32 v158, v60, v61
 v_mfma_f32_16x16x32_bf16 a[8:11], a[192:195], v[144:147], a[8:11]
 ds_read_b128 a[220:223], v240 offset:23552
 v_cvt_pk_bf16_f32 v159, v62, v63
 v_mfma_f32_16x16x32_bf16 a[8:11], a[196:199], v[148:151], a[8:11]
 v_exp_f32 v72, v72
 v_mfma_f32_16x16x32_bf16 a[12:15], a[192:195], v[152:155], a[12:15]
 v_exp_f32 v73, v73
 v_mfma_f32_16x16x32_bf16 a[12:15], a[196:199], v[156:159], a[12:15]
 ds_read_b128 a[224:227], v240 offset:24576
 ds_read_b128 a[228:231], v240 offset:25600
 v_mfma_f32_16x16x32_bf16 a[28:31], a[200:203], v[152:155], a[28:31]
 v_exp_f32 v74, v74
 v_mfma_f32_16x16x32_bf16 a[28:31], a[204:207], v[156:159], a[28:31]
 buffer_load_dwordx4 v255, s[12:15], s92 offen offset:3072 sc1 lds
 v_mfma_f32_16x16x32_bf16 a[24:27], a[204:207], v[148:151], a[24:27]
 s_add_u32 s92, s92, 28672
 ds_read_b128 a[232:235], v240 offset:26624
 ds_read_b128 a[236:239], v240 offset:27648
 v_mfma_f32_16x16x32_bf16 a[24:27], a[200:203], v[144:147], a[24:27]
 s_and_b32 m0, s92, 0x1ffff
 v_exp_f32 v75, v75
 v_smfmac_f32_16x16x64_bf16 v[232:235], v[244:247], v[144:151], v206
 s_waitcnt lgkmcnt(4)
 ds_read_b128 a[240:243], v240 offset:28672
 v_mfma_f32_16x16x32_bf16 a[40:43], a[208:211], v[144:147], a[40:43]
 v_exp_f32 v76, v76
 v_mfma_f32_16x16x32_bf16 a[40:43], a[212:215], v[148:151], a[40:43]
 ds_read_b128 a[244:247], v240 offset:29696
 v_cvt_pk_bf16_f32 v176, v72, v73
 v_mfma_f32_16x16x32_bf16 a[44:47], a[212:215], v[156:159], a[44:47]
 v_exp_f32 v77, v77
 v_mfma_f32_16x16x32_bf16 a[44:47], a[208:211], v[152:155], a[44:47]
 ds_read_b128 a[248:251], v240 offset:30720
 v_xor_b32 v241, 0x10000, v241
 v_mfma_f32_16x16x32_bf16 a[60:63], a[216:219], v[152:155], a[60:63]
 v_exp_f32 v78, v78
 v_mfma_f32_16x16x32_bf16 a[60:63], a[220:223], v[156:159], a[60:63]
 s_waitcnt vmcnt(9)
 v_exp_f32 v79, v79
 v_mfma_f32_16x16x32_bf16 a[56:59], a[220:223], v[148:151], a[56:59]
 s_barrier
 ds_read_b128 a[252:255], v240 offset:31744
 v_cvt_pk_bf16_f32 v177, v74, v75
 v_mfma_f32_16x16x32_bf16 a[56:59], a[216:219], v[144:147], a[56:59]
 s_waitcnt lgkmcnt(4)
 v_exp_f32 v88, v88
 v_mfma_f32_16x16x32_bf16 a[72:75], a[224:227], v[144:147], a[72:75]
 buffer_load_dwordx4 v255, s[12:15], s92 offen sc1 lds
 v_mfma_f32_16x16x32_bf16 a[72:75], a[228:231], v[148:151], a[72:75]
 ds_read_b128 a[192:195], v241 offset:0
 v_cvt_pk_bf16_f32 v184, v76, v77
 v_mfma_f32_16x16x32_bf16 a[76:79], a[228:231], v[156:159], a[76:79]
 v_exp_f32 v89, v89
 v_mfma_f32_16x16x32_bf16 a[76:79], a[224:227], v[152:155], a[76:79]
 v_exp_f32 v90, v90
 v_mfma_f32_16x16x32_bf16 a[92:95], a[232:235], v[152:155], a[92:95]
 ds_read_b128 a[196:199], v241 offset:1024
 ds_read_b128 a[200:203], v241 offset:2048
 v_mfma_f32_16x16x32_bf16 a[92:95], a[236:239], v[156:159], a[92:95]
 v_exp_f32 v91, v91
 v_mfma_f32_16x16x32_bf16 a[88:91], a[236:239], v[148:151], a[88:91]
 ds_read_b128 a[204:207], v241 offset:3072
 v_cvt_pk_bf16_f32 v185, v78, v79
 v_mfma_f32_16x16x32_bf16 a[88:91], a[232:235], v[144:147], a[88:91]
 v_exp_f32 v92, v92
 v_smfmac_f32_16x16x64_bf16 v[236:239], v[244:247], v[152:159], v206
 s_waitcnt lgkmcnt(4)
 ds_read_b128 a[208:211], v241 offset:4096
 v_mfma_f32_16x16x32_bf16 a[104:107], a[240:243], v[144:147], a[104:107]
 buffer_load_dwordx4 v255, s[12:15], s92 offen offset:1024 sc1 lds
 v_mfma_f32_16x16x32_bf16 a[104:107], a[244:247], v[148:151], a[104:107]
 v_exp_f32 v93, v93
 v_mfma_f32_16x16x32_bf16 a[108:111], a[244:247], v[156:159], a[108:111]
 ds_read_b128 a[212:215], v241 offset:5120
 v_cvt_pk_bf16_f32 v178, v88, v89
 v_mfma_f32_16x16x32_bf16 a[108:111], a[240:243], v[152:155], a[108:111]
 v_exp_f32 v94, v94
 v_mfma_f32_16x16x32_bf16 a[124:127], a[248:251], v[152:155], a[124:127]
 ds_read_b128 a[216:219], v241 offset:6144
 ds_read_b128 a[220:223], v241 offset:7168
 v_mfma_f32_16x16x32_bf16 a[124:127], a[252:255], v[156:159], a[124:127]
 s_waitcnt lgkmcnt(4)
 v_exp_f32 v95, v95
 v_mfma_f32_16x16x32_bf16 a[120:123], a[252:255], v[148:151], a[120:123]
 s_sub_u32 s31, s31, 1
 v_cvt_pk_bf16_f32 v186, v92, v93
 v_cvt_pk_bf16_f32 v179, v90, v91
 v_mfma_f32_16x16x32_bf16 a[120:123], a[248:251], v[144:147], a[120:123]
 v_cvt_pk_bf16_f32 v187, v94, v95
 v_mfma_f32_16x16x32_bf16 v[8:11], a[192:195], a[160:163], v[216:219]
 v_exp_f32 v104, v104
 v_mfma_f32_16x16x32_bf16 v[8:11], a[196:199], a[164:167], v[8:11]
 v_exp_f32 v105, v105
 v_mfma_f32_16x16x32_bf16 v[8:11], a[200:203], a[168:171], v[8:11]
 buffer_load_dwordx4 v255, s[12:15], s92 offen offset:2048 sc1 lds
 v_mfma_f32_16x16x32_bf16 v[8:11], a[204:207], a[172:175], v[8:11]
 s_lshl_b32 s33, s31, s32
 ds_read_b128 a[224:227], v241 offset:8192
 ds_read_b128 a[228:231], v241 offset:9216
 v_mfma_f32_16x16x32_bf16 v[12:15], a[204:207], a[188:191], v[220:223]
 v_exp_f32 v106, v106
 v_mfma_f32_16x16x32_bf16 v[12:15], a[200:203], a[184:187], v[12:15]
 ds_read_b128 a[232:235], v241 offset:10240
 ds_read_b128 a[236:239], v241 offset:11264
 v_mfma_f32_16x16x32_bf16 v[12:15], a[196:199], a[180:183], v[12:15]
 v_exp_f32 v107, v107
 v_mfma_f32_16x16x32_bf16 v[12:15], a[192:195], a[176:179], v[12:15]
 s_waitcnt lgkmcnt(4)
 v_exp_f32 v108, v108
 v_mfma_f32_16x16x32_bf16 v[28:31], a[208:211], a[176:179], v[220:223]
 ds_read_b128 a[240:243], v241 offset:12288
 v_cvt_pk_bf16_f32 v180, v104, v105
 v_mfma_f32_16x16x32_bf16 v[28:31], a[212:215], a[180:183], v[28:31]
 buffer_load_dwordx4 v255, s[12:15], s92 offen offset:3072 sc1 lds
 v_mfma_f32_16x16x32_bf16 v[28:31], a[216:219], a[184:187], v[28:31]
 s_add_u32 s92, s92, 4096
 v_exp_f32 v109, v109
 v_mfma_f32_16x16x32_bf16 v[28:31], a[220:223], a[188:191], v[28:31]
 s_and_b32 m0, s92, 0x1ffff
 ds_read_b128 a[244:247], v241 offset:13312
 ds_read_b128 a[248:251], v241 offset:14336
 v_mfma_f32_16x16x32_bf16 v[24:27], a[220:223], a[172:175], v[216:219]
 v_exp_f32 v110, v110
 v_mfma_f32_16x16x32_bf16 v[24:27], a[216:219], a[168:171], v[24:27]
 v_exp_f32 v111, v111
 v_mfma_f32_16x16x32_bf16 v[24:27], a[212:215], a[164:167], v[24:27]
 ds_read_b128 a[252:255], v241 offset:15360
 v_cvt_pk_bf16_f32 v181, v106, v107
 v_mfma_f32_16x16x32_bf16 v[24:27], a[208:211], a[160:163], v[24:27]
 s_waitcnt lgkmcnt(4)
 v_exp_f32 v120, v120
 v_mfma_f32_16x16x32_bf16 v[40:43], a[224:227], a[160:163], v[216:219]
 buffer_load_dwordx4 v255, s[12:15], s92 offen sc1 lds
 v_mfma_f32_16x16x32_bf16 v[40:43], a[228:231], a[164:167], v[40:43]
 ds_read_b128 a[192:195], v240 offset:49152
 v_cvt_pk_bf16_f32 v188, v108, v109
 v_mfma_f32_16x16x32_bf16 v[40:43], a[232:235], a[168:171], v[40:43]
 v_exp_f32 v121, v121
 v_mfma_f32_16x16x32_bf16 v[40:43], a[236:239], a[172:175], v[40:43]
 v_exp_f32 v122, v122
 v_mfma_f32_16x16x32_bf16 v[44:47], a[236:239], a[188:191], v[220:223]
 ds_read_b128 a[196:199], v240 offset:50176
 ds_read_b128 a[200:203], v240 offset:51200
 v_mfma_f32_16x16x32_bf16 v[44:47], a[232:235], a[184:187], v[44:47]
 v_exp_f32 v123, v123
 v_mfma_f32_16x16x32_bf16 v[44:47], a[228:231], a[180:183], v[44:47]
 ds_read_b128 a[204:207], v240 offset:52224
 v_cvt_pk_bf16_f32 v189, v110, v111
 v_mfma_f32_16x16x32_bf16 v[44:47], a[224:227], a[176:179], v[44:47]
 s_waitcnt lgkmcnt(4)
 buffer_load_dwordx4 v255, s[12:15], s92 offen offset:1024 sc1 lds
 v_mfma_f32_16x16x32_bf16 v[60:63], a[240:243], a[176:179], v[220:223]
 v_exp_f32 v124, v124
 v_mfma_f32_16x16x32_bf16 v[60:63], a[244:247], a[180:183], v[60:63]
 v_exp_f32 v125, v125
 v_mfma_f32_16x16x32_bf16 v[60:63], a[248:251], a[184:187], v[60:63]
 ds_read_b128 a[208:211], v240 offset:53248
 v_cvt_pk_bf16_f32 v182, v120, v121
 v_mfma_f32_16x16x32_bf16 v[60:63], a[252:255], a[188:191], v[60:63]
 v_exp_f32 v126, v126
 v_mfma_f32_16x16x32_bf16 v[56:59], a[252:255], a[172:175], v[216:219]
 ds_read_b128 a[212:215], v240 offset:54272
 v_cvt_pk_bf16_f32 v183, v122, v123
 v_mfma_f32_16x16x32_bf16 v[56:59], a[248:251], a[168:171], v[56:59]
 v_exp_f32 v127, v127
 v_mfma_f32_16x16x32_bf16 v[56:59], a[244:247], a[164:167], v[56:59]
 buffer_load_dwordx4 v255, s[12:15], s92 offen offset:2048 sc1 lds
 v_mfma_f32_16x16x32_bf16 v[56:59], a[240:243], a[160:163], v[56:59]
 s_waitcnt lgkmcnt(2)
 ds_read_b128 a[216:219], v240 offset:55296
 v_cvt_pk_bf16_f32 v190, v124, v125
 v_mfma_f32_16x16x32_bf16 a[8:11], a[192:195], v[176:179], a[8:11]
 ds_read_b128 a[220:223], v240 offset:56320
 v_cvt_pk_bf16_f32 v191, v126, v127
 v_mfma_f32_16x16x32_bf16 a[8:11], a[196:199], v[180:183], a[8:11]
 v_exp_f32 v8, v8
 v_mfma_f32_16x16x32_bf16 a[12:15], a[192:195], v[184:187], a[12:15]
 v_exp_f32 v9, v9
 v_mfma_f32_16x16x32_bf16 a[12:15], a[196:199], v[188:191], a[12:15]
 ds_read_b128 a[224:227], v240 offset:57344
 ds_read_b128 a[228:231], v240 offset:58368
 v_mfma_f32_16x16x32_bf16 a[28:31], a[200:203], v[184:187], a[28:31]
 v_exp_f32 v10, v10
 v_mfma_f32_16x16x32_bf16 a[28:31], a[204:207], v[188:191], a[28:31]
 buffer_load_dwordx4 v255, s[12:15], s92 offen offset:3072 sc1 lds
 v_mfma_f32_16x16x32_bf16 a[24:27], a[204:207], v[180:183], a[24:27]
 s_add_u32 s92, s92, 28672
 v_exp_f32 v11, v11
 v_mfma_f32_16x16x32_bf16 a[24:27], a[200:203], v[176:179], a[24:27]
 s_and_b32 m0, s92, 0x1ffff
 ds_read_b128 a[232:235], v240 offset:59392
 ds_read_b128 a[236:239], v240 offset:60416
 v_smfmac_f32_16x16x64_bf16 v[232:235], v[244:247], v[176:183], v206
 s_waitcnt lgkmcnt(4)
 ds_read_b128 a[240:243], v240 offset:61440
 v_mfma_f32_16x16x32_bf16 a[40:43], a[208:211], v[176:179], a[40:43]
 v_exp_f32 v12, v12
 v_mfma_f32_16x16x32_bf16 a[40:43], a[212:215], v[180:183], a[40:43]
 ds_read_b128 a[244:247], v240 offset:62464
 v_cvt_pk_bf16_f32 v144, v8, v9
 v_mfma_f32_16x16x32_bf16 a[44:47], a[212:215], v[188:191], a[44:47]
 v_exp_f32 v13, v13
 v_mfma_f32_16x16x32_bf16 a[44:47], a[208:211], v[184:187], a[44:47]
 v_exp_f32 v14, v14
 v_mfma_f32_16x16x32_bf16 a[60:63], a[216:219], v[184:187], a[60:63]
 ds_read_b128 a[248:251], v240 offset:63488
 v_cvt_pk_bf16_f32 v145, v10, v11
 v_mfma_f32_16x16x32_bf16 a[60:63], a[220:223], v[188:191], a[60:63]
 s_waitcnt vmcnt(8)
 v_exp_f32 v15, v15
 v_mfma_f32_16x16x32_bf16 a[56:59], a[220:223], v[180:183], a[56:59]
 s_barrier
 ds_read_b128 a[252:255], v240 offset:64512
 v_cvt_pk_bf16_f32 v152, v12, v13
 v_mfma_f32_16x16x32_bf16 a[56:59], a[216:219], v[176:179], a[56:59]
 s_waitcnt lgkmcnt(4)
 buffer_load_dword v243, v242, s[16:19], s33 offen sc1
 v_mfma_f32_16x16x32_bf16 a[72:75], a[224:227], v[176:179], a[72:75]
 buffer_load_dwordx4 v255, s[12:15], s92 offen sc1 lds
 v_mfma_f32_16x16x32_bf16 a[72:75], a[228:231], v[180:183], a[72:75]
 v_exp_f32 v24, v24
 v_mfma_f32_16x16x32_bf16 a[76:79], a[228:231], v[188:191], a[76:79]
Lw3_6:
 s_cbranch_execz Lw3_back
 v_exp_f32 v25, v25
 v_mfma_f32_16x16x32_bf16 a[76:79], a[224:227], v[184:187], a[76:79]
 ds_read_b128 a[192:195], v241 offset:32768
 ds_read_b128 a[196:199], v241 offset:33792
 v_mfma_f32_16x16x32_bf16 a[92:95], a[232:235], v[184:187], a[92:95]
 v_exp_f32 v26, v26
 v_mfma_f32_16x16x32_bf16 a[92:95], a[236:239], v[188:191], a[92:95]
 v_exp_f32 v27, v27
 v_mfma_f32_16x16x32_bf16 a[88:91], a[236:239], v[180:183], a[88:91]
 ds_read_b128 a[200:203], v241 offset:34816
 v_cvt_pk_bf16_f32 v153, v14, v15
 v_mfma_f32_16x16x32_bf16 a[88:91], a[232:235], v[176:179], a[88:91]
 v_exp_f32 v28, v28
 v_smfmac_f32_16x16x64_bf16 v[236:239], v[244:247], v[184:191], v206
 s_waitcnt lgkmcnt(3)
 ds_read_b128 a[204:207], v241 offset:35840
 v_mfma_f32_16x16x32_bf16 a[104:107], a[240:243], v[176:179], a[104:107]
 buffer_load_dwordx4 v255, s[12:15], s92 offen offset:1024 sc1 lds
 v_mfma_f32_16x16x32_bf16 a[104:107], a[244:247], v[180:183], a[104:107]
 ds_read_b128 a[208:211], v241 offset:36864
 v_cvt_pk_bf16_f32 v146, v24, v25
 v_mfma_f32_16x16x32_bf16 a[108:111], a[244:247], v[188:191], a[108:111]
 v_exp_f32 v29, v29
 v_mfma_f32_16x16x32_bf16 a[108:111], a[240:243], v[184:187], a[108:111]
 v_exp_f32 v30, v30
 v_mfma_f32_16x16x32_bf16 a[124:127], a[248:251], v[184:187], a[124:127]
 ds_read_b128 a[212:215], v241 offset:37888
 ds_read_b128 a[216:219], v241 offset:38912
 v_mfma_f32_16x16x32_bf16 a[124:127], a[252:255], v[188:191], a[124:127]
 s_waitcnt lgkmcnt(3)
 v_exp_f32 v31, v31
 v_mfma_f32_16x16x32_bf16 a[120:123], a[252:255], v[180:183], a[120:123]
 s_cmp_lg_u32 s31, 0
 ds_read_b128 a[220:223], v241 offset:39936
 v_cvt_pk_bf16_f32 v147, v26, v27
 v_mfma_f32_16x16x32_bf16 a[120:123], a[248:251], v[176:179], a[120:123]
 v_xor_b32 v240, 0x10000, v240
 v_cvt_pk_bf16_f32 v155, v30, v31
 v_cvt_pk_bf16_f32 v154, v28, v29
 s_cbranch_scc1 L22
L21:
 v_mfma_f32_16x16x32_bf16 v[76:79], a[192:195], a[176:179], v[220:223]
 v_exp_f32 v40, v40
 v_exp_f32 v41, v41
 v_mfma_f32_16x16x32_bf16 v[76:79], a[196:199], a[180:183], v[76:79]
 s_add_u32 m0, s47, 0
 v_exp_f32 v42, v42
 v_mfma_f32_16x16x32_bf16 v[76:79], a[200:203], a[184:187], v[76:79]
 buffer_load_dwordx4 v200, s[8:11], s59 offen lds
 v_mfma_f32_16x16x32_bf16 v[76:79], a[204:207], a[188:191], v[76:79]
 s_waitcnt lgkmcnt(0)
 ds_read_b128 a[224:227], v240 offset:40960
 v_exp_f32 v43, v43
 v_mfma_f32_16x16x32_bf16 v[92:95], a[208:211], a[176:179], v[220:223]
 s_mov_b32 s16, s64
 ds_read_b128 a[228:231], v240 offset:41984
 v_and_b32 v147, v147, v195
 v_and_b32 v146, v146, v194
 v_and_b32 v145, v145, v193
 v_and_b32 v144, v144, v192
 v_exp_f32 v44, v44
 v_exp_f32 v45, v45
 v_mfma_f32_16x16x32_bf16 v[92:95], a[212:215], a[180:183], v[92:95]
 s_mov_b32 s17, s65
 ds_read_b128 a[232:235], v240 offset:43008
 v_exp_f32 v46, v46
 v_mfma_f32_16x16x32_bf16 v[92:95], a[216:219], a[184:187], v[92:95]
 s_mov_b32 s18, 2097152
 buffer_load_dwordx4 v201, s[8:11], s59 offen offset:1024 lds
 ds_read_b128 a[236:239], v240 offset:44032
 v_mfma_f32_16x16x32_bf16 v[92:95], a[220:223], a[188:191], v[92:95]
 s_waitcnt lgkmcnt(3)
 ds_read_b128 a[240:243], v240 offset:45056
 v_exp_f32 v47, v47
 v_mfma_f32_16x16x32_bf16 v[108:111], a[224:227], a[176:179], v[220:223]
 s_waitcnt lgkmcnt(3)
 ds_read_b128 a[244:247], v240 offset:46080
 v_exp_f32 v56, v56
 v_exp_f32 v57, v57
 v_mfma_f32_16x16x32_bf16 v[108:111], a[228:231], a[180:183], v[108:111]
 s_waitcnt lgkmcnt(3)
 ds_read_b128 a[248:251], v240 offset:47104
 v_exp_f32 v58, v58
 v_mfma_f32_16x16x32_bf16 v[108:111], a[232:235], a[184:187], v[108:111]
 s_waitcnt lgkmcnt(3)
 buffer_load_dwordx4 v202, s[8:11], s59 offen offset:2048 lds
 ds_read_b128 a[252:255], v240 offset:48128
 v_mfma_f32_16x16x32_bf16 v[108:111], a[236:239], a[188:191], v[108:111]
 s_waitcnt lgkmcnt(3)
 ds_read_b128 a[192:195], v240 offset:16384
 v_cvt_pk_bf16_f32 v148, v40, v41
 v_exp_f32 v59, v59
 v_mfma_f32_16x16x32_bf16 v[124:127], a[240:243], a[176:179], v[220:223]
 s_waitcnt lgkmcnt(3)
 ds_read_b128 a[196:199], v240 offset:17408
 v_exp_f32 v60, v60
 v_exp_f32 v61, v61
 v_mfma_f32_16x16x32_bf16 v[124:127], a[244:247], a[180:183], v[124:127]
 s_waitcnt lgkmcnt(3)
 ds_read_b128 a[200:203], v240 offset:18432
 v_cvt_pk_bf16_f32 v151, v58, v59
 v_cvt_pk_bf16_f32 v150, v56, v57
 v_cvt_pk_bf16_f32 v149, v42, v43
 v_exp_f32 v62, v62
 v_mfma_f32_16x16x32_bf16 v[124:127], a[248:251], a[184:187], v[124:127]
 s_waitcnt lgkmcnt(3)
 buffer_load_dwordx4 v203, s[8:11], s59 offen offset:3072 lds
 ds_read_b128 a[204:207], v240 offset:19456
 v_and_b32 v151, v151, v199
 v_and_b32 v150, v150, v198
 v_and_b32 v149, v149, v197
 v_and_b32 v148, v148, v196
 v_mfma_f32_16x16x32_bf16 v[124:127], a[252:255], a[188:191], v[124:127]
 s_waitcnt lgkmcnt(3)
 ds_read_b128 a[208:211], v240 offset:20480
 v_cvt_pk_bf16_f32 v156, v44, v45
 v_exp_f32 v63, v63
 v_mfma_f32_16x16x32_bf16 a[8:11], a[192:195], v[144:147], a[8:11]
 s_waitcnt lgkmcnt(3)
 ds_read_b128 a[212:215], v240 offset:21504
 v_cvt_pk_bf16_f32 v159, v62, v63
 v_cvt_pk_bf16_f32 v158, v60, v61
 v_cvt_pk_bf16_f32 v157, v46, v47
 v_mfma_f32_16x16x32_bf16 a[8:11], a[196:199], v[148:151], a[8:11]
 s_add_u32 s59, s59, 131072
 s_add_u32 m0, s47, 16384
 ds_read_b128 a[216:219], v240 offset:22528
 v_exp_f32 v76, v76
 v_mfma_f32_16x16x32_bf16 a[12:15], a[192:195], v[152:155], a[12:15]
 buffer_load_dwordx4 v200, s[8:11], s59 offen lds
 ds_read_b128 a[220:223], v240 offset:23552
 v_mfma_f32_16x16x32_bf16 a[12:15], a[196:199], v[156:159], a[12:15]
 s_waitcnt lgkmcnt(5)
 ds_read_b128 a[224:227], v240 offset:24576
 ds_read_b128 a[228:231], v240 offset:25600
 v_mfma_f32_16x16x32_bf16 a[28:31], a[200:203], v[152:155], a[28:31]
 s_waitcnt lgkmcnt(6)
 v_exp_f32 v77, v77
 v_mfma_f32_16x16x32_bf16 a[28:31], a[204:207], v[156:159], a[28:31]
 buffer_load_dwordx4 v201, s[8:11], s59 offen offset:1024 lds
 v_mfma_f32_16x16x32_bf16 a[24:27], a[204:207], v[148:151], a[24:27]
 ds_read_b128 a[232:235], v240 offset:26624
 ds_read_b128 a[236:239], v240 offset:27648
 v_mfma_f32_16x16x32_bf16 a[24:27], a[200:203], v[144:147], a[24:27]
 ds_read_b128 a[240:243], v240 offset:28672
 v_cvt_pk_bf16_f32 v184, v76, v77
 v_smfmac_f32_16x16x64_bf16 v[232:235], v[244:247], v[144:151], v206
 s_waitcnt lgkmcnt(6)
 ds_read_b128 a[244:247], v240 offset:29696
 v_mfma_f32_16x16x32_bf16 a[40:43], a[208:211], v[144:147], a[40:43]
 buffer_load_dwordx4 v202, s[8:11], s59 offen offset:2048 lds
 v_mfma_f32_16x16x32_bf16 a[40:43], a[212:215], v[148:151], a[40:43]
 v_exp_f32 v78, v78
 v_mfma_f32_16x16x32_bf16 a[44:47], a[212:215], v[156:159], a[44:47]
 buffer_load_dwordx4 v203, s[8:11], s59 offen offset:3072 lds
 v_mfma_f32_16x16x32_bf16 a[44:47], a[208:211], v[152:155], a[44:47]
 s_add_u32 s59, s59, 131072
 ds_read_b128 a[248:251], v240 offset:30720
 ds_read_b128 a[252:255], v240 offset:31744
 v_mfma_f32_16x16x32_bf16 a[60:63], a[216:219], v[152:155], a[60:63]
 s_waitcnt lgkmcnt(6)
 v_exp_f32 v79, v79
 v_mfma_f32_16x16x32_bf16 a[60:63], a[220:223], v[156:159], a[60:63]
 s_waitcnt vmcnt(8)
 v_cvt_pk_bf16_f32 v185, v78, v79
 v_mfma_f32_16x16x32_bf16 a[56:59], a[220:223], v[148:151], a[56:59]
 s_barrier
 v_mfma_f32_16x16x32_bf16 a[56:59], a[216:219], v[144:147], a[56:59]
 buffer_store_dword v253, v163, s[4:7], s30 offen sc1
 v_mfma_f32_16x16x32_bf16 a[72:75], a[224:227], v[144:147], a[72:75]
 s_add_u32 m0, s36, 0
 v_exp_f32 v92, v92
 v_mfma_f32_16x16x32_bf16 a[72:75], a[228:231], v[148:151], a[72:75]
 buffer_load_dwordx4 v200, s[8:11], s59 offen lds
 v_mfma_f32_16x16x32_bf16 a[76:79], a[228:231], v[156:159], a[76:79]
 ds_read_b128 a[192:195], v240 offset:49152
 ds_read_b128 a[196:199], v240 offset:50176
 v_mfma_f32_16x16x32_bf16 a[76:79], a[224:227], v[152:155], a[76:79]
 s_waitcnt lgkmcnt(5)
 ds_read_b128 a[200:203], v240 offset:51200
 v_mfma_f32_16x16x32_bf16 a[92:95], a[232:235], v[152:155], a[92:95]
 v_exp_f32 v93, v93
 v_mfma_f32_16x16x32_bf16 a[92:95], a[236:239], v[156:159], a[92:95]
 buffer_load_dwordx4 v201, s[8:11], s59 offen offset:1024 lds
 v_mfma_f32_16x16x32_bf16 a[88:91], a[236:239], v[148:151], a[88:91]
 ds_read_b128 a[204:207], v240 offset:52224
 ds_read_b128 a[208:211], v240 offset:53248
 v_mfma_f32_16x16x32_bf16 a[88:91], a[232:235], v[144:147], a[88:91]
 v_exp_f32 v94, v94
 v_smfmac_f32_16x16x64_bf16 v[236:239], v[244:247], v[152:159], v206
 ds_read_b128 a[212:215], v240 offset:54272
 v_mfma_f32_16x16x32_bf16 a[104:107], a[240:243], v[144:147], a[104:107]
 s_waitcnt lgkmcnt(6)
 buffer_load_dwordx4 v202, s[8:11], s59 offen offset:2048 lds
 v_mfma_f32_16x16x32_bf16 a[104:107], a[244:247], v[148:151], a[104:107]
 ds_read_b128 a[216:219], v240 offset:55296
 v_cvt_pk_bf16_f32 v186, v92, v93
 v_mfma_f32_16x16x32_bf16 a[108:111], a[244:247], v[156:159], a[108:111]
 v_mfma_f32_16x16x32_bf16 a[108:111], a[240:243], v[152:155], a[108:111]
 v_exp_f32 v95, v95
 v_mfma_f32_16x16x32_bf16 a[124:127], a[248:251], v[152:155], a[124:127]
 buffer_load_dwordx4 v203, s[8:11], s59 offen offset:3072 lds
 v_mfma_f32_16x16x32_bf16 a[124:127], a[252:255], v[156:159], a[124:127]
 s_add_u32 s59, s59, 131072
 ds_read_b128 a[220:223], v240 offset:56320
 v_cvt_pk_bf16_f32 v187, v94, v95
 v_mfma_f32_16x16x32_bf16 a[120:123], a[252:255], v[148:151], a[120:123]
 s_waitcnt lgkmcnt(4)
 v_mfma_f32_16x16x32_bf16 a[120:123], a[248:251], v[144:147], a[120:123]
 v_exp_f32 v108, v108
 v_exp_f32 v109, v109
 v_exp_f32 v110, v110
 v_cvt_pk_bf16_f32 v188, v108, v109
 v_exp_f32 v111, v111
 v_exp_f32 v124, v124
 v_cvt_pk_bf16_f32 v189, v110, v111
 v_exp_f32 v125, v125
 v_exp_f32 v126, v126
 v_cvt_pk_bf16_f32 v190, v124, v125
 v_exp_f32 v127, v127
 s_nop 0
 v_cvt_pk_bf16_f32 v191, v126, v127
 v_and_b32 v184, v184, v192
 v_and_b32 v185, v185, v193
 v_and_b32 v186, v186, v194
 v_and_b32 v187, v187, v195
 v_and_b32 v188, v188, v196
 v_and_b32 v189, v189, v197
 v_and_b32 v190, v190, v198
 v_and_b32 v191, v191, v199
 s_nop 1
 v_mfma_f32_16x16x32_bf16 a[12:15], a[192:195], v[184:187], a[12:15]
 ds_read_b128 a[224:227], v240 offset:57344
 ds_read_b128 a[228:231], v240 offset:58368
 v_add_f32 v232, v232, v233
 v_rcp_f32 v234, v232
 v_mfma_f32_16x16x32_bf16 a[12:15], a[196:199], v[188:191], a[12:15]
 ds_read_b128 a[232:235], v240 offset:59392
 ds_read_b128 a[236:239], v240 offset:60416
 v_accvgpr_read_b32 v8, a8
 v_accvgpr_read_b32 v9, a9
 v_accvgpr_read_b32 v10, a10
 v_mfma_f32_16x16x32_bf16 a[28:31], a[200:203], v[184:187], a[28:31]
 ds_read_b128 a[240:243], v240 offset:61440
 s_add_u32 m0, s36, 16384
 v_accvgpr_read_b32 v11, a11
 buffer_load_dwordx4 v200, s[8:11], s59 offen lds
 v_accvgpr_read_b32 v72, a24
 v_mfma_f32_16x16x32_bf16 a[28:31], a[204:207], v[188:191], a[28:31]
 s_waitcnt lgkmcnt(5)
 ds_read_b128 a[244:247], v240 offset:62464
 v_accvgpr_read_b32 v73, a25
 v_accvgpr_read_b32 v74, a26
 v_accvgpr_read_b32 v75, a27
 v_mul_f32 v8, v8, v234
 v_mfma_f32_16x16x32_bf16 a[44:47], a[208:211], v[184:187], a[44:47]
 ds_read_b128 a[248:251], v240 offset:63488
 v_mul_f32 v9, v9, v234
 v_mul_f32 v10, v10, v234
 v_mul_f32 v11, v11, v234
 v_mul_f32 v72, v72, v234
 v_mfma_f32_16x16x32_bf16 a[44:47], a[212:215], v[188:191], a[44:47]
 ds_read_b128 a[252:255], v240 offset:64512
 v_mul_f32 v73, v73, v234
 buffer_load_dwordx4 v201, s[8:11], s59 offen offset:1024 lds
 v_mul_f32 v74, v74, v234
 v_mul_f32 v75, v75, v234
 v_mfma_f32_16x16x32_bf16 a[60:63], a[216:219], v[184:187], a[60:63]
 v_cvt_pk_bf16_f32 v8, v8, v9
 v_cvt_pk_bf16_f32 v9, v10, v11
 v_cvt_pk_bf16_f32 v10, v72, v73
 v_cvt_pk_bf16_f32 v11, v74, v75
 buffer_store_dwordx4 v[8:11], v249, s[4:7], s100 offen sc1
 v_mfma_f32_16x16x32_bf16 a[60:63], a[220:223], v[188:191], a[60:63]
 v_accvgpr_read_b32 v24, a40
 v_accvgpr_read_b32 v25, a41
 v_accvgpr_read_b32 v26, a42
 buffer_load_dwordx4 v202, s[8:11], s59 offen offset:2048 lds
 v_accvgpr_read_b32 v27, a43
 v_smfmac_f32_16x16x64_bf16 v[236:239], v[244:247], v[184:191], v206
 s_waitcnt lgkmcnt(4)
 v_accvgpr_read_b32 v88, a56
 v_accvgpr_read_b32 v89, a57
 v_accvgpr_read_b32 v90, a58
 v_accvgpr_read_b32 v91, a59
 v_mfma_f32_16x16x32_bf16 a[76:79], a[224:227], v[184:187], a[76:79]
 v_mul_f32 v24, v24, v234
 v_mul_f32 v25, v25, v234
 v_mul_f32 v26, v26, v234
 v_mul_f32 v27, v27, v234
 v_mul_f32 v88, v88, v234
 v_mfma_f32_16x16x32_bf16 a[76:79], a[228:231], v[188:191], a[76:79]
 buffer_load_dwordx4 v203, s[8:11], s59 offen offset:3072 lds
 s_add_u32 s59, s59, 131072
 v_mul_f32 v89, v89, v234
 v_mul_f32 v90, v90, v234
 v_mul_f32 v91, v91, v234
 v_mfma_f32_16x16x32_bf16 a[92:95], a[232:235], v[184:187], a[92:95]
 v_cvt_pk_bf16_f32 v24, v24, v25
 v_cvt_pk_bf16_f32 v25, v26, v27
 v_cvt_pk_bf16_f32 v26, v88, v89
 v_cvt_pk_bf16_f32 v27, v90, v91
 buffer_store_dwordx4 v[24:27], v250, s[4:7], s100 offen sc1
 v_mfma_f32_16x16x32_bf16 a[92:95], a[236:239], v[188:191], a[92:95]
 s_waitcnt lgkmcnt(0)
 v_accvgpr_read_b32 v40, a72
 v_accvgpr_read_b32 v41, a73
 v_accvgpr_read_b32 v42, a74
 s_add_u32 m0, s36, 32768
 v_accvgpr_read_b32 v43, a75
 v_mfma_f32_16x16x32_bf16 a[108:111], a[240:243], v[184:187], a[108:111]
 buffer_load_dwordx4 v200, s[8:11], s59 offen lds
 v_accvgpr_read_b32 v104, a88
 v_accvgpr_read_b32 v105, a89
 v_accvgpr_read_b32 v106, a90
 v_accvgpr_read_b32 v107, a91
 v_mfma_f32_16x16x32_bf16 a[108:111], a[244:247], v[188:191], a[108:111]
 v_mul_f32 v40, v40, v234
 v_mul_f32 v41, v41, v234
 v_mul_f32 v42, v42, v234
 v_mul_f32 v43, v43, v234
 v_mul_f32 v104, v104, v234
 v_mfma_f32_16x16x32_bf16 a[124:127], a[248:251], v[184:187], a[124:127]
 v_mul_f32 v105, v105, v234
 buffer_load_dwordx4 v201, s[8:11], s59 offen offset:1024 lds
 v_mul_f32 v106, v106, v234
 v_mul_f32 v107, v107, v234
 v_cvt_pk_bf16_f32 v40, v40, v41
 v_mfma_f32_16x16x32_bf16 a[124:127], a[252:255], v[188:191], a[124:127]
 v_cvt_pk_bf16_f32 v41, v42, v43
 v_cvt_pk_bf16_f32 v42, v104, v105
 v_cvt_pk_bf16_f32 v43, v106, v107
 buffer_store_dwordx4 v[40:43], v251, s[4:7], s100 offen sc1
 v_accvgpr_read_b32 v56, a104
 v_accvgpr_read_b32 v57, a105
 v_accvgpr_read_b32 v58, a106
 buffer_load_dwordx4 v202, s[8:11], s59 offen offset:2048 lds
 v_accvgpr_read_b32 v59, a107
 v_accvgpr_read_b32 v120, a120
 v_accvgpr_read_b32 v121, a121
 v_accvgpr_read_b32 v122, a122
 v_accvgpr_read_b32 v123, a123
 v_mul_f32 v56, v56, v234
 v_mul_f32 v57, v57, v234
 v_mul_f32 v58, v58, v234
 v_mul_f32 v59, v59, v234
 v_mul_f32 v120, v120, v234
 buffer_load_dwordx4 v203, s[8:11], s59 offen offset:3072 lds
 s_add_u32 s59, s59, 131072
 v_mul_f32 v121, v121, v234
 v_mul_f32 v122, v122, v234
 v_mul_f32 v123, v123, v234
 v_cvt_pk_bf16_f32 v56, v56, v57
 v_cvt_pk_bf16_f32 v57, v58, v59
 v_cvt_pk_bf16_f32 v58, v120, v121
 v_cvt_pk_bf16_f32 v59, v122, v123
 buffer_store_dwordx4 v[56:59], v252, s[4:7], s100 offen sc1
 s_waitcnt vmcnt(17)
 s_barrier
 global_load_dword v162, v162, s[28:29]
 s_nop 3
 v_add_f32 v236, v236, v237
 v_rcp_f32 v238, v236
 v_accvgpr_read_b32 v12, a12
 v_accvgpr_read_b32 v13, a13
 v_accvgpr_read_b32 v14, a14
 v_accvgpr_read_b32 v15, a15
 v_accvgpr_read_b32 v76, a28
 s_add_u32 m0, s36, 49152
 v_accvgpr_read_b32 v77, a29
 buffer_load_dwordx4 v200, s[8:11], s59 offen lds
 v_accvgpr_read_b32 v78, a30
 v_accvgpr_read_b32 v79, a31
 v_pk_mul_f32 v[12:13], v[12:13], v[238:239] op_sel_hi:[1,0]
 v_pk_mul_f32 v[14:15], v[14:15], v[238:239] op_sel_hi:[1,0]
 v_pk_mul_f32 v[76:77], v[76:77], v[238:239] op_sel_hi:[1,0]
 v_pk_mul_f32 v[78:79], v[78:79], v[238:239] op_sel_hi:[1,0]
 v_cvt_pk_bf16_f32 v12, v12, v13
 v_cvt_pk_bf16_f32 v13, v14, v15
 v_cvt_pk_bf16_f32 v14, v76, v77
 v_cvt_pk_bf16_f32 v15, v78, v79
 buffer_store_dwordx4 v[12:15], v249, s[4:7], s101 offen sc1
 v_accvgpr_read_b32 v28, a44
 v_accvgpr_read_b32 v29, a45
 v_accvgpr_read_b32 v30, a46
 v_accvgpr_read_b32 v31, a47
 v_accvgpr_read_b32 v92, a60
 v_accvgpr_read_b32 v93, a61
 buffer_load_dwordx4 v201, s[8:11], s59 offen offset:1024 lds
 v_accvgpr_read_b32 v94, a62
 v_accvgpr_read_b32 v95, a63
 v_pk_mul_f32 v[28:29], v[28:29], v[238:239] op_sel_hi:[1,0]
 v_pk_mul_f32 v[30:31], v[30:31], v[238:239] op_sel_hi:[1,0]
 v_pk_mul_f32 v[92:93], v[92:93], v[238:239] op_sel_hi:[1,0]
 v_pk_mul_f32 v[94:95], v[94:95], v[238:239] op_sel_hi:[1,0]
 v_cvt_pk_bf16_f32 v28, v28, v29
 v_cvt_pk_bf16_f32 v29, v30, v31
 v_cvt_pk_bf16_f32 v30, v92, v93
 v_cvt_pk_bf16_f32 v31, v94, v95
 buffer_store_dwordx4 v[28:31], v250, s[4:7], s101 offen sc1
 v_accvgpr_read_b32 v44, a76
 v_accvgpr_read_b32 v45, a77
 v_accvgpr_read_b32 v46, a78
 v_accvgpr_read_b32 v47, a79
 v_accvgpr_read_b32 v108, a92
 v_accvgpr_read_b32 v109, a93
 buffer_load_dwordx4 v202, s[8:11], s59 offen offset:2048 lds
 v_accvgpr_read_b32 v110, a94
 v_accvgpr_read_b32 v111, a95
 v_pk_mul_f32 v[44:45], v[44:45], v[238:239] op_sel_hi:[1,0]
 v_pk_mul_f32 v[46:47], v[46:47], v[238:239] op_sel_hi:[1,0]
 v_pk_mul_f32 v[108:109], v[108:109], v[238:239] op_sel_hi:[1,0]
 v_pk_mul_f32 v[110:111], v[110:111], v[238:239] op_sel_hi:[1,0]
 v_cvt_pk_bf16_f32 v44, v44, v45
 v_cvt_pk_bf16_f32 v45, v46, v47
 v_cvt_pk_bf16_f32 v46, v108, v109
 v_cvt_pk_bf16_f32 v47, v110, v111
 buffer_store_dwordx4 v[44:47], v251, s[4:7], s101 offen sc1
 v_accvgpr_read_b32 v60, a108
 v_accvgpr_read_b32 v61, a109
 v_accvgpr_read_b32 v62, a110
 v_accvgpr_read_b32 v63, a111
 v_accvgpr_read_b32 v124, a124
 v_accvgpr_read_b32 v125, a125
 buffer_load_dwordx4 v203, s[8:11], s59 offen offset:3072 lds
 s_add_u32 s59, s59, 131072
 v_accvgpr_read_b32 v126, a126
 v_accvgpr_read_b32 v127, a127
 v_pk_mul_f32 v[60:61], v[60:61], v[238:239] op_sel_hi:[1,0]
 v_pk_mul_f32 v[62:63], v[62:63], v[238:239] op_sel_hi:[1,0]
 v_pk_mul_f32 v[124:125], v[124:125], v[238:239] op_sel_hi:[1,0]
 v_pk_mul_f32 v[126:127], v[126:127], v[238:239] op_sel_hi:[1,0]
 v_cvt_pk_bf16_f32 v60, v60, v61
 v_cvt_pk_bf16_f32 v61, v62, v63
 v_cvt_pk_bf16_f32 v62, v124, v125
 v_cvt_pk_bf16_f32 v63, v126, v127
 buffer_store_dwordx4 v[60:63], v252, s[4:7], s101 offen sc1
 v_max3_u32 v204, v224, v228, v232
 v_max_u32 v204, v204, v236
 v_cmp_le_u32 vcc, 0x5f800000, v204
 s_nop 1
 s_cbranch_vccnz Lslow
Lslow_back:
Lround2:
 buffer_load_dword v160, v161, s[4:7], 0 offen sc1
 v_lshrrev_b32 v221, 6, v255
 v_lshlrev_b32 v220, 7, v221
 v_bfe_u32 v221, v255, 7, 2
 v_lshl_add_u32 v220, v221, 5, v220
 v_bfe_u32 v221, v255, 4, 2
 v_lshl_add_u32 v220, v221, 3, v220
 v_add_u32 v192, 0x20000, v220
 v_add_u32 v204, s34, v220
 v_xor_b32 v196, 0x10000, v204
 v_xor_b32 v193, 32, v192
 v_xor_b32 v194, 64, v192
 v_xor_b32 v195, 96, v192
 v_xor_b32 v197, 32, v196
 v_xor_b32 v198, 64, v196
 v_xor_b32 v199, 96, v196
 v_xor_b32 v205, 32, v204
 v_xor_b32 v206, 64, v204
 v_xor_b32 v207, 96, v204
 s_mov_b32 s93, s54
 s_lshl_b32 s23, s20, 15
 s_add_u32 s23, s23, 262144
 s_sub_u32 s54, s54, s23
 v_subrev_u32 v233, s23, v161
 ds_read_b64_tr_b16 v[64:65], v192 offset:0
 ds_read_b64_tr_b16 v[66:67], v192 offset:2048
 ds_read_b64_tr_b16 v[68:69], v192 offset:4096
 ds_read_b64_tr_b16 v[70:71], v192 offset:6144
 ds_read_b64_tr_b16 v[72:73], v192 offset:8192
 ds_read_b64_tr_b16 v[74:75], v192 offset:10240
 ds_read_b64_tr_b16 v[76:77], v192 offset:12288
 ds_read_b64_tr_b16 v[78:79], v192 offset:14336
 ds_read_b64_tr_b16 v[80:81], v193 offset:0
 ds_read_b64_tr_b16 v[82:83], v193 offset:2048
 ds_read_b64_tr_b16 v[84:85], v193 offset:4096
 ds_read_b64_tr_b16 v[86:87], v193 offset:6144
 ds_read_b64_tr_b16 v[88:89], v193 offset:8192
 ds_read_b64_tr_b16 v[90:91], v193 offset:10240
 ds_read_b64_tr_b16 v[92:93], v193 offset:12288
 ds_read_b64_tr_b16 v[94:95], v193 offset:14336
 ds_read_b64_tr_b16 v[96:97], v194 offset:0
 ds_read_b64_tr_b16 v[98:99], v194 offset:2048
 ds_read_b64_tr_b16 v[100:101], v194 offset:4096
 ds_read_b64_tr_b16 v[102:103], v194 offset:6144
 ds_read_b64_tr_b16 v[104:105], v194 offset:8192
 ds_read_b64_tr_b16 v[106:107], v194 offset:10240
 ds_read_b64_tr_b16 v[108:109], v194 offset:12288
 ds_read_b64_tr_b16 v[110:111], v194 offset:14336
 ds_read_b64_tr_b16 v[112:113], v195 offset:0
 ds_read_b64_tr_b16 v[114:115], v195 offset:2048
 ds_read_b64_tr_b16 v[116:117], v195 offset:4096
 ds_read_b64_tr_b16 v[118:119], v195 offset:6144
 ds_read_b64_tr_b16 v[120:121], v195 offset:8192
 ds_read_b64_tr_b16 v[122:123], v195 offset:10240
 ds_read_b64_tr_b16 v[124:125], v195 offset:12288
 ds_read_b64_tr_b16 v[126:127], v195 offset:14336
 s_mov_b64 exec, 0
 s_cmp_eq_u32 s20, 0
 s_cbranch_scc1 Lw2_0
 s_cmp_eq_u32 s20, 1
 s_cbranch_scc1 Lw2_1
 s_cmp_eq_u32 s20, 2
 s_cbranch_scc1 Lw2_2
 s_branch Lw2_3
Lw2_back:
 s_mov_b64 exec, -1
 v_lshrrev_b32 v242, 6, v255
 v_and_b32 v250, 0x30, v255
 v_lshl_add_u32 v242, v242, 10, v250
 v_and_b32 v250, 0xf0, v255
 v_lshrrev_b32 v251, 8, v255
 v_lshlrev_b32 v251, 3, v251
 v_lshl_add_u32 v250, v250, 2, v251
 v_add_u32 v243, s37, v250
 s_waitcnt vmcnt(1)
 s_barrier
 buffer_store_dword v253, v254, s[4:7], s54 offen sc1
 s_waitcnt vmcnt(1)
 v_cmp_gt_u32 vcc, 1, v160
 s_mov_b32 s27, 0
 s_nop 0
 s_cbranch_vccz Lback11
Lspin10:
 buffer_load_dword v160, v161, s[4:7], 0 offen sc1
 s_add_u32 s27, s27, 1
 s_waitcnt vmcnt(0)
 v_cmp_gt_u32 vcc, 1, v160
 s_cmp_gt_u32 s27, 1048576
 s_cbranch_scc1 Lback11
 s_cbranch_vccnz Lspin10
Lback11:
 buffer_load_dwordx4 a[0:3], v255, s[4:7], s38 offen sc1
 s_add_u32 s38, s38, 4096
 ds_read_b64_tr_b16 v[128:129], v192 offset:16384
 ds_read_b64_tr_b16 v[130:131], v192 offset:18432
 ds_read_b64_tr_b16 v[132:133], v192 offset:20480
 ds_read_b64_tr_b16 v[134:135], v192 offset:22528
 buffer_load_dwordx4 a[8:11], v255, s[4:7], s38 offen sc1
 s_add_u32 s38, s38, 4096
 ds_read_b64_tr_b16 v[136:137], v192 offset:24576
 ds_read_b64_tr_b16 v[138:139], v192 offset:26624
 ds_read_b64_tr_b16 v[140:141], v192 offset:28672
 ds_read_b64_tr_b16 v[142:143], v192 offset:30720
 buffer_load_dwordx4 a[16:19], v255, s[4:7], s38 offen sc1
 s_add_u32 s38, s38, 4096
 ds_read_b64_tr_b16 v[144:145], v193 offset:16384
 ds_read_b64_tr_b16 v[146:147], v193 offset:18432
 ds_read_b64_tr_b16 v[148:149], v193 offset:20480
 ds_read_b64_tr_b16 v[150:151], v193 offset:22528
 buffer_load_dwordx4 a[24:27], v255, s[4:7], s38 offen sc1
 s_add_u32 s38, s38, 4096
 ds_read_b64_tr_b16 v[152:153], v193 offset:24576
 ds_read_b64_tr_b16 v[154:155], v193 offset:26624
 ds_read_b64_tr_b16 v[156:157], v193 offset:28672
 ds_read_b64_tr_b16 v[158:159], v193 offset:30720
 buffer_load_dwordx4 a[32:35], v255, s[4:7], s38 offen sc1
 s_add_u32 s38, s38, 4096
 ds_read_b64_tr_b16 v[160:161], v194 offset:16384
 ds_read_b64_tr_b16 v[162:163], v194 offset:18432
 ds_read_b64_tr_b16 v[164:165], v194 offset:20480
 ds_read_b64_tr_b16 v[166:167], v194 offset:22528
 buffer_load_dwordx4 a[40:43], v255, s[4:7], s38 offen sc1
 s_add_u32 s38, s38, 4096
 ds_read_b64_tr_b16 v[168:169], v194 offset:24576
 ds_read_b64_tr_b16 v[170:171], v194 offset:26624
 ds_read_b64_tr_b16 v[172:173], v194 offset:28672
 ds_read_b64_tr_b16 v[174:175], v194 offset:30720
 buffer_load_dwordx4 a[48:51], v255, s[4:7], s38 offen sc1
 s_add_u32 s38, s38, 4096
 ds_read_b64_tr_b16 v[176:177], v195 offset:16384
 ds_read_b64_tr_b16 v[178:179], v195 offset:18432
 ds_read_b64_tr_b16 v[180:181], v195 offset:20480
 ds_read_b64_tr_b16 v[182:183], v195 offset:22528
 buffer_load_dwordx4 a[56:59], v255, s[4:7], s38 offen sc1
 s_add_u32 s38, s38, 4096
 ds_read_b64_tr_b16 v[184:185], v195 offset:24576
 ds_read_b64_tr_b16 v[186:187], v195 offset:26624
 ds_read_b64_tr_b16 v[188:189], v195 offset:28672
 ds_read_b64_tr_b16 v[190:191], v195 offset:30720
 s_add_u32 m0, s37, 49152
 s_nop 0
 buffer_load_dwordx4 v242, s[16:19], s63 offen lds
 s_lshl_b32 s52, s60, 2
 s_add_u32 s52, s52, s61
 s_lshl_b32 s52, s52, 2
 s_add_u32 s52, s52, s62
 s_add_u32 m0, s37, 50176
 s_nop 0
 buffer_load_dwordx4 v242, s[16:19], s94 offen lds
 s_mul_i32 s24, s20, 6144
 s_xor_b32 s23, s52, 0
 s_mul_i32 s23, s23, 24576
 s_add_u32 s23, s23, s24
 buffer_load_dwordx4 a[64:67], v255, s[4:7], s38 offen sc1
 s_add_u32 s38, s38, 4096
 s_add_u32 s48, s23, 52428800
 s_xor_b32 s23, s52, 1
 s_mul_i32 s23, s23, 24576
 s_add_u32 s23, s23, s24
 buffer_load_dwordx4 a[72:75], v255, s[4:7], s38 offen sc1
 s_add_u32 s38, s38, 4096
 s_add_u32 s49, s23, 52428800
 s_xor_b32 s23, s52, 2
 s_mul_i32 s23, s23, 24576
 s_add_u32 s23, s23, s24
 buffer_load_dwordx4 a[80:83], v255, s[4:7], s38 offen sc1
 s_add_u32 s38, s38, 4096
 s_add_u32 s50, s23, 52430848
 s_xor_b32 s23, s52, 3
Lw2_0:
 s_cbranch_execz Lw2_4
 s_mul_i32 s23, s23, 24576
 s_add_u32 s23, s23, s24
 buffer_load_dwordx4 a[88:91], v255, s[4:7], s38 offen sc1
 s_add_u32 s38, s38, 4096
 s_add_u32 s51, s23, 52432896
 s_bfe_u32 s23, s2, 0x20003
 s_lshl_b32 s41, s62, 2
 s_add_u32 s41, s41, s23
 buffer_load_dwordx4 a[96:99], v255, s[4:7], s38 offen sc1
 s_add_u32 s38, s38, 4096
 s_and_b32 s24, s2, 1
 s_lshl_b32 s42, s22, 1
 s_add_u32 s42, s42, s24
 s_add_u32 s25, s22, 1
 buffer_load_dwordx4 a[104:107], v255, s[4:7], s38 offen sc1
 s_add_u32 s38, s38, 4096
 s_lshr_b32 s25, s25, 2
 s_lshl_b32 s32, s20, 14
 s_add_u32 s32, s32, s34
 s_xor_b32 s33, s32, 0x10000
 buffer_load_dwordx4 a[112:115], v255, s[4:7], s38 offen sc1
 s_add_u32 s38, s38, 4096
 s_mul_i32 s40, s20, 458752
 s_lshl_b32 s24, s42, 7
 s_add_u32 s40, s40, s24
 s_lshr_b32 s25, s25, 1
 buffer_load_dwordx4 a[120:123], v255, s[4:7], s38 offen sc1
 s_add_u32 s38, s38, 4096
 s_lshl_b32 s25, s25, 29
 s_add_u32 s40, s40, s25
 s_mul_i32 s24, s20, 344064
 s_sub_u32 s39, s40, s24
 buffer_load_dwordx4 a[128:131], v255, s[4:7], s38 offen sc1
 s_add_u32 s38, s38, 4096
 s_add_u32 s39, s39, 1792
 s_mov_b32 s12, s78
 s_mov_b32 s13, s79
 s_mov_b32 s14, 1835008
 buffer_load_dwordx4 a[136:139], v255, s[4:7], s38 offen sc1
 s_add_u32 s38, s38, 4096
 s_mov_b32 s15, 0x20000
 s_and_b32 s23, s62, 1
 s_lshl_b32 s23, s23, 6
 v_xor_b32 v223, s23, v200
 buffer_load_dwordx4 a[144:147], v255, s[4:7], s38 offen sc1
 s_add_u32 s38, s38, 4096
 v_lshrrev_b32 v222, 7, v255
 v_mul_u32_u24 v221, 2560, v222
 v_add_u32 v216, v221, v223
 v_add_u32 v217, 27648, v216
 buffer_load_dwordx4 a[152:155], v255, s[4:7], s38 offen sc1
 s_add_u32 s38, s38, 4096
 v_add_u32 v218, 55296, v216
 v_add_u32 v219, 82944, v216
 v_mul_u32_u24 v250, 3072, v222
 v_and_b32 v251, 4, v222
 buffer_load_dwordx4 a[160:163], v255, s[4:7], s38 offen sc1
 s_add_u32 s38, s38, 4096
 v_lshl_add_u32 v250, v251, 12, v250
 v_add_u32 v228, v250, v223
 v_add_u32 v229, 64512, v228
 v_add_u32 v230, 14336, v228
 buffer_load_dwordx4 a[168:171], v255, s[4:7], s38 offen sc1
 s_add_u32 s38, s38, 4096
 v_add_u32 v231, 78848, v228
 v_add_u32 v224, 0, v223
 v_add_u32 v225, 7168, v223
 v_add_u32 v226, 14336, v223
 buffer_load_dwordx4 a[176:179], v255, s[4:7], s38 offen sc1
 s_add_u32 s38, s38, 4096
 v_add_u32 v227, 21504, v223
 v_bfe_u32 v250, v255, 4, 4
 v_and_b32 v251, 6, v250
 v_lshrrev_b32 v252, 8, v255
 buffer_load_dwordx4 a[184:187], v255, s[4:7], s38 offen sc1
 s_add_u32 s38, s38, 4096
 v_xor_b32 v251, v251, v252
 v_lshlrev_b32 v251, 4, v251
 buffer_load_dword v232, v233, s[4:7], 0 offen sc1
 buffer_load_dwordx4 a[192:195], v255, s[4:7], s38 offen sc1
 s_add_u32 s38, s38, 4096
 v_lshl_add_u32 v250, v250, 7, v251
 v_add_u32 v244, s35, v250
 v_add_u32 v246, s32, v250
 v_xor_b32 v248, 0x10000, v246
 v_xor_b32 v245, 64, v244
 buffer_load_dwordx4 a[200:203], v255, s[4:7], s38 offen sc1
 s_add_u32 s38, s38, 4096
 v_xor_b32 v247, 64, v246
 v_xor_b32 v249, 64, v248
 s_lshl_b32 s23, s41, 19
 s_lshl_b32 s24, s20, 17
 s_add_u32 s23, s23, s24
 buffer_load_dwordx4 a[208:211], v255, s[4:7], s38 offen sc1
 s_add_u32 s38, s38, 4096
 s_and_b32 s24, s2, 1
 s_lshl_b32 s24, s24, 11
 s_add_u32 s23, s23, s24
 s_add_u32 s46, s23, s25
 s_lshl_b32 s23, s20, 15
 buffer_load_dwordx4 a[216:219], v255, s[4:7], s38 offen sc1
 s_add_u32 s38, s38, 4096
 s_lshl_b32 s24, s22, 7
 s_add_u32 s43, s23, s24
 s_lshl_b32 s23, s20, 12
 s_add_u32 s23, s23, s34
 s_xor_b32 s44, s23, 0x10000
 buffer_load_dwordx4 a[224:227], v255, s[4:7], s38 offen sc1
 s_add_u32 s38, s38, 4096
 s_lshl_b32 s54, s52, 7
 s_add_u32 s54, s54, 83591168
 buffer_load_dwordx4 a[232:235], v255, s[4:7], s38 offen sc1
 s_add_u32 s38, s38, 4096
 buffer_load_dwordx4 a[240:243], v255, s[4:7], s38 offen sc1
 s_add_u32 s38, s38, 4096
 buffer_load_dwordx4 a[248:251], v255, s[4:7], s38 offen sc1
 s_add_u32 s38, s38, 4096
 s_add_u32 m0, s37, 0
 s_nop 0
 buffer_load_dwordx4 v200, s[8:11], s59 offen lds
 buffer_load_dwordx4 v201, s[8:11], s59 offen offset:1024 lds
 buffer_load_dwordx4 v202, s[8:11], s59 offen offset:2048 lds
 buffer_load_dwordx4 v203, s[8:11], s59 offen offset:3072 lds
 s_add_u32 s59, s59, 131072
 s_waitcnt vmcnt(12)
 ds_read_b64 v[208:209], v243 offset:49152
 ds_read_b64 v[210:211], v243 offset:49184
 ds_read_b64 v[212:213], v243 offset:50176
 ds_read_b64 v[214:215], v243 offset:50208
 v_cmp_gt_u32 vcc, 1, v232
 s_mov_b32 s27, 0
 s_nop 0
 s_cbranch_vccz Lback13
Lspin12:
 buffer_load_dword v232, v233, s[4:7], 0 offen sc1
 s_add_u32 s27, s27, 1
 s_waitcnt vmcnt(0)
 v_cmp_gt_u32 vcc, 1, v232
 s_cmp_gt_u32 s27, 1048576
 s_cbranch_scc1 Lback13
 s_cbranch_vccnz Lspin12
Lback13:
 buffer_load_dwordx4 a[4:7], v255, s[4:7], s45 offen sc1
 s_add_u32 s45, s45, 4096
 buffer_load_dwordx4 a[12:15], v255, s[4:7], s45 offen sc1
 s_add_u32 s45, s45, 4096
 buffer_load_dwordx4 a[20:23], v255, s[4:7], s45 offen sc1
 s_add_u32 s45, s45, 4096
 buffer_load_dwordx4 a[28:31], v255, s[4:7], s45 offen sc1
 s_add_u32 s45, s45, 4096
 buffer_load_dwordx4 a[36:39], v255, s[4:7], s45 offen sc1
 s_add_u32 s45, s45, 4096
 buffer_load_dwordx4 a[44:47], v255, s[4:7], s45 offen sc1
 s_add_u32 s45, s45, 4096
 buffer_load_dwordx4 a[52:55], v255, s[4:7], s45 offen sc1
 s_add_u32 s45, s45, 4096
 buffer_load_dwordx4 a[60:63], v255, s[4:7], s45 offen sc1
 s_add_u32 s45, s45, 4096
 s_waitcnt lgkmcnt(15)
 v_mfma_f32_16x16x32_bf16 v[32:35], v[64:67], a[0:3], 0
 s_waitcnt lgkmcnt(15)
 v_mfma_f32_16x16x32_bf16 v[32:35], v[68:71], a[8:11], v[32:35]
 s_waitcnt lgkmcnt(15)
 buffer_load_dwordx4 a[68:71], v255, s[4:7], s45 offen sc1
 v_mfma_f32_16x16x32_bf16 v[32:35], v[72:75], a[16:19], v[32:35]
 s_waitcnt lgkmcnt(15)
 s_add_u32 s45, s45, 4096
 v_mfma_f32_16x16x32_bf16 v[32:35], v[76:79], a[24:27], v[32:35]
 s_waitcnt lgkmcnt(15)
 v_mfma_f32_16x16x32_bf16 v[40:43], v[80:83], a[0:3], 0
 v_mfma_f32_16x16x32_bf16 v[40:43], v[84:87], a[8:11], v[40:43]
 buffer_load_dwordx4 a[76:79], v255, s[4:7], s45 offen sc1
 v_mfma_f32_16x16x32_bf16 v[40:43], v[88:91], a[16:19], v[40:43]
 s_waitcnt lgkmcnt(15)
 s_add_u32 s45, s45, 4096
 v_mfma_f32_16x16x32_bf16 v[40:43], v[92:95], a[24:27], v[40:43]
 v_mfma_f32_16x16x32_bf16 v[48:51], v[96:99], a[0:3], 0
 v_mfma_f32_16x16x32_bf16 v[48:51], v[100:103], a[8:11], v[48:51]
 s_waitcnt lgkmcnt(15)
 buffer_load_dwordx4 a[84:87], v255, s[4:7], s45 offen sc1
 v_mfma_f32_16x16x32_bf16 v[48:51], v[104:107], a[16:19], v[48:51]
 s_add_u32 s45, s45, 4096
 v_mfma_f32_16x16x32_bf16 v[48:51], v[108:111], a[24:27], v[48:51]
 v_mfma_f32_16x16x32_bf16 v[56:59], v[112:115], a[0:3], 0
 s_waitcnt lgkmcnt(15)
 v_mfma_f32_16x16x32_bf16 v[56:59], v[116:119], a[8:11], v[56:59]
 buffer_load_dwordx4 a[92:95], v255, s[4:7], s45 offen sc1
 v_mfma_f32_16x16x32_bf16 v[56:59], v[120:123], a[16:19], v[56:59]
 s_add_u32 s45, s45, 4096
 v_mfma_f32_16x16x32_bf16 v[56:59], v[124:127], a[24:27], v[56:59]
 s_waitcnt lgkmcnt(15)
 v_mfma_f32_16x16x32_bf16 v[32:35], v[128:131], a[32:35], v[32:35]
 v_mfma_f32_16x16x32_bf16 v[32:35], v[132:135], a[40:43], v[32:35]
 buffer_load_dwordx4 a[100:103], v255, s[4:7], s45 offen sc1
 v_mfma_f32_16x16x32_bf16 v[32:35], v[136:139], a[48:51], v[32:35]
 s_waitcnt lgkmcnt(15)
 s_add_u32 s45, s45, 4096
 v_mfma_f32_16x16x32_bf16 v[32:35], v[140:143], a[56:59], v[32:35]
 v_mfma_f32_16x16x32_bf16 v[40:43], v[144:147], a[32:35], v[40:43]
 v_mfma_f32_16x16x32_bf16 v[40:43], v[148:151], a[40:43], v[40:43]
 s_waitcnt lgkmcnt(15)
 buffer_load_dwordx4 a[108:111], v255, s[4:7], s45 offen sc1
 v_mfma_f32_16x16x32_bf16 v[40:43], v[152:155], a[48:51], v[40:43]
 s_add_u32 s45, s45, 4096
 v_mfma_f32_16x16x32_bf16 v[40:43], v[156:159], a[56:59], v[40:43]
 v_mfma_f32_16x16x32_bf16 v[48:51], v[160:163], a[32:35], v[48:51]
 s_waitcnt lgkmcnt(12)
 v_mfma_f32_16x16x32_bf16 v[48:51], v[164:167], a[40:43], v[48:51]
 buffer_load_dwordx4 a[116:119], v255, s[4:7], s45 offen sc1
 v_mfma_f32_16x16x32_bf16 v[48:51], v[168:171], a[48:51], v[48:51]
 s_add_u32 s45, s45, 4096
 v_mfma_f32_16x16x32_bf16 v[48:51], v[172:175], a[56:59], v[48:51]
 s_waitcnt lgkmcnt(6)
 v_mfma_f32_16x16x32_bf16 v[56:59], v[176:179], a[32:35], v[56:59]
 v_mfma_f32_16x16x32_bf16 v[56:59], v[180:183], a[40:43], v[56:59]
 buffer_load_dwordx4 a[124:127], v255, s[4:7], s45 offen sc1
 v_mfma_f32_16x16x32_bf16 v[56:59], v[184:187], a[48:51], v[56:59]
 s_waitcnt lgkmcnt(4)
 s_add_u32 s45, s45, 4096
 v_mfma_f32_16x16x32_bf16 v[56:59], v[188:191], a[56:59], v[56:59]
 s_waitcnt vmcnt(15)
 v_mfma_f32_16x16x32_bf16 v[36:39], v[64:67], a[4:7], 0
 s_waitcnt vmcnt(14)
 v_mfma_f32_16x16x32_bf16 v[36:39], v[68:71], a[12:15], v[36:39]
 s_waitcnt vmcnt(13)
 buffer_load_dwordx4 a[132:135], v255, s[4:7], s45 offen sc1
 v_mfma_f32_16x16x32_bf16 v[36:39], v[72:75], a[20:23], v[36:39]
 s_waitcnt vmcnt(13)
 s_add_u32 s45, s45, 4096
 v_mfma_f32_16x16x32_bf16 v[36:39], v[76:79], a[28:31], v[36:39]
 v_mfma_f32_16x16x32_bf16 v[44:47], v[80:83], a[4:7], 0
 v_mfma_f32_16x16x32_bf16 v[44:47], v[84:87], a[12:15], v[44:47]
 buffer_load_dwordx4 a[140:143], v255, s[4:7], s45 offen sc1
 v_mfma_f32_16x16x32_bf16 v[44:47], v[88:91], a[20:23], v[44:47]
 s_add_u32 s45, s45, 4096
 v_mfma_f32_16x16x32_bf16 v[44:47], v[92:95], a[28:31], v[44:47]
 v_mfma_f32_16x16x32_bf16 v[52:55], v[96:99], a[4:7], 0
 v_mfma_f32_16x16x32_bf16 v[52:55], v[100:103], a[12:15], v[52:55]
 buffer_load_dwordx4 a[148:151], v255, s[4:7], s45 offen sc1
 v_mfma_f32_16x16x32_bf16 v[52:55], v[104:107], a[20:23], v[52:55]
 s_add_u32 s45, s45, 4096
 v_mfma_f32_16x16x32_bf16 v[52:55], v[108:111], a[28:31], v[52:55]
 v_mfma_f32_16x16x32_bf16 v[60:63], v[112:115], a[4:7], 0
 v_mfma_f32_16x16x32_bf16 v[60:63], v[116:119], a[12:15], v[60:63]
 buffer_load_dwordx4 a[156:159], v255, s[4:7], s45 offen sc1
 v_mfma_f32_16x16x32_bf16 v[60:63], v[120:123], a[20:23], v[60:63]
 s_add_u32 s45, s45, 4096
 v_mfma_f32_16x16x32_bf16 v[60:63], v[124:127], a[28:31], v[60:63]
 s_waitcnt vmcnt(15)
 v_mfma_f32_16x16x32_bf16 v[36:39], v[128:131], a[36:39], v[36:39]
 s_waitcnt vmcnt(14)
 v_mfma_f32_16x16x32_bf16 v[36:39], v[132:135], a[44:47], v[36:39]
 s_barrier
 buffer_load_dwordx4 a[164:167], v255, s[4:7], s45 offen sc1
 s_waitcnt vmcnt(14)
 v_mfma_f32_16x16x32_bf16 v[36:39], v[136:139], a[52:55], v[36:39]
 s_waitcnt vmcnt(13)
 s_add_u32 s45, s45, 4096
 ds_read_b64_tr_b16 v[64:65], v196 offset:0
 ds_read_b64_tr_b16 v[66:67], v196 offset:2048
 v_mfma_f32_16x16x32_bf16 v[36:39], v[140:143], a[60:63], v[36:39]
 v_mfma_f32_16x16x32_bf16 v[44:47], v[144:147], a[36:39], v[44:47]
 ds_read_b64_tr_b16 v[68:69], v196 offset:4096
 ds_read_b64_tr_b16 v[70:71], v196 offset:6144
 v_mfma_f32_16x16x32_bf16 v[44:47], v[148:151], a[44:47], v[44:47]
 buffer_load_dwordx4 a[172:175], v255, s[4:7], s45 offen sc1
 v_mfma_f32_16x16x32_bf16 v[44:47], v[152:155], a[52:55], v[44:47]
 s_add_u32 s45, s45, 4096
 ds_read_b64_tr_b16 v[72:73], v196 offset:8192
 ds_read_b64_tr_b16 v[74:75], v196 offset:10240
 v_mfma_f32_16x16x32_bf16 v[44:47], v[156:159], a[60:63], v[44:47]
 v_mfma_f32_16x16x32_bf16 v[52:55], v[160:163], a[36:39], v[52:55]
 ds_read_b64_tr_b16 v[76:77], v196 offset:12288
 ds_read_b64_tr_b16 v[78:79], v196 offset:14336
 v_mfma_f32_16x16x32_bf16 v[52:55], v[164:167], a[44:47], v[52:55]
 buffer_load_dwordx4 a[180:183], v255, s[4:7], s45 offen sc1
 v_mfma_f32_16x16x32_bf16 v[52:55], v[168:171], a[52:55], v[52:55]
 s_add_u32 s45, s45, 4096
 ds_read_b64_tr_b16 v[80:81], v197 offset:0
 ds_read_b64_tr_b16 v[82:83], v197 offset:2048
 v_mfma_f32_16x16x32_bf16 v[52:55], v[172:175], a[60:63], v[52:55]
 v_mfma_f32_16x16x32_bf16 v[60:63], v[176:179], a[36:39], v[60:63]
 ds_read_b64_tr_b16 v[84:85], v197 offset:4096
 ds_read_b64_tr_b16 v[86:87], v197 offset:6144
 v_mfma_f32_16x16x32_bf16 v[60:63], v[180:183], a[44:47], v[60:63]
 buffer_load_dwordx4 a[188:191], v255, s[4:7], s45 offen sc1
 v_mfma_f32_16x16x32_bf16 v[60:63], v[184:187], a[52:55], v[60:63]
 s_add_u32 s45, s45, 4096
 ds_read_b64_tr_b16 v[88:89], v197 offset:8192
 ds_read_b64_tr_b16 v[90:91], v197 offset:10240
 v_mfma_f32_16x16x32_bf16 v[60:63], v[188:191], a[60:63], v[60:63]
 s_waitcnt lgkmcnt(8)
 v_mfma_f32_16x16x32_bf16 v[32:35], v[64:67], a[64:67], v[32:35]
 ds_read_b64_tr_b16 v[92:93], v197 offset:12288
 ds_read_b64_tr_b16 v[94:95], v197 offset:14336
 v_mfma_f32_16x16x32_bf16 v[32:35], v[68:71], a[72:75], v[32:35]
 buffer_load_dwordx4 a[196:199], v255, s[4:7], s45 offen sc1
 v_mfma_f32_16x16x32_bf16 v[32:35], v[72:75], a[80:83], v[32:35]
 s_waitcnt lgkmcnt(8)
 s_add_u32 s45, s45, 4096
 ds_read_b64_tr_b16 v[96:97], v198 offset:0
 ds_read_b64_tr_b16 v[98:99], v198 offset:2048
 v_mfma_f32_16x16x32_bf16 v[32:35], v[76:79], a[88:91], v[32:35]
 s_waitcnt vmcnt(13)
 v_mov_b32 v234, v204
 v_mov_b32 v238, v196
 v_mfma_f32_16x16x32_bf16 v[36:39], v[76:79], a[92:95], v[36:39]
 ds_read_b64_tr_b16 v[100:101], v198 offset:4096
 ds_read_b64_tr_b16 v[102:103], v198 offset:6144
 v_mfma_f32_16x16x32_bf16 v[36:39], v[72:75], a[84:87], v[36:39]
 buffer_load_dwordx4 a[204:207], v255, s[4:7], s45 offen sc1
 v_mfma_f32_16x16x32_bf16 v[36:39], v[68:71], a[76:79], v[36:39]
 s_add_u32 s45, s45, 4096
 ds_read_b64_tr_b16 v[104:105], v198 offset:8192
 ds_read_b64_tr_b16 v[106:107], v198 offset:10240
 v_mfma_f32_16x16x32_bf16 v[36:39], v[64:67], a[68:71], v[36:39]
 s_waitcnt lgkmcnt(8)
 v_mov_b32 v235, v205
 v_mov_b32 v239, v197
 v_mfma_f32_16x16x32_bf16 v[44:47], v[80:83], a[68:71], v[44:47]
 ds_read_b64_tr_b16 v[108:109], v198 offset:12288
 ds_read_b64_tr_b16 v[110:111], v198 offset:14336
 v_mfma_f32_16x16x32_bf16 v[44:47], v[84:87], a[76:79], v[44:47]
 buffer_load_dwordx4 a[212:215], v255, s[4:7], s45 offen sc1
 v_mfma_f32_16x16x32_bf16 v[44:47], v[88:91], a[84:87], v[44:47]
 s_waitcnt lgkmcnt(8)
 s_add_u32 s45, s45, 4096
 ds_read_b64_tr_b16 v[112:113], v199 offset:0
 ds_read_b64_tr_b16 v[114:115], v199 offset:2048
 v_mfma_f32_16x16x32_bf16 v[44:47], v[92:95], a[92:95], v[44:47]
 v_mov_b32 v236, v206
 v_mov_b32 v240, v198
 v_mfma_f32_16x16x32_bf16 v[40:43], v[92:95], a[88:91], v[40:43]
 ds_read_b64_tr_b16 v[116:117], v199 offset:4096
 ds_read_b64_tr_b16 v[118:119], v199 offset:6144
 v_mfma_f32_16x16x32_bf16 v[40:43], v[88:91], a[80:83], v[40:43]
 buffer_load_dwordx4 a[220:223], v255, s[4:7], s45 offen sc1
 v_mfma_f32_16x16x32_bf16 v[40:43], v[84:87], a[72:75], v[40:43]
 s_add_u32 s45, s45, 4096
 ds_read_b64_tr_b16 v[120:121], v199 offset:8192
 ds_read_b64_tr_b16 v[122:123], v199 offset:10240
 v_mfma_f32_16x16x32_bf16 v[40:43], v[80:83], a[64:67], v[40:43]
 s_waitcnt lgkmcnt(8)
 v_mov_b32 v237, v207
 v_mov_b32 v241, v199
 v_mfma_f32_16x16x32_bf16 v[48:51], v[96:99], a[64:67], v[48:51]
 s_add_u32 m0, s37, 16384
 ds_read_b64_tr_b16 v[124:125], v199 offset:12288
 ds_read_b64_tr_b16 v[126:127], v199 offset:14336
 v_mfma_f32_16x16x32_bf16 v[48:51], v[100:103], a[72:75], v[48:51]
 s_barrier
 buffer_load_dwordx4 v200, s[8:11], s59 offen lds
 v_mfma_f32_16x16x32_bf16 v[48:51], v[104:107], a[80:83], v[48:51]
 s_waitcnt lgkmcnt(8)
 ds_read_b64_tr_b16 v[64:65], v196 offset:16384
 ds_read_b64_tr_b16 v[66:67], v196 offset:18432
 v_mfma_f32_16x16x32_bf16 v[48:51], v[108:111], a[88:91], v[48:51]
 v_mov_b32 v220, 0x3f803f80
 v_mov_b32 v221, 0x3f803f80
 v_mfma_f32_16x16x32_bf16 v[52:55], v[108:111], a[92:95], v[52:55]
 ds_read_b64_tr_b16 v[68:69], v196 offset:20480
 ds_read_b64_tr_b16 v[70:71], v196 offset:22528
 v_mfma_f32_16x16x32_bf16 v[52:55], v[104:107], a[84:87], v[52:55]
 buffer_load_dwordx4 v201, s[8:11], s59 offen offset:1024 lds
 v_mfma_f32_16x16x32_bf16 v[52:55], v[100:103], a[76:79], v[52:55]
 ds_read_b64_tr_b16 v[72:73], v196 offset:24576
 ds_read_b64_tr_b16 v[74:75], v196 offset:26624
 v_mfma_f32_16x16x32_bf16 v[52:55], v[96:99], a[68:71], v[52:55]
 s_waitcnt lgkmcnt(8)
 v_mov_b32 v222, 0x3f803f80
 v_mov_b32 v223, 0x3f803f80
 v_mfma_f32_16x16x32_bf16 v[60:63], v[112:115], a[68:71], v[60:63]
 s_xor_b32 s23, s54, 256
 ds_read_b64_tr_b16 v[76:77], v196 offset:28672
 ds_read_b64_tr_b16 v[78:79], v196 offset:30720
 v_mfma_f32_16x16x32_bf16 v[60:63], v[116:119], a[76:79], v[60:63]
 s_and_b32 s23, s23, 0xffffff7f
 buffer_load_dwordx4 v202, s[8:11], s59 offen offset:2048 lds
 v_mfma_f32_16x16x32_bf16 v[60:63], v[120:123], a[84:87], v[60:63]
 s_waitcnt lgkmcnt(8)
 ds_read_b64_tr_b16 v[80:81], v197 offset:16384
 ds_read_b64_tr_b16 v[82:83], v197 offset:18432
 v_mfma_f32_16x16x32_bf16 v[60:63], v[124:127], a[92:95], v[60:63]
 v_and_b32 v233, 16, v255
 v_lshl_add_u32 v233, v233, 3, s23
 v_mfma_f32_16x16x32_bf16 v[56:59], v[124:127], a[88:91], v[56:59]
 s_xor_b32 s23, s93, 1024
 ds_read_b64_tr_b16 v[84:85], v197 offset:20480
 ds_read_b64_tr_b16 v[86:87], v197 offset:22528
 v_mfma_f32_16x16x32_bf16 v[56:59], v[120:123], a[80:83], v[56:59]
 s_xor_b32 s24, s93, 512
 buffer_load_dwordx4 v203, s[8:11], s59 offen offset:3072 lds
 v_mfma_f32_16x16x32_bf16 v[56:59], v[116:119], a[72:75], v[56:59]
 s_add_u32 s59, s59, 131072
 ds_read_b64_tr_b16 v[88:89], v197 offset:24576
 ds_read_b64_tr_b16 v[90:91], v197 offset:26624
 v_mfma_f32_16x16x32_bf16 v[56:59], v[112:115], a[64:67], v[56:59]
 s_waitcnt lgkmcnt(8)
 v_mov_b32 v131, s23
 v_writelane_b32 v131, s24, 1
 v_mfma_f32_16x16x32_bf16 v[32:35], v[64:67], a[96:99], v[32:35]
 s_xor_b32 s49, s95, 65536
 ds_read_b64_tr_b16 v[92:93], v197 offset:28672
 ds_read_b64_tr_b16 v[94:95], v197 offset:30720
 v_mfma_f32_16x16x32_bf16 v[32:35], v[68:71], a[104:107], v[32:35]
 buffer_load_dwordx4 a[228:231], v255, s[4:7], s45 offen sc1
 v_mfma_f32_16x16x32_bf16 v[32:35], v[72:75], a[112:115], v[32:35]
 s_waitcnt lgkmcnt(8)
 s_add_u32 s45, s45, 4096
 ds_read_b64_tr_b16 v[96:97], v198 offset:16384
 ds_read_b64_tr_b16 v[98:99], v198 offset:18432
 v_mfma_f32_16x16x32_bf16 v[32:35], v[76:79], a[120:123], v[32:35]
 s_waitcnt vmcnt(17)
 v_and_b32 v128, 0x330, v255
 v_bfe_u32 v130, v255, 7, 1
 v_mfma_f32_16x16x32_bf16 v[36:39], v[76:79], a[124:127], v[36:39]
 ds_read_b64_tr_b16 v[100:101], v198 offset:20480
 ds_read_b64_tr_b16 v[102:103], v198 offset:22528
 v_mfma_f32_16x16x32_bf16 v[36:39], v[72:75], a[116:119], v[36:39]
 buffer_load_dwordx4 a[236:239], v255, s[4:7], s45 offen sc1
 v_mfma_f32_16x16x32_bf16 v[36:39], v[68:71], a[108:111], v[36:39]
 s_add_u32 s45, s45, 4096
 ds_read_b64_tr_b16 v[104:105], v198 offset:24576
 ds_read_b64_tr_b16 v[106:107], v198 offset:26624
 v_mfma_f32_16x16x32_bf16 v[36:39], v[64:67], a[100:103], v[36:39]
 s_waitcnt lgkmcnt(8)
 v_lshl_add_u32 v128, v130, 6, v128
 v_bfe_u32 v130, v255, 6, 1
 v_mfma_f32_16x16x32_bf16 v[44:47], v[80:83], a[100:103], v[44:47]
 ds_read_b64_tr_b16 v[108:109], v198 offset:28672
 ds_read_b64_tr_b16 v[110:111], v198 offset:30720
 v_mfma_f32_16x16x32_bf16 v[44:47], v[84:87], a[108:111], v[44:47]
 buffer_load_dwordx4 a[244:247], v255, s[4:7], s45 offen sc1
 v_mfma_f32_16x16x32_bf16 v[44:47], v[88:91], a[116:119], v[44:47]
 s_waitcnt lgkmcnt(8)
 s_add_u32 s45, s45, 4096
 ds_read_b64_tr_b16 v[112:113], v199 offset:16384
 ds_read_b64_tr_b16 v[114:115], v199 offset:18432
 v_mfma_f32_16x16x32_bf16 v[44:47], v[92:95], a[124:127], v[44:47]
 v_lshl_add_u32 v128, v130, 14, v128
 v_and_b32 v129, 0x330, v255
 v_mfma_f32_16x16x32_bf16 v[40:43], v[92:95], a[120:123], v[40:43]
 ds_read_b64_tr_b16 v[116:117], v199 offset:20480
 ds_read_b64_tr_b16 v[118:119], v199 offset:22528
 v_mfma_f32_16x16x32_bf16 v[40:43], v[88:91], a[112:115], v[40:43]
 buffer_load_dwordx4 a[252:255], v255, s[4:7], s45 offen sc1
 v_mfma_f32_16x16x32_bf16 v[40:43], v[84:87], a[104:107], v[40:43]
 s_add_u32 s45, s45, 4096
 ds_read_b64_tr_b16 v[120:121], v199 offset:24576
 ds_read_b64_tr_b16 v[122:123], v199 offset:26624
 v_mfma_f32_16x16x32_bf16 v[40:43], v[80:83], a[96:99], v[40:43]
 s_waitcnt lgkmcnt(8)
 v_bfe_u32 v130, v255, 7, 1
 v_lshl_add_u32 v129, v130, 6, v129
 v_mfma_f32_16x16x32_bf16 v[48:51], v[96:99], a[96:99], v[48:51]
 s_add_u32 m0, s37, 32768
 ds_read_b64_tr_b16 v[124:125], v199 offset:28672
 ds_read_b64_tr_b16 v[126:127], v199 offset:30720
 v_mfma_f32_16x16x32_bf16 v[48:51], v[100:103], a[104:107], v[48:51]
 s_barrier
 buffer_load_dwordx4 v200, s[8:11], s58 offen lds
 v_mfma_f32_16x16x32_bf16 v[48:51], v[104:107], a[112:115], v[48:51]
 s_waitcnt lgkmcnt(8)
 ds_read_b64_tr_b16 v[64:65], v196 offset:32768
 ds_read_b64_tr_b16 v[66:67], v196 offset:34816
 v_mfma_f32_16x16x32_bf16 v[48:51], v[108:111], a[120:123], v[48:51]
 v_bfe_u32 v130, v255, 6, 1
 v_lshl_add_u32 v129, v130, 3, v129
 v_mfma_f32_16x16x32_bf16 v[52:55], v[108:111], a[124:127], v[52:55]
 s_lshl_b32 s23, s60, 14
 ds_read_b64_tr_b16 v[68:69], v196 offset:36864
 ds_read_b64_tr_b16 v[70:71], v196 offset:38912
 v_mfma_f32_16x16x32_bf16 v[52:55], v[104:107], a[116:119], v[52:55]
 s_sub_u32 s23, 253696, s23
 buffer_load_dwordx4 v201, s[8:11], s58 offen offset:1024 lds
 v_mfma_f32_16x16x32_bf16 v[52:55], v[100:103], a[108:111], v[52:55]
 ds_read_b64_tr_b16 v[72:73], v196 offset:40960
 ds_read_b64_tr_b16 v[74:75], v196 offset:43008
 v_mfma_f32_16x16x32_bf16 v[52:55], v[96:99], a[100:103], v[52:55]
 s_waitcnt lgkmcnt(8)
 v_bfe_u32 v130, v255, 8, 1
 v_mad_u32_u24 v129, v130, s23, v129
 v_mfma_f32_16x16x32_bf16 v[60:63], v[112:115], a[100:103], v[60:63]
 ds_read_b64_tr_b16 v[76:77], v196 offset:45056
 ds_read_b64_tr_b16 v[78:79], v196 offset:47104
 v_mfma_f32_16x16x32_bf16 v[60:63], v[116:119], a[108:111], v[60:63]
 buffer_load_dwordx4 v202, s[8:11], s58 offen offset:2048 lds
 v_mfma_f32_16x16x32_bf16 v[60:63], v[120:123], a[116:119], v[60:63]
 s_waitcnt lgkmcnt(8)
 ds_read_b64_tr_b16 v[80:81], v197 offset:32768
 ds_read_b64_tr_b16 v[82:83], v197 offset:34816
 v_mfma_f32_16x16x32_bf16 v[60:63], v[124:127], a[124:127], v[60:63]
 v_mov_b32 v130, 536870912
 v_cmp_gt_u32 vcc, 512, v255
 v_mfma_f32_16x16x32_bf16 v[56:59], v[124:127], a[120:123], v[56:59]
 s_lshr_b32 s23, s20, 1
 ds_read_b64_tr_b16 v[84:85], v197 offset:36864
 ds_read_b64_tr_b16 v[86:87], v197 offset:38912
 v_mfma_f32_16x16x32_bf16 v[56:59], v[120:123], a[112:115], v[56:59]
 s_and_b32 s25, s52, 15
 buffer_load_dwordx4 v203, s[8:11], s58 offen offset:3072 lds
 v_mfma_f32_16x16x32_bf16 v[56:59], v[116:119], a[104:107], v[56:59]
 s_add_u32 s58, s58, 131072
 ds_read_b64_tr_b16 v[88:89], v197 offset:40960
 ds_read_b64_tr_b16 v[90:91], v197 offset:43008
 v_mfma_f32_16x16x32_bf16 v[56:59], v[112:115], a[96:99], v[56:59]
 s_waitcnt lgkmcnt(8)
 v_cndmask_b32 v129, v130, v129, vcc
 v_mfma_f32_16x16x32_bf16 v[32:35], v[64:67], a[128:131], v[32:35]
 s_add_u32 m0, s37, 49152
 ds_read_b64_tr_b16 v[92:93], v197 offset:45056
 ds_read_b64_tr_b16 v[94:95], v197 offset:47104
 v_mfma_f32_16x16x32_bf16 v[32:35], v[68:71], a[136:139], v[32:35]
 s_lshl_b32 s24, s23, 5
 buffer_load_dwordx4 v200, s[8:11], s58 offen lds
 v_mfma_f32_16x16x32_bf16 v[32:35], v[72:75], a[144:147], v[32:35]
 s_waitcnt lgkmcnt(8)
 s_add_u32 s24, s24, s25
 ds_read_b64_tr_b16 v[96:97], v198 offset:32768
 ds_read_b64_tr_b16 v[98:99], v198 offset:34816
 v_mfma_f32_16x16x32_bf16 v[32:35], v[76:79], a[152:155], v[32:35]
 s_waitcnt vmcnt(21)
 s_lshl_b32 s24, s24, 10
 v_mfma_f32_16x16x32_bf16 v[36:39], v[76:79], a[156:159], v[36:39]
 s_and_b32 s26, s20, 1
 ds_read_b64_tr_b16 v[100:101], v198 offset:36864
 ds_read_b64_tr_b16 v[102:103], v198 offset:38912
 v_mfma_f32_16x16x32_bf16 v[36:39], v[72:75], a[148:151], v[36:39]
 s_lshl_b32 s26, s26, 7
 buffer_load_dwordx4 v201, s[8:11], s58 offen offset:1024 lds
 v_mfma_f32_16x16x32_bf16 v[36:39], v[68:71], a[140:143], v[36:39]
 s_add_u32 s24, s24, s26
 ds_read_b64_tr_b16 v[104:105], v198 offset:40960
 ds_read_b64_tr_b16 v[106:107], v198 offset:43008
 v_mfma_f32_16x16x32_bf16 v[36:39], v[64:67], a[132:135], v[36:39]
 s_waitcnt lgkmcnt(8)
 s_lshl_b32 s99, s60, 16
 v_mfma_f32_16x16x32_bf16 v[44:47], v[80:83], a[132:135], v[44:47]
 s_add_u32 s98, s24, s99
 ds_read_b64_tr_b16 v[108:109], v198 offset:45056
 ds_read_b64_tr_b16 v[110:111], v198 offset:47104
 v_mfma_f32_16x16x32_bf16 v[44:47], v[84:87], a[140:143], v[44:47]
 s_sub_u32 s100, s24, s99
 buffer_load_dwordx4 v202, s[8:11], s58 offen offset:2048 lds
 v_mfma_f32_16x16x32_bf16 v[44:47], v[88:91], a[148:151], v[44:47]
 s_waitcnt lgkmcnt(8)
 s_add_u32 s98, s98, 68157440
 ds_read_b64_tr_b16 v[112:113], v199 offset:32768
 ds_read_b64_tr_b16 v[114:115], v199 offset:34816
 v_mfma_f32_16x16x32_bf16 v[44:47], v[92:95], a[156:159], v[44:47]
 s_add_u32 s100, s100, 70189056
 v_mfma_f32_16x16x32_bf16 v[40:43], v[92:95], a[152:155], v[40:43]
 s_lshl_b32 s24, s60, 1
 ds_read_b64_tr_b16 v[116:117], v199 offset:36864
 ds_read_b64_tr_b16 v[118:119], v199 offset:38912
 v_mfma_f32_16x16x32_bf16 v[40:43], v[88:91], a[144:147], v[40:43]
 s_add_u32 s23, s23, s24
 buffer_load_dwordx4 v203, s[8:11], s58 offen offset:3072 lds
 v_mfma_f32_16x16x32_bf16 v[40:43], v[84:87], a[136:139], v[40:43]
 s_add_u32 s58, s58, 131072
 ds_read_b64_tr_b16 v[120:121], v199 offset:40960
 ds_read_b64_tr_b16 v[122:123], v199 offset:43008
 v_mfma_f32_16x16x32_bf16 v[40:43], v[80:83], a[128:131], v[40:43]
 s_waitcnt lgkmcnt(8)
 s_lshl_b32 s23, s23, 4
 v_mfma_f32_16x16x32_bf16 v[48:51], v[96:99], a[128:131], v[48:51]
 s_add_u32 m0, s47, 0
 ds_read_b64_tr_b16 v[124:125], v199 offset:45056
 ds_read_b64_tr_b16 v[126:127], v199 offset:47104
 v_mfma_f32_16x16x32_bf16 v[48:51], v[100:103], a[136:139], v[48:51]
 s_barrier
 buffer_load_dwordx4 v200, s[8:11], s58 offen lds
 v_mfma_f32_16x16x32_bf16 v[48:51], v[104:107], a[144:147], v[48:51]
 s_waitcnt lgkmcnt(8)
 s_add_u32 s23, s23, s25
 ds_read_b64_tr_b16 v[64:65], v196 offset:49152
 ds_read_b64_tr_b16 v[66:67], v196 offset:51200
 v_mfma_f32_16x16x32_bf16 v[48:51], v[108:111], a[152:155], v[48:51]
 s_lshl_b32 s23, s23, 8
 v_mfma_f32_16x16x32_bf16 v[52:55], v[108:111], a[156:159], v[52:55]
 s_add_u32 s23, s23, s26
 ds_read_b64_tr_b16 v[68:69], v196 offset:53248
 ds_read_b64_tr_b16 v[70:71], v196 offset:55296
 v_mfma_f32_16x16x32_bf16 v[52:55], v[104:107], a[148:151], v[52:55]
Lw2_1:
 s_cbranch_execz Lw2_5
 s_add_u32 s99, s23, 82837504
 buffer_load_dwordx4 v201, s[8:11], s58 offen offset:1024 lds
 v_mfma_f32_16x16x32_bf16 v[52:55], v[100:103], a[140:143], v[52:55]
 ds_read_b64_tr_b16 v[72:73], v196 offset:57344
 ds_read_b64_tr_b16 v[74:75], v196 offset:59392
 v_mfma_f32_16x16x32_bf16 v[52:55], v[96:99], a[132:135], v[52:55]
 s_waitcnt lgkmcnt(8)
 v_lshlrev_b32 v144, 16, v208
 v_and_b32 v145, 0xffff0000, v208
 v_mfma_f32_16x16x32_bf16 v[60:63], v[112:115], a[132:135], v[60:63]
 ds_read_b64_tr_b16 v[76:77], v196 offset:61440
 ds_read_b64_tr_b16 v[78:79], v196 offset:63488
 v_mfma_f32_16x16x32_bf16 v[60:63], v[116:119], a[140:143], v[60:63]
 buffer_load_dwordx4 v202, s[8:11], s58 offen offset:2048 lds
 v_mfma_f32_16x16x32_bf16 v[60:63], v[120:123], a[148:151], v[60:63]
 s_waitcnt lgkmcnt(8)
 ds_read_b64_tr_b16 v[80:81], v197 offset:49152
 ds_read_b64_tr_b16 v[82:83], v197 offset:51200
 v_mfma_f32_16x16x32_bf16 v[60:63], v[124:127], a[156:159], v[60:63]
 v_lshlrev_b32 v146, 16, v209
 v_and_b32 v147, 0xffff0000, v209
 v_mfma_f32_16x16x32_bf16 v[56:59], v[124:127], a[152:155], v[56:59]
 ds_read_b64_tr_b16 v[84:85], v197 offset:53248
 ds_read_b64_tr_b16 v[86:87], v197 offset:55296
 v_mfma_f32_16x16x32_bf16 v[56:59], v[120:123], a[144:147], v[56:59]
 buffer_load_dwordx4 v203, s[8:11], s58 offen offset:3072 lds
 v_mfma_f32_16x16x32_bf16 v[56:59], v[116:119], a[136:139], v[56:59]
 s_add_u32 s58, s58, 131072
 ds_read_b64_tr_b16 v[88:89], v197 offset:57344
 ds_read_b64_tr_b16 v[90:91], v197 offset:59392
 v_mfma_f32_16x16x32_bf16 v[56:59], v[112:115], a[128:131], v[56:59]
 s_waitcnt lgkmcnt(8)
 v_lshlrev_b32 v148, 16, v210
 v_and_b32 v149, 0xffff0000, v210
 v_mfma_f32_16x16x32_bf16 v[32:35], v[64:67], a[160:163], v[32:35]
 s_add_u32 m0, s47, 16384
 ds_read_b64_tr_b16 v[92:93], v197 offset:61440
 ds_read_b64_tr_b16 v[94:95], v197 offset:63488
 v_mfma_f32_16x16x32_bf16 v[32:35], v[68:71], a[168:171], v[32:35]
 buffer_load_dwordx4 v200, s[8:11], s58 offen lds
 v_mfma_f32_16x16x32_bf16 v[32:35], v[72:75], a[176:179], v[32:35]
 s_waitcnt lgkmcnt(8)
 ds_read_b64_tr_b16 v[96:97], v198 offset:49152
 ds_read_b64_tr_b16 v[98:99], v198 offset:51200
 v_mfma_f32_16x16x32_bf16 v[32:35], v[76:79], a[184:187], v[32:35]
 s_waitcnt vmcnt(25)
 v_lshlrev_b32 v150, 16, v211
 v_and_b32 v151, 0xffff0000, v211
 v_mfma_f32_16x16x32_bf16 v[36:39], v[76:79], a[188:191], v[36:39]
 ds_read_b64_tr_b16 v[100:101], v198 offset:53248
 ds_read_b64_tr_b16 v[102:103], v198 offset:55296
 v_mfma_f32_16x16x32_bf16 v[36:39], v[72:75], a[180:183], v[36:39]
 buffer_load_dwordx4 v201, s[8:11], s58 offen offset:1024 lds
 v_mfma_f32_16x16x32_bf16 v[36:39], v[68:71], a[172:175], v[36:39]
 ds_read_b64_tr_b16 v[104:105], v198 offset:57344
 ds_read_b64_tr_b16 v[106:107], v198 offset:59392
 v_mfma_f32_16x16x32_bf16 v[36:39], v[64:67], a[164:167], v[36:39]
 s_waitcnt lgkmcnt(8)
 v_lshlrev_b32 v152, 16, v212
 v_and_b32 v153, 0xffff0000, v212
 v_mfma_f32_16x16x32_bf16 v[44:47], v[80:83], a[164:167], v[44:47]
 ds_read_b64_tr_b16 v[108:109], v198 offset:61440
 ds_read_b64_tr_b16 v[110:111], v198 offset:63488
 v_mfma_f32_16x16x32_bf16 v[44:47], v[84:87], a[172:175], v[44:47]
 buffer_load_dwordx4 v202, s[8:11], s58 offen offset:2048 lds
 v_mfma_f32_16x16x32_bf16 v[44:47], v[88:91], a[180:183], v[44:47]
 s_waitcnt lgkmcnt(8)
 ds_read_b64_tr_b16 v[112:113], v199 offset:49152
 ds_read_b64_tr_b16 v[114:115], v199 offset:51200
 v_mfma_f32_16x16x32_bf16 v[44:47], v[92:95], a[188:191], v[44:47]
 v_lshlrev_b32 v154, 16, v213
 v_and_b32 v155, 0xffff0000, v213
 v_mfma_f32_16x16x32_bf16 v[40:43], v[92:95], a[184:187], v[40:43]
 ds_read_b64_tr_b16 v[116:117], v199 offset:53248
 ds_read_b64_tr_b16 v[118:119], v199 offset:55296
 v_mfma_f32_16x16x32_bf16 v[40:43], v[88:91], a[176:179], v[40:43]
 buffer_load_dwordx4 v203, s[8:11], s58 offen offset:3072 lds
 v_mfma_f32_16x16x32_bf16 v[40:43], v[84:87], a[168:171], v[40:43]
 s_add_u32 s58, s58, 131072
 ds_read_b64_tr_b16 v[120:121], v199 offset:57344
 ds_read_b64_tr_b16 v[122:123], v199 offset:59392
 v_mfma_f32_16x16x32_bf16 v[40:43], v[80:83], a[160:163], v[40:43]
 s_waitcnt lgkmcnt(8)
 v_lshlrev_b32 v156, 16, v214
 v_and_b32 v157, 0xffff0000, v214
 v_mfma_f32_16x16x32_bf16 v[48:51], v[96:99], a[160:163], v[48:51]
 s_waitcnt vmcnt(52)
 s_add_u32 m0, s36, 0
 ds_read_b64_tr_b16 v[124:125], v199 offset:61440
 ds_read_b64_tr_b16 v[126:127], v199 offset:63488
 v_mfma_f32_16x16x32_bf16 v[48:51], v[100:103], a[168:171], v[48:51]
 s_barrier
 buffer_load_dwordx4 v200, s[8:11], s58 offen lds
 v_mfma_f32_16x16x32_bf16 v[48:51], v[104:107], a[176:179], v[48:51]
 s_waitcnt lgkmcnt(8)
 ds_read_b64_tr_b16 v[64:65], v204 offset:0
 ds_read_b64_tr_b16 v[66:67], v204 offset:2048
 v_mfma_f32_16x16x32_bf16 v[48:51], v[108:111], a[184:187], v[48:51]
 v_lshlrev_b32 v158, 16, v215
 v_and_b32 v159, 0xffff0000, v215
 v_mfma_f32_16x16x32_bf16 v[52:55], v[108:111], a[188:191], v[52:55]
 ds_read_b64_tr_b16 v[68:69], v204 offset:4096
 ds_read_b64_tr_b16 v[70:71], v204 offset:6144
 v_mfma_f32_16x16x32_bf16 v[52:55], v[104:107], a[180:183], v[52:55]
 buffer_load_dwordx4 v201, s[8:11], s58 offen offset:1024 lds
 v_mfma_f32_16x16x32_bf16 v[52:55], v[100:103], a[172:175], v[52:55]
 ds_read_b64_tr_b16 v[72:73], v204 offset:8192
 ds_read_b64_tr_b16 v[74:75], v204 offset:10240
 v_mfma_f32_16x16x32_bf16 v[52:55], v[96:99], a[164:167], v[52:55]
 s_waitcnt lgkmcnt(8)
 v_mfma_f32_16x16x32_bf16 v[60:63], v[112:115], a[164:167], v[60:63]
 ds_read_b64_tr_b16 v[76:77], v204 offset:12288
 ds_read_b64_tr_b16 v[78:79], v204 offset:14336
 v_mfma_f32_16x16x32_bf16 v[60:63], v[116:119], a[172:175], v[60:63]
 buffer_load_dwordx4 v202, s[8:11], s58 offen offset:2048 lds
 v_mfma_f32_16x16x32_bf16 v[60:63], v[120:123], a[180:183], v[60:63]
 s_waitcnt lgkmcnt(8)
 ds_read_b64_tr_b16 v[80:81], v205 offset:0
 ds_read_b64_tr_b16 v[82:83], v205 offset:2048
 v_mfma_f32_16x16x32_bf16 v[60:63], v[124:127], a[188:191], v[60:63]
 v_mfma_f32_16x16x32_bf16 v[56:59], v[124:127], a[184:187], v[56:59]
 ds_read_b64_tr_b16 v[84:85], v205 offset:4096
 ds_read_b64_tr_b16 v[86:87], v205 offset:6144
 v_mfma_f32_16x16x32_bf16 v[56:59], v[120:123], a[176:179], v[56:59]
 buffer_load_dwordx4 v203, s[8:11], s58 offen offset:3072 lds
 v_mfma_f32_16x16x32_bf16 v[56:59], v[116:119], a[168:171], v[56:59]
 s_add_u32 s58, s58, 131072
 ds_read_b64_tr_b16 v[88:89], v205 offset:8192
 ds_read_b64_tr_b16 v[90:91], v205 offset:10240
 v_mfma_f32_16x16x32_bf16 v[56:59], v[112:115], a[160:163], v[56:59]
 s_waitcnt lgkmcnt(8)
 v_mfma_f32_16x16x32_bf16 v[32:35], v[64:67], a[192:195], v[32:35]
 s_add_u32 m0, s36, 16384
 ds_read_b64_tr_b16 v[92:93], v205 offset:12288
 ds_read_b64_tr_b16 v[94:95], v205 offset:14336
 v_mfma_f32_16x16x32_bf16 v[32:35], v[68:71], a[200:203], v[32:35]
 buffer_load_dwordx4 v200, s[8:11], s58 offen lds
 v_mfma_f32_16x16x32_bf16 v[32:35], v[72:75], a[208:211], v[32:35]
 s_waitcnt lgkmcnt(8)
 ds_read_b64_tr_b16 v[96:97], v206 offset:0
 ds_read_b64_tr_b16 v[98:99], v206 offset:2048
 v_mfma_f32_16x16x32_bf16 v[32:35], v[76:79], a[216:219], v[32:35]
 s_waitcnt vmcnt(29)
 v_mfma_f32_16x16x32_bf16 v[36:39], v[76:79], a[220:223], v[36:39]
 ds_read_b64_tr_b16 v[100:101], v206 offset:4096
 ds_read_b64_tr_b16 v[102:103], v206 offset:6144
 v_mfma_f32_16x16x32_bf16 v[36:39], v[72:75], a[212:215], v[36:39]
 buffer_load_dwordx4 v201, s[8:11], s58 offen offset:1024 lds
 v_mfma_f32_16x16x32_bf16 v[36:39], v[68:71], a[204:207], v[36:39]
 ds_read_b64_tr_b16 v[104:105], v206 offset:8192
 ds_read_b64_tr_b16 v[106:107], v206 offset:10240
 v_mfma_f32_16x16x32_bf16 v[36:39], v[64:67], a[196:199], v[36:39]
 s_waitcnt lgkmcnt(8)
 v_mfma_f32_16x16x32_bf16 v[44:47], v[80:83], a[196:199], v[44:47]
 ds_read_b64_tr_b16 v[108:109], v206 offset:12288
 ds_read_b64_tr_b16 v[110:111], v206 offset:14336
 v_mfma_f32_16x16x32_bf16 v[44:47], v[84:87], a[204:207], v[44:47]
 buffer_load_dwordx4 v202, s[8:11], s58 offen offset:2048 lds
 v_mfma_f32_16x16x32_bf16 v[44:47], v[88:91], a[212:215], v[44:47]
 s_waitcnt lgkmcnt(8)
 ds_read_b64_tr_b16 v[112:113], v207 offset:0
 ds_read_b64_tr_b16 v[114:115], v207 offset:2048
 v_mfma_f32_16x16x32_bf16 v[44:47], v[92:95], a[220:223], v[44:47]
 v_mfma_f32_16x16x32_bf16 v[40:43], v[92:95], a[216:219], v[40:43]
 ds_read_b64_tr_b16 v[116:117], v207 offset:4096
 ds_read_b64_tr_b16 v[118:119], v207 offset:6144
 v_mfma_f32_16x16x32_bf16 v[40:43], v[88:91], a[208:211], v[40:43]
 buffer_load_dwordx4 v203, s[8:11], s58 offen offset:3072 lds
 v_mfma_f32_16x16x32_bf16 v[40:43], v[84:87], a[200:203], v[40:43]
 s_add_u32 s58, s58, 131072
 ds_read_b64_tr_b16 v[120:121], v207 offset:8192
 ds_read_b64_tr_b16 v[122:123], v207 offset:10240
 v_mfma_f32_16x16x32_bf16 v[40:43], v[80:83], a[192:195], v[40:43]
 s_waitcnt lgkmcnt(8)
 v_mfma_f32_16x16x32_bf16 v[48:51], v[96:99], a[192:195], v[48:51]
 s_waitcnt vmcnt(28)
 s_add_u32 m0, s36, 32768
 ds_read_b64_tr_b16 v[124:125], v207 offset:12288
 ds_read_b64_tr_b16 v[126:127], v207 offset:14336
 v_mfma_f32_16x16x32_bf16 v[48:51], v[100:103], a[200:203], v[48:51]
 s_barrier
 buffer_load_dwordx4 v200, s[8:11], s58 offen lds
 v_mfma_f32_16x16x32_bf16 v[48:51], v[104:107], a[208:211], v[48:51]
 s_waitcnt lgkmcnt(8)
 ds_read_b64_tr_b16 v[64:65], v204 offset:16384
 ds_read_b64_tr_b16 v[66:67], v204 offset:18432
 v_mfma_f32_16x16x32_bf16 v[48:51], v[108:111], a[216:219], v[48:51]
 v_mfma_f32_16x16x32_bf16 v[52:55], v[108:111], a[220:223], v[52:55]
 ds_read_b64_tr_b16 v[68:69], v204 offset:20480
 ds_read_b64_tr_b16 v[70:71], v204 offset:22528
 v_mfma_f32_16x16x32_bf16 v[52:55], v[104:107], a[212:215], v[52:55]
 buffer_load_dwordx4 v201, s[8:11], s58 offen offset:1024 lds
 v_mfma_f32_16x16x32_bf16 v[52:55], v[100:103], a[204:207], v[52:55]
 ds_read_b64_tr_b16 v[72:73], v204 offset:24576
 ds_read_b64_tr_b16 v[74:75], v204 offset:26624
 v_mfma_f32_16x16x32_bf16 v[52:55], v[96:99], a[196:199], v[52:55]
 s_waitcnt lgkmcnt(8)
 v_mfma_f32_16x16x32_bf16 v[60:63], v[112:115], a[196:199], v[60:63]
 ds_read_b64_tr_b16 v[76:77], v204 offset:28672
 ds_read_b64_tr_b16 v[78:79], v204 offset:30720
 v_mfma_f32_16x16x32_bf16 v[60:63], v[116:119], a[204:207], v[60:63]
 buffer_load_dwordx4 v202, s[8:11], s58 offen offset:2048 lds
 v_mfma_f32_16x16x32_bf16 v[60:63], v[120:123], a[212:215], v[60:63]
 s_waitcnt lgkmcnt(8)
 ds_read_b64_tr_b16 v[80:81], v205 offset:16384
 ds_read_b64_tr_b16 v[82:83], v205 offset:18432
 v_mfma_f32_16x16x32_bf16 v[60:63], v[124:127], a[220:223], v[60:63]
 v_mfma_f32_16x16x32_bf16 v[56:59], v[124:127], a[216:219], v[56:59]
 ds_read_b64_tr_b16 v[84:85], v205 offset:20480
 ds_read_b64_tr_b16 v[86:87], v205 offset:22528
 v_mfma_f32_16x16x32_bf16 v[56:59], v[120:123], a[208:211], v[56:59]
 buffer_load_dwordx4 v203, s[8:11], s58 offen offset:3072 lds
 v_mfma_f32_16x16x32_bf16 v[56:59], v[116:119], a[200:203], v[56:59]
 s_add_u32 s58, s58, 131072
 ds_read_b64_tr_b16 v[88:89], v205 offset:24576
 ds_read_b64_tr_b16 v[90:91], v205 offset:26624
 v_mfma_f32_16x16x32_bf16 v[56:59], v[112:115], a[192:195], v[56:59]
 s_waitcnt lgkmcnt(8)
 v_mfma_f32_16x16x32_bf16 v[32:35], v[64:67], a[224:227], v[32:35]
 s_add_u32 m0, s36, 49152
 ds_read_b64_tr_b16 v[92:93], v205 offset:28672
 ds_read_b64_tr_b16 v[94:95], v205 offset:30720
 v_mfma_f32_16x16x32_bf16 v[32:35], v[68:71], a[232:235], v[32:35]
 buffer_load_dwordx4 v200, s[8:11], s58 offen lds
 v_mfma_f32_16x16x32_bf16 v[32:35], v[72:75], a[240:243], v[32:35]
 s_waitcnt lgkmcnt(8)
 ds_read_b64_tr_b16 v[96:97], v206 offset:16384
 ds_read_b64_tr_b16 v[98:99], v206 offset:18432
 v_mfma_f32_16x16x32_bf16 v[32:35], v[76:79], a[248:251], v[32:35]
 s_waitcnt vmcnt(29)
 v_mfma_f32_16x16x32_bf16 v[36:39], v[76:79], a[252:255], v[36:39]
 ds_read_b64_tr_b16 v[100:101], v206 offset:20480
 ds_read_b64_tr_b16 v[102:103], v206 offset:22528
 v_mfma_f32_16x16x32_bf16 v[36:39], v[72:75], a[244:247], v[36:39]
 buffer_load_dwordx4 v201, s[8:11], s58 offen offset:1024 lds
 v_mfma_f32_16x16x32_bf16 v[36:39], v[68:71], a[236:239], v[36:39]
 ds_read_b64_tr_b16 v[104:105], v206 offset:24576
 ds_read_b64_tr_b16 v[106:107], v206 offset:26624
 v_mfma_f32_16x16x32_bf16 v[36:39], v[64:67], a[228:231], v[36:39]
 s_waitcnt lgkmcnt(8)
 v_mfma_f32_16x16x32_bf16 v[40:43], v[80:83], a[224:227], v[40:43]
 ds_read_b64_tr_b16 v[108:109], v206 offset:28672
 ds_read_b64_tr_b16 v[110:111], v206 offset:30720
 v_mfma_f32_16x16x32_bf16 v[40:43], v[84:87], a[232:235], v[40:43]
 buffer_load_dwordx4 v202, s[8:11], s58 offen offset:2048 lds
 v_mfma_f32_16x16x32_bf16 v[40:43], v[88:91], a[240:243], v[40:43]
 s_waitcnt lgkmcnt(8)
 ds_read_b64_tr_b16 v[112:113], v207 offset:16384
 ds_read_b64_tr_b16 v[114:115], v207 offset:18432
 v_mfma_f32_16x16x32_bf16 v[40:43], v[92:95], a[248:251], v[40:43]
 v_mfma_f32_16x16x32_bf16 v[44:47], v[92:95], a[252:255], v[44:47]
 ds_read_b64_tr_b16 v[116:117], v207 offset:20480
 ds_read_b64_tr_b16 v[118:119], v207 offset:22528
 v_mfma_f32_16x16x32_bf16 v[44:47], v[88:91], a[244:247], v[44:47]
 buffer_load_dwordx4 v203, s[8:11], s58 offen offset:3072 lds
 v_mfma_f32_16x16x32_bf16 v[44:47], v[84:87], a[236:239], v[44:47]
 s_add_u32 s58, s58, 131072
 ds_read_b64_tr_b16 v[120:121], v207 offset:24576
 ds_read_b64_tr_b16 v[122:123], v207 offset:26624
 v_mfma_f32_16x16x32_bf16 v[44:47], v[80:83], a[228:231], v[44:47]
 s_waitcnt lgkmcnt(8)
 v_cvt_pk_bf16_f32 v32, v32, v33
 v_cvt_pk_bf16_f32 v33, v34, v35
 v_mfma_f32_16x16x32_bf16 v[48:51], v[96:99], a[224:227], v[48:51]
 s_waitcnt vmcnt(24)
 ds_read_b64_tr_b16 v[124:125], v207 offset:28672
 ds_read_b64_tr_b16 v[126:127], v207 offset:30720
 v_mfma_f32_16x16x32_bf16 v[48:51], v[100:103], a[232:235], v[48:51]
 s_barrier
 v_mfma_f32_16x16x32_bf16 v[48:51], v[104:107], a[240:243], v[48:51]
 s_waitcnt lgkmcnt(8)
 ds_read_b64_tr_b16 v[64:65], v206 offset:32768
 ds_read_b64_tr_b16 v[66:67], v206 offset:34816
 v_mfma_f32_16x16x32_bf16 v[48:51], v[108:111], a[248:251], v[48:51]
 v_cvt_pk_bf16_f32 v34, v40, v41
 v_cvt_pk_bf16_f32 v35, v42, v43
 v_cvt_pk_bf16_f32 v36, v36, v37
 v_cvt_pk_bf16_f32 v37, v38, v39
 v_mfma_f32_16x16x32_bf16 v[52:55], v[108:111], a[252:255], v[52:55]
 ds_read_b64_tr_b16 v[68:69], v206 offset:36864
 ds_read_b64_tr_b16 v[70:71], v206 offset:38912
 v_mfma_f32_16x16x32_bf16 v[52:55], v[104:107], a[244:247], v[52:55]
 buffer_store_dwordx4 v[32:35], v255, s[4:7], s50 offen sc1
 v_mfma_f32_16x16x32_bf16 v[52:55], v[100:103], a[236:239], v[52:55]
 ds_read_b64_tr_b16 v[72:73], v206 offset:40960
 ds_read_b64_tr_b16 v[74:75], v206 offset:43008
 v_mfma_f32_16x16x32_bf16 v[52:55], v[96:99], a[228:231], v[52:55]
 s_waitcnt lgkmcnt(8)
 v_cvt_pk_bf16_f32 v38, v44, v45
 v_cvt_pk_bf16_f32 v39, v46, v47
 v_mfma_f32_16x16x32_bf16 v[56:59], v[112:115], a[224:227], v[56:59]
 ds_read_b64_tr_b16 v[76:77], v206 offset:45056
 ds_read_b64_tr_b16 v[78:79], v206 offset:47104
 v_mfma_f32_16x16x32_bf16 v[56:59], v[116:119], a[232:235], v[56:59]
 buffer_store_dwordx4 v[36:39], v255, s[4:7], s50 offen offset:1024 sc1
 v_mfma_f32_16x16x32_bf16 v[56:59], v[120:123], a[240:243], v[56:59]
 s_waitcnt lgkmcnt(8)
 ds_read_b64_tr_b16 v[80:81], v207 offset:32768
 ds_read_b64_tr_b16 v[82:83], v207 offset:34816
 v_mfma_f32_16x16x32_bf16 v[56:59], v[124:127], a[248:251], v[56:59]
 v_mfma_f32_16x16x32_bf16 v[60:63], v[124:127], a[252:255], v[60:63]
 ds_read_b64_tr_b16 v[84:85], v207 offset:36864
 ds_read_b64_tr_b16 v[86:87], v207 offset:38912
 v_mfma_f32_16x16x32_bf16 v[60:63], v[120:123], a[244:247], v[60:63]
 v_mfma_f32_16x16x32_bf16 v[60:63], v[116:119], a[236:239], v[60:63]
 ds_read_b64_tr_b16 v[88:89], v207 offset:40960
 ds_read_b64_tr_b16 v[90:91], v207 offset:43008
 v_mfma_f32_16x16x32_bf16 v[60:63], v[112:115], a[228:231], v[60:63]
 s_waitcnt lgkmcnt(8)
 v_cvt_pk_bf16_f32 v48, v48, v49
 v_cvt_pk_bf16_f32 v49, v50, v51
 v_mfma_f32_16x16x32_bf16 v[16:19], v[64:67], a[0:3], 0
 ds_read_b64_tr_b16 v[92:93], v207 offset:45056
 ds_read_b64_tr_b16 v[94:95], v207 offset:47104
 v_mfma_f32_16x16x32_bf16 v[16:19], v[68:71], a[8:11], v[16:19]
 v_mfma_f32_16x16x32_bf16 v[16:19], v[72:75], a[16:19], v[16:19]
 s_waitcnt lgkmcnt(8)
 ds_read_b64_tr_b16 v[96:97], v206 offset:49152
 ds_read_b64_tr_b16 v[98:99], v206 offset:51200
 v_mfma_f32_16x16x32_bf16 v[16:19], v[76:79], a[24:27], v[16:19]
 v_cvt_pk_bf16_f32 v50, v56, v57
 v_cvt_pk_bf16_f32 v51, v58, v59
 v_cvt_pk_bf16_f32 v52, v52, v53
 v_cvt_pk_bf16_f32 v53, v54, v55
 v_mfma_f32_16x16x32_bf16 v[20:23], v[76:79], a[28:31], 0
 ds_read_b64_tr_b16 v[100:101], v206 offset:53248
 ds_read_b64_tr_b16 v[102:103], v206 offset:55296
 v_mfma_f32_16x16x32_bf16 v[20:23], v[72:75], a[20:23], v[20:23]
 buffer_store_dwordx4 v[48:51], v255, s[4:7], s51 offen sc1
 v_mfma_f32_16x16x32_bf16 v[20:23], v[68:71], a[12:15], v[20:23]
 ds_read_b64_tr_b16 v[104:105], v206 offset:57344
 ds_read_b64_tr_b16 v[106:107], v206 offset:59392
 v_mfma_f32_16x16x32_bf16 v[20:23], v[64:67], a[4:7], v[20:23]
 s_waitcnt lgkmcnt(8)
 v_cvt_pk_bf16_f32 v54, v60, v61
 v_cvt_pk_bf16_f32 v55, v62, v63
 v_mfma_f32_16x16x32_bf16 v[28:31], v[80:83], a[4:7], 0
 ds_read_b64_tr_b16 v[108:109], v206 offset:61440
 ds_read_b64_tr_b16 v[110:111], v206 offset:63488
 v_mfma_f32_16x16x32_bf16 v[28:31], v[84:87], a[12:15], v[28:31]
 buffer_store_dwordx4 v[52:55], v255, s[4:7], s51 offen offset:1024 sc1
 v_mfma_f32_16x16x32_bf16 v[28:31], v[88:91], a[20:23], v[28:31]
 s_waitcnt lgkmcnt(8)
 ds_read_b64_tr_b16 v[112:113], v207 offset:49152
 ds_read_b64_tr_b16 v[114:115], v207 offset:51200
 v_mfma_f32_16x16x32_bf16 v[28:31], v[92:95], a[28:31], v[28:31]
 v_mfma_f32_16x16x32_bf16 v[24:27], v[92:95], a[24:27], 0
 ds_read_b64_tr_b16 v[116:117], v207 offset:53248
 ds_read_b64_tr_b16 v[118:119], v207 offset:55296
 v_mfma_f32_16x16x32_bf16 v[24:27], v[88:91], a[16:19], v[24:27]
 v_mfma_f32_16x16x32_bf16 v[24:27], v[84:87], a[8:11], v[24:27]
 ds_read_b64_tr_b16 v[120:121], v207 offset:57344
 ds_read_b64_tr_b16 v[122:123], v207 offset:59392
 v_mfma_f32_16x16x32_bf16 v[24:27], v[80:83], a[0:3], v[24:27]
 s_waitcnt lgkmcnt(8)
 v_mfma_f32_16x16x32_bf16 v[16:19], v[96:99], a[32:35], v[16:19]
 s_waitcnt vmcnt(20)
 ds_read_b64_tr_b16 v[124:125], v207 offset:61440
 ds_read_b64_tr_b16 v[126:127], v207 offset:63488
 v_mfma_f32_16x16x32_bf16 v[16:19], v[100:103], a[40:43], v[16:19]
 s_barrier
 v_mfma_f32_16x16x32_bf16 v[16:19], v[104:107], a[48:51], v[16:19]
 s_waitcnt lgkmcnt(8)
 ds_read_b64_tr_b16 v[64:65], v194 offset:0
 ds_read_b64_tr_b16 v[66:67], v194 offset:2048
 v_mfma_f32_16x16x32_bf16 v[16:19], v[108:111], a[56:59], v[16:19]
 v_mfma_f32_16x16x32_bf16 v[20:23], v[108:111], a[60:63], v[20:23]
 ds_read_b64_tr_b16 v[68:69], v194 offset:4096
 ds_read_b64_tr_b16 v[70:71], v194 offset:6144
 v_mfma_f32_16x16x32_bf16 v[20:23], v[104:107], a[52:55], v[20:23]
 v_mfma_f32_16x16x32_bf16 v[20:23], v[100:103], a[44:47], v[20:23]
 ds_read_b64_tr_b16 v[72:73], v194 offset:8192
 ds_read_b64_tr_b16 v[74:75], v194 offset:10240
 v_mfma_f32_16x16x32_bf16 v[20:23], v[96:99], a[36:39], v[20:23]
 s_waitcnt lgkmcnt(8)
 v_mfma_f32_16x16x32_bf16 v[28:31], v[112:115], a[36:39], v[28:31]
 ds_read_b64_tr_b16 v[76:77], v194 offset:12288
 ds_read_b64_tr_b16 v[78:79], v194 offset:14336
 v_mfma_f32_16x16x32_bf16 v[28:31], v[116:119], a[44:47], v[28:31]
 v_mfma_f32_16x16x32_bf16 v[28:31], v[120:123], a[52:55], v[28:31]
 s_waitcnt lgkmcnt(8)
 ds_read_b64_tr_b16 v[80:81], v195 offset:0
 ds_read_b64_tr_b16 v[82:83], v195 offset:2048
 v_mfma_f32_16x16x32_bf16 v[28:31], v[124:127], a[60:63], v[28:31]
 v_mfma_f32_16x16x32_bf16 v[24:27], v[124:127], a[56:59], v[24:27]
 ds_read_b64_tr_b16 v[84:85], v195 offset:4096
 ds_read_b64_tr_b16 v[86:87], v195 offset:6144
 v_mfma_f32_16x16x32_bf16 v[24:27], v[120:123], a[48:51], v[24:27]
 v_mfma_f32_16x16x32_bf16 v[24:27], v[116:119], a[40:43], v[24:27]
 ds_read_b64_tr_b16 v[88:89], v195 offset:8192
 ds_read_b64_tr_b16 v[90:91], v195 offset:10240
 v_mfma_f32_16x16x32_bf16 v[24:27], v[112:115], a[32:35], v[24:27]
 s_waitcnt lgkmcnt(8)
 v_mfma_f32_16x16x32_bf16 v[16:19], v[64:67], a[64:67], v[16:19]
 ds_read_b64_tr_b16 v[92:93], v195 offset:12288
 ds_read_b64_tr_b16 v[94:95], v195 offset:14336
 v_mfma_f32_16x16x32_bf16 v[16:19], v[68:71], a[72:75], v[16:19]
 v_mfma_f32_16x16x32_bf16 v[16:19], v[72:75], a[80:83], v[16:19]
 s_waitcnt lgkmcnt(8)
 ds_read_b64_tr_b16 v[96:97], v194 offset:16384
 ds_read_b64_tr_b16 v[98:99], v194 offset:18432
 v_mfma_f32_16x16x32_bf16 v[16:19], v[76:79], a[88:91], v[16:19]
 v_mfma_f32_16x16x32_bf16 v[20:23], v[76:79], a[92:95], v[20:23]
 ds_read_b64_tr_b16 v[100:101], v194 offset:20480
 ds_read_b64_tr_b16 v[102:103], v194 offset:22528
 v_mfma_f32_16x16x32_bf16 v[20:23], v[72:75], a[84:87], v[20:23]
 v_mfma_f32_16x16x32_bf16 v[20:23], v[68:71], a[76:79], v[20:23]
 ds_read_b64_tr_b16 v[104:105], v194 offset:24576
 ds_read_b64_tr_b16 v[106:107], v194 offset:26624
 v_mfma_f32_16x16x32_bf16 v[20:23], v[64:67], a[68:71], v[20:23]
 s_waitcnt lgkmcnt(8)
 v_mfma_f32_16x16x32_bf16 v[28:31], v[80:83], a[68:71], v[28:31]
 ds_read_b64_tr_b16 v[108:109], v194 offset:28672
 ds_read_b64_tr_b16 v[110:111], v194 offset:30720
 v_mfma_f32_16x16x32_bf16 v[28:31], v[84:87], a[76:79], v[28:31]
 v_mfma_f32_16x16x32_bf16 v[28:31], v[88:91], a[84:87], v[28:31]
 s_waitcnt lgkmcnt(8)
 ds_read_b64_tr_b16 v[112:113], v195 offset:16384
 ds_read_b64_tr_b16 v[114:115], v195 offset:18432
 v_mfma_f32_16x16x32_bf16 v[28:31], v[92:95], a[92:95], v[28:31]
 v_mfma_f32_16x16x32_bf16 v[24:27], v[92:95], a[88:91], v[24:27]
 s_add_u32 s51, s48, 4096
 ds_read_b64_tr_b16 v[116:117], v195 offset:20480
 ds_read_b64_tr_b16 v[118:119], v195 offset:22528
 v_mfma_f32_16x16x32_bf16 v[24:27], v[88:91], a[80:83], v[24:27]
 v_mfma_f32_16x16x32_bf16 v[24:27], v[84:87], a[72:75], v[24:27]
 ds_read_b64_tr_b16 v[120:121], v195 offset:24576
 ds_read_b64_tr_b16 v[122:123], v195 offset:26624
 v_mfma_f32_16x16x32_bf16 v[24:27], v[80:83], a[64:67], v[24:27]
 s_waitcnt lgkmcnt(8)
 v_mfma_f32_16x16x32_bf16 v[16:19], v[96:99], a[96:99], v[16:19]
 s_waitcnt vmcnt(12)
 ds_read_b64_tr_b16 v[124:125], v195 offset:28672
 ds_read_b64_tr_b16 v[126:127], v195 offset:30720
 v_mfma_f32_16x16x32_bf16 v[16:19], v[100:103], a[104:107], v[16:19]
 s_barrier
 v_mfma_f32_16x16x32_bf16 v[16:19], v[104:107], a[112:115], v[16:19]
 s_waitcnt lgkmcnt(8)
 ds_read_b64_tr_b16 v[64:65], v198 offset:0
 ds_read_b64_tr_b16 v[66:67], v198 offset:2048
 v_mfma_f32_16x16x32_bf16 v[16:19], v[108:111], a[120:123], v[16:19]
 v_mfma_f32_16x16x32_bf16 v[20:23], v[108:111], a[124:127], v[20:23]
 ds_read_b64_tr_b16 v[68:69], v198 offset:4096
 ds_read_b64_tr_b16 v[70:71], v198 offset:6144
 v_mfma_f32_16x16x32_bf16 v[20:23], v[104:107], a[116:119], v[20:23]
 buffer_load_dword v232, v131, s[4:7], 0 offen sc1
 v_mfma_f32_16x16x32_bf16 v[20:23], v[100:103], a[108:111], v[20:23]
 ds_read_b64_tr_b16 v[72:73], v198 offset:8192
 ds_read_b64_tr_b16 v[74:75], v198 offset:10240
 v_mfma_f32_16x16x32_bf16 v[20:23], v[96:99], a[100:103], v[20:23]
 s_waitcnt lgkmcnt(8)
 v_mfma_f32_16x16x32_bf16 v[28:31], v[112:115], a[100:103], v[28:31]
 ds_read_b64_tr_b16 v[76:77], v198 offset:12288
 ds_read_b64_tr_b16 v[78:79], v198 offset:14336
 v_mfma_f32_16x16x32_bf16 v[28:31], v[116:119], a[108:111], v[28:31]
 v_mfma_f32_16x16x32_bf16 v[28:31], v[120:123], a[116:119], v[28:31]
 s_waitcnt lgkmcnt(8)
 ds_read_b64_tr_b16 v[80:81], v199 offset:0
 ds_read_b64_tr_b16 v[82:83], v199 offset:2048
 v_mfma_f32_16x16x32_bf16 v[28:31], v[124:127], a[124:127], v[28:31]
 v_mfma_f32_16x16x32_bf16 v[24:27], v[124:127], a[120:123], v[24:27]
 ds_read_b64_tr_b16 v[84:85], v199 offset:4096
 ds_read_b64_tr_b16 v[86:87], v199 offset:6144
 v_mfma_f32_16x16x32_bf16 v[24:27], v[120:123], a[112:115], v[24:27]
 v_mfma_f32_16x16x32_bf16 v[24:27], v[116:119], a[104:107], v[24:27]
 ds_read_b64_tr_b16 v[88:89], v199 offset:8192
 ds_read_b64_tr_b16 v[90:91], v199 offset:10240
 v_mfma_f32_16x16x32_bf16 v[24:27], v[112:115], a[96:99], v[24:27]
 s_waitcnt lgkmcnt(8)
 v_mfma_f32_16x16x32_bf16 v[16:19], v[64:67], a[128:131], v[16:19]
 ds_read_b64_tr_b16 v[92:93], v199 offset:12288
 ds_read_b64_tr_b16 v[94:95], v199 offset:14336
 v_mfma_f32_16x16x32_bf16 v[16:19], v[68:71], a[136:139], v[16:19]
 v_mfma_f32_16x16x32_bf16 v[16:19], v[72:75], a[144:147], v[16:19]
 s_waitcnt lgkmcnt(8)
 ds_read_b64_tr_b16 v[96:97], v198 offset:16384
 ds_read_b64_tr_b16 v[98:99], v198 offset:18432
 v_mfma_f32_16x16x32_bf16 v[16:19], v[76:79], a[152:155], v[16:19]
 v_mfma_f32_16x16x32_bf16 v[20:23], v[76:79], a[156:159], v[20:23]
 ds_read_b64_tr_b16 v[100:101], v198 offset:20480
 ds_read_b64_tr_b16 v[102:103], v198 offset:22528
 v_mfma_f32_16x16x32_bf16 v[20:23], v[72:75], a[148:151], v[20:23]
 v_mfma_f32_16x16x32_bf16 v[20:23], v[68:71], a[140:143], v[20:23]
 ds_read_b64_tr_b16 v[104:105], v198 offset:24576
 ds_read_b64_tr_b16 v[106:107], v198 offset:26624
 v_mfma_f32_16x16x32_bf16 v[20:23], v[64:67], a[132:135], v[20:23]
 s_waitcnt lgkmcnt(8)
 v_mfma_f32_16x16x32_bf16 v[28:31], v[80:83], a[132:135], v[28:31]
 ds_read_b64_tr_b16 v[108:109], v198 offset:28672
 ds_read_b64_tr_b16 v[110:111], v198 offset:30720
 v_mfma_f32_16x16x32_bf16 v[28:31], v[84:87], a[140:143], v[28:31]
 v_mfma_f32_16x16x32_bf16 v[28:31], v[88:91], a[148:151], v[28:31]
 s_waitcnt lgkmcnt(8)
 ds_read_b64_tr_b16 v[112:113], v199 offset:16384
 ds_read_b64_tr_b16 v[114:115], v199 offset:18432
 v_mfma_f32_16x16x32_bf16 v[28:31], v[92:95], a[156:159], v[28:31]
 v_mfma_f32_16x16x32_bf16 v[24:27], v[92:95], a[152:155], v[24:27]
 ds_read_b64_tr_b16 v[116:117], v199 offset:20480
 ds_read_b64_tr_b16 v[118:119], v199 offset:22528
 v_mfma_f32_16x16x32_bf16 v[24:27], v[88:91], a[144:147], v[24:27]
 v_mfma_f32_16x16x32_bf16 v[24:27], v[84:87], a[136:139], v[24:27]
 ds_read_b64_tr_b16 v[120:121], v199 offset:24576
 ds_read_b64_tr_b16 v[122:123], v199 offset:26624
 v_mfma_f32_16x16x32_bf16 v[24:27], v[80:83], a[128:131], v[24:27]
 s_waitcnt lgkmcnt(8)
 v_mfma_f32_16x16x32_bf16 v[16:19], v[96:99], a[160:163], v[16:19]
 s_waitcnt vmcnt(1)
 ds_read_b64_tr_b16 v[124:125], v199 offset:28672
 ds_read_b64_tr_b16 v[126:127], v199 offset:30720
 v_mfma_f32_16x16x32_bf16 v[16:19], v[100:103], a[168:171], v[16:19]
 s_barrier
 buffer_store_dword v253, v254, s[4:7], s54 offen sc1
 v_mfma_f32_16x16x32_bf16 v[16:19], v[104:107], a[176:179], v[16:19]
 s_waitcnt lgkmcnt(8)
 ds_read_b64_tr_b16 v[64:65], v198 offset:32768
 ds_read_b64_tr_b16 v[66:67], v198 offset:34816
 v_mfma_f32_16x16x32_bf16 v[16:19], v[108:111], a[184:187], v[16:19]
 v_mfma_f32_16x16x32_bf16 v[20:23], v[108:111], a[188:191], v[20:23]
 s_add_u32 m0, s37, 0
 ds_read_b64_tr_b16 v[68:69], v198 offset:36864
 ds_read_b64_tr_b16 v[70:71], v198 offset:38912
 v_mfma_f32_16x16x32_bf16 v[20:23], v[104:107], a[180:183], v[20:23]
 buffer_load_dwordx4 v216, s[12:15], s39 offen lds
 v_mfma_f32_16x16x32_bf16 v[20:23], v[100:103], a[172:175], v[20:23]
 ds_read_b64_tr_b16 v[72:73], v198 offset:40960
 ds_read_b64_tr_b16 v[74:75], v198 offset:43008
 v_mfma_f32_16x16x32_bf16 v[20:23], v[96:99], a[164:167], v[20:23]
 s_waitcnt lgkmcnt(8)
 v_mfma_f32_16x16x32_bf16 v[28:31], v[112:115], a[164:167], v[28:31]
 ds_read_b64_tr_b16 v[76:77], v198 offset:45056
 ds_read_b64_tr_b16 v[78:79], v198 offset:47104
 v_mfma_f32_16x16x32_bf16 v[28:31], v[116:119], a[172:175], v[28:31]
 buffer_load_dwordx4 v217, s[12:15], s39 offen offset:1024 lds
 v_mfma_f32_16x16x32_bf16 v[28:31], v[120:123], a[180:183], v[28:31]
 s_waitcnt lgkmcnt(8)
 ds_read_b64_tr_b16 v[80:81], v199 offset:32768
 ds_read_b64_tr_b16 v[82:83], v199 offset:34816
 v_mfma_f32_16x16x32_bf16 v[28:31], v[124:127], a[188:191], v[28:31]
 v_mfma_f32_16x16x32_bf16 v[24:27], v[124:127], a[184:187], v[24:27]
 ds_read_b64_tr_b16 v[84:85], v199 offset:36864
 ds_read_b64_tr_b16 v[86:87], v199 offset:38912
 v_mfma_f32_16x16x32_bf16 v[24:27], v[120:123], a[176:179], v[24:27]
 buffer_load_dwordx4 v218, s[12:15], s39 offen offset:2048 lds
 v_mfma_f32_16x16x32_bf16 v[24:27], v[116:119], a[168:171], v[24:27]
Lw2_2:
 s_cbranch_execz Lw2_6
 ds_read_b64_tr_b16 v[88:89], v199 offset:40960
 ds_read_b64_tr_b16 v[90:91], v199 offset:43008
 v_mfma_f32_16x16x32_bf16 v[24:27], v[112:115], a[160:163], v[24:27]
 s_waitcnt lgkmcnt(8)
 v_mfma_f32_16x16x32_bf16 v[16:19], v[64:67], a[192:195], v[16:19]
 ds_read_b64_tr_b16 v[92:93], v199 offset:45056
 ds_read_b64_tr_b16 v[94:95], v199 offset:47104
 v_mfma_f32_16x16x32_bf16 v[16:19], v[68:71], a[200:203], v[16:19]
 buffer_load_dwordx4 v219, s[12:15], s39 offen offset:3072 lds
 v_mfma_f32_16x16x32_bf16 v[16:19], v[72:75], a[208:211], v[16:19]
 s_waitcnt lgkmcnt(8)
 s_add_u32 s39, s39, 458752
 ds_read_b64_tr_b16 v[96:97], v198 offset:49152
 ds_read_b64_tr_b16 v[98:99], v198 offset:51200
 v_mfma_f32_16x16x32_bf16 v[16:19], v[76:79], a[216:219], v[16:19]
 v_mfma_f32_16x16x32_bf16 v[20:23], v[76:79], a[220:223], v[20:23]
 ds_read_b64_tr_b16 v[100:101], v198 offset:53248
 ds_read_b64_tr_b16 v[102:103], v198 offset:55296
 v_mfma_f32_16x16x32_bf16 v[20:23], v[72:75], a[212:215], v[20:23]
 v_mfma_f32_16x16x32_bf16 v[20:23], v[68:71], a[204:207], v[20:23]
 ds_read_b64_tr_b16 v[104:105], v198 offset:57344
 ds_read_b64_tr_b16 v[106:107], v198 offset:59392
 v_mfma_f32_16x16x32_bf16 v[20:23], v[64:67], a[196:199], v[20:23]
 s_waitcnt lgkmcnt(8)
 v_mfma_f32_16x16x32_bf16 v[28:31], v[80:83], a[196:199], v[28:31]
 s_add_u32 m0, s37, 16384
 ds_read_b64_tr_b16 v[108:109], v198 offset:61440
 ds_read_b64_tr_b16 v[110:111], v198 offset:63488
 v_mfma_f32_16x16x32_bf16 v[28:31], v[84:87], a[204:207], v[28:31]
 buffer_load_dwordx4 v216, s[12:15], s39 offen lds
 v_mfma_f32_16x16x32_bf16 v[28:31], v[88:91], a[212:215], v[28:31]
 s_waitcnt lgkmcnt(8)
 ds_read_b64_tr_b16 v[112:113], v199 offset:49152
 ds_read_b64_tr_b16 v[114:115], v199 offset:51200
 v_mfma_f32_16x16x32_bf16 v[28:31], v[92:95], a[220:223], v[28:31]
 v_mfma_f32_16x16x32_bf16 v[24:27], v[92:95], a[216:219], v[24:27]
 ds_read_b64_tr_b16 v[116:117], v199 offset:53248
 ds_read_b64_tr_b16 v[118:119], v199 offset:55296
 v_mfma_f32_16x16x32_bf16 v[24:27], v[88:91], a[208:211], v[24:27]
 buffer_load_dwordx4 v217, s[12:15], s39 offen offset:1024 lds
 v_mfma_f32_16x16x32_bf16 v[24:27], v[84:87], a[200:203], v[24:27]
 ds_read_b64_tr_b16 v[120:121], v199 offset:57344
 ds_read_b64_tr_b16 v[122:123], v199 offset:59392
 v_mfma_f32_16x16x32_bf16 v[24:27], v[80:83], a[192:195], v[24:27]
 s_waitcnt lgkmcnt(8)
 v_mfma_f32_16x16x32_bf16 v[16:19], v[96:99], a[224:227], v[16:19]
 s_waitcnt vmcnt(7)
 ds_read_b64_tr_b16 v[124:125], v199 offset:61440
 ds_read_b64_tr_b16 v[126:127], v199 offset:63488
 v_mfma_f32_16x16x32_bf16 v[16:19], v[100:103], a[232:235], v[16:19]
 s_barrier
 buffer_load_dwordx4 v218, s[12:15], s39 offen offset:2048 lds
 v_cmp_gt_u32 vcc, 1, v232
 s_nop 1
 s_cbranch_vccnz Lspin14
Lback15:
 v_mfma_f32_16x16x32_bf16 v[16:19], v[104:107], a[240:243], v[16:19]
 s_waitcnt lgkmcnt(8)
 ds_read_b64_tr_b16 v[64:65], v204 offset:32768
 ds_read_b64_tr_b16 v[66:67], v204 offset:34816
 v_mfma_f32_16x16x32_bf16 v[16:19], v[108:111], a[248:251], v[16:19]
 v_mfma_f32_16x16x32_bf16 v[20:23], v[108:111], a[252:255], v[20:23]
 ds_read_b64_tr_b16 v[68:69], v204 offset:36864
 ds_read_b64_tr_b16 v[70:71], v204 offset:38912
 v_mfma_f32_16x16x32_bf16 v[20:23], v[104:107], a[244:247], v[20:23]
 buffer_load_dwordx4 v219, s[12:15], s39 offen offset:3072 lds
 v_mfma_f32_16x16x32_bf16 v[20:23], v[100:103], a[236:239], v[20:23]
 s_add_u32 s39, s39, 458752
 ds_read_b64_tr_b16 v[72:73], v204 offset:40960
 ds_read_b64_tr_b16 v[74:75], v204 offset:43008
 v_mfma_f32_16x16x32_bf16 v[20:23], v[96:99], a[228:231], v[20:23]
 s_waitcnt lgkmcnt(8)
 v_mfma_f32_16x16x32_bf16 v[24:27], v[112:115], a[224:227], v[24:27]
 ds_read_b64_tr_b16 v[76:77], v204 offset:45056
 ds_read_b64_tr_b16 v[78:79], v204 offset:47104
 v_mfma_f32_16x16x32_bf16 v[24:27], v[116:119], a[232:235], v[24:27]
 v_mfma_f32_16x16x32_bf16 v[24:27], v[120:123], a[240:243], v[24:27]
 s_waitcnt lgkmcnt(8)
 ds_read_b64_tr_b16 v[80:81], v205 offset:32768
 ds_read_b64_tr_b16 v[82:83], v205 offset:34816
 v_mfma_f32_16x16x32_bf16 v[24:27], v[124:127], a[248:251], v[24:27]
 v_mfma_f32_16x16x32_bf16 v[28:31], v[124:127], a[252:255], v[28:31]
 ds_read_b64_tr_b16 v[84:85], v205 offset:36864
 ds_read_b64_tr_b16 v[86:87], v205 offset:38912
 v_mfma_f32_16x16x32_bf16 v[28:31], v[120:123], a[244:247], v[28:31]
 buffer_load_dword v232, v233, s[4:7], 0 offen sc1
 v_mfma_f32_16x16x32_bf16 v[28:31], v[116:119], a[236:239], v[28:31]
 ds_read_b64_tr_b16 v[88:89], v205 offset:40960
 ds_read_b64_tr_b16 v[90:91], v205 offset:43008
 v_mfma_f32_16x16x32_bf16 v[28:31], v[112:115], a[228:231], v[28:31]
 s_waitcnt lgkmcnt(8)
 v_cvt_pk_bf16_f32 v16, v16, v17
 v_cvt_pk_bf16_f32 v17, v18, v19
 v_mfma_f32_16x16x32_bf16 v[0:3], v[64:67], a[0:3], v[144:147]
 ds_read_b64_tr_b16 v[92:93], v205 offset:45056
 ds_read_b64_tr_b16 v[94:95], v205 offset:47104
 v_mfma_f32_16x16x32_bf16 v[0:3], v[68:71], a[8:11], v[0:3]
 v_mfma_f32_16x16x32_bf16 v[0:3], v[72:75], a[16:19], v[0:3]
 s_waitcnt lgkmcnt(8)
 ds_read_b64_tr_b16 v[96:97], v204 offset:49152
 ds_read_b64_tr_b16 v[98:99], v204 offset:51200
 v_mfma_f32_16x16x32_bf16 v[0:3], v[76:79], a[24:27], v[0:3]
 v_cvt_pk_bf16_f32 v18, v24, v25
 v_cvt_pk_bf16_f32 v19, v26, v27
 v_cvt_pk_bf16_f32 v20, v20, v21
 v_cvt_pk_bf16_f32 v21, v22, v23
 v_mfma_f32_16x16x32_bf16 v[4:7], v[76:79], a[28:31], v[152:155]
 ds_read_b64_tr_b16 v[100:101], v204 offset:53248
 ds_read_b64_tr_b16 v[102:103], v204 offset:55296
 v_mfma_f32_16x16x32_bf16 v[4:7], v[72:75], a[20:23], v[4:7]
 buffer_store_dwordx4 v[16:19], v255, s[4:7], s49 offen sc1
 v_mfma_f32_16x16x32_bf16 v[4:7], v[68:71], a[12:15], v[4:7]
 ds_read_b64_tr_b16 v[104:105], v204 offset:57344
 ds_read_b64_tr_b16 v[106:107], v204 offset:59392
 v_mfma_f32_16x16x32_bf16 v[4:7], v[64:67], a[4:7], v[4:7]
 s_waitcnt lgkmcnt(8)
 v_cvt_pk_bf16_f32 v22, v28, v29
 v_cvt_pk_bf16_f32 v23, v30, v31
 v_mfma_f32_16x16x32_bf16 v[12:15], v[80:83], a[4:7], v[156:159]
 ds_read_b64_tr_b16 v[108:109], v204 offset:61440
 ds_read_b64_tr_b16 v[110:111], v204 offset:63488
 v_mfma_f32_16x16x32_bf16 v[12:15], v[84:87], a[12:15], v[12:15]
 buffer_store_dwordx4 v[20:23], v255, s[4:7], s49 offen offset:1024 sc1
 v_mfma_f32_16x16x32_bf16 v[12:15], v[88:91], a[20:23], v[12:15]
 s_waitcnt lgkmcnt(8)
 ds_read_b64_tr_b16 v[112:113], v205 offset:49152
 ds_read_b64_tr_b16 v[114:115], v205 offset:51200
 v_mfma_f32_16x16x32_bf16 v[12:15], v[92:95], a[28:31], v[12:15]
 v_mfma_f32_16x16x32_bf16 v[8:11], v[92:95], a[24:27], v[148:151]
 ds_read_b64_tr_b16 v[116:117], v205 offset:53248
 ds_read_b64_tr_b16 v[118:119], v205 offset:55296
 v_mfma_f32_16x16x32_bf16 v[8:11], v[88:91], a[16:19], v[8:11]
 v_mfma_f32_16x16x32_bf16 v[8:11], v[84:87], a[8:11], v[8:11]
 ds_read_b64_tr_b16 v[120:121], v205 offset:57344
 ds_read_b64_tr_b16 v[122:123], v205 offset:59392
 v_mfma_f32_16x16x32_bf16 v[8:11], v[80:83], a[0:3], v[8:11]
 s_waitcnt lgkmcnt(8)
 v_mfma_f32_16x16x32_bf16 v[0:3], v[96:99], a[32:35], v[0:3]
 ds_read_b64_tr_b16 v[124:125], v205 offset:61440
 ds_read_b64_tr_b16 v[126:127], v205 offset:63488
 v_mfma_f32_16x16x32_bf16 v[0:3], v[100:103], a[40:43], v[0:3]
 s_barrier
 v_mfma_f32_16x16x32_bf16 v[0:3], v[104:107], a[48:51], v[0:3]
 s_waitcnt lgkmcnt(8)
 ds_read_b64_tr_b16 v[64:65], v192 offset:0
 ds_read_b64_tr_b16 v[66:67], v192 offset:2048
 v_mfma_f32_16x16x32_bf16 v[0:3], v[108:111], a[56:59], v[0:3]
 v_mfma_f32_16x16x32_bf16 v[4:7], v[108:111], a[60:63], v[4:7]
 ds_read_b64_tr_b16 v[68:69], v192 offset:4096
 ds_read_b64_tr_b16 v[70:71], v192 offset:6144
 v_mfma_f32_16x16x32_bf16 v[4:7], v[104:107], a[52:55], v[4:7]
 v_mfma_f32_16x16x32_bf16 v[4:7], v[100:103], a[44:47], v[4:7]
 ds_read_b64_tr_b16 v[72:73], v192 offset:8192
 ds_read_b64_tr_b16 v[74:75], v192 offset:10240
 v_mfma_f32_16x16x32_bf16 v[4:7], v[96:99], a[36:39], v[4:7]
 s_waitcnt lgkmcnt(8)
 v_mfma_f32_16x16x32_bf16 v[12:15], v[112:115], a[36:39], v[12:15]
 ds_read_b64_tr_b16 v[76:77], v192 offset:12288
 ds_read_b64_tr_b16 v[78:79], v192 offset:14336
 v_mfma_f32_16x16x32_bf16 v[12:15], v[116:119], a[44:47], v[12:15]
 v_mfma_f32_16x16x32_bf16 v[12:15], v[120:123], a[52:55], v[12:15]
 s_waitcnt lgkmcnt(8)
 ds_read_b64_tr_b16 v[80:81], v193 offset:0
 ds_read_b64_tr_b16 v[82:83], v193 offset:2048
 v_mfma_f32_16x16x32_bf16 v[12:15], v[124:127], a[60:63], v[12:15]
 v_mfma_f32_16x16x32_bf16 v[8:11], v[124:127], a[56:59], v[8:11]
 ds_read_b64_tr_b16 v[84:85], v193 offset:4096
 ds_read_b64_tr_b16 v[86:87], v193 offset:6144
 v_mfma_f32_16x16x32_bf16 v[8:11], v[120:123], a[48:51], v[8:11]
 v_mfma_f32_16x16x32_bf16 v[8:11], v[116:119], a[40:43], v[8:11]
 ds_read_b64_tr_b16 v[88:89], v193 offset:8192
 ds_read_b64_tr_b16 v[90:91], v193 offset:10240
 v_mfma_f32_16x16x32_bf16 v[8:11], v[112:115], a[32:35], v[8:11]
 s_waitcnt lgkmcnt(8)
 v_mfma_f32_16x16x32_bf16 v[0:3], v[64:67], a[64:67], v[0:3]
 ds_read_b64_tr_b16 v[92:93], v193 offset:12288
 ds_read_b64_tr_b16 v[94:95], v193 offset:14336
 v_mfma_f32_16x16x32_bf16 v[0:3], v[68:71], a[72:75], v[0:3]
 v_mfma_f32_16x16x32_bf16 v[0:3], v[72:75], a[80:83], v[0:3]
 s_waitcnt lgkmcnt(8)
 ds_read_b64_tr_b16 v[96:97], v192 offset:16384
 ds_read_b64_tr_b16 v[98:99], v192 offset:18432
 v_mfma_f32_16x16x32_bf16 v[0:3], v[76:79], a[88:91], v[0:3]
 v_mfma_f32_16x16x32_bf16 v[4:7], v[76:79], a[92:95], v[4:7]
 ds_read_b64_tr_b16 v[100:101], v192 offset:20480
 ds_read_b64_tr_b16 v[102:103], v192 offset:22528
 v_mfma_f32_16x16x32_bf16 v[4:7], v[72:75], a[84:87], v[4:7]
 v_mfma_f32_16x16x32_bf16 v[4:7], v[68:71], a[76:79], v[4:7]
 ds_read_b64_tr_b16 v[104:105], v192 offset:24576
 ds_read_b64_tr_b16 v[106:107], v192 offset:26624
 v_mfma_f32_16x16x32_bf16 v[4:7], v[64:67], a[68:71], v[4:7]
 s_waitcnt lgkmcnt(8)
 v_mfma_f32_16x16x32_bf16 v[12:15], v[80:83], a[68:71], v[12:15]
 ds_read_b64_tr_b16 v[108:109], v192 offset:28672
 ds_read_b64_tr_b16 v[110:111], v192 offset:30720
 v_mfma_f32_16x16x32_bf16 v[12:15], v[84:87], a[76:79], v[12:15]
 v_mfma_f32_16x16x32_bf16 v[12:15], v[88:91], a[84:87], v[12:15]
 s_waitcnt lgkmcnt(8)
 ds_read_b64_tr_b16 v[112:113], v193 offset:16384
 ds_read_b64_tr_b16 v[114:115], v193 offset:18432
 v_mfma_f32_16x16x32_bf16 v[12:15], v[92:95], a[92:95], v[12:15]
 v_mfma_f32_16x16x32_bf16 v[8:11], v[92:95], a[88:91], v[8:11]
 ds_read_b64_tr_b16 v[116:117], v193 offset:20480
 ds_read_b64_tr_b16 v[118:119], v193 offset:22528
 v_mfma_f32_16x16x32_bf16 v[8:11], v[88:91], a[80:83], v[8:11]
 v_mfma_f32_16x16x32_bf16 v[8:11], v[84:87], a[72:75], v[8:11]
 ds_read_b64_tr_b16 v[120:121], v193 offset:24576
 ds_read_b64_tr_b16 v[122:123], v193 offset:26624
 v_mfma_f32_16x16x32_bf16 v[8:11], v[80:83], a[64:67], v[8:11]
 s_waitcnt lgkmcnt(8)
 v_mfma_f32_16x16x32_bf16 v[0:3], v[96:99], a[96:99], v[0:3]
 s_waitcnt vmcnt(2)
 ds_read_b64_tr_b16 v[124:125], v193 offset:28672
 ds_read_b64_tr_b16 v[126:127], v193 offset:30720
 v_mfma_f32_16x16x32_bf16 v[0:3], v[100:103], a[104:107], v[0:3]
 s_barrier
 v_cmp_gt_u32 vcc, 1, v232
 s_nop 1
 s_cbranch_vccnz Lspin16
Lback17:
 v_mfma_f32_16x16x32_bf16 v[0:3], v[104:107], a[112:115], v[0:3]
 s_waitcnt lgkmcnt(8)
 ds_read_b64_tr_b16 v[64:65], v196 offset:0
 ds_read_b64_tr_b16 v[66:67], v196 offset:2048
 v_mfma_f32_16x16x32_bf16 v[0:3], v[108:111], a[120:123], v[0:3]
 v_mfma_f32_16x16x32_bf16 v[4:7], v[108:111], a[124:127], v[4:7]
 ds_read_b64_tr_b16 v[68:69], v196 offset:4096
 ds_read_b64_tr_b16 v[70:71], v196 offset:6144
 v_mfma_f32_16x16x32_bf16 v[4:7], v[104:107], a[116:119], v[4:7]
 buffer_load_dwordx4 v[164:167], v255, s[4:7], s48 offen offset:2048 sc1
 v_mfma_f32_16x16x32_bf16 v[4:7], v[100:103], a[108:111], v[4:7]
 ds_read_b64_tr_b16 v[72:73], v196 offset:8192
 ds_read_b64_tr_b16 v[74:75], v196 offset:10240
 v_mfma_f32_16x16x32_bf16 v[4:7], v[96:99], a[100:103], v[4:7]
 s_waitcnt lgkmcnt(8)
 v_mfma_f32_16x16x32_bf16 v[12:15], v[112:115], a[100:103], v[12:15]
 ds_read_b64_tr_b16 v[76:77], v196 offset:12288
 ds_read_b64_tr_b16 v[78:79], v196 offset:14336
 v_mfma_f32_16x16x32_bf16 v[12:15], v[116:119], a[108:111], v[12:15]
 buffer_load_dwordx4 v[168:171], v255, s[4:7], s51 offen sc1
 v_mfma_f32_16x16x32_bf16 v[12:15], v[120:123], a[116:119], v[12:15]
 s_waitcnt lgkmcnt(8)
 ds_read_b64_tr_b16 v[80:81], v197 offset:0
 ds_read_b64_tr_b16 v[82:83], v197 offset:2048
 v_mfma_f32_16x16x32_bf16 v[12:15], v[124:127], a[124:127], v[12:15]
 v_mfma_f32_16x16x32_bf16 v[8:11], v[124:127], a[120:123], v[8:11]
 ds_read_b64_tr_b16 v[84:85], v197 offset:4096
 ds_read_b64_tr_b16 v[86:87], v197 offset:6144
 v_mfma_f32_16x16x32_bf16 v[8:11], v[120:123], a[112:115], v[8:11]
 buffer_load_dwordx4 v[176:179], v255, s[4:7], s48 offen offset:3072 sc1
 v_mfma_f32_16x16x32_bf16 v[8:11], v[116:119], a[104:107], v[8:11]
 ds_read_b64_tr_b16 v[88:89], v197 offset:8192
 ds_read_b64_tr_b16 v[90:91], v197 offset:10240
 v_mfma_f32_16x16x32_bf16 v[8:11], v[112:115], a[96:99], v[8:11]
 s_waitcnt lgkmcnt(8)
 v_mfma_f32_16x16x32_bf16 v[0:3], v[64:67], a[128:131], v[0:3]
 ds_read_b64_tr_b16 v[92:93], v197 offset:12288
 ds_read_b64_tr_b16 v[94:95], v197 offset:14336
 v_mfma_f32_16x16x32_bf16 v[0:3], v[68:71], a[136:139], v[0:3]
 buffer_load_dwordx4 v[180:183], v255, s[4:7], s51 offen offset:1024 sc1
 v_mfma_f32_16x16x32_bf16 v[0:3], v[72:75], a[144:147], v[0:3]
 s_waitcnt lgkmcnt(8)
 ds_read_b64_tr_b16 v[96:97], v196 offset:16384
 ds_read_b64_tr_b16 v[98:99], v196 offset:18432
 v_mfma_f32_16x16x32_bf16 v[0:3], v[76:79], a[152:155], v[0:3]
 v_mfma_f32_16x16x32_bf16 v[4:7], v[76:79], a[156:159], v[4:7]
 ds_read_b64_tr_b16 v[100:101], v196 offset:20480
 ds_read_b64_tr_b16 v[102:103], v196 offset:22528
 v_mfma_f32_16x16x32_bf16 v[4:7], v[72:75], a[148:151], v[4:7]
 buffer_load_dwordx4 v[160:163], v255, s[4:7], s95 offen sc1
 v_mfma_f32_16x16x32_bf16 v[4:7], v[68:71], a[140:143], v[4:7]
 ds_read_b64_tr_b16 v[104:105], v196 offset:24576
 ds_read_b64_tr_b16 v[106:107], v196 offset:26624
 v_mfma_f32_16x16x32_bf16 v[4:7], v[64:67], a[132:135], v[4:7]
 s_waitcnt lgkmcnt(8)
 v_mfma_f32_16x16x32_bf16 v[12:15], v[80:83], a[132:135], v[12:15]
 ds_read_b64_tr_b16 v[108:109], v196 offset:28672
 ds_read_b64_tr_b16 v[110:111], v196 offset:30720
 v_mfma_f32_16x16x32_bf16 v[12:15], v[84:87], a[140:143], v[12:15]
 buffer_load_dwordx4 v[172:175], v255, s[4:7], s95 offen offset:1024 sc1
 v_mfma_f32_16x16x32_bf16 v[12:15], v[88:91], a[148:151], v[12:15]
 s_waitcnt lgkmcnt(8)
 ds_read_b64_tr_b16 v[112:113], v197 offset:16384
 ds_read_b64_tr_b16 v[114:115], v197 offset:18432
 v_mfma_f32_16x16x32_bf16 v[12:15], v[92:95], a[156:159], v[12:15]
 v_mfma_f32_16x16x32_bf16 v[8:11], v[92:95], a[152:155], v[8:11]
 ds_read_b64_tr_b16 v[116:117], v197 offset:20480
 ds_read_b64_tr_b16 v[118:119], v197 offset:22528
 v_mfma_f32_16x16x32_bf16 v[8:11], v[88:91], a[144:147], v[8:11]
 v_mfma_f32_16x16x32_bf16 v[8:11], v[84:87], a[136:139], v[8:11]
 ds_read_b64_tr_b16 v[120:121], v197 offset:24576
 ds_read_b64_tr_b16 v[122:123], v197 offset:26624
 v_mfma_f32_16x16x32_bf16 v[8:11], v[80:83], a[128:131], v[8:11]
 s_waitcnt lgkmcnt(8)
 v_mfma_f32_16x16x32_bf16 v[0:3], v[96:99], a[160:163], v[0:3]
 ds_read_b64_tr_b16 v[124:125], v197 offset:28672
 ds_read_b64_tr_b16 v[126:127], v197 offset:30720
 v_mfma_f32_16x16x32_bf16 v[0:3], v[100:103], a[168:171], v[0:3]
 s_barrier
 v_mfma_f32_16x16x32_bf16 v[0:3], v[104:107], a[176:179], v[0:3]
 s_waitcnt lgkmcnt(8)
 ds_read_b64_tr_b16 v[64:65], v196 offset:32768
 ds_read_b64_tr_b16 v[66:67], v196 offset:34816
 v_mfma_f32_16x16x32_bf16 v[0:3], v[108:111], a[184:187], v[0:3]
 v_mfma_f32_16x16x32_bf16 v[4:7], v[108:111], a[188:191], v[4:7]
 ds_read_b64_tr_b16 v[68:69], v196 offset:36864
 ds_read_b64_tr_b16 v[70:71], v196 offset:38912
 v_mfma_f32_16x16x32_bf16 v[4:7], v[104:107], a[180:183], v[4:7]
 v_mfma_f32_16x16x32_bf16 v[4:7], v[100:103], a[172:175], v[4:7]
 ds_read_b64_tr_b16 v[72:73], v196 offset:40960
 ds_read_b64_tr_b16 v[74:75], v196 offset:43008
 v_mfma_f32_16x16x32_bf16 v[4:7], v[96:99], a[164:167], v[4:7]
 s_waitcnt lgkmcnt(8)
 v_mfma_f32_16x16x32_bf16 v[12:15], v[112:115], a[164:167], v[12:15]
 s_add_u32 m0, s37, 32768
 ds_read_b64_tr_b16 v[76:77], v196 offset:45056
 ds_read_b64_tr_b16 v[78:79], v196 offset:47104
 v_mfma_f32_16x16x32_bf16 v[12:15], v[116:119], a[172:175], v[12:15]
 buffer_load_dwordx4 v216, s[12:15], s39 offen lds
 v_mfma_f32_16x16x32_bf16 v[12:15], v[120:123], a[180:183], v[12:15]
 s_waitcnt lgkmcnt(8)
 ds_read_b64_tr_b16 v[80:81], v197 offset:32768
 ds_read_b64_tr_b16 v[82:83], v197 offset:34816
 v_mfma_f32_16x16x32_bf16 v[12:15], v[124:127], a[188:191], v[12:15]
 v_mfma_f32_16x16x32_bf16 v[8:11], v[124:127], a[184:187], v[8:11]
 ds_read_b64_tr_b16 v[84:85], v197 offset:36864
 ds_read_b64_tr_b16 v[86:87], v197 offset:38912
 v_mfma_f32_16x16x32_bf16 v[8:11], v[120:123], a[176:179], v[8:11]
 buffer_load_dwordx4 v217, s[12:15], s39 offen offset:1024 lds
 v_mfma_f32_16x16x32_bf16 v[8:11], v[116:119], a[168:171], v[8:11]
 ds_read_b64_tr_b16 v[88:89], v197 offset:40960
 ds_read_b64_tr_b16 v[90:91], v197 offset:43008
 v_mfma_f32_16x16x32_bf16 v[8:11], v[112:115], a[160:163], v[8:11]
 s_waitcnt lgkmcnt(8)
 v_mfma_f32_16x16x32_bf16 v[0:3], v[64:67], a[192:195], v[0:3]
 ds_read_b64_tr_b16 v[92:93], v197 offset:45056
 ds_read_b64_tr_b16 v[94:95], v197 offset:47104
 v_mfma_f32_16x16x32_bf16 v[0:3], v[68:71], a[200:203], v[0:3]
 buffer_load_dwordx4 v218, s[12:15], s39 offen offset:2048 lds
 v_mfma_f32_16x16x32_bf16 v[0:3], v[72:75], a[208:211], v[0:3]
 s_waitcnt lgkmcnt(8)
 ds_read_b64_tr_b16 v[96:97], v196 offset:49152
 ds_read_b64_tr_b16 v[98:99], v196 offset:51200
 v_mfma_f32_16x16x32_bf16 v[0:3], v[76:79], a[216:219], v[0:3]
 v_mfma_f32_16x16x32_bf16 v[4:7], v[76:79], a[220:223], v[4:7]
 ds_read_b64_tr_b16 v[100:101], v196 offset:53248
 ds_read_b64_tr_b16 v[102:103], v196 offset:55296
 v_mfma_f32_16x16x32_bf16 v[4:7], v[72:75], a[212:215], v[4:7]
 buffer_load_dwordx4 v219, s[12:15], s39 offen offset:3072 lds
 v_mfma_f32_16x16x32_bf16 v[4:7], v[68:71], a[204:207], v[4:7]
 s_add_u32 s39, s39, 458752
 ds_read_b64_tr_b16 v[104:105], v196 offset:57344
 ds_read_b64_tr_b16 v[106:107], v196 offset:59392
 v_mfma_f32_16x16x32_bf16 v[4:7], v[64:67], a[196:199], v[4:7]
 s_waitcnt lgkmcnt(8)
 v_mfma_f32_16x16x32_bf16 v[12:15], v[80:83], a[196:199], v[12:15]
 s_add_u32 m0, s37, 49152
 ds_read_b64_tr_b16 v[108:109], v196 offset:61440
 ds_read_b64_tr_b16 v[110:111], v196 offset:63488
 v_mfma_f32_16x16x32_bf16 v[12:15], v[84:87], a[204:207], v[12:15]
 buffer_load_dwordx4 v216, s[12:15], s39 offen lds
 v_mfma_f32_16x16x32_bf16 v[12:15], v[88:91], a[212:215], v[12:15]
 s_waitcnt lgkmcnt(8)
 ds_read_b64_tr_b16 v[112:113], v197 offset:49152
 ds_read_b64_tr_b16 v[114:115], v197 offset:51200
 v_mfma_f32_16x16x32_bf16 v[12:15], v[92:95], a[220:223], v[12:15]
 s_waitcnt vmcnt(10)
 v_lshlrev_b32 v16, 16, v164
 v_and_b32 v17, 0xffff0000, v164
 v_mfma_f32_16x16x32_bf16 v[8:11], v[92:95], a[216:219], v[8:11]
 ds_read_b64_tr_b16 v[116:117], v197 offset:53248
 ds_read_b64_tr_b16 v[118:119], v197 offset:55296
 v_mfma_f32_16x16x32_bf16 v[8:11], v[88:91], a[208:211], v[8:11]
 buffer_load_dwordx4 v217, s[12:15], s39 offen offset:1024 lds
 v_mfma_f32_16x16x32_bf16 v[8:11], v[84:87], a[200:203], v[8:11]
 ds_read_b64_tr_b16 v[120:121], v197 offset:57344
 ds_read_b64_tr_b16 v[122:123], v197 offset:59392
 v_mfma_f32_16x16x32_bf16 v[8:11], v[80:83], a[192:195], v[8:11]
 s_waitcnt vmcnt(10) lgkmcnt(8)
 v_lshlrev_b32 v32, 16, v168
 v_and_b32 v33, 0xffff0000, v168
 v_mfma_f32_16x16x32_bf16 v[0:3], v[96:99], a[224:227], v[0:3]
 ds_read_b64_tr_b16 v[124:125], v197 offset:61440
 ds_read_b64_tr_b16 v[126:127], v197 offset:63488
 v_mfma_f32_16x16x32_bf16 v[0:3], v[100:103], a[232:235], v[0:3]
 buffer_load_dwordx4 v218, s[12:15], s39 offen offset:2048 lds
 v_mfma_f32_16x16x32_bf16 v[0:3], v[104:107], a[240:243], v[0:3]
 s_waitcnt lgkmcnt(8)
 v_lshlrev_b32 v18, 16, v165
 v_and_b32 v19, 0xffff0000, v165
 v_mfma_f32_16x16x32_bf16 v[0:3], v[108:111], a[248:251], v[0:3]
 v_lshlrev_b32 v34, 16, v169
 v_and_b32 v35, 0xffff0000, v169
 v_mfma_f32_16x16x32_bf16 v[4:7], v[108:111], a[252:255], v[4:7]
 s_mov_b32 s10, 8388608
 v_lshlrev_b32 v20, 16, v166
 v_and_b32 v21, 0xffff0000, v166
 v_mfma_f32_16x16x32_bf16 v[4:7], v[104:107], a[244:247], v[4:7]
 s_mov_b32 s8, s80
 buffer_load_dwordx4 v219, s[12:15], s39 offen offset:3072 lds
 v_mfma_f32_16x16x32_bf16 v[4:7], v[100:103], a[236:239], v[4:7]
 s_add_u32 s39, s39, 458752
 v_lshlrev_b32 v36, 16, v170
 v_and_b32 v37, 0xffff0000, v170
 v_mfma_f32_16x16x32_bf16 v[4:7], v[96:99], a[228:231], v[4:7]
 s_waitcnt lgkmcnt(2)
 s_mov_b32 s9, s81
 v_lshlrev_b32 v22, 16, v167
 v_and_b32 v23, 0xffff0000, v167
 v_mfma_f32_16x16x32_bf16 v[8:11], v[112:115], a[224:227], v[8:11]
 s_add_u32 s26, s54, 0xfffd8000
 v_lshlrev_b32 v38, 16, v171
 v_and_b32 v39, 0xffff0000, v171
 v_mfma_f32_16x16x32_bf16 v[8:11], v[116:119], a[232:235], v[8:11]
 s_waitcnt vmcnt(11)
 v_lshlrev_b32 v24, 16, v176
 v_and_b32 v25, 0xffff0000, v176
 v_mfma_f32_16x16x32_bf16 v[8:11], v[120:123], a[240:243], v[8:11]
 s_waitcnt vmcnt(10) lgkmcnt(0)
 v_lshlrev_b32 v40, 16, v180
 v_and_b32 v41, 0xffff0000, v180
 v_mfma_f32_16x16x32_bf16 v[8:11], v[124:127], a[248:251], v[8:11]
 v_lshlrev_b32 v26, 16, v177
 v_and_b32 v27, 0xffff0000, v177
 v_mfma_f32_16x16x32_bf16 v[12:15], v[124:127], a[252:255], v[12:15]
 v_lshlrev_b32 v42, 16, v181
 v_and_b32 v43, 0xffff0000, v181
 v_mfma_f32_16x16x32_bf16 v[12:15], v[120:123], a[244:247], v[12:15]
 v_lshlrev_b32 v28, 16, v178
 v_and_b32 v29, 0xffff0000, v178
 v_mfma_f32_16x16x32_bf16 v[12:15], v[116:119], a[236:239], v[12:15]
 v_lshlrev_b32 v44, 16, v182
 v_and_b32 v45, 0xffff0000, v182
 v_mfma_f32_16x16x32_bf16 v[12:15], v[112:115], a[228:231], v[12:15]
 v_lshlrev_b32 v30, 16, v179
 v_and_b32 v31, 0xffff0000, v179
 v_lshlrev_b32 v46, 16, v183
 v_and_b32 v47, 0xffff0000, v183
 v_pk_add_f32 v[16:17], v[16:17], v[32:33]
 v_pk_add_f32 v[18:19], v[18:19], v[34:35]
 v_pk_add_f32 v[20:21], v[20:21], v[36:37]
 v_pk_add_f32 v[22:23], v[22:23], v[38:39]
 v_pk_add_f32 v[24:25], v[24:25], v[40:41]
 v_pk_add_f32 v[26:27], v[26:27], v[42:43]
 v_pk_add_f32 v[28:29], v[28:29], v[44:45]
 v_pk_add_f32 v[30:31], v[30:31], v[46:47]
 v_pk_add_f32 v[0:1], v[0:1], v[16:17]
 v_pk_add_f32 v[2:3], v[2:3], v[18:19]
 v_pk_add_f32 v[8:9], v[8:9], v[20:21]
 v_pk_add_f32 v[10:11], v[10:11], v[22:23]
 v_pk_add_f32 v[4:5], v[4:5], v[24:25]
 v_pk_add_f32 v[6:7], v[6:7], v[26:27]
 v_pk_add_f32 v[12:13], v[12:13], v[28:29]
 v_pk_add_f32 v[14:15], v[14:15], v[30:31]
 s_waitcnt vmcnt(8)
 v_max3_u32 v232, v160, v161, v162
 v_max3_u32 v232, v232, v163, v172
 v_max3_u32 v232, v232, v173, v174
 v_max_u32 v232, v232, v175
 v_cmp_eq_u32 vcc, -1, v232
 s_nop 1
 s_cbranch_vccnz Ltag18
Ltag18b:
 v_lshlrev_b32 v48, 16, v160
 v_and_b32 v49, 0xffff0000, v160
 v_lshlrev_b32 v50, 16, v161
 v_and_b32 v51, 0xffff0000, v161
 v_lshlrev_b32 v52, 16, v162
 v_and_b32 v53, 0xffff0000, v162
 v_lshlrev_b32 v54, 16, v163
 v_and_b32 v55, 0xffff0000, v163
 v_pk_add_f32 v[0:1], v[0:1], v[48:49]
 v_pk_add_f32 v[2:3], v[2:3], v[50:51]
 v_pk_add_f32 v[8:9], v[8:9], v[52:53]
 v_pk_add_f32 v[10:11], v[10:11], v[54:55]
 v_cvt_pk_bf16_f32 v120, v0, v1
 v_cvt_pk_bf16_f32 v121, v2, v3
 v_cvt_pk_bf16_f32 v122, v8, v9
 v_cvt_pk_bf16_f32 v123, v10, v11
 buffer_store_dwordx4 v[120:123], v128, s[4:7], s98 offen sc1
 v_pk_add_f32 v[132:133], v[0:1], v[2:3]
 v_pk_mul_f32 v[134:135], v[0:1], v[0:1]
 v_pk_fma_f32 v[134:135], v[2:3], v[2:3], v[134:135]
 v_pk_add_f32 v[132:133], v[132:133], v[8:9]
 v_pk_fma_f32 v[134:135], v[8:9], v[8:9], v[134:135]
 v_pk_add_f32 v[132:133], v[132:133], v[10:11]
 v_pk_fma_f32 v[134:135], v[10:11], v[10:11], v[134:135]
 v_add_f32 v132, v132, v133
 v_add_f32 v133, v134, v135
 v_lshlrev_b32 v56, 16, v172
 v_and_b32 v57, 0xffff0000, v172
 v_lshlrev_b32 v58, 16, v173
 v_and_b32 v59, 0xffff0000, v173
 v_lshlrev_b32 v60, 16, v174
 v_and_b32 v61, 0xffff0000, v174
 v_lshlrev_b32 v62, 16, v175
 v_and_b32 v63, 0xffff0000, v175
 v_pk_add_f32 v[4:5], v[4:5], v[56:57]
 v_pk_add_f32 v[6:7], v[6:7], v[58:59]
 v_pk_add_f32 v[12:13], v[12:13], v[60:61]
 v_pk_add_f32 v[14:15], v[14:15], v[62:63]
 v_cvt_pk_bf16_f32 v124, v4, v5
 v_cvt_pk_bf16_f32 v125, v6, v7
 v_cvt_pk_bf16_f32 v126, v12, v13
 v_cvt_pk_bf16_f32 v127, v14, v15
 buffer_store_dwordx4 v[124:127], v128, s[4:7], s100 offen sc1
 v_pk_add_f32 v[136:137], v[4:5], v[6:7]
 v_pk_mul_f32 v[138:139], v[4:5], v[4:5]
 v_pk_fma_f32 v[138:139], v[6:7], v[6:7], v[138:139]
 v_pk_add_f32 v[136:137], v[136:137], v[12:13]
 v_pk_fma_f32 v[138:139], v[12:13], v[12:13], v[138:139]
 v_pk_add_f32 v[136:137], v[136:137], v[14:15]
 v_pk_fma_f32 v[138:139], v[14:15], v[14:15], v[138:139]
 v_add_f32 v136, v136, v137
 v_add_f32 v137, v138, v139
 s_nop 0
 v_permlane16_swap_b32 v132, v136
 v_permlane16_swap_b32 v133, v137
 v_pk_add_f32 v[132:133], v[132:133], v[136:137]
 v_mov_b32 v134, v132
 v_mov_b32 v135, v133
 s_nop 0
 v_permlane32_swap_b32 v132, v134
 v_permlane32_swap_b32 v133, v135
 v_pk_add_f32 v[132:133], v[132:133], v[134:135]
 buffer_store_dwordx2 v[132:133], v129, s[4:7], s99 offen sc1
 s_barrier
 s_add_u32 m0, s33, 0
 s_nop 0
 buffer_load_dwordx4 v216, s[12:15], s40 offen lds
 s_mov_b32 s16, s84
 buffer_load_dwordx4 v217, s[12:15], s40 offen offset:1024 lds
 s_mov_b32 s17, s85
 buffer_load_dwordx4 v218, s[12:15], s40 offen offset:2048 lds
 s_mov_b32 s18, 917504
 buffer_load_dwordx4 v219, s[12:15], s40 offen offset:3072 lds
 s_add_u32 s40, s40, 114688
 s_mov_b32 s19, 0x20000
 s_waitcnt vmcnt(4)
 s_barrier
 buffer_store_dword v253, v254, s[4:7], s26 offen sc1
 s_cmp_ge_u32 s2, 224
 s_cbranch_scc1 Lidle5
 s_add_u32 m0, s33, 4096
 s_nop 0
 buffer_load_dwordx4 v216, s[12:15], s40 offen lds
 s_lshl_b32 s23, s41, 1
 s_lshr_b32 s24, s20, 1
 s_add_u32 s23, s23, s24
 s_sub_u32 s24, 31, s23
 s_min_u32 s23, s23, s24
 buffer_load_dwordx4 v217, s[12:15], s40 offen offset:1024 lds
 s_lshl_b32 s23, s23, 11
 s_add_u32 s23, s23, 83427328
 v_and_b32 v233, 240, v255
 v_lshl_add_u32 v233, v233, 3, s23
 s_lshl_b32 s23, s41, 2
 buffer_load_dwordx4 v218, s[12:15], s40 offen offset:2048 lds
 s_add_u32 s23, s23, s20
 s_lshl_b32 s48, s23, 15
 s_add_u32 s48, s48, 68157440
 s_add_u32 s49, s48, 16384
 s_lshl_b32 s26, s23, 12
 buffer_load_dwordx4 v219, s[12:15], s40 offen offset:3072 lds
 s_add_u32 s40, s40, 114688
 s_add_u32 s26, s26, 82837504
 s_lshl_b32 s50, s23, 12
 s_add_u32 s50, s50, 83099648
 s_lshl_b32 s55, s23, 6
 s_mul_i32 s53, s23, 28
 s_add_u32 m0, s33, 8192
 s_nop 0
 buffer_load_dwordx4 v216, s[12:15], s40 offen lds
 s_add_u32 s53, s53, s42
 s_lshl_b32 s53, s53, 11
 s_add_u32 s53, s53, 78643200
 s_add_u32 s54, s53, 28672
 s_lshl_b32 s24, s42, 18
 buffer_load_dwordx4 v217, s[12:15], s40 offen offset:1024 lds
 s_add_u32 s24, s24, 74448896
 s_lshl_b32 s23, s23, 12
 s_add_u32 s51, s24, s23
Lw2_3:
 s_cbranch_execz Lw2_7
 s_lshl_b32 s23, s20, 12
 s_add_u32 s24, s24, s23
 buffer_load_dwordx4 v218, s[12:15], s40 offen offset:2048 lds
 s_and_b32 s25, s2, 1
 s_lshl_b32 s60, s25, 17
 s_add_u32 s60, s60, s24
 s_xor_b32 s52, s60, 262144
 s_add_u32 s62, s95, 2048
 buffer_load_dwordx4 v219, s[12:15], s40 offen offset:3072 lds
 s_add_u32 s40, s40, 114688
 s_xor_b32 s63, s62, 32768
 s_lshl_b32 s23, s22, 12
 s_lshl_b32 s25, s25, 10
 s_add_u32 s23, s23, s25
 s_add_u32 s23, s23, 83460096
 s_add_u32 m0, s33, 12288
 s_nop 0
 buffer_load_dwordx4 v216, s[12:15], s40 offen lds
 buffer_load_dwordx4 v217, s[12:15], s40 offen offset:1024 lds
 buffer_load_dwordx4 v218, s[12:15], s40 offen offset:2048 lds
 buffer_load_dwordx4 v219, s[12:15], s40 offen offset:3072 lds
 s_add_u32 s40, s40, 114688
 buffer_load_dword v232, v233, s[4:7], 0 offen sc1
 v_and_b32 v250, 368, v255
 v_lshl_add_u32 v250, v250, 3, s23
 s_xor_b32 s23, s34, 0x10000
 v_add_u32 v251, s23, v255
 v_bfe_u32 v252, v255, 6, 2
 v_bfe_u32 v144, v255, 4, 2
 v_lshl_add_u32 v252, v252, 3, v144
 v_lshlrev_b32 v252, 1, v252
 v_mov_b32 v162, 0xbdd2d3e8
 v_mov_b32 v163, 0xc0135761
 v_lshrrev_b32 v243, 8, v255
 v_lshlrev_b32 v243, 4, v243
 v_lshrrev_b32 v164, 2, v255
 v_and_b32 v165, 0x30, v255
 v_cmp_eq_u32 vcc, 0, v165
 v_mov_b32 v167, 536870912
 v_and_b32 v165, 0xf0, v255
 v_cndmask_b32 v164, v167, v164, vcc
 v_cmp_gt_u32 vcc, 0xe0, v165
 v_lshlrev_b32 v166, 2, v243
 v_lshl_add_u32 v165, v165, 4, v166
 v_cndmask_b32 v165, v167, v165, vcc
 v_and_b32 v166, 0xf0, v255
 v_lshl_add_u32 v166, v243, 6, v166
 v_bfe_u32 v160, v255, 4, 1
 v_mul_u32_u24 v160, 0xaaaa, v160
 v_add_u32 v160, 0x4444, v160
 v_mov_b32 v176, 0
 v_mov_b32 v177, 0
 v_mov_b32 v178, 0
 v_mov_b32 v179, 0
 v_mov_b32 v180, 0
 v_mov_b32 v181, 0
 v_mov_b32 v182, 0
 v_mov_b32 v183, 0
 v_mov_b32 v184, 0
 v_mov_b32 v185, 0
 v_mov_b32 v186, 0
 v_mov_b32 v187, 0
 v_mov_b32 v188, 0
 v_mov_b32 v189, 0
 v_mov_b32 v190, 0
 v_mov_b32 v191, 0
 v_mov_b32 v152, 0
 v_mov_b32 v153, 0
 v_mov_b32 v154, 0
 v_mov_b32 v155, 0
 v_mov_b32 v156, 0
 v_mov_b32 v157, 0
 v_mov_b32 v158, 0
 v_mov_b32 v159, 0
 v_mov_b32 v192, 0
 v_mov_b32 v193, 0
 v_mov_b32 v194, 0
 v_mov_b32 v195, 0
 v_mov_b32 v216, 0
 v_mov_b32 v217, 0
 v_mov_b32 v218, 0
 v_mov_b32 v219, 0
 ds_read_b64_tr_b16 v[64:65], v234 offset:0
 ds_read_b64_tr_b16 v[66:67], v234 offset:2048
 ds_read_b64_tr_b16 v[68:69], v234 offset:4096
 ds_read_b64_tr_b16 v[70:71], v234 offset:6144
 ds_read_b64_tr_b16 v[72:73], v235 offset:0
 ds_read_b64_tr_b16 v[74:75], v235 offset:2048
 ds_read_b64_tr_b16 v[76:77], v235 offset:4096
 ds_read_b64_tr_b16 v[78:79], v235 offset:6144
 ds_read_b64_tr_b16 v[80:81], v236 offset:0
 ds_read_b64_tr_b16 v[82:83], v236 offset:2048
 ds_read_b64_tr_b16 v[84:85], v236 offset:4096
 ds_read_b64_tr_b16 v[86:87], v236 offset:6144
 s_waitcnt vmcnt(0)
 v_cmp_gt_u32 vcc, 1, v232
 s_mov_b32 s27, 0
 s_nop 0
 s_cbranch_vccz Lback20
Lspin19:
 buffer_load_dword v232, v233, s[4:7], 0 offen sc1
 s_add_u32 s27, s27, 1
 s_waitcnt vmcnt(0)
 v_cmp_gt_u32 vcc, 1, v232
 s_cmp_gt_u32 s27, 1048576
 s_cbranch_scc1 Lback20
 s_cbranch_vccnz Lspin19
Lback20:
 buffer_load_dwordx4 a[0:3], v255, s[4:7], s48 offen sc1
 buffer_load_dwordx4 a[4:7], v255, s[4:7], s49 offen sc1
 buffer_load_dwordx4 a[8:11], v255, s[4:7], s48 offen offset:1024 sc1
 buffer_load_dwordx4 a[12:15], v255, s[4:7], s49 offen offset:1024 sc1
 buffer_load_dwordx4 v[168:171], v166, s[4:7], s26 offen sc1
 buffer_load_dwordx4 v[172:175], v166, s[4:7], s26 offen offset:256 sc1
 buffer_load_dwordx4 v[144:147], v166, s[4:7], s26 offen offset:512 sc1
 buffer_load_dwordx4 v[148:151], v166, s[4:7], s26 offen offset:768 sc1
 buffer_load_dwordx4 a[16:19], v255, s[4:7], s48 offen offset:2048 sc1
 buffer_load_dwordx4 a[20:23], v255, s[4:7], s49 offen offset:2048 sc1
 buffer_load_dwordx4 a[24:27], v255, s[4:7], s48 offen offset:3072 sc1
 s_add_u32 s48, s48, 4096
 buffer_load_dwordx4 a[28:31], v255, s[4:7], s49 offen offset:3072 sc1
 s_add_u32 s49, s49, 4096
 buffer_load_dwordx4 a[32:35], v255, s[4:7], s48 offen sc1
 buffer_load_dwordx4 a[36:39], v255, s[4:7], s49 offen sc1
 s_barrier
 s_waitcnt lgkmcnt(8)
 v_smfmac_f32_16x16x64_bf16 v[176:179], v[220:223], v[64:71], v160
 s_waitcnt vmcnt(13)
 v_mfma_f32_16x16x32_bf16 v[0:3], a[0:3], v[64:67], 0
 s_waitcnt vmcnt(11)
 ds_read_b64_tr_b16 v[88:89], v237 offset:0
 ds_read_b64_tr_b16 v[90:91], v237 offset:2048
 v_mfma_f32_16x16x32_bf16 v[0:3], a[8:11], v[68:71], v[0:3]
 s_waitcnt vmcnt(10)
 buffer_load_dwordx4 a[40:43], v255, s[4:7], s48 offen offset:1024 sc1
 v_mfma_f32_16x16x32_bf16 v[4:7], a[12:15], v[68:71], 0
 ds_read_b64_tr_b16 v[92:93], v237 offset:4096
 ds_read_b64_tr_b16 v[94:95], v237 offset:6144
 v_mfma_f32_16x16x32_bf16 v[4:7], a[4:7], v[64:67], v[4:7]
 s_waitcnt lgkmcnt(8)
 v_smfmac_f32_16x16x64_bf16 v[180:183], v[220:223], v[72:79], v160
 v_mfma_f32_16x16x32_bf16 v[8:11], a[0:3], v[72:75], 0
 ds_read_b64_tr_b16 v[96:97], v238 offset:0
 ds_read_b64_tr_b16 v[98:99], v238 offset:2048
 v_mfma_f32_16x16x32_bf16 v[8:11], a[8:11], v[76:79], v[8:11]
 buffer_load_dwordx4 a[44:47], v255, s[4:7], s49 offen offset:1024 sc1
 v_mfma_f32_16x16x32_bf16 v[12:15], a[12:15], v[76:79], 0
 ds_read_b64_tr_b16 v[100:101], v238 offset:4096
 ds_read_b64_tr_b16 v[102:103], v238 offset:6144
 v_mfma_f32_16x16x32_bf16 v[12:15], a[4:7], v[72:75], v[12:15]
 s_waitcnt lgkmcnt(8)
 v_smfmac_f32_16x16x64_bf16 v[184:187], v[220:223], v[80:87], v160
 v_mfma_f32_16x16x32_bf16 v[16:19], a[0:3], v[80:83], 0
 ds_read_b64_tr_b16 v[104:105], v234 offset:8192
 ds_read_b64_tr_b16 v[106:107], v234 offset:10240
 v_mfma_f32_16x16x32_bf16 v[16:19], a[8:11], v[84:87], v[16:19]
 buffer_load_dwordx4 a[48:51], v255, s[4:7], s48 offen offset:2048 sc1
 v_mfma_f32_16x16x32_bf16 v[20:23], a[12:15], v[84:87], 0
 ds_read_b64_tr_b16 v[108:109], v234 offset:12288
 ds_read_b64_tr_b16 v[110:111], v234 offset:14336
 v_mfma_f32_16x16x32_bf16 v[20:23], a[4:7], v[80:83], v[20:23]
 s_waitcnt vmcnt(10) lgkmcnt(8)
 v_add_f32 v168, v168, v144
 v_add_f32 v169, v169, v145
 v_smfmac_f32_16x16x64_bf16 v[188:191], v[220:223], v[88:95], v160
 v_add_f32 v170, v170, v146
 v_mfma_f32_16x16x32_bf16 v[24:27], a[0:3], v[88:91], 0
 ds_read_b64_tr_b16 v[64:65], v235 offset:8192
 ds_read_b64_tr_b16 v[66:67], v235 offset:10240
 v_mfma_f32_16x16x32_bf16 v[24:27], a[8:11], v[92:95], v[24:27]
 buffer_load_dwordx4 a[52:55], v255, s[4:7], s49 offen offset:2048 sc1
 v_mfma_f32_16x16x32_bf16 v[28:31], a[12:15], v[92:95], 0
 ds_read_b64_tr_b16 v[68:69], v235 offset:12288
 ds_read_b64_tr_b16 v[70:71], v235 offset:14336
 v_mfma_f32_16x16x32_bf16 v[28:31], a[4:7], v[88:91], v[28:31]
 s_waitcnt lgkmcnt(8)
 v_add_f32 v171, v171, v147
 s_waitcnt vmcnt(10)
 v_add_f32 v172, v172, v148
 v_smfmac_f32_16x16x64_bf16 v[152:155], v[220:223], v[96:103], v160
 v_add_f32 v173, v173, v149
 v_mfma_f32_16x16x32_bf16 v[32:35], v[96:99], a[0:3], 0
 ds_read_b64_tr_b16 v[72:73], v236 offset:8192
 ds_read_b64_tr_b16 v[74:75], v236 offset:10240
 v_mfma_f32_16x16x32_bf16 v[32:35], v[100:103], a[8:11], v[32:35]
 buffer_load_dwordx4 a[56:59], v255, s[4:7], s48 offen offset:3072 sc1
 v_mfma_f32_16x16x32_bf16 v[36:39], v[100:103], a[12:15], 0
 s_add_u32 s48, s48, 4096
 ds_read_b64_tr_b16 v[76:77], v236 offset:12288
 ds_read_b64_tr_b16 v[78:79], v236 offset:14336
 v_mfma_f32_16x16x32_bf16 v[36:39], v[96:99], a[4:7], v[36:39]
 s_waitcnt lgkmcnt(8)
 v_add_f32 v174, v174, v150
 v_add_f32 v175, v175, v151
 v_smfmac_f32_16x16x64_bf16 v[176:179], v[220:223], v[104:111], v160
 s_waitcnt vmcnt(10)
 v_add_f32 v168, v168, v172
 v_mfma_f32_16x16x32_bf16 v[0:3], a[16:19], v[104:107], v[0:3]
 s_waitcnt vmcnt(8)
 ds_read_b64_tr_b16 v[80:81], v237 offset:8192
 ds_read_b64_tr_b16 v[82:83], v237 offset:10240
 v_mfma_f32_16x16x32_bf16 v[0:3], a[24:27], v[108:111], v[0:3]
 s_waitcnt vmcnt(7)
 buffer_load_dwordx4 a[60:63], v255, s[4:7], s49 offen offset:3072 sc1
 v_mfma_f32_16x16x32_bf16 v[4:7], a[28:31], v[108:111], v[4:7]
 s_add_u32 s49, s49, 4096
 ds_read_b64_tr_b16 v[84:85], v237 offset:12288
 ds_read_b64_tr_b16 v[86:87], v237 offset:14336
 v_mfma_f32_16x16x32_bf16 v[4:7], a[20:23], v[104:107], v[4:7]
 s_waitcnt lgkmcnt(8)
 v_add_f32 v169, v169, v173
 v_add_f32 v170, v170, v174
 v_smfmac_f32_16x16x64_bf16 v[180:183], v[220:223], v[64:71], v160
 v_add_f32 v171, v171, v175
 v_mfma_f32_16x16x32_bf16 v[8:11], a[16:19], v[64:67], v[8:11]
 ds_read_b64_tr_b16 v[88:89], v238 offset:8192
 ds_read_b64_tr_b16 v[90:91], v238 offset:10240
 v_mfma_f32_16x16x32_bf16 v[8:11], a[24:27], v[68:71], v[8:11]
 buffer_load_dwordx4 a[64:67], v255, s[4:7], s48 offen sc1
 v_mfma_f32_16x16x32_bf16 v[12:15], a[28:31], v[68:71], v[12:15]
 ds_read_b64_tr_b16 v[92:93], v238 offset:12288
 ds_read_b64_tr_b16 v[94:95], v238 offset:14336
 v_mfma_f32_16x16x32_bf16 v[12:15], a[20:23], v[64:67], v[12:15]
 s_waitcnt lgkmcnt(8)
 v_mov_b32 v172, v168
 v_mov_b32 v173, v169
 v_smfmac_f32_16x16x64_bf16 v[184:187], v[220:223], v[72:79], v160
 v_mov_b32 v174, v170
 v_mfma_f32_16x16x32_bf16 v[16:19], a[16:19], v[72:75], v[16:19]
 ds_read_b64_tr_b16 v[96:97], v234 offset:16384
 ds_read_b64_tr_b16 v[98:99], v234 offset:18432
 v_mfma_f32_16x16x32_bf16 v[16:19], a[24:27], v[76:79], v[16:19]
 buffer_load_dwordx4 a[68:71], v255, s[4:7], s49 offen sc1
 v_mfma_f32_16x16x32_bf16 v[20:23], a[28:31], v[76:79], v[20:23]
 ds_read_b64_tr_b16 v[100:101], v234 offset:20480
 ds_read_b64_tr_b16 v[102:103], v234 offset:22528
 v_mfma_f32_16x16x32_bf16 v[20:23], a[20:23], v[72:75], v[20:23]
 s_waitcnt lgkmcnt(8)
 v_mov_b32 v175, v171
 v_permlane16_swap_b32 v168, v172
 v_smfmac_f32_16x16x64_bf16 v[188:191], v[220:223], v[80:87], v160
 v_permlane16_swap_b32 v169, v173
 v_mfma_f32_16x16x32_bf16 v[24:27], a[16:19], v[80:83], v[24:27]
 ds_read_b64_tr_b16 v[104:105], v235 offset:16384
 ds_read_b64_tr_b16 v[106:107], v235 offset:18432
 v_mfma_f32_16x16x32_bf16 v[24:27], a[24:27], v[84:87], v[24:27]
 buffer_load_dwordx4 a[72:75], v255, s[4:7], s48 offen offset:1024 sc1
 v_mfma_f32_16x16x32_bf16 v[28:31], a[28:31], v[84:87], v[28:31]
 ds_read_b64_tr_b16 v[108:109], v235 offset:20480
 ds_read_b64_tr_b16 v[110:111], v235 offset:22528
 v_mfma_f32_16x16x32_bf16 v[28:31], a[20:23], v[80:83], v[28:31]
 s_waitcnt lgkmcnt(8)
 v_permlane16_swap_b32 v170, v174
 v_permlane16_swap_b32 v171, v175
 v_smfmac_f32_16x16x64_bf16 v[152:155], v[220:223], v[88:95], v160
 v_add_f32 v168, v168, v172
 v_mfma_f32_16x16x32_bf16 v[32:35], v[88:91], a[16:19], v[32:35]
 ds_read_b64_tr_b16 v[64:65], v236 offset:16384
 ds_read_b64_tr_b16 v[66:67], v236 offset:18432
 v_mfma_f32_16x16x32_bf16 v[32:35], v[92:95], a[24:27], v[32:35]
 buffer_load_dwordx4 a[76:79], v255, s[4:7], s49 offen offset:1024 sc1
 v_mfma_f32_16x16x32_bf16 v[36:39], v[92:95], a[28:31], v[36:39]
 ds_read_b64_tr_b16 v[68:69], v236 offset:20480
 ds_read_b64_tr_b16 v[70:71], v236 offset:22528
 v_mfma_f32_16x16x32_bf16 v[36:39], v[88:91], a[20:23], v[36:39]
 s_waitcnt lgkmcnt(8)
 v_add_f32 v169, v169, v173
 v_add_f32 v170, v170, v174
 v_smfmac_f32_16x16x64_bf16 v[176:179], v[220:223], v[96:103], v160
 s_waitcnt vmcnt(11)
 v_add_f32 v171, v171, v175
 v_mfma_f32_16x16x32_bf16 v[0:3], a[32:35], v[96:99], v[0:3]
 s_waitcnt vmcnt(9)
 ds_read_b64_tr_b16 v[72:73], v237 offset:16384
 ds_read_b64_tr_b16 v[74:75], v237 offset:18432
 v_mfma_f32_16x16x32_bf16 v[0:3], a[40:43], v[100:103], v[0:3]
 s_waitcnt vmcnt(8)
 buffer_load_dwordx4 a[80:83], v255, s[4:7], s48 offen offset:2048 sc1
 v_mfma_f32_16x16x32_bf16 v[4:7], a[44:47], v[100:103], v[4:7]
 ds_read_b64_tr_b16 v[76:77], v237 offset:20480
 ds_read_b64_tr_b16 v[78:79], v237 offset:22528
 v_mfma_f32_16x16x32_bf16 v[4:7], a[36:39], v[96:99], v[4:7]
 s_waitcnt lgkmcnt(8)
 v_mov_b32 v172, v168
 v_mov_b32 v173, v169
 v_smfmac_f32_16x16x64_bf16 v[180:183], v[220:223], v[104:111], v160
 v_mov_b32 v174, v170
 v_mfma_f32_16x16x32_bf16 v[8:11], a[32:35], v[104:107], v[8:11]
 ds_read_b64_tr_b16 v[80:81], v238 offset:16384
 ds_read_b64_tr_b16 v[82:83], v238 offset:18432
 v_mfma_f32_16x16x32_bf16 v[8:11], a[40:43], v[108:111], v[8:11]
 buffer_load_dwordx4 a[84:87], v255, s[4:7], s49 offen offset:2048 sc1
 v_mfma_f32_16x16x32_bf16 v[12:15], a[44:47], v[108:111], v[12:15]
 ds_read_b64_tr_b16 v[84:85], v238 offset:20480
 ds_read_b64_tr_b16 v[86:87], v238 offset:22528
 v_mfma_f32_16x16x32_bf16 v[12:15], a[36:39], v[104:107], v[12:15]
 s_waitcnt lgkmcnt(8)
 v_mov_b32 v175, v171
 v_permlane32_swap_b32 v168, v172
 v_smfmac_f32_16x16x64_bf16 v[184:187], v[220:223], v[64:71], v160
 s_mov_b32 s12, s82
 v_permlane32_swap_b32 v169, v173
 v_mfma_f32_16x16x32_bf16 v[16:19], a[32:35], v[64:67], v[16:19]
 s_mov_b32 s13, s83
 ds_read_b64_tr_b16 v[88:89], v234 offset:24576
 ds_read_b64_tr_b16 v[90:91], v234 offset:26624
 v_mfma_f32_16x16x32_bf16 v[16:19], a[40:43], v[68:71], v[16:19]
 s_mov_b32 s14, 4096
 buffer_load_dwordx4 a[88:91], v255, s[4:7], s48 offen offset:3072 sc1
 v_mfma_f32_16x16x32_bf16 v[20:23], a[44:47], v[68:71], v[20:23]
 s_add_u32 s48, s48, 4096
 ds_read_b64_tr_b16 v[92:93], v234 offset:28672
 ds_read_b64_tr_b16 v[94:95], v234 offset:30720
 v_mfma_f32_16x16x32_bf16 v[20:23], a[36:39], v[64:67], v[20:23]
 s_waitcnt lgkmcnt(8)
 v_permlane32_swap_b32 v170, v174
 v_permlane32_swap_b32 v171, v175
 v_smfmac_f32_16x16x64_bf16 v[188:191], v[220:223], v[72:79], v160
 v_add_f32 v168, v168, v172
 v_mfma_f32_16x16x32_bf16 v[24:27], a[32:35], v[72:75], v[24:27]
 ds_read_b64_tr_b16 v[96:97], v235 offset:24576
 ds_read_b64_tr_b16 v[98:99], v235 offset:26624
 v_mfma_f32_16x16x32_bf16 v[24:27], a[40:43], v[76:79], v[24:27]
 buffer_load_dwordx4 a[92:95], v255, s[4:7], s49 offen offset:3072 sc1
 v_mfma_f32_16x16x32_bf16 v[28:31], a[44:47], v[76:79], v[28:31]
 s_add_u32 s49, s49, 4096
 ds_read_b64_tr_b16 v[100:101], v235 offset:28672
 ds_read_b64_tr_b16 v[102:103], v235 offset:30720
 v_mfma_f32_16x16x32_bf16 v[28:31], a[36:39], v[72:75], v[28:31]
 s_waitcnt lgkmcnt(8)
 v_add_f32 v169, v169, v173
 v_add_f32 v170, v170, v174
 v_smfmac_f32_16x16x64_bf16 v[152:155], v[220:223], v[80:87], v160
 v_add_f32 v171, v171, v175
 v_mfma_f32_16x16x32_bf16 v[32:35], v[80:83], a[32:35], v[32:35]
 ds_read_b64_tr_b16 v[104:105], v236 offset:24576
 ds_read_b64_tr_b16 v[106:107], v236 offset:26624
 v_mfma_f32_16x16x32_bf16 v[32:35], v[84:87], a[40:43], v[32:35]
 buffer_load_dwordx4 a[96:99], v255, s[4:7], s48 offen sc1
 v_mfma_f32_16x16x32_bf16 v[36:39], v[84:87], a[44:47], v[36:39]
 ds_read_b64_tr_b16 v[108:109], v236 offset:28672
 ds_read_b64_tr_b16 v[110:111], v236 offset:30720
 v_mfma_f32_16x16x32_bf16 v[36:39], v[80:83], a[36:39], v[36:39]
 s_waitcnt lgkmcnt(8)
 v_mul_f32 v168, 0x3b000000, v168
 v_mul_f32 v170, 0x3b000000, v170
 v_smfmac_f32_16x16x64_bf16 v[176:179], v[220:223], v[88:95], v160
 s_waitcnt vmcnt(12)
 v_mul_f32 v169, 0x3b000000, v169
 v_mfma_f32_16x16x32_bf16 v[0:3], a[48:51], v[88:91], v[0:3]
 s_waitcnt vmcnt(10)
 ds_read_b64_tr_b16 v[64:65], v237 offset:24576
 ds_read_b64_tr_b16 v[66:67], v237 offset:26624
 v_mfma_f32_16x16x32_bf16 v[0:3], a[56:59], v[92:95], v[0:3]
 s_waitcnt vmcnt(9)
 buffer_load_dwordx4 a[100:103], v255, s[4:7], s49 offen sc1
 v_mfma_f32_16x16x32_bf16 v[4:7], a[60:63], v[92:95], v[4:7]
 ds_read_b64_tr_b16 v[68:69], v237 offset:28672
 ds_read_b64_tr_b16 v[70:71], v237 offset:30720
 v_mfma_f32_16x16x32_bf16 v[4:7], a[52:55], v[88:91], v[4:7]
 s_waitcnt lgkmcnt(8)
 v_mul_f32 v171, 0x3b000000, v171
 v_fma_f32 v169, -v168, v168, v169
 v_smfmac_f32_16x16x64_bf16 v[180:183], v[220:223], v[96:103], v160
 v_fma_f32 v171, -v170, v170, v171
 v_mfma_f32_16x16x32_bf16 v[8:11], a[48:51], v[96:99], v[8:11]
 ds_read_b64_tr_b16 v[72:73], v238 offset:24576
 ds_read_b64_tr_b16 v[74:75], v238 offset:26624
 v_mfma_f32_16x16x32_bf16 v[8:11], a[56:59], v[100:103], v[8:11]
 buffer_load_dwordx4 a[104:107], v255, s[4:7], s48 offen offset:1024 sc1
 v_mfma_f32_16x16x32_bf16 v[12:15], a[60:63], v[100:103], v[12:15]
 ds_read_b64_tr_b16 v[76:77], v238 offset:28672
 ds_read_b64_tr_b16 v[78:79], v238 offset:30720
 v_mfma_f32_16x16x32_bf16 v[12:15], a[52:55], v[96:99], v[12:15]
 s_waitcnt lgkmcnt(8)
 v_max_f32 v169, 0, v169
 v_max_f32 v171, 0, v171
 v_smfmac_f32_16x16x64_bf16 v[184:187], v[220:223], v[104:111], v160
 v_add_f32 v169, 0x3727c5ac, v169
 v_mfma_f32_16x16x32_bf16 v[16:19], a[48:51], v[104:107], v[16:19]
 ds_read_b64_tr_b16 v[80:81], v234 offset:32768
 ds_read_b64_tr_b16 v[82:83], v234 offset:34816
 v_mfma_f32_16x16x32_bf16 v[16:19], a[56:59], v[108:111], v[16:19]
 buffer_load_dwordx4 a[108:111], v255, s[4:7], s49 offen offset:1024 sc1
 v_mfma_f32_16x16x32_bf16 v[20:23], a[60:63], v[108:111], v[20:23]
 ds_read_b64_tr_b16 v[84:85], v234 offset:36864
 ds_read_b64_tr_b16 v[86:87], v234 offset:38912
 v_mfma_f32_16x16x32_bf16 v[20:23], a[52:55], v[104:107], v[20:23]
 s_waitcnt lgkmcnt(8)
 v_add_f32 v171, 0x3727c5ac, v171
 v_smfmac_f32_16x16x64_bf16 v[188:191], v[220:223], v[64:71], v160
 v_mfma_f32_16x16x32_bf16 v[24:27], a[48:51], v[64:67], v[24:27]
 ds_read_b64_tr_b16 v[88:89], v235 offset:32768
 ds_read_b64_tr_b16 v[90:91], v235 offset:34816
 v_mfma_f32_16x16x32_bf16 v[24:27], a[56:59], v[68:71], v[24:27]
 buffer_load_dwordx4 a[112:115], v255, s[4:7], s48 offen offset:2048 sc1
 v_mfma_f32_16x16x32_bf16 v[28:31], a[60:63], v[68:71], v[28:31]
 ds_read_b64_tr_b16 v[92:93], v235 offset:36864
 ds_read_b64_tr_b16 v[94:95], v235 offset:38912
 v_mfma_f32_16x16x32_bf16 v[28:31], a[52:55], v[64:67], v[28:31]
 s_waitcnt lgkmcnt(8)
 v_rsq_f32 v196, v169
 v_smfmac_f32_16x16x64_bf16 v[152:155], v[220:223], v[72:79], v160
 v_mfma_f32_16x16x32_bf16 v[32:35], v[72:75], a[48:51], v[32:35]
 ds_read_b64_tr_b16 v[96:97], v236 offset:32768
 ds_read_b64_tr_b16 v[98:99], v236 offset:34816
 v_mfma_f32_16x16x32_bf16 v[32:35], v[76:79], a[56:59], v[32:35]
 buffer_load_dwordx4 a[116:119], v255, s[4:7], s49 offen offset:2048 sc1
 v_mfma_f32_16x16x32_bf16 v[36:39], v[76:79], a[60:63], v[36:39]
 ds_read_b64_tr_b16 v[100:101], v236 offset:36864
 ds_read_b64_tr_b16 v[102:103], v236 offset:38912
 v_mfma_f32_16x16x32_bf16 v[36:39], v[72:75], a[52:55], v[36:39]
 s_waitcnt lgkmcnt(8)
 v_rsq_f32 v197, v171
 v_smfmac_f32_16x16x64_bf16 v[176:179], v[220:223], v[80:87], v160
 s_waitcnt vmcnt(13)
 v_mul_f32_e64 v198, -v168, v196
 v_mfma_f32_16x16x32_bf16 v[0:3], a[64:67], v[80:83], v[0:3]
 s_waitcnt vmcnt(11)
 ds_read_b64_tr_b16 v[104:105], v237 offset:32768
 ds_read_b64_tr_b16 v[106:107], v237 offset:34816
 v_mfma_f32_16x16x32_bf16 v[0:3], a[72:75], v[84:87], v[0:3]
 s_waitcnt vmcnt(10)
 buffer_load_dwordx4 a[120:123], v255, s[4:7], s48 offen offset:3072 sc1
 v_mfma_f32_16x16x32_bf16 v[4:7], a[76:79], v[84:87], v[4:7]
 s_add_u32 s48, s48, 4096
 ds_read_b64_tr_b16 v[108:109], v237 offset:36864
 ds_read_b64_tr_b16 v[110:111], v237 offset:38912
 v_mfma_f32_16x16x32_bf16 v[4:7], a[68:71], v[80:83], v[4:7]
 s_waitcnt lgkmcnt(8)
 v_mul_f32_e64 v199, -v170, v197
 v_smfmac_f32_16x16x64_bf16 v[180:183], v[220:223], v[88:95], v160
 ds_bpermute_b32 v208, v243, v198 offset:0
 v_mfma_f32_16x16x32_bf16 v[8:11], a[64:67], v[88:91], v[8:11]
 ds_read_b64_tr_b16 v[64:65], v238 offset:32768
 ds_read_b64_tr_b16 v[66:67], v238 offset:34816
 v_mfma_f32_16x16x32_bf16 v[8:11], a[72:75], v[92:95], v[8:11]
 buffer_load_dwordx4 a[124:127], v255, s[4:7], s49 offen offset:3072 sc1
 v_mfma_f32_16x16x32_bf16 v[12:15], a[76:79], v[92:95], v[12:15]
 s_add_u32 s49, s49, 4096
 ds_read_b64_tr_b16 v[68:69], v238 offset:36864
 ds_read_b64_tr_b16 v[70:71], v238 offset:38912
 v_mfma_f32_16x16x32_bf16 v[12:15], a[68:71], v[88:91], v[12:15]
 s_waitcnt lgkmcnt(9)
 ds_bpermute_b32 v200, v243, v196 offset:0
 ds_bpermute_b32 v209, v243, v198 offset:4
 v_smfmac_f32_16x16x64_bf16 v[184:187], v[220:223], v[96:103], v160
 ds_bpermute_b32 v201, v243, v196 offset:4
 v_mfma_f32_16x16x32_bf16 v[16:19], a[64:67], v[96:99], v[16:19]
 ds_read_b64_tr_b16 v[72:73], v234 offset:40960
 ds_read_b64_tr_b16 v[74:75], v234 offset:43008
 v_mfma_f32_16x16x32_bf16 v[16:19], a[72:75], v[100:103], v[16:19]
 v_mfma_f32_16x16x32_bf16 v[20:23], a[76:79], v[100:103], v[20:23]
 ds_read_b64_tr_b16 v[76:77], v234 offset:45056
 ds_read_b64_tr_b16 v[78:79], v234 offset:47104
 v_mfma_f32_16x16x32_bf16 v[20:23], a[68:71], v[96:99], v[20:23]
 s_waitcnt lgkmcnt(12)
 ds_bpermute_b32 v210, v243, v198 offset:8
 ds_bpermute_b32 v202, v243, v196 offset:8
 v_smfmac_f32_16x16x64_bf16 v[188:191], v[220:223], v[104:111], v160
 ds_bpermute_b32 v211, v243, v198 offset:12
 v_mfma_f32_16x16x32_bf16 v[24:27], a[64:67], v[104:107], v[24:27]
 ds_read_b64_tr_b16 v[80:81], v235 offset:40960
 ds_read_b64_tr_b16 v[82:83], v235 offset:43008
 v_mfma_f32_16x16x32_bf16 v[24:27], a[72:75], v[108:111], v[24:27]
 v_mfma_f32_16x16x32_bf16 v[28:31], a[76:79], v[108:111], v[28:31]
 ds_read_b64_tr_b16 v[84:85], v235 offset:45056
 ds_read_b64_tr_b16 v[86:87], v235 offset:47104
 v_mfma_f32_16x16x32_bf16 v[28:31], a[68:71], v[104:107], v[28:31]
 s_waitcnt lgkmcnt(14)
 ds_bpermute_b32 v203, v243, v196 offset:12
 ds_bpermute_b32 v212, v243, v199 offset:0
 v_smfmac_f32_16x16x64_bf16 v[152:155], v[220:223], v[64:71], v160
 ds_bpermute_b32 v204, v243, v197 offset:0
 v_mfma_f32_16x16x32_bf16 v[32:35], v[64:67], a[64:67], v[32:35]
 ds_read_b64_tr_b16 v[88:89], v236 offset:40960
 ds_read_b64_tr_b16 v[90:91], v236 offset:43008
 v_mfma_f32_16x16x32_bf16 v[32:35], v[68:71], a[72:75], v[32:35]
 v_mfma_f32_16x16x32_bf16 v[36:39], v[68:71], a[76:79], v[36:39]
 ds_read_b64_tr_b16 v[92:93], v236 offset:45056
 ds_read_b64_tr_b16 v[94:95], v236 offset:47104
 v_mfma_f32_16x16x32_bf16 v[36:39], v[64:67], a[68:71], v[36:39]
 s_waitcnt lgkmcnt(14)
 ds_bpermute_b32 v213, v243, v199 offset:4
 ds_bpermute_b32 v205, v243, v197 offset:4
 v_smfmac_f32_16x16x64_bf16 v[176:179], v[220:223], v[72:79], v160
 s_waitcnt vmcnt(11)
 ds_bpermute_b32 v214, v243, v199 offset:8
 v_mfma_f32_16x16x32_bf16 v[0:3], a[80:83], v[72:75], v[0:3]
 s_waitcnt vmcnt(9)
 ds_read_b64_tr_b16 v[96:97], v237 offset:40960
 ds_read_b64_tr_b16 v[98:99], v237 offset:43008
 v_mfma_f32_16x16x32_bf16 v[0:3], a[88:91], v[76:79], v[0:3]
 s_waitcnt vmcnt(8)
 v_mfma_f32_16x16x32_bf16 v[4:7], a[92:95], v[76:79], v[4:7]
 ds_read_b64_tr_b16 v[100:101], v237 offset:45056
 ds_read_b64_tr_b16 v[102:103], v237 offset:47104
 v_mfma_f32_16x16x32_bf16 v[4:7], a[84:87], v[72:75], v[4:7]
 s_waitcnt lgkmcnt(14)
 ds_bpermute_b32 v206, v243, v197 offset:8
 ds_bpermute_b32 v215, v243, v199 offset:12
 v_smfmac_f32_16x16x64_bf16 v[180:183], v[220:223], v[80:87], v160
 ds_bpermute_b32 v207, v243, v197 offset:12
 v_mfma_f32_16x16x32_bf16 v[8:11], a[80:83], v[80:83], v[8:11]
 ds_read_b64_tr_b16 v[104:105], v238 offset:40960
 ds_read_b64_tr_b16 v[106:107], v238 offset:43008
 v_mfma_f32_16x16x32_bf16 v[8:11], a[88:91], v[84:87], v[8:11]
 v_mfma_f32_16x16x32_bf16 v[12:15], a[92:95], v[84:87], v[12:15]
 ds_read_b64_tr_b16 v[108:109], v238 offset:45056
 ds_read_b64_tr_b16 v[110:111], v238 offset:47104
 v_mfma_f32_16x16x32_bf16 v[12:15], a[84:87], v[80:83], v[12:15]
 s_waitcnt lgkmcnt(14)
 v_smfmac_f32_16x16x64_bf16 v[184:187], v[220:223], v[88:95], v160
 v_mfma_f32_16x16x32_bf16 v[16:19], a[80:83], v[88:91], v[16:19]
 ds_read_b64_tr_b16 v[64:65], v234 offset:49152
 ds_read_b64_tr_b16 v[66:67], v234 offset:51200
 v_mfma_f32_16x16x32_bf16 v[16:19], a[88:91], v[92:95], v[16:19]
 v_mfma_f32_16x16x32_bf16 v[20:23], a[92:95], v[92:95], v[20:23]
 ds_read_b64_tr_b16 v[68:69], v234 offset:53248
 ds_read_b64_tr_b16 v[70:71], v234 offset:55296
 v_mfma_f32_16x16x32_bf16 v[20:23], a[84:87], v[88:91], v[20:23]
 s_waitcnt lgkmcnt(11)
 v_smfmac_f32_16x16x64_bf16 v[188:191], v[220:223], v[96:103], v160
 v_mfma_f32_16x16x32_bf16 v[24:27], a[80:83], v[96:99], v[24:27]
 ds_read_b64_tr_b16 v[72:73], v235 offset:49152
 ds_read_b64_tr_b16 v[74:75], v235 offset:51200
 v_mfma_f32_16x16x32_bf16 v[24:27], a[88:91], v[100:103], v[24:27]
 v_mfma_f32_16x16x32_bf16 v[28:31], a[92:95], v[100:103], v[28:31]
 ds_read_b64_tr_b16 v[76:77], v235 offset:53248
 ds_read_b64_tr_b16 v[78:79], v235 offset:55296
 v_mfma_f32_16x16x32_bf16 v[28:31], a[84:87], v[96:99], v[28:31]
 s_waitcnt lgkmcnt(8)
 v_smfmac_f32_16x16x64_bf16 v[152:155], v[220:223], v[104:111], v160
 v_mfma_f32_16x16x32_bf16 v[32:35], v[104:107], a[80:83], v[32:35]
 ds_read_b64_tr_b16 v[80:81], v236 offset:49152
 ds_read_b64_tr_b16 v[82:83], v236 offset:51200
 v_mfma_f32_16x16x32_bf16 v[32:35], v[108:111], a[88:91], v[32:35]
 v_mfma_f32_16x16x32_bf16 v[36:39], v[108:111], a[92:95], v[36:39]
 ds_read_b64_tr_b16 v[84:85], v236 offset:53248
 ds_read_b64_tr_b16 v[86:87], v236 offset:55296
 v_mfma_f32_16x16x32_bf16 v[36:39], v[104:107], a[84:87], v[36:39]
 s_waitcnt lgkmcnt(8)
 v_smfmac_f32_16x16x64_bf16 v[176:179], v[220:223], v[64:71], v160
 s_waitcnt vmcnt(7)
 v_mfma_f32_16x16x32_bf16 v[0:3], a[96:99], v[64:67], v[0:3]
 s_waitcnt vmcnt(5)
 ds_read_b64_tr_b16 v[88:89], v237 offset:49152
 ds_read_b64_tr_b16 v[90:91], v237 offset:51200
 v_mfma_f32_16x16x32_bf16 v[0:3], a[104:107], v[68:71], v[0:3]
 s_waitcnt vmcnt(4)
 v_mfma_f32_16x16x32_bf16 v[4:7], a[108:111], v[68:71], v[4:7]
 ds_read_b64_tr_b16 v[92:93], v237 offset:53248
 ds_read_b64_tr_b16 v[94:95], v237 offset:55296
 v_mfma_f32_16x16x32_bf16 v[4:7], a[100:103], v[64:67], v[4:7]
 s_waitcnt lgkmcnt(8)
 v_smfmac_f32_16x16x64_bf16 v[180:183], v[220:223], v[72:79], v160
 v_mfma_f32_16x16x32_bf16 v[8:11], a[96:99], v[72:75], v[8:11]
 ds_read_b64_tr_b16 v[96:97], v238 offset:49152
 ds_read_b64_tr_b16 v[98:99], v238 offset:51200
 v_mfma_f32_16x16x32_bf16 v[8:11], a[104:107], v[76:79], v[8:11]
 v_mfma_f32_16x16x32_bf16 v[12:15], a[108:111], v[76:79], v[12:15]
 ds_read_b64_tr_b16 v[100:101], v238 offset:53248
 ds_read_b64_tr_b16 v[102:103], v238 offset:55296
 v_mfma_f32_16x16x32_bf16 v[12:15], a[100:103], v[72:75], v[12:15]
 s_waitcnt lgkmcnt(8)
 v_smfmac_f32_16x16x64_bf16 v[184:187], v[220:223], v[80:87], v160
 v_mfma_f32_16x16x32_bf16 v[16:19], a[96:99], v[80:83], v[16:19]
 ds_read_b64_tr_b16 v[104:105], v234 offset:57344
 ds_read_b64_tr_b16 v[106:107], v234 offset:59392
 v_mfma_f32_16x16x32_bf16 v[16:19], a[104:107], v[84:87], v[16:19]
 v_mfma_f32_16x16x32_bf16 v[20:23], a[108:111], v[84:87], v[20:23]
 ds_read_b64_tr_b16 v[108:109], v234 offset:61440
 ds_read_b64_tr_b16 v[110:111], v234 offset:63488
 v_mfma_f32_16x16x32_bf16 v[20:23], a[100:103], v[80:83], v[20:23]
 s_waitcnt lgkmcnt(8)
 v_smfmac_f32_16x16x64_bf16 v[188:191], v[220:223], v[88:95], v160
 v_mfma_f32_16x16x32_bf16 v[24:27], a[96:99], v[88:91], v[24:27]
 ds_read_b64_tr_b16 v[64:65], v235 offset:57344
 ds_read_b64_tr_b16 v[66:67], v235 offset:59392
 v_mfma_f32_16x16x32_bf16 v[24:27], a[104:107], v[92:95], v[24:27]
 v_mfma_f32_16x16x32_bf16 v[28:31], a[108:111], v[92:95], v[28:31]
 ds_read_b64_tr_b16 v[68:69], v235 offset:61440
 ds_read_b64_tr_b16 v[70:71], v235 offset:63488
 v_mfma_f32_16x16x32_bf16 v[28:31], a[100:103], v[88:91], v[28:31]
 s_waitcnt lgkmcnt(8)
 v_smfmac_f32_16x16x64_bf16 v[152:155], v[220:223], v[96:103], v160
 v_mfma_f32_16x16x32_bf16 v[32:35], v[96:99], a[96:99], v[32:35]
 ds_read_b64_tr_b16 v[72:73], v236 offset:57344
 ds_read_b64_tr_b16 v[74:75], v236 offset:59392
 v_mfma_f32_16x16x32_bf16 v[32:35], v[100:103], a[104:107], v[32:35]
Lw2_4:
 s_cbranch_execz Lw2_8
 v_mfma_f32_16x16x32_bf16 v[36:39], v[100:103], a[108:111], v[36:39]
 ds_read_b64_tr_b16 v[76:77], v236 offset:61440
 ds_read_b64_tr_b16 v[78:79], v236 offset:63488
 v_mfma_f32_16x16x32_bf16 v[36:39], v[96:99], a[100:103], v[36:39]
 s_waitcnt lgkmcnt(8)
 v_smfmac_f32_16x16x64_bf16 v[176:179], v[220:223], v[104:111], v160
 s_waitcnt vmcnt(3)
 v_mfma_f32_16x16x32_bf16 v[0:3], a[112:115], v[104:107], v[0:3]
 s_waitcnt vmcnt(1)
 ds_read_b64_tr_b16 v[80:81], v237 offset:57344
 ds_read_b64_tr_b16 v[82:83], v237 offset:59392
 v_mfma_f32_16x16x32_bf16 v[0:3], a[120:123], v[108:111], v[0:3]
 s_waitcnt vmcnt(0)
 v_mfma_f32_16x16x32_bf16 v[4:7], a[124:127], v[108:111], v[4:7]
 ds_read_b64_tr_b16 v[84:85], v237 offset:61440
 ds_read_b64_tr_b16 v[86:87], v237 offset:63488
 v_mfma_f32_16x16x32_bf16 v[4:7], a[116:119], v[104:107], v[4:7]
 s_waitcnt lgkmcnt(8)
 v_smfmac_f32_16x16x64_bf16 v[180:183], v[220:223], v[64:71], v160
 v_mfma_f32_16x16x32_bf16 v[8:11], a[112:115], v[64:67], v[8:11]
 ds_read_b64_tr_b16 v[88:89], v238 offset:57344
 ds_read_b64_tr_b16 v[90:91], v238 offset:59392
 v_mfma_f32_16x16x32_bf16 v[8:11], a[120:123], v[68:71], v[8:11]
 v_mfma_f32_16x16x32_bf16 v[12:15], a[124:127], v[68:71], v[12:15]
 ds_read_b64_tr_b16 v[92:93], v238 offset:61440
 ds_read_b64_tr_b16 v[94:95], v238 offset:63488
 v_mfma_f32_16x16x32_bf16 v[12:15], a[116:119], v[64:67], v[12:15]
 s_waitcnt lgkmcnt(8)
 v_smfmac_f32_16x16x64_bf16 v[184:187], v[220:223], v[72:79], v160
 v_mfma_f32_16x16x32_bf16 v[16:19], a[112:115], v[72:75], v[16:19]
 ds_read_b64_tr_b16 v[96:97], v239 offset:0
 ds_read_b64_tr_b16 v[98:99], v239 offset:2048
 v_mfma_f32_16x16x32_bf16 v[16:19], a[120:123], v[76:79], v[16:19]
 buffer_load_ushort v136, v252, s[12:15], s55 offen
 v_mfma_f32_16x16x32_bf16 v[20:23], a[124:127], v[76:79], v[20:23]
 ds_read_b64_tr_b16 v[100:101], v239 offset:4096
 ds_read_b64_tr_b16 v[102:103], v239 offset:6144
 v_mfma_f32_16x16x32_bf16 v[20:23], a[116:119], v[72:75], v[20:23]
 s_waitcnt lgkmcnt(8)
 v_smfmac_f32_16x16x64_bf16 v[188:191], v[220:223], v[80:87], v160
 v_mfma_f32_16x16x32_bf16 v[24:27], a[112:115], v[80:83], v[24:27]
 ds_read_b64_tr_b16 v[104:105], v239 offset:8192
 ds_read_b64_tr_b16 v[106:107], v239 offset:10240
 v_mfma_f32_16x16x32_bf16 v[24:27], a[120:123], v[84:87], v[24:27]
 buffer_load_ushort v140, v252, s[12:15], s55 offen offset:8
 v_mfma_f32_16x16x32_bf16 v[28:31], a[124:127], v[84:87], v[28:31]
 s_barrier
 ds_read_b64_tr_b16 v[108:109], v239 offset:12288
 ds_read_b64_tr_b16 v[110:111], v239 offset:14336
 v_mfma_f32_16x16x32_bf16 v[28:31], a[116:119], v[80:83], v[28:31]
 s_waitcnt lgkmcnt(8)
 v_add_f32 v176, v176, v177
 s_add_u32 m0, s35, 0
 s_nop 0
 buffer_load_dwordx4 v228, s[8:11], s46 offen lds
 v_add_f32 v180, v180, v181
 v_add_f32 v184, v184, v185
 v_pk_mul_f32 v[128:129], v[208:209], v[176:177] op_sel_hi:[1,0]
 v_pk_mul_f32 v[130:131], v[210:211], v[176:177] op_sel_hi:[1,0]
 v_pk_fma_f32 v[0:1], v[0:1], v[200:201], v[128:129]
 v_pk_fma_f32 v[2:3], v[2:3], v[202:203], v[130:131]
 v_pk_mul_f32 v[128:129], v[0:1], v[0:1]
 v_pk_mul_f32 v[130:131], v[2:3], v[2:3]
 v_pk_fma_f32 v[128:129], v[128:129], v[162:163], v[162:163] op_sel:[0,0,1] op_sel_hi:[1,0,1]
 v_pk_fma_f32 v[130:131], v[130:131], v[162:163], v[162:163] op_sel:[0,0,1] op_sel_hi:[1,0,1]
 v_pk_mul_f32 v[128:129], v[128:129], v[0:1]
 buffer_load_dwordx4 v229, s[8:11], s46 offen offset:1024 lds
 v_pk_mul_f32 v[130:131], v[130:131], v[2:3]
 v_exp_f32 v128, v128
 v_exp_f32 v129, v129
 v_exp_f32 v130, v130
 v_exp_f32 v131, v131
 v_pk_add_f32 v[128:129], 1.0, v[128:129] op_sel_hi:[0,1]
 v_pk_add_f32 v[130:131], 1.0, v[130:131] op_sel_hi:[0,1]
 v_rcp_f32 v128, v128
 v_rcp_f32 v129, v129
 v_rcp_f32 v130, v130
 v_rcp_f32 v131, v131
 buffer_load_dwordx4 v230, s[8:11], s46 offen offset:2048 lds
 v_pk_mul_f32 v[0:1], v[0:1], v[128:129]
 v_pk_mul_f32 v[2:3], v[2:3], v[130:131]
 v_pk_mul_f32 v[114:115], v[0:1], v[0:1]
 v_pk_mul_f32 v[118:119], v[2:3], v[2:3]
 v_pk_mul_f32 v[132:133], v[212:213], v[176:177] op_sel_hi:[1,0]
 v_pk_mul_f32 v[134:135], v[214:215], v[176:177] op_sel_hi:[1,0]
 v_pk_fma_f32 v[4:5], v[4:5], v[204:205], v[132:133]
 v_pk_fma_f32 v[6:7], v[6:7], v[206:207], v[134:135]
 v_pk_mul_f32 v[132:133], v[4:5], v[4:5]
 v_pk_mul_f32 v[134:135], v[6:7], v[6:7]
 v_pk_fma_f32 v[132:133], v[132:133], v[162:163], v[162:163] op_sel:[0,0,1] op_sel_hi:[1,0,1]
 buffer_load_dwordx4 v231, s[8:11], s46 offen offset:3072 lds
 s_add_u32 s46, s46, 128
 v_pk_fma_f32 v[134:135], v[134:135], v[162:163], v[162:163] op_sel:[0,0,1] op_sel_hi:[1,0,1]
 v_pk_mul_f32 v[132:133], v[132:133], v[4:5]
 v_pk_mul_f32 v[134:135], v[134:135], v[6:7]
 v_exp_f32 v132, v132
 v_exp_f32 v133, v133
 v_exp_f32 v134, v134
 v_exp_f32 v135, v135
 v_pk_add_f32 v[132:133], 1.0, v[132:133] op_sel_hi:[0,1]
 v_pk_add_f32 v[134:135], 1.0, v[134:135] op_sel_hi:[0,1]
 v_rcp_f32 v132, v132
 v_rcp_f32 v133, v133
 s_add_u32 m0, s35, 4096
 s_nop 0
 buffer_load_dwordx4 v228, s[8:11], s46 offen lds
 v_rcp_f32 v134, v134
 v_rcp_f32 v135, v135
 v_pk_mul_f32 v[4:5], v[4:5], v[132:133]
 v_pk_mul_f32 v[6:7], v[6:7], v[134:135]
 v_pk_mul_f32 v[122:123], v[4:5], v[4:5]
 v_pk_mul_f32 v[126:127], v[6:7], v[6:7]
 v_add_f32 v188, v188, v189
 v_pk_mul_f32 v[128:129], v[208:209], v[180:181] op_sel_hi:[1,0]
 v_pk_mul_f32 v[130:131], v[210:211], v[180:181] op_sel_hi:[1,0]
 v_pk_fma_f32 v[8:9], v[8:9], v[200:201], v[128:129]
 v_pk_fma_f32 v[10:11], v[10:11], v[202:203], v[130:131]
 buffer_load_dwordx4 v229, s[8:11], s46 offen offset:1024 lds
 v_pk_mul_f32 v[128:129], v[8:9], v[8:9]
 v_pk_mul_f32 v[130:131], v[10:11], v[10:11]
 v_pk_fma_f32 v[128:129], v[128:129], v[162:163], v[162:163] op_sel:[0,0,1] op_sel_hi:[1,0,1]
 v_pk_fma_f32 v[130:131], v[130:131], v[162:163], v[162:163] op_sel:[0,0,1] op_sel_hi:[1,0,1]
 v_pk_mul_f32 v[128:129], v[128:129], v[8:9]
 v_pk_mul_f32 v[130:131], v[130:131], v[10:11]
 v_exp_f32 v128, v128
 v_exp_f32 v129, v129
 v_exp_f32 v130, v130
 v_exp_f32 v131, v131
 v_pk_add_f32 v[128:129], 1.0, v[128:129] op_sel_hi:[0,1]
 buffer_load_dwordx4 v230, s[8:11], s46 offen offset:2048 lds
 v_pk_add_f32 v[130:131], 1.0, v[130:131] op_sel_hi:[0,1]
 v_rcp_f32 v128, v128
 v_rcp_f32 v129, v129
 v_rcp_f32 v130, v130
 v_rcp_f32 v131, v131
 v_pk_mul_f32 v[8:9], v[8:9], v[128:129]
 v_pk_mul_f32 v[10:11], v[10:11], v[130:131]
 v_pk_add_f32 v[112:113], v[0:1], v[8:9]
 v_pk_fma_f32 v[114:115], v[8:9], v[8:9], v[114:115]
 v_pk_add_f32 v[116:117], v[2:3], v[10:11]
 v_pk_fma_f32 v[118:119], v[10:11], v[10:11], v[118:119]
 buffer_load_dwordx4 v231, s[8:11], s46 offen offset:3072 lds
 s_add_u32 s46, s46, 128
 v_pk_mul_f32 v[132:133], v[212:213], v[180:181] op_sel_hi:[1,0]
 v_pk_mul_f32 v[134:135], v[214:215], v[180:181] op_sel_hi:[1,0]
 v_pk_fma_f32 v[12:13], v[12:13], v[204:205], v[132:133]
 v_pk_fma_f32 v[14:15], v[14:15], v[206:207], v[134:135]
 v_pk_mul_f32 v[132:133], v[12:13], v[12:13]
 v_pk_mul_f32 v[134:135], v[14:15], v[14:15]
 v_pk_fma_f32 v[132:133], v[132:133], v[162:163], v[162:163] op_sel:[0,0,1] op_sel_hi:[1,0,1]
 v_pk_fma_f32 v[134:135], v[134:135], v[162:163], v[162:163] op_sel:[0,0,1] op_sel_hi:[1,0,1]
 v_pk_mul_f32 v[132:133], v[132:133], v[12:13]
 v_pk_mul_f32 v[134:135], v[134:135], v[14:15]
 v_exp_f32 v132, v132
 s_add_u32 m0, s32, 0
 s_nop 0
 buffer_load_dwordx4 v228, s[8:11], s46 offen lds
 v_exp_f32 v133, v133
 v_exp_f32 v134, v134
 v_exp_f32 v135, v135
 v_pk_add_f32 v[132:133], 1.0, v[132:133] op_sel_hi:[0,1]
 v_pk_add_f32 v[134:135], 1.0, v[134:135] op_sel_hi:[0,1]
 v_rcp_f32 v132, v132
 v_rcp_f32 v133, v133
 v_rcp_f32 v134, v134
 v_rcp_f32 v135, v135
 v_pk_mul_f32 v[12:13], v[12:13], v[132:133]
 v_pk_mul_f32 v[14:15], v[14:15], v[134:135]
 buffer_load_dwordx4 v229, s[8:11], s46 offen offset:1024 lds
 v_pk_add_f32 v[120:121], v[4:5], v[12:13]
 v_pk_fma_f32 v[122:123], v[12:13], v[12:13], v[122:123]
 v_pk_add_f32 v[124:125], v[6:7], v[14:15]
 v_pk_fma_f32 v[126:127], v[14:15], v[14:15], v[126:127]
 v_pk_mul_f32 v[128:129], v[208:209], v[184:185] op_sel_hi:[1,0]
 v_pk_mul_f32 v[130:131], v[210:211], v[184:185] op_sel_hi:[1,0]
 v_pk_fma_f32 v[16:17], v[16:17], v[200:201], v[128:129]
 v_pk_fma_f32 v[18:19], v[18:19], v[202:203], v[130:131]
 v_pk_mul_f32 v[128:129], v[16:17], v[16:17]
 v_pk_mul_f32 v[130:131], v[18:19], v[18:19]
 v_pk_fma_f32 v[128:129], v[128:129], v[162:163], v[162:163] op_sel:[0,0,1] op_sel_hi:[1,0,1]
 buffer_load_dwordx4 v230, s[8:11], s46 offen offset:2048 lds
 v_pk_fma_f32 v[130:131], v[130:131], v[162:163], v[162:163] op_sel:[0,0,1] op_sel_hi:[1,0,1]
 v_pk_mul_f32 v[128:129], v[128:129], v[16:17]
 v_pk_mul_f32 v[130:131], v[130:131], v[18:19]
 v_exp_f32 v128, v128
 v_exp_f32 v129, v129
 v_exp_f32 v130, v130
 v_exp_f32 v131, v131
 v_pk_add_f32 v[128:129], 1.0, v[128:129] op_sel_hi:[0,1]
 v_pk_add_f32 v[130:131], 1.0, v[130:131] op_sel_hi:[0,1]
 v_rcp_f32 v128, v128
 v_rcp_f32 v129, v129
 buffer_load_dwordx4 v231, s[8:11], s46 offen offset:3072 lds
 s_add_u32 s46, s46, 128
 v_rcp_f32 v130, v130
 v_rcp_f32 v131, v131
 v_pk_mul_f32 v[16:17], v[16:17], v[128:129]
 v_pk_mul_f32 v[18:19], v[18:19], v[130:131]
 v_pk_add_f32 v[112:113], v[112:113], v[16:17]
 v_pk_fma_f32 v[114:115], v[16:17], v[16:17], v[114:115]
 v_pk_add_f32 v[116:117], v[116:117], v[18:19]
 v_pk_fma_f32 v[118:119], v[18:19], v[18:19], v[118:119]
 v_pk_mul_f32 v[132:133], v[212:213], v[184:185] op_sel_hi:[1,0]
 v_pk_mul_f32 v[134:135], v[214:215], v[184:185] op_sel_hi:[1,0]
 v_pk_fma_f32 v[20:21], v[20:21], v[204:205], v[132:133]
 s_add_u32 m0, s32, 4096
 s_nop 0
 buffer_load_dwordx4 v228, s[8:11], s46 offen lds
 v_pk_fma_f32 v[22:23], v[22:23], v[206:207], v[134:135]
 v_pk_mul_f32 v[132:133], v[20:21], v[20:21]
 v_pk_mul_f32 v[134:135], v[22:23], v[22:23]
 v_pk_fma_f32 v[132:133], v[132:133], v[162:163], v[162:163] op_sel:[0,0,1] op_sel_hi:[1,0,1]
 v_pk_fma_f32 v[134:135], v[134:135], v[162:163], v[162:163] op_sel:[0,0,1] op_sel_hi:[1,0,1]
 v_pk_mul_f32 v[132:133], v[132:133], v[20:21]
 v_pk_mul_f32 v[134:135], v[134:135], v[22:23]
 v_exp_f32 v132, v132
 v_exp_f32 v133, v133
 v_exp_f32 v134, v134
 v_exp_f32 v135, v135
 buffer_load_dwordx4 v229, s[8:11], s46 offen offset:1024 lds
 v_pk_add_f32 v[132:133], 1.0, v[132:133] op_sel_hi:[0,1]
 v_pk_add_f32 v[134:135], 1.0, v[134:135] op_sel_hi:[0,1]
 v_rcp_f32 v132, v132
 v_rcp_f32 v133, v133
 v_rcp_f32 v134, v134
 v_rcp_f32 v135, v135
 v_pk_mul_f32 v[20:21], v[20:21], v[132:133]
 v_pk_mul_f32 v[22:23], v[22:23], v[134:135]
 v_pk_add_f32 v[120:121], v[120:121], v[20:21]
 v_pk_fma_f32 v[122:123], v[20:21], v[20:21], v[122:123]
 v_pk_add_f32 v[124:125], v[124:125], v[22:23]
 buffer_load_dwordx4 v230, s[8:11], s46 offen offset:2048 lds
 v_pk_fma_f32 v[126:127], v[22:23], v[22:23], v[126:127]
 v_pk_mul_f32 v[128:129], v[208:209], v[188:189] op_sel_hi:[1,0]
 v_pk_mul_f32 v[130:131], v[210:211], v[188:189] op_sel_hi:[1,0]
 v_pk_fma_f32 v[24:25], v[24:25], v[200:201], v[128:129]
 v_pk_fma_f32 v[26:27], v[26:27], v[202:203], v[130:131]
 v_pk_mul_f32 v[128:129], v[24:25], v[24:25]
 v_pk_mul_f32 v[130:131], v[26:27], v[26:27]
 v_pk_fma_f32 v[128:129], v[128:129], v[162:163], v[162:163] op_sel:[0,0,1] op_sel_hi:[1,0,1]
 v_pk_fma_f32 v[130:131], v[130:131], v[162:163], v[162:163] op_sel:[0,0,1] op_sel_hi:[1,0,1]
 v_pk_mul_f32 v[128:129], v[128:129], v[24:25]
 v_pk_mul_f32 v[130:131], v[130:131], v[26:27]
 buffer_load_dwordx4 v231, s[8:11], s46 offen offset:3072 lds
 s_add_u32 s46, s46, 128
 v_exp_f32 v128, v128
 v_exp_f32 v129, v129
 v_exp_f32 v130, v130
 v_exp_f32 v131, v131
 v_pk_add_f32 v[128:129], 1.0, v[128:129] op_sel_hi:[0,1]
 v_pk_add_f32 v[130:131], 1.0, v[130:131] op_sel_hi:[0,1]
 v_rcp_f32 v128, v128
 v_rcp_f32 v129, v129
 v_rcp_f32 v130, v130
 v_rcp_f32 v131, v131
 v_pk_mul_f32 v[24:25], v[24:25], v[128:129]
 v_pk_mul_f32 v[26:27], v[26:27], v[130:131]
 v_pk_add_f32 v[112:113], v[112:113], v[24:25]
 v_pk_fma_f32 v[114:115], v[24:25], v[24:25], v[114:115]
 v_pk_add_f32 v[116:117], v[116:117], v[26:27]
 v_pk_fma_f32 v[118:119], v[26:27], v[26:27], v[118:119]
 v_pk_mul_f32 v[132:133], v[212:213], v[188:189] op_sel_hi:[1,0]
 v_pk_mul_f32 v[134:135], v[214:215], v[188:189] op_sel_hi:[1,0]
 v_pk_fma_f32 v[28:29], v[28:29], v[204:205], v[132:133]
 v_pk_fma_f32 v[30:31], v[30:31], v[206:207], v[134:135]
 v_pk_mul_f32 v[132:133], v[28:29], v[28:29]
 v_pk_mul_f32 v[134:135], v[30:31], v[30:31]
 v_pk_fma_f32 v[132:133], v[132:133], v[162:163], v[162:163] op_sel:[0,0,1] op_sel_hi:[1,0,1]
 v_pk_fma_f32 v[134:135], v[134:135], v[162:163], v[162:163] op_sel:[0,0,1] op_sel_hi:[1,0,1]
 v_pk_mul_f32 v[132:133], v[132:133], v[28:29]
 v_pk_mul_f32 v[134:135], v[134:135], v[30:31]
 v_exp_f32 v132, v132
 v_exp_f32 v133, v133
 v_exp_f32 v134, v134
 v_exp_f32 v135, v135
 v_pk_add_f32 v[132:133], 1.0, v[132:133] op_sel_hi:[0,1]
 v_pk_add_f32 v[134:135], 1.0, v[134:135] op_sel_hi:[0,1]
 v_rcp_f32 v132, v132
 v_rcp_f32 v133, v133
 v_rcp_f32 v134, v134
 v_rcp_f32 v135, v135
 v_pk_mul_f32 v[28:29], v[28:29], v[132:133]
 v_pk_mul_f32 v[30:31], v[30:31], v[134:135]
 v_pk_add_f32 v[120:121], v[120:121], v[28:29]
 v_pk_fma_f32 v[122:123], v[28:29], v[28:29], v[122:123]
 v_pk_add_f32 v[124:125], v[124:125], v[30:31]
 v_pk_fma_f32 v[126:127], v[30:31], v[30:31], v[126:127]
 v_add_f32_dpp v112, v112, v112 row_ror:8 row_mask:0xf bank_mask:0x3
 v_add_f32_dpp v113, v113, v113 row_ror:8 row_mask:0xf bank_mask:0x3
 v_add_f32_dpp v114, v114, v114 row_ror:8 row_mask:0xf bank_mask:0x3
 v_add_f32_dpp v115, v115, v115 row_ror:8 row_mask:0xf bank_mask:0x3
 v_add_f32_dpp v116, v116, v116 row_ror:8 row_mask:0xf bank_mask:0x3
 v_add_f32_dpp v117, v117, v117 row_ror:8 row_mask:0xf bank_mask:0x3
 v_add_f32_dpp v118, v118, v118 row_ror:8 row_mask:0xf bank_mask:0x3
 v_add_f32_dpp v119, v119, v119 row_ror:8 row_mask:0xf bank_mask:0x3
 v_add_f32_dpp v112, v120, v120 row_ror:8 row_mask:0xf bank_mask:0xc
 v_add_f32_dpp v113, v121, v121 row_ror:8 row_mask:0xf bank_mask:0xc
 v_add_f32_dpp v114, v122, v122 row_ror:8 row_mask:0xf bank_mask:0xc
 v_add_f32_dpp v115, v123, v123 row_ror:8 row_mask:0xf bank_mask:0xc
 v_add_f32_dpp v116, v124, v124 row_ror:8 row_mask:0xf bank_mask:0xc
 v_add_f32_dpp v117, v125, v125 row_ror:8 row_mask:0xf bank_mask:0xc
 v_add_f32_dpp v118, v126, v126 row_ror:8 row_mask:0xf bank_mask:0xc
 v_add_f32_dpp v119, v127, v127 row_ror:8 row_mask:0xf bank_mask:0xc
 v_add_f32_dpp v112, v112, v112 row_half_mirror row_mask:0xf bank_mask:0x5
 v_add_f32_dpp v113, v113, v113 row_half_mirror row_mask:0xf bank_mask:0x5
 v_add_f32_dpp v114, v114, v114 row_half_mirror row_mask:0xf bank_mask:0x5
 v_add_f32_dpp v115, v115, v115 row_half_mirror row_mask:0xf bank_mask:0x5
 v_add_f32_dpp v112, v116, v116 row_half_mirror row_mask:0xf bank_mask:0xa
 v_add_f32_dpp v113, v117, v117 row_half_mirror row_mask:0xf bank_mask:0xa
 v_add_f32_dpp v114, v118, v118 row_half_mirror row_mask:0xf bank_mask:0xa
 v_add_f32_dpp v115, v119, v119 row_half_mirror row_mask:0xf bank_mask:0xa
 v_add_f32_dpp v112, v112, v112 quad_perm:[2,3,0,1] row_mask:0xf bank_mask:0xf
 v_add_f32_dpp v113, v113, v113 quad_perm:[2,3,0,1] row_mask:0xf bank_mask:0xf
 v_add_f32_dpp v114, v114, v114 quad_perm:[2,3,0,1] row_mask:0xf bank_mask:0xf
 v_add_f32_dpp v115, v115, v115 quad_perm:[2,3,0,1] row_mask:0xf bank_mask:0xf
 v_add_f32_dpp v112, v112, v112 quad_perm:[1,0,3,2] row_mask:0xf bank_mask:0xf
 v_add_f32_dpp v113, v113, v113 quad_perm:[1,0,3,2] row_mask:0xf bank_mask:0xf
 v_add_f32_dpp v114, v114, v114 quad_perm:[1,0,3,2] row_mask:0xf bank_mask:0xf
 v_add_f32_dpp v115, v115, v115 quad_perm:[1,0,3,2] row_mask:0xf bank_mask:0xf
 v_min_u32 v112, -2, v112
 v_min_u32 v113, -2, v113
 v_min_u32 v114, -2, v114
 v_min_u32 v115, -2, v115
 s_lshl_b32 s23, s42, 8
 s_add_u32 s23, s23, s50
 buffer_store_dwordx4 v[112:115], v164, s[4:7], s23 offen sc1
 v_smfmac_f32_16x16x64_bf16 v[152:155], v[220:223], v[88:95], v160
 v_mfma_f32_16x16x32_bf16 v[32:35], v[88:91], a[112:115], v[32:35]
 s_add_u32 m0, s32, 8192
 ds_read_b64_tr_b16 v[64:65], v239 offset:16384
 ds_read_b64_tr_b16 v[66:67], v239 offset:18432
 v_mfma_f32_16x16x32_bf16 v[32:35], v[92:95], a[120:123], v[32:35]
 buffer_load_dwordx4 v228, s[8:11], s46 offen lds
 v_mfma_f32_16x16x32_bf16 v[36:39], v[92:95], a[124:127], v[36:39]
 ds_read_b64_tr_b16 v[68:69], v239 offset:20480
 ds_read_b64_tr_b16 v[70:71], v239 offset:22528
 v_mfma_f32_16x16x32_bf16 v[36:39], v[88:91], a[116:119], v[36:39]
 s_waitcnt vmcnt(14) lgkmcnt(8)
 ds_read_b128 a[128:131], v244 offset:0
 ds_read_b128 a[132:135], v244 offset:2048
 v_smfmac_f32_16x16x64_bf16 v[156:159], v[220:223], v[96:103], v160
 v_mfma_f32_16x16x32_bf16 v[40:43], v[96:99], a[0:3], 0
 ds_read_b64_tr_b16 v[72:73], v239 offset:24576
 ds_read_b64_tr_b16 v[74:75], v239 offset:26624
 v_mfma_f32_16x16x32_bf16 v[40:43], v[100:103], a[8:11], v[40:43]
 buffer_load_dwordx4 v229, s[8:11], s46 offen offset:1024 lds
 v_mfma_f32_16x16x32_bf16 v[44:47], v[100:103], a[12:15], 0
 ds_read_b64_tr_b16 v[76:77], v239 offset:28672
 ds_read_b64_tr_b16 v[78:79], v239 offset:30720
 v_mfma_f32_16x16x32_bf16 v[44:47], v[96:99], a[4:7], v[44:47]
 s_waitcnt lgkmcnt(10)
 ds_read_b128 a[136:139], v245 offset:0
 ds_read_b128 a[140:143], v245 offset:2048
 v_smfmac_f32_16x16x64_bf16 v[156:159], v[220:223], v[104:111], v160
 v_mfma_f32_16x16x32_bf16 v[40:43], v[104:107], a[16:19], v[40:43]
 ds_read_b64_tr_b16 v[80:81], v239 offset:32768
 ds_read_b64_tr_b16 v[82:83], v239 offset:34816
 v_mfma_f32_16x16x32_bf16 v[40:43], v[108:111], a[24:27], v[40:43]
 buffer_load_dwordx4 v230, s[8:11], s46 offen offset:2048 lds
 v_mfma_f32_16x16x32_bf16 v[44:47], v[108:111], a[28:31], v[44:47]
 ds_read_b64_tr_b16 v[84:85], v239 offset:36864
 ds_read_b64_tr_b16 v[86:87], v239 offset:38912
 v_mfma_f32_16x16x32_bf16 v[44:47], v[104:107], a[20:23], v[44:47]
 s_waitcnt vmcnt(12) lgkmcnt(12)
 ds_read_b128 a[144:147], v244 offset:4096
 ds_read_b128 a[148:151], v244 offset:6144
 v_smfmac_f32_16x16x64_bf16 v[156:159], v[220:223], v[64:71], v160
 v_mfma_f32_16x16x32_bf16 v[40:43], v[64:67], a[32:35], v[40:43]
 ds_read_b64_tr_b16 v[88:89], v239 offset:40960
 ds_read_b64_tr_b16 v[90:91], v239 offset:43008
 v_mfma_f32_16x16x32_bf16 v[40:43], v[68:71], a[40:43], v[40:43]
 buffer_load_dwordx4 v231, s[8:11], s46 offen offset:3072 lds
 v_mfma_f32_16x16x32_bf16 v[44:47], v[68:71], a[44:47], v[44:47]
 s_add_u32 s46, s46, 128
 ds_read_b64_tr_b16 v[92:93], v239 offset:45056
 ds_read_b64_tr_b16 v[94:95], v239 offset:47104
 v_mfma_f32_16x16x32_bf16 v[44:47], v[64:67], a[36:39], v[44:47]
 s_waitcnt lgkmcnt(12)
 ds_read_b128 a[152:155], v245 offset:4096
 ds_read_b128 a[156:159], v245 offset:6144
 v_smfmac_f32_16x16x64_bf16 v[156:159], v[220:223], v[72:79], v160
 v_mfma_f32_16x16x32_bf16 v[40:43], v[72:75], a[48:51], v[40:43]
 s_add_u32 m0, s32, 12288
 ds_read_b64_tr_b16 v[96:97], v239 offset:49152
 ds_read_b64_tr_b16 v[98:99], v239 offset:51200
 v_mfma_f32_16x16x32_bf16 v[40:43], v[76:79], a[56:59], v[40:43]
 buffer_load_dwordx4 v228, s[8:11], s46 offen lds
 v_mfma_f32_16x16x32_bf16 v[44:47], v[76:79], a[60:63], v[44:47]
 ds_read_b64_tr_b16 v[100:101], v239 offset:53248
 ds_read_b64_tr_b16 v[102:103], v239 offset:55296
 v_mfma_f32_16x16x32_bf16 v[44:47], v[72:75], a[52:55], v[44:47]
 s_waitcnt vmcnt(10) lgkmcnt(12)
 ds_read_b128 a[160:163], v246 offset:0
 ds_read_b128 a[164:167], v246 offset:2048
 v_smfmac_f32_16x16x64_bf16 v[156:159], v[220:223], v[80:87], v160
 v_mfma_f32_16x16x32_bf16 v[40:43], v[80:83], a[64:67], v[40:43]
 ds_read_b64_tr_b16 v[104:105], v239 offset:57344
 ds_read_b64_tr_b16 v[106:107], v239 offset:59392
 v_mfma_f32_16x16x32_bf16 v[40:43], v[84:87], a[72:75], v[40:43]
 buffer_load_dwordx4 v229, s[8:11], s46 offen offset:1024 lds
 v_mfma_f32_16x16x32_bf16 v[44:47], v[84:87], a[76:79], v[44:47]
 ds_read_b64_tr_b16 v[108:109], v239 offset:61440
 ds_read_b64_tr_b16 v[110:111], v239 offset:63488
 v_mfma_f32_16x16x32_bf16 v[44:47], v[80:83], a[68:71], v[44:47]
 s_waitcnt lgkmcnt(12)
 ds_read_b128 a[168:171], v247 offset:0
 ds_read_b128 a[172:175], v247 offset:2048
 v_smfmac_f32_16x16x64_bf16 v[156:159], v[220:223], v[88:95], v160
 v_mfma_f32_16x16x32_bf16 v[40:43], v[88:91], a[80:83], v[40:43]
 ds_read_b64_tr_b16 v[64:65], v240 offset:0
 ds_read_b64_tr_b16 v[66:67], v240 offset:2048
 v_mfma_f32_16x16x32_bf16 v[40:43], v[92:95], a[88:91], v[40:43]
 buffer_load_dwordx4 v230, s[8:11], s46 offen offset:2048 lds
 v_mfma_f32_16x16x32_bf16 v[44:47], v[92:95], a[92:95], v[44:47]
 ds_read_b64_tr_b16 v[68:69], v240 offset:4096
 ds_read_b64_tr_b16 v[70:71], v240 offset:6144
 v_mfma_f32_16x16x32_bf16 v[44:47], v[88:91], a[84:87], v[44:47]
 s_waitcnt vmcnt(8) lgkmcnt(12)
 ds_read_b128 a[176:179], v246 offset:4096
 ds_read_b128 a[180:183], v246 offset:6144
 v_smfmac_f32_16x16x64_bf16 v[156:159], v[220:223], v[96:103], v160
 v_mfma_f32_16x16x32_bf16 v[40:43], v[96:99], a[96:99], v[40:43]
 ds_read_b64_tr_b16 v[72:73], v240 offset:8192
 ds_read_b64_tr_b16 v[74:75], v240 offset:10240
 v_mfma_f32_16x16x32_bf16 v[40:43], v[100:103], a[104:107], v[40:43]
 buffer_load_dwordx4 v231, s[8:11], s46 offen offset:3072 lds
 v_mfma_f32_16x16x32_bf16 v[44:47], v[100:103], a[108:111], v[44:47]
 s_add_u32 s46, s46, 128
 ds_read_b64_tr_b16 v[76:77], v240 offset:12288
 ds_read_b64_tr_b16 v[78:79], v240 offset:14336
 v_mfma_f32_16x16x32_bf16 v[44:47], v[96:99], a[100:103], v[44:47]
 s_waitcnt lgkmcnt(12)
 ds_read_b128 a[184:187], v247 offset:4096
 ds_read_b128 a[188:191], v247 offset:6144
 v_smfmac_f32_16x16x64_bf16 v[156:159], v[220:223], v[104:111], v160
 v_mfma_f32_16x16x32_bf16 v[40:43], v[104:107], a[112:115], v[40:43]
 s_add_u32 m0, s35, 0
 ds_read_b64_tr_b16 v[80:81], v240 offset:16384
 ds_read_b64_tr_b16 v[82:83], v240 offset:18432
 v_mfma_f32_16x16x32_bf16 v[40:43], v[108:111], a[120:123], v[40:43]
 buffer_load_dwordx4 v228, s[8:11], s46 offen lds
 v_mfma_f32_16x16x32_bf16 v[44:47], v[108:111], a[124:127], v[44:47]
 ds_read_b64_tr_b16 v[84:85], v240 offset:20480
 ds_read_b64_tr_b16 v[86:87], v240 offset:22528
 v_mfma_f32_16x16x32_bf16 v[44:47], v[104:107], a[116:119], v[44:47]
 s_waitcnt lgkmcnt(12)
 v_smfmac_f32_16x16x64_bf16 v[192:195], v[220:223], v[64:71], v160
 v_mfma_f32_16x16x32_bf16 v[48:51], v[64:67], a[0:3], 0
 ds_read_b64_tr_b16 v[88:89], v240 offset:24576
 ds_read_b64_tr_b16 v[90:91], v240 offset:26624
 v_mfma_f32_16x16x32_bf16 v[48:51], v[68:71], a[8:11], v[48:51]
 buffer_load_dwordx4 v229, s[8:11], s46 offen offset:1024 lds
 v_mfma_f32_16x16x32_bf16 v[52:55], v[68:71], a[12:15], 0
 ds_read_b64_tr_b16 v[92:93], v240 offset:28672
 ds_read_b64_tr_b16 v[94:95], v240 offset:30720
 v_mfma_f32_16x16x32_bf16 v[52:55], v[64:67], a[4:7], v[52:55]
 s_waitcnt lgkmcnt(10)
 v_smfmac_f32_16x16x64_bf16 v[192:195], v[220:223], v[72:79], v160
 v_mfma_f32_16x16x32_bf16 v[48:51], v[72:75], a[16:19], v[48:51]
 ds_read_b64_tr_b16 v[96:97], v240 offset:32768
 ds_read_b64_tr_b16 v[98:99], v240 offset:34816
 v_mfma_f32_16x16x32_bf16 v[48:51], v[76:79], a[24:27], v[48:51]
 buffer_load_dwordx4 v230, s[8:11], s46 offen offset:2048 lds
 v_mfma_f32_16x16x32_bf16 v[52:55], v[76:79], a[28:31], v[52:55]
 ds_read_b64_tr_b16 v[100:101], v240 offset:36864
 ds_read_b64_tr_b16 v[102:103], v240 offset:38912
 v_mfma_f32_16x16x32_bf16 v[52:55], v[72:75], a[20:23], v[52:55]
 s_waitcnt lgkmcnt(8)
 v_smfmac_f32_16x16x64_bf16 v[192:195], v[220:223], v[80:87], v160
 v_mfma_f32_16x16x32_bf16 v[48:51], v[80:83], a[32:35], v[48:51]
 ds_read_b64_tr_b16 v[104:105], v240 offset:40960
 ds_read_b64_tr_b16 v[106:107], v240 offset:43008
 v_mfma_f32_16x16x32_bf16 v[48:51], v[84:87], a[40:43], v[48:51]
 buffer_load_dwordx4 v231, s[8:11], s46 offen offset:3072 lds
 v_mfma_f32_16x16x32_bf16 v[52:55], v[84:87], a[44:47], v[52:55]
 s_add_u32 s46, s46, 128
 ds_read_b64_tr_b16 v[108:109], v240 offset:45056
 ds_read_b64_tr_b16 v[110:111], v240 offset:47104
 v_mfma_f32_16x16x32_bf16 v[52:55], v[80:83], a[36:39], v[52:55]
 s_waitcnt lgkmcnt(8)
 v_smfmac_f32_16x16x64_bf16 v[192:195], v[220:223], v[88:95], v160
 v_mfma_f32_16x16x32_bf16 v[48:51], v[88:91], a[48:51], v[48:51]
 s_add_u32 m0, s35, 4096
 ds_read_b64_tr_b16 v[64:65], v240 offset:49152
 ds_read_b64_tr_b16 v[66:67], v240 offset:51200
 v_mfma_f32_16x16x32_bf16 v[48:51], v[92:95], a[56:59], v[48:51]
 buffer_load_dwordx4 v228, s[8:11], s46 offen lds
 v_mfma_f32_16x16x32_bf16 v[52:55], v[92:95], a[60:63], v[52:55]
 ds_read_b64_tr_b16 v[68:69], v240 offset:53248
 ds_read_b64_tr_b16 v[70:71], v240 offset:55296
 v_mfma_f32_16x16x32_bf16 v[52:55], v[88:91], a[52:55], v[52:55]
 s_waitcnt lgkmcnt(8)
 v_smfmac_f32_16x16x64_bf16 v[192:195], v[220:223], v[96:103], v160
 v_mfma_f32_16x16x32_bf16 v[48:51], v[96:99], a[64:67], v[48:51]
 ds_read_b64_tr_b16 v[72:73], v240 offset:57344
 ds_read_b64_tr_b16 v[74:75], v240 offset:59392
 v_mfma_f32_16x16x32_bf16 v[48:51], v[100:103], a[72:75], v[48:51]
 buffer_load_dwordx4 v229, s[8:11], s46 offen offset:1024 lds
 v_mfma_f32_16x16x32_bf16 v[52:55], v[100:103], a[76:79], v[52:55]
 ds_read_b64_tr_b16 v[76:77], v240 offset:61440
 ds_read_b64_tr_b16 v[78:79], v240 offset:63488
 v_mfma_f32_16x16x32_bf16 v[52:55], v[96:99], a[68:71], v[52:55]
 s_waitcnt lgkmcnt(8)
 v_smfmac_f32_16x16x64_bf16 v[192:195], v[220:223], v[104:111], v160
 v_mfma_f32_16x16x32_bf16 v[48:51], v[104:107], a[80:83], v[48:51]
 ds_read_b64_tr_b16 v[80:81], v241 offset:0
 ds_read_b64_tr_b16 v[82:83], v241 offset:2048
 v_mfma_f32_16x16x32_bf16 v[48:51], v[108:111], a[88:91], v[48:51]
 buffer_load_dwordx4 v230, s[8:11], s46 offen offset:2048 lds
 v_mfma_f32_16x16x32_bf16 v[52:55], v[108:111], a[92:95], v[52:55]
 ds_read_b64_tr_b16 v[84:85], v241 offset:4096
 ds_read_b64_tr_b16 v[86:87], v241 offset:6144
 v_mfma_f32_16x16x32_bf16 v[52:55], v[104:107], a[84:87], v[52:55]
 s_waitcnt lgkmcnt(8)
 v_smfmac_f32_16x16x64_bf16 v[192:195], v[220:223], v[64:71], v160
 v_mfma_f32_16x16x32_bf16 v[48:51], v[64:67], a[96:99], v[48:51]
 ds_read_b64_tr_b16 v[88:89], v241 offset:8192
 ds_read_b64_tr_b16 v[90:91], v241 offset:10240
 v_mfma_f32_16x16x32_bf16 v[48:51], v[68:71], a[104:107], v[48:51]
 buffer_load_dwordx4 v231, s[8:11], s46 offen offset:3072 lds
 v_mfma_f32_16x16x32_bf16 v[52:55], v[68:71], a[108:111], v[52:55]
 s_add_u32 s46, s46, 128
 ds_read_b64_tr_b16 v[92:93], v241 offset:12288
 ds_read_b64_tr_b16 v[94:95], v241 offset:14336
 v_mfma_f32_16x16x32_bf16 v[52:55], v[64:67], a[100:103], v[52:55]
 s_waitcnt lgkmcnt(8)
 v_smfmac_f32_16x16x64_bf16 v[192:195], v[220:223], v[72:79], v160
 v_mfma_f32_16x16x32_bf16 v[48:51], v[72:75], a[112:115], v[48:51]
 ds_read_b64_tr_b16 v[96:97], v241 offset:16384
 ds_read_b64_tr_b16 v[98:99], v241 offset:18432
 v_mfma_f32_16x16x32_bf16 v[48:51], v[76:79], a[120:123], v[48:51]
 buffer_load_dwordx4 v[112:115], v165, s[4:7], s50 offen sc1
 v_mfma_f32_16x16x32_bf16 v[52:55], v[76:79], a[124:127], v[52:55]
 ds_read_b64_tr_b16 v[100:101], v241 offset:20480
 ds_read_b64_tr_b16 v[102:103], v241 offset:22528
 v_mfma_f32_16x16x32_bf16 v[52:55], v[72:75], a[116:119], v[52:55]
 s_waitcnt lgkmcnt(8)
 buffer_load_dwordx4 v[116:119], v165, s[4:7], s50 offen offset:16 sc1
 v_smfmac_f32_16x16x64_bf16 v[216:219], v[220:223], v[80:87], v160
 v_mfma_f32_16x16x32_bf16 v[56:59], v[80:83], a[0:3], 0
 ds_read_b64_tr_b16 v[104:105], v241 offset:24576
 ds_read_b64_tr_b16 v[106:107], v241 offset:26624
 v_mfma_f32_16x16x32_bf16 v[56:59], v[84:87], a[8:11], v[56:59]
 buffer_load_dwordx4 v[120:123], v165, s[4:7], s50 offen offset:32 sc1
 v_mfma_f32_16x16x32_bf16 v[60:63], v[84:87], a[12:15], 0
 ds_read_b64_tr_b16 v[108:109], v241 offset:28672
 ds_read_b64_tr_b16 v[110:111], v241 offset:30720
 v_mfma_f32_16x16x32_bf16 v[60:63], v[80:83], a[4:7], v[60:63]
 s_waitcnt lgkmcnt(8)
 buffer_load_dwordx4 v[124:127], v165, s[4:7], s50 offen offset:48 sc1
 v_smfmac_f32_16x16x64_bf16 v[216:219], v[220:223], v[88:95], v160
 v_mfma_f32_16x16x32_bf16 v[56:59], v[88:91], a[16:19], v[56:59]
 s_add_u32 m0, s32, 0
 ds_read_b64_tr_b16 v[64:65], v241 offset:32768
 ds_read_b64_tr_b16 v[66:67], v241 offset:34816
 v_mfma_f32_16x16x32_bf16 v[56:59], v[92:95], a[24:27], v[56:59]
 buffer_load_dwordx4 v228, s[8:11], s46 offen lds
 v_mfma_f32_16x16x32_bf16 v[60:63], v[92:95], a[28:31], v[60:63]
 ds_read_b64_tr_b16 v[68:69], v241 offset:36864
 ds_read_b64_tr_b16 v[70:71], v241 offset:38912
 v_mfma_f32_16x16x32_bf16 v[60:63], v[88:91], a[20:23], v[60:63]
 s_waitcnt lgkmcnt(8)
 v_smfmac_f32_16x16x64_bf16 v[216:219], v[220:223], v[96:103], v160
 v_mfma_f32_16x16x32_bf16 v[56:59], v[96:99], a[32:35], v[56:59]
 ds_read_b64_tr_b16 v[72:73], v241 offset:40960
 ds_read_b64_tr_b16 v[74:75], v241 offset:43008
 v_mfma_f32_16x16x32_bf16 v[56:59], v[100:103], a[40:43], v[56:59]
Lw2_5:
 s_cbranch_execz Lw2_back
 buffer_load_dwordx4 v229, s[8:11], s46 offen offset:1024 lds
 v_mfma_f32_16x16x32_bf16 v[60:63], v[100:103], a[44:47], v[60:63]
 ds_read_b64_tr_b16 v[76:77], v241 offset:45056
 ds_read_b64_tr_b16 v[78:79], v241 offset:47104
 v_mfma_f32_16x16x32_bf16 v[60:63], v[96:99], a[36:39], v[60:63]
 s_waitcnt lgkmcnt(8)
 v_smfmac_f32_16x16x64_bf16 v[216:219], v[220:223], v[104:111], v160
 v_mfma_f32_16x16x32_bf16 v[56:59], v[104:107], a[48:51], v[56:59]
 ds_read_b64_tr_b16 v[80:81], v241 offset:49152
 ds_read_b64_tr_b16 v[82:83], v241 offset:51200
 v_mfma_f32_16x16x32_bf16 v[56:59], v[108:111], a[56:59], v[56:59]
 buffer_load_dwordx4 v230, s[8:11], s46 offen offset:2048 lds
 v_mfma_f32_16x16x32_bf16 v[60:63], v[108:111], a[60:63], v[60:63]
 ds_read_b64_tr_b16 v[84:85], v241 offset:53248
 ds_read_b64_tr_b16 v[86:87], v241 offset:55296
 v_mfma_f32_16x16x32_bf16 v[60:63], v[104:107], a[52:55], v[60:63]
 s_waitcnt lgkmcnt(8)
 v_smfmac_f32_16x16x64_bf16 v[216:219], v[220:223], v[64:71], v160
 v_mfma_f32_16x16x32_bf16 v[56:59], v[64:67], a[64:67], v[56:59]
 ds_read_b64_tr_b16 v[88:89], v241 offset:57344
 ds_read_b64_tr_b16 v[90:91], v241 offset:59392
 v_mfma_f32_16x16x32_bf16 v[56:59], v[68:71], a[72:75], v[56:59]
 buffer_load_dwordx4 v231, s[8:11], s46 offen offset:3072 lds
 v_mfma_f32_16x16x32_bf16 v[60:63], v[68:71], a[76:79], v[60:63]
 s_add_u32 s46, s46, 128
 ds_read_b64_tr_b16 v[92:93], v241 offset:61440
 ds_read_b64_tr_b16 v[94:95], v241 offset:63488
 v_mfma_f32_16x16x32_bf16 v[60:63], v[64:67], a[68:71], v[60:63]
 s_waitcnt lgkmcnt(8)
 v_smfmac_f32_16x16x64_bf16 v[216:219], v[220:223], v[72:79], v160
 v_mfma_f32_16x16x32_bf16 v[56:59], v[72:75], a[80:83], v[56:59]
 v_mfma_f32_16x16x32_bf16 v[56:59], v[76:79], a[88:91], v[56:59]
 v_mfma_f32_16x16x32_bf16 v[60:63], v[76:79], a[92:95], v[60:63]
 v_mfma_f32_16x16x32_bf16 v[60:63], v[72:75], a[84:87], v[60:63]
 s_waitcnt lgkmcnt(4)
 v_smfmac_f32_16x16x64_bf16 v[216:219], v[220:223], v[80:87], v160
 v_mfma_f32_16x16x32_bf16 v[56:59], v[80:83], a[96:99], v[56:59]
 v_mfma_f32_16x16x32_bf16 v[56:59], v[84:87], a[104:107], v[56:59]
 v_mfma_f32_16x16x32_bf16 v[60:63], v[84:87], a[108:111], v[60:63]
 v_mfma_f32_16x16x32_bf16 v[60:63], v[80:83], a[100:103], v[60:63]
 s_waitcnt lgkmcnt(0)
 v_smfmac_f32_16x16x64_bf16 v[216:219], v[220:223], v[88:95], v160
 v_mfma_f32_16x16x32_bf16 v[56:59], v[88:91], a[112:115], v[56:59]
 v_mfma_f32_16x16x32_bf16 v[56:59], v[92:95], a[120:123], v[56:59]
 s_barrier
 v_mfma_f32_16x16x32_bf16 v[60:63], v[92:95], a[124:127], v[60:63]
 v_mfma_f32_16x16x32_bf16 v[60:63], v[88:91], a[116:119], v[60:63]
 s_waitcnt vmcnt(4)
 v_max3_u32 v144, v112, v113, v114
 v_max3_u32 v144, v144, v115, v116
 v_max3_u32 v144, v144, v117, v118
 v_max3_u32 v144, v144, v119, v120
 v_max3_u32 v144, v144, v121, v122
 v_max3_u32 v144, v144, v123, v124
 v_max3_u32 v144, v144, v125, v126
 v_max_u32 v144, v144, v127
 v_cmp_eq_u32 vcc, -1, v144
 s_nop 1
 s_cbranch_vccnz Lzs
Lzs_back:
 v_add_f32_dpp v112, v112, v112 row_ror:8 row_mask:0xf bank_mask:0x3
 v_add_f32_dpp v113, v113, v113 row_ror:8 row_mask:0xf bank_mask:0x3
 v_add_f32_dpp v114, v114, v114 row_ror:8 row_mask:0xf bank_mask:0x3
 v_add_f32_dpp v115, v115, v115 row_ror:8 row_mask:0xf bank_mask:0x3
 v_add_f32_dpp v116, v116, v116 row_ror:8 row_mask:0xf bank_mask:0x3
 v_add_f32_dpp v117, v117, v117 row_ror:8 row_mask:0xf bank_mask:0x3
 v_add_f32_dpp v118, v118, v118 row_ror:8 row_mask:0xf bank_mask:0x3
 v_add_f32_dpp v119, v119, v119 row_ror:8 row_mask:0xf bank_mask:0x3
 v_add_f32_dpp v112, v120, v120 row_ror:8 row_mask:0xf bank_mask:0xc
 v_add_f32_dpp v113, v121, v121 row_ror:8 row_mask:0xf bank_mask:0xc
 v_add_f32_dpp v114, v122, v122 row_ror:8 row_mask:0xf bank_mask:0xc
 v_add_f32_dpp v115, v123, v123 row_ror:8 row_mask:0xf bank_mask:0xc
 v_add_f32_dpp v116, v124, v124 row_ror:8 row_mask:0xf bank_mask:0xc
 v_add_f32_dpp v117, v125, v125 row_ror:8 row_mask:0xf bank_mask:0xc
 v_add_f32_dpp v118, v126, v126 row_ror:8 row_mask:0xf bank_mask:0xc
 v_add_f32_dpp v119, v127, v127 row_ror:8 row_mask:0xf bank_mask:0xc
 v_add_f32_dpp v112, v112, v112 row_half_mirror row_mask:0xf bank_mask:0x5
 v_add_f32_dpp v113, v113, v113 row_half_mirror row_mask:0xf bank_mask:0x5
 v_add_f32_dpp v114, v114, v114 row_half_mirror row_mask:0xf bank_mask:0x5
 v_add_f32_dpp v115, v115, v115 row_half_mirror row_mask:0xf bank_mask:0x5
 v_add_f32_dpp v112, v116, v116 row_half_mirror row_mask:0xf bank_mask:0xa
 v_add_f32_dpp v113, v117, v117 row_half_mirror row_mask:0xf bank_mask:0xa
 v_add_f32_dpp v114, v118, v118 row_half_mirror row_mask:0xf bank_mask:0xa
 v_add_f32_dpp v115, v119, v119 row_half_mirror row_mask:0xf bank_mask:0xa
 v_add_f32_dpp v112, v112, v112 quad_perm:[2,3,0,1] row_mask:0xf bank_mask:0xf
 v_add_f32_dpp v113, v113, v113 quad_perm:[2,3,0,1] row_mask:0xf bank_mask:0xf
 v_add_f32_dpp v114, v114, v114 quad_perm:[2,3,0,1] row_mask:0xf bank_mask:0xf
 v_add_f32_dpp v115, v115, v115 quad_perm:[2,3,0,1] row_mask:0xf bank_mask:0xf
 v_add_f32_dpp v112, v112, v112 quad_perm:[1,0,3,2] row_mask:0xf bank_mask:0xf
 v_add_f32_dpp v113, v113, v113 quad_perm:[1,0,3,2] row_mask:0xf bank_mask:0xf
 v_add_f32_dpp v114, v114, v114 quad_perm:[1,0,3,2] row_mask:0xf bank_mask:0xf
 v_add_f32_dpp v115, v115, v115 quad_perm:[1,0,3,2] row_mask:0xf bank_mask:0xf
 v_mul_f32 v112, 0x3a924925, v112
 v_mul_f32 v113, 0x3a924925, v113
 v_mul_f32 v114, 0x3a924925, v114
 v_mul_f32 v115, 0x3a924925, v115
 v_fma_f32 v114, -v112, v112, v114
 v_fma_f32 v115, -v113, v113, v115
 v_max_f32 v114, 0, v114
 v_max_f32 v115, 0, v115
 v_add_f32 v114, 0x3727c5ac, v114
 v_add_f32 v115, 0x3727c5ac, v115
 v_rsq_f32 v116, v114
 v_rsq_f32 v117, v115
 v_mul_f32_e64 v118, -v112, v116
 v_mul_f32_e64 v119, -v113, v117
 s_nop 0
 v_mov_b32_dpp v200, v116 row_newbcast:0 row_mask:0xf bank_mask:0xf
 v_mov_b32_dpp v201, v117 row_newbcast:0 row_mask:0xf bank_mask:0xf
 v_mov_b32_dpp v202, v116 row_newbcast:4 row_mask:0xf bank_mask:0xf
 v_mov_b32_dpp v203, v117 row_newbcast:4 row_mask:0xf bank_mask:0xf
 v_mov_b32_dpp v204, v116 row_newbcast:8 row_mask:0xf bank_mask:0xf
 v_mov_b32_dpp v205, v117 row_newbcast:8 row_mask:0xf bank_mask:0xf
 v_mov_b32_dpp v206, v116 row_newbcast:12 row_mask:0xf bank_mask:0xf
 v_mov_b32_dpp v207, v117 row_newbcast:12 row_mask:0xf bank_mask:0xf
 v_mov_b32_dpp v208, v118 row_newbcast:0 row_mask:0xf bank_mask:0xf
 v_mov_b32_dpp v209, v119 row_newbcast:0 row_mask:0xf bank_mask:0xf
 v_mov_b32_dpp v210, v118 row_newbcast:4 row_mask:0xf bank_mask:0xf
 v_mov_b32_dpp v211, v119 row_newbcast:4 row_mask:0xf bank_mask:0xf
 v_mov_b32_dpp v212, v118 row_newbcast:8 row_mask:0xf bank_mask:0xf
 v_mov_b32_dpp v213, v119 row_newbcast:8 row_mask:0xf bank_mask:0xf
 v_mov_b32_dpp v214, v118 row_newbcast:12 row_mask:0xf bank_mask:0xf
 v_mov_b32_dpp v215, v119 row_newbcast:12 row_mask:0xf bank_mask:0xf
 v_pk_fma_f32 v[0:1], v[0:1], v[200:201], v[208:209]
 v_pk_fma_f32 v[2:3], v[2:3], v[202:203], v[210:211]
 v_pk_fma_f32 v[4:5], v[4:5], v[204:205], v[212:213]
 v_pk_fma_f32 v[6:7], v[6:7], v[206:207], v[214:215]
 v_cvt_pk_bf16_f32 v0, v0, v1
 v_cvt_pk_bf16_f32 v1, v2, v3
 v_cvt_pk_bf16_f32 v2, v4, v5
 v_cvt_pk_bf16_f32 v3, v6, v7
 buffer_store_dwordx4 v[0:3], v255, s[4:7], s51 offen sc1
 v_pk_fma_f32 v[8:9], v[8:9], v[200:201], v[208:209]
 v_pk_fma_f32 v[10:11], v[10:11], v[202:203], v[210:211]
 v_pk_fma_f32 v[12:13], v[12:13], v[204:205], v[212:213]
 v_pk_fma_f32 v[14:15], v[14:15], v[206:207], v[214:215]
 v_cvt_pk_bf16_f32 v8, v8, v9
 v_cvt_pk_bf16_f32 v9, v10, v11
 v_cvt_pk_bf16_f32 v10, v12, v13
 v_cvt_pk_bf16_f32 v11, v14, v15
 buffer_store_dwordx4 v[8:11], v255, s[4:7], s51 offen offset:1024 sc1
 v_pk_fma_f32 v[16:17], v[16:17], v[200:201], v[208:209]
 v_pk_fma_f32 v[18:19], v[18:19], v[202:203], v[210:211]
 v_pk_fma_f32 v[20:21], v[20:21], v[204:205], v[212:213]
 v_pk_fma_f32 v[22:23], v[22:23], v[206:207], v[214:215]
 v_cvt_pk_bf16_f32 v16, v16, v17
 v_cvt_pk_bf16_f32 v17, v18, v19
 v_cvt_pk_bf16_f32 v18, v20, v21
 v_cvt_pk_bf16_f32 v19, v22, v23
 buffer_store_dwordx4 v[16:19], v255, s[4:7], s51 offen offset:2048 sc1
 v_pk_fma_f32 v[24:25], v[24:25], v[200:201], v[208:209]
 v_pk_fma_f32 v[26:27], v[26:27], v[202:203], v[210:211]
 v_pk_fma_f32 v[28:29], v[28:29], v[204:205], v[212:213]
 v_pk_fma_f32 v[30:31], v[30:31], v[206:207], v[214:215]
 v_cvt_pk_bf16_f32 v24, v24, v25
 v_cvt_pk_bf16_f32 v25, v26, v27
 v_cvt_pk_bf16_f32 v26, v28, v29
 v_cvt_pk_bf16_f32 v27, v30, v31
 buffer_store_dwordx4 v[24:27], v255, s[4:7], s51 offen offset:3072 sc1
 s_lshl_b32 s26, s42, 4
 s_add_u32 s26, s26, s41
 s_lshl_b32 s26, s26, 7
 s_add_u32 s26, s26, 83460096
 s_lshl_b32 s55, s20, 12
 s_add_u32 s55, s55, 0x20000
 s_add_u32 m0, s32, 4096
 s_nop 0
 buffer_load_dwordx4 v228, s[8:11], s46 offen lds
 v_add_u32 v252, 0x20000, v255
 v_lshlrev_b32 v136, 16, v136
 v_mov_b32 v137, v136
 v_mov_b32 v138, v136
 v_mov_b32 v139, v136
 v_lshlrev_b32 v140, 16, v140
 v_mov_b32 v141, v140
 v_mov_b32 v142, v140
 v_mov_b32 v143, v140
 v_add_f32 v152, v152, v153
 v_add_f32 v156, v156, v157
 v_add_f32 v192, v192, v193
 buffer_load_dwordx4 v229, s[8:11], s46 offen offset:1024 lds
 v_add_f32 v216, v216, v217
 ds_bpermute_b32 v153, v243, v152 offset:4
 ds_bpermute_b32 v154, v243, v152 offset:8
 ds_bpermute_b32 v155, v243, v152 offset:12
 ds_bpermute_b32 v152, v243, v152 offset:0
 ds_bpermute_b32 v157, v243, v156 offset:4
 ds_bpermute_b32 v158, v243, v156 offset:8
 ds_bpermute_b32 v159, v243, v156 offset:12
 ds_bpermute_b32 v156, v243, v156 offset:0
 ds_bpermute_b32 v193, v243, v192 offset:4
 ds_bpermute_b32 v194, v243, v192 offset:8
 ds_bpermute_b32 v195, v243, v192 offset:12
 buffer_load_dwordx4 v230, s[8:11], s46 offen offset:2048 lds
 ds_bpermute_b32 v192, v243, v192 offset:0
 ds_bpermute_b32 v217, v243, v216 offset:4
 ds_bpermute_b32 v218, v243, v216 offset:8
 ds_bpermute_b32 v219, v243, v216 offset:12
 ds_bpermute_b32 v216, v243, v216 offset:0
 ds_read_b128 a[192:195], v246 offset:8192
 ds_read_b128 a[196:199], v246 offset:10240
 ds_read_b128 a[200:203], v247 offset:8192
 ds_read_b128 a[204:207], v247 offset:10240
 ds_read_b128 a[208:211], v246 offset:12288
 buffer_load_dwordx4 v231, s[8:11], s46 offen offset:3072 lds
 s_add_u32 s46, s46, 128
 ds_read_b128 a[212:215], v246 offset:14336
 ds_read_b128 a[216:219], v247 offset:12288
 ds_read_b128 a[220:223], v247 offset:14336
 ds_read_b128 a[224:227], v244 offset:0
 ds_read_b128 a[228:231], v244 offset:2048
 ds_read_b128 a[232:235], v245 offset:0
 ds_read_b128 a[236:239], v245 offset:2048
 ds_read_b128 a[240:243], v244 offset:4096
 ds_read_b128 a[244:247], v244 offset:6144
 ds_read_b128 a[248:251], v245 offset:4096
 ds_read_b128 a[252:255], v245 offset:6144
 s_waitcnt vmcnt(8)
 ds_read_b128 a[0:3], v246 offset:0
 ds_read_b128 a[4:7], v246 offset:2048
 ds_read_b128 a[8:11], v247 offset:0
 ds_read_b128 a[12:15], v247 offset:2048
 s_waitcnt lgkmcnt(15)
 v_pk_mul_f32 v[144:145], v[152:153], v[198:199] op_sel:[0,0] op_sel_hi:[1,0]
 v_pk_mul_f32 v[146:147], v[154:155], v[198:199] op_sel:[0,0] op_sel_hi:[1,0]
 v_pk_fma_f32 v[32:33], v[32:33], v[196:197], v[144:145] op_sel:[0,0,0] op_sel_hi:[1,0,1]
 v_pk_fma_f32 v[34:35], v[34:35], v[196:197], v[146:147] op_sel:[0,0,0] op_sel_hi:[1,0,1]
 v_pk_mul_f32 v[144:145], v[32:33], v[32:33]
 v_pk_mul_f32 v[146:147], v[34:35], v[34:35]
 v_pk_fma_f32 v[144:145], v[144:145], v[162:163], v[162:163] op_sel:[0,0,1] op_sel_hi:[1,0,1]
 v_pk_fma_f32 v[146:147], v[146:147], v[162:163], v[162:163] op_sel:[0,0,1] op_sel_hi:[1,0,1]
 v_pk_mul_f32 v[144:145], v[144:145], v[32:33]
 v_pk_mul_f32 v[146:147], v[146:147], v[34:35]
 v_exp_f32 v144, v144
 v_exp_f32 v145, v145
 v_exp_f32 v146, v146
 v_exp_f32 v147, v147
 v_pk_add_f32 v[144:145], 1.0, v[144:145] op_sel_hi:[0,1]
 v_pk_add_f32 v[146:147], 1.0, v[146:147] op_sel_hi:[0,1]
 v_rcp_f32 v144, v144
 v_rcp_f32 v145, v145
 v_rcp_f32 v146, v146
 v_rcp_f32 v147, v147
 v_pk_mul_f32 v[32:33], v[32:33], v[144:145]
 v_pk_mul_f32 v[34:35], v[34:35], v[146:147]
 v_pk_mul_f32 v[148:149], v[152:153], v[198:199] op_sel:[0,1] op_sel_hi:[1,1]
 v_pk_mul_f32 v[150:151], v[154:155], v[198:199] op_sel:[0,1] op_sel_hi:[1,1]
 v_pk_fma_f32 v[36:37], v[36:37], v[196:197], v[148:149] op_sel:[0,1,0] op_sel_hi:[1,1,1]
 v_pk_fma_f32 v[38:39], v[38:39], v[196:197], v[150:151] op_sel:[0,1,0] op_sel_hi:[1,1,1]
 v_pk_mul_f32 v[148:149], v[36:37], v[36:37]
 v_pk_mul_f32 v[150:151], v[38:39], v[38:39]
 v_pk_fma_f32 v[148:149], v[148:149], v[162:163], v[162:163] op_sel:[0,0,1] op_sel_hi:[1,0,1]
 v_pk_fma_f32 v[150:151], v[150:151], v[162:163], v[162:163] op_sel:[0,0,1] op_sel_hi:[1,0,1]
 v_pk_mul_f32 v[148:149], v[148:149], v[36:37]
 v_pk_mul_f32 v[150:151], v[150:151], v[38:39]
 v_exp_f32 v148, v148
 v_exp_f32 v149, v149
 v_exp_f32 v150, v150
 v_exp_f32 v151, v151
 v_pk_add_f32 v[148:149], 1.0, v[148:149] op_sel_hi:[0,1]
 v_pk_add_f32 v[150:151], 1.0, v[150:151] op_sel_hi:[0,1]
 v_rcp_f32 v148, v148
 v_rcp_f32 v149, v149
 v_rcp_f32 v150, v150
 v_rcp_f32 v151, v151
 v_pk_mul_f32 v[36:37], v[36:37], v[148:149]
 v_pk_mul_f32 v[38:39], v[38:39], v[150:151]
 s_waitcnt lgkmcnt(0)
 s_waitcnt vmcnt(4)
 s_barrier
 buffer_store_dword v253, v254, s[4:7], s26 offen sc1
 s_add_u32 m0, s32, 8192
 s_nop 0
 buffer_load_dwordx4 v228, s[8:11], s46 offen lds
 v_pk_mul_f32 v[144:145], v[156:157], v[198:199] op_sel:[0,0] op_sel_hi:[1,0]
 v_pk_mul_f32 v[146:147], v[158:159], v[198:199] op_sel:[0,0] op_sel_hi:[1,0]
 v_pk_fma_f32 v[40:41], v[40:41], v[196:197], v[144:145] op_sel:[0,0,0] op_sel_hi:[1,0,1]
 buffer_load_dwordx4 v229, s[8:11], s46 offen offset:1024 lds
 v_pk_fma_f32 v[42:43], v[42:43], v[196:197], v[146:147] op_sel:[0,0,0] op_sel_hi:[1,0,1]
 v_pk_mul_f32 v[144:145], v[40:41], v[40:41]
 v_pk_mul_f32 v[146:147], v[42:43], v[42:43]
 buffer_load_dwordx4 v230, s[8:11], s46 offen offset:2048 lds
 v_pk_fma_f32 v[144:145], v[144:145], v[162:163], v[162:163] op_sel:[0,0,1] op_sel_hi:[1,0,1]
 v_pk_fma_f32 v[146:147], v[146:147], v[162:163], v[162:163] op_sel:[0,0,1] op_sel_hi:[1,0,1]
 v_pk_mul_f32 v[144:145], v[144:145], v[40:41]
 buffer_load_dwordx4 v231, s[8:11], s46 offen offset:3072 lds
 s_add_u32 s46, s46, 128
 v_pk_mul_f32 v[146:147], v[146:147], v[42:43]
 v_exp_f32 v144, v144
 v_exp_f32 v145, v145
 s_add_u32 m0, s32, 12288
 s_nop 0
 buffer_load_dwordx4 v228, s[8:11], s46 offen lds
 v_exp_f32 v146, v146
 v_exp_f32 v147, v147
 v_pk_add_f32 v[144:145], 1.0, v[144:145] op_sel_hi:[0,1]
 buffer_load_dwordx4 v229, s[8:11], s46 offen offset:1024 lds
 v_pk_add_f32 v[146:147], 1.0, v[146:147] op_sel_hi:[0,1]
 v_rcp_f32 v144, v144
 v_rcp_f32 v145, v145
 buffer_load_dwordx4 v230, s[8:11], s46 offen offset:2048 lds
 v_rcp_f32 v146, v146
 v_rcp_f32 v147, v147
 v_pk_mul_f32 v[40:41], v[40:41], v[144:145]
 buffer_load_dwordx4 v231, s[8:11], s46 offen offset:3072 lds
 s_add_u32 s46, s46, 128
 v_pk_mul_f32 v[42:43], v[42:43], v[146:147]
 v_pk_mul_f32 v[148:149], v[156:157], v[198:199] op_sel:[0,1] op_sel_hi:[1,1]
 v_pk_mul_f32 v[150:151], v[158:159], v[198:199] op_sel:[0,1] op_sel_hi:[1,1]
 v_pk_fma_f32 v[44:45], v[44:45], v[196:197], v[148:149] op_sel:[0,1,0] op_sel_hi:[1,1,1]
 v_pk_fma_f32 v[46:47], v[46:47], v[196:197], v[150:151] op_sel:[0,1,0] op_sel_hi:[1,1,1]
 v_pk_mul_f32 v[148:149], v[44:45], v[44:45]
 v_pk_mul_f32 v[150:151], v[46:47], v[46:47]
 v_pk_fma_f32 v[148:149], v[148:149], v[162:163], v[162:163] op_sel:[0,0,1] op_sel_hi:[1,0,1]
 v_pk_fma_f32 v[150:151], v[150:151], v[162:163], v[162:163] op_sel:[0,0,1] op_sel_hi:[1,0,1]
 v_pk_mul_f32 v[148:149], v[148:149], v[44:45]
 v_pk_mul_f32 v[150:151], v[150:151], v[46:47]
 v_exp_f32 v148, v148
 v_exp_f32 v149, v149
 v_exp_f32 v150, v150
 v_exp_f32 v151, v151
 v_pk_add_f32 v[148:149], 1.0, v[148:149] op_sel_hi:[0,1]
 v_pk_add_f32 v[150:151], 1.0, v[150:151] op_sel_hi:[0,1]
 v_rcp_f32 v148, v148
 v_rcp_f32 v149, v149
 v_rcp_f32 v150, v150
 v_rcp_f32 v151, v151
 v_pk_mul_f32 v[44:45], v[44:45], v[148:149]
 v_pk_mul_f32 v[46:47], v[46:47], v[150:151]
 v_pk_mul_f32 v[144:145], v[192:193], v[198:199] op_sel:[0,0] op_sel_hi:[1,0]
 v_pk_mul_f32 v[146:147], v[194:195], v[198:199] op_sel:[0,0] op_sel_hi:[1,0]
 v_pk_fma_f32 v[48:49], v[48:49], v[196:197], v[144:145] op_sel:[0,0,0] op_sel_hi:[1,0,1]
 v_pk_fma_f32 v[50:51], v[50:51], v[196:197], v[146:147] op_sel:[0,0,0] op_sel_hi:[1,0,1]
 v_pk_mul_f32 v[144:145], v[48:49], v[48:49]
 v_pk_mul_f32 v[146:147], v[50:51], v[50:51]
 v_pk_fma_f32 v[144:145], v[144:145], v[162:163], v[162:163] op_sel:[0,0,1] op_sel_hi:[1,0,1]
 v_pk_fma_f32 v[146:147], v[146:147], v[162:163], v[162:163] op_sel:[0,0,1] op_sel_hi:[1,0,1]
 v_pk_mul_f32 v[144:145], v[144:145], v[48:49]
 v_pk_mul_f32 v[146:147], v[146:147], v[50:51]
 v_exp_f32 v144, v144
 v_exp_f32 v145, v145
 v_exp_f32 v146, v146
 v_exp_f32 v147, v147
 v_pk_add_f32 v[144:145], 1.0, v[144:145] op_sel_hi:[0,1]
 v_pk_add_f32 v[146:147], 1.0, v[146:147] op_sel_hi:[0,1]
 buffer_load_dword v232, v250, s[4:7], 0 offen sc1
 s_waitcnt vmcnt(10)
 ds_read_b128 a[16:19], v246 offset:4096
 ds_read_b128 a[20:23], v246 offset:6144
 ds_read_b128 a[24:27], v247 offset:4096
 ds_read_b128 a[28:31], v247 offset:6144
 v_rcp_f32 v144, v144
 v_rcp_f32 v145, v145
 v_rcp_f32 v146, v146
 v_rcp_f32 v147, v147
 v_pk_mul_f32 v[48:49], v[48:49], v[144:145]
 v_pk_mul_f32 v[50:51], v[50:51], v[146:147]
 v_pk_mul_f32 v[148:149], v[192:193], v[198:199] op_sel:[0,1] op_sel_hi:[1,1]
 v_pk_mul_f32 v[150:151], v[194:195], v[198:199] op_sel:[0,1] op_sel_hi:[1,1]
 v_pk_fma_f32 v[52:53], v[52:53], v[196:197], v[148:149] op_sel:[0,1,0] op_sel_hi:[1,1,1]
 v_pk_fma_f32 v[54:55], v[54:55], v[196:197], v[150:151] op_sel:[0,1,0] op_sel_hi:[1,1,1]
 v_pk_mul_f32 v[148:149], v[52:53], v[52:53]
 v_pk_mul_f32 v[150:151], v[54:55], v[54:55]
 v_pk_fma_f32 v[148:149], v[148:149], v[162:163], v[162:163] op_sel:[0,0,1] op_sel_hi:[1,0,1]
 v_pk_fma_f32 v[150:151], v[150:151], v[162:163], v[162:163] op_sel:[0,0,1] op_sel_hi:[1,0,1]
 v_pk_mul_f32 v[148:149], v[148:149], v[52:53]
 v_pk_mul_f32 v[150:151], v[150:151], v[54:55]
 v_exp_f32 v148, v148
 v_exp_f32 v149, v149
 v_exp_f32 v150, v150
 v_exp_f32 v151, v151
 v_pk_add_f32 v[148:149], 1.0, v[148:149] op_sel_hi:[0,1]
 v_pk_add_f32 v[150:151], 1.0, v[150:151] op_sel_hi:[0,1]
 v_rcp_f32 v148, v148
 v_rcp_f32 v149, v149
 v_rcp_f32 v150, v150
 v_rcp_f32 v151, v151
 v_pk_mul_f32 v[52:53], v[52:53], v[148:149]
 v_pk_mul_f32 v[54:55], v[54:55], v[150:151]
 s_waitcnt vmcnt(0)
 v_cmp_gt_u32 vcc, 1, v232
 s_mov_b32 s27, 0
 s_nop 0
 s_cbranch_vccz Lback22
Lspin21:
 buffer_load_dword v232, v250, s[4:7], 0 offen sc1
 s_add_u32 s27, s27, 1
 s_waitcnt vmcnt(0)
 v_cmp_gt_u32 vcc, 1, v232
 s_cmp_gt_u32 s27, 1048576
 s_cbranch_scc1 Lback22
 s_cbranch_vccnz Lspin21
Lback22:
 s_add_u32 m0, s44, 0
 s_nop 0
 buffer_load_dwordx4 v255, s[4:7], s52 offen sc1 lds
 v_pk_mul_f32 v[144:145], v[216:217], v[198:199] op_sel:[0,0] op_sel_hi:[1,0]
 v_pk_mul_f32 v[146:147], v[218:219], v[198:199] op_sel:[0,0] op_sel_hi:[1,0]
 v_pk_fma_f32 v[56:57], v[56:57], v[196:197], v[144:145] op_sel:[0,0,0] op_sel_hi:[1,0,1]
 v_pk_fma_f32 v[58:59], v[58:59], v[196:197], v[146:147] op_sel:[0,0,0] op_sel_hi:[1,0,1]
 buffer_load_dwordx4 v255, s[4:7], s52 offen offset:1024 sc1 lds
 v_pk_mul_f32 v[144:145], v[56:57], v[56:57]
 v_pk_mul_f32 v[146:147], v[58:59], v[58:59]
 v_pk_fma_f32 v[144:145], v[144:145], v[162:163], v[162:163] op_sel:[0,0,1] op_sel_hi:[1,0,1]
 v_pk_fma_f32 v[146:147], v[146:147], v[162:163], v[162:163] op_sel:[0,0,1] op_sel_hi:[1,0,1]
 buffer_load_dwordx4 v255, s[4:7], s52 offen offset:2048 sc1 lds
 v_pk_mul_f32 v[144:145], v[144:145], v[56:57]
 v_pk_mul_f32 v[146:147], v[146:147], v[58:59]
 v_exp_f32 v144, v144
 v_exp_f32 v145, v145
 buffer_load_dwordx4 v255, s[4:7], s52 offen offset:3072 sc1 lds
 s_add_u32 s52, s52, 16384
 v_exp_f32 v146, v146
 v_exp_f32 v147, v147
 v_pk_add_f32 v[144:145], 1.0, v[144:145] op_sel_hi:[0,1]
 v_pk_add_f32 v[146:147], 1.0, v[146:147] op_sel_hi:[0,1]
 s_add_u32 m0, s44, 16384
 s_nop 0
 buffer_load_dwordx4 v255, s[4:7], s52 offen sc1 lds
 v_rcp_f32 v144, v144
 v_rcp_f32 v145, v145
 v_rcp_f32 v146, v146
 v_rcp_f32 v147, v147
 buffer_load_dwordx4 v255, s[4:7], s52 offen offset:1024 sc1 lds
 v_pk_mul_f32 v[56:57], v[56:57], v[144:145]
 v_pk_mul_f32 v[58:59], v[58:59], v[146:147]
 v_pk_mul_f32 v[148:149], v[216:217], v[198:199] op_sel:[0,1] op_sel_hi:[1,1]
 v_pk_mul_f32 v[150:151], v[218:219], v[198:199] op_sel:[0,1] op_sel_hi:[1,1]
 buffer_load_dwordx4 v255, s[4:7], s52 offen offset:2048 sc1 lds
 v_pk_fma_f32 v[60:61], v[60:61], v[196:197], v[148:149] op_sel:[0,1,0] op_sel_hi:[1,1,1]
 v_pk_fma_f32 v[62:63], v[62:63], v[196:197], v[150:151] op_sel:[0,1,0] op_sel_hi:[1,1,1]
 v_pk_mul_f32 v[148:149], v[60:61], v[60:61]
 v_pk_mul_f32 v[150:151], v[62:63], v[62:63]
 buffer_load_dwordx4 v255, s[4:7], s52 offen offset:3072 sc1 lds
 s_add_u32 s52, s52, 16384
 v_pk_fma_f32 v[148:149], v[148:149], v[162:163], v[162:163] op_sel:[0,0,1] op_sel_hi:[1,0,1]
 v_pk_fma_f32 v[150:151], v[150:151], v[162:163], v[162:163] op_sel:[0,0,1] op_sel_hi:[1,0,1]
 v_pk_mul_f32 v[148:149], v[148:149], v[60:61]
 v_pk_mul_f32 v[150:151], v[150:151], v[62:63]
 s_add_u32 m0, s44, 32768
 s_nop 0
 buffer_load_dwordx4 v255, s[4:7], s52 offen sc1 lds
 v_exp_f32 v148, v148
 v_exp_f32 v149, v149
 v_exp_f32 v150, v150
 v_exp_f32 v151, v151
 buffer_load_dwordx4 v255, s[4:7], s52 offen offset:1024 sc1 lds
 v_pk_add_f32 v[148:149], 1.0, v[148:149] op_sel_hi:[0,1]
 v_pk_add_f32 v[150:151], 1.0, v[150:151] op_sel_hi:[0,1]
 v_rcp_f32 v148, v148
 v_rcp_f32 v149, v149
 buffer_load_dwordx4 v255, s[4:7], s52 offen offset:2048 sc1 lds
 v_rcp_f32 v150, v150
 v_rcp_f32 v151, v151
 v_pk_mul_f32 v[60:61], v[60:61], v[148:149]
 v_pk_mul_f32 v[62:63], v[62:63], v[150:151]
 buffer_load_dwordx4 v255, s[4:7], s52 offen offset:3072 sc1 lds
 s_add_u32 s52, s52, 16384
 s_waitcnt vmcnt(8)
 s_barrier
 ds_read_b128 v[64:67], v251 offset:0
 ds_read_b128 v[68:71], v251 offset:4096
 ds_read_b128 v[72:75], v251 offset:8192
 ds_read_b128 v[76:79], v251 offset:12288
 ds_read_b128 v[80:83], v251 offset:1024
 ds_read_b128 v[84:87], v251 offset:5120
 ds_read_b128 v[88:91], v251 offset:9216
 ds_read_b128 v[92:95], v251 offset:13312
 s_waitcnt lgkmcnt(7)
 v_mfma_f32_16x16x32_bf16 v[192:195], v[64:67], a[128:131], 0
 s_waitcnt lgkmcnt(6)
 s_add_u32 m0, s44, 49152
 ds_read_b128 v[96:99], v251 offset:2048
 v_mfma_f32_16x16x32_bf16 v[192:195], v[68:71], a[136:139], v[192:195]
 s_waitcnt lgkmcnt(6)
 buffer_load_dwordx4 v255, s[4:7], s52 offen sc1 lds
 v_mfma_f32_16x16x32_bf16 v[192:195], v[72:75], a[144:147], v[192:195]
 s_waitcnt lgkmcnt(5)
 ds_read_b128 v[100:103], v251 offset:6144
 ds_read_b128 a[32:35], v246 offset:8192
 v_mfma_f32_16x16x32_bf16 v[192:195], v[76:79], a[152:155], v[192:195]
 v_mfma_f32_16x16x32_bf16 v[196:199], v[76:79], a[156:159], 0
 ds_read_b128 v[104:107], v251 offset:10240
 ds_read_b128 a[36:39], v246 offset:10240
 v_mfma_f32_16x16x32_bf16 v[196:199], v[72:75], a[148:151], v[196:199]
 buffer_load_dwordx4 v255, s[4:7], s52 offen offset:1024 sc1 lds
 v_mfma_f32_16x16x32_bf16 v[196:199], v[68:71], a[140:143], v[196:199]
 ds_read_b128 v[108:111], v251 offset:14336
 ds_read_b128 a[40:43], v247 offset:8192
 v_mfma_f32_16x16x32_bf16 v[196:199], v[64:67], a[132:135], v[196:199]
 s_waitcnt lgkmcnt(8)
 v_mfma_f32_16x16x32_bf16 v[204:207], v[80:83], a[132:135], 0
 ds_read_b128 v[64:67], v251 offset:3072
 ds_read_b128 a[44:47], v247 offset:10240
 v_mfma_f32_16x16x32_bf16 v[204:207], v[84:87], a[140:143], v[204:207]
 buffer_load_dwordx4 v255, s[4:7], s52 offen offset:2048 sc1 lds
 v_mfma_f32_16x16x32_bf16 v[204:207], v[88:91], a[148:151], v[204:207]
 s_waitcnt lgkmcnt(9)
 ds_read_b128 v[68:71], v251 offset:7168
 ds_read_b128 a[48:51], v246 offset:12288
 v_mfma_f32_16x16x32_bf16 v[204:207], v[92:95], a[156:159], v[204:207]
 v_mfma_f32_16x16x32_bf16 v[200:203], v[92:95], a[152:155], 0
 ds_read_b128 v[72:75], v251 offset:11264
 ds_read_b128 a[52:55], v246 offset:14336
 v_mfma_f32_16x16x32_bf16 v[200:203], v[88:91], a[144:147], v[200:203]
 buffer_load_dwordx4 v255, s[4:7], s52 offen offset:3072 sc1 lds
 v_mfma_f32_16x16x32_bf16 v[200:203], v[84:87], a[136:139], v[200:203]
 s_waitcnt vmcnt(8)
 s_add_u32 s52, s52, 16384
 ds_read_b128 v[76:79], v251 offset:15360
 ds_read_b128 a[56:59], v247 offset:12288
 v_mfma_f32_16x16x32_bf16 v[200:203], v[80:83], a[128:131], v[200:203]
 s_barrier
 s_waitcnt lgkmcnt(13)
 v_mfma_f32_16x16x32_bf16 v[208:211], v[96:99], a[128:131], 0
 s_add_u32 m0, s55, 0
 ds_read_b128 v[80:83], v251 offset:16384
 ds_read_b128 a[60:63], v247 offset:14336
 v_mfma_f32_16x16x32_bf16 v[208:211], v[100:103], a[136:139], v[208:211]
 s_waitcnt lgkmcnt(13)
 buffer_load_dwordx4 v255, s[4:7], s52 offen sc1 lds
 v_mfma_f32_16x16x32_bf16 v[208:211], v[104:107], a[144:147], v[208:211]
 s_waitcnt lgkmcnt(11)
 ds_read_b128 v[84:87], v251 offset:20480
 v_mfma_f32_16x16x32_bf16 v[208:211], v[108:111], a[152:155], v[208:211]
 v_mfma_f32_16x16x32_bf16 v[212:215], v[108:111], a[156:159], 0
 ds_read_b128 v[88:91], v251 offset:24576
 v_mfma_f32_16x16x32_bf16 v[212:215], v[104:107], a[148:151], v[212:215]
 buffer_load_dwordx4 v255, s[4:7], s52 offen offset:1024 sc1 lds
 v_mfma_f32_16x16x32_bf16 v[212:215], v[100:103], a[140:143], v[212:215]
 ds_read_b128 v[92:95], v251 offset:28672
 v_mfma_f32_16x16x32_bf16 v[212:215], v[96:99], a[132:135], v[212:215]
 s_waitcnt lgkmcnt(12)
 v_mfma_f32_16x16x32_bf16 v[220:223], v[64:67], a[132:135], 0
 s_waitcnt lgkmcnt(10)
 ds_read_b128 v[96:99], v251 offset:17408
 v_mfma_f32_16x16x32_bf16 v[220:223], v[68:71], a[140:143], v[220:223]
 s_waitcnt lgkmcnt(9)
 buffer_load_dwordx4 v255, s[4:7], s52 offen offset:2048 sc1 lds
 v_mfma_f32_16x16x32_bf16 v[220:223], v[72:75], a[148:151], v[220:223]
 s_waitcnt lgkmcnt(7)
 ds_read_b128 v[100:103], v251 offset:21504
 v_mfma_f32_16x16x32_bf16 v[220:223], v[76:79], a[156:159], v[220:223]
 v_mfma_f32_16x16x32_bf16 v[216:219], v[76:79], a[152:155], 0
 ds_read_b128 v[104:107], v251 offset:25600
 v_mfma_f32_16x16x32_bf16 v[216:219], v[72:75], a[144:147], v[216:219]
 buffer_load_dwordx4 v255, s[4:7], s52 offen offset:3072 sc1 lds
 v_mfma_f32_16x16x32_bf16 v[216:219], v[68:71], a[136:139], v[216:219]
 s_add_u32 s52, s52, 16384
 ds_read_b128 v[108:111], v251 offset:29696
 v_mfma_f32_16x16x32_bf16 v[216:219], v[64:67], a[128:131], v[216:219]
 s_waitcnt lgkmcnt(8)
 v_mfma_f32_16x16x32_bf16 v[192:195], v[80:83], a[160:163], v[192:195]
 s_waitcnt lgkmcnt(4)
 s_add_u32 m0, s32, 0
 ds_read_b128 v[64:67], v251 offset:18432
 v_mfma_f32_16x16x32_bf16 v[192:195], v[84:87], a[168:171], v[192:195]
 buffer_load_dwordx4 v228, s[8:11], s46 offen lds
 v_mfma_f32_16x16x32_bf16 v[192:195], v[88:91], a[176:179], v[192:195]
 ds_read_b128 v[68:71], v251 offset:22528
 v_mfma_f32_16x16x32_bf16 v[192:195], v[92:95], a[184:187], v[192:195]
 v_mfma_f32_16x16x32_bf16 v[196:199], v[92:95], a[188:191], v[196:199]
 ds_read_b128 v[72:75], v251 offset:26624
 v_mfma_f32_16x16x32_bf16 v[196:199], v[88:91], a[180:183], v[196:199]
 buffer_load_dwordx4 v229, s[8:11], s46 offen offset:1024 lds
 v_mfma_f32_16x16x32_bf16 v[196:199], v[84:87], a[172:175], v[196:199]
 ds_read_b128 v[76:79], v251 offset:30720
 v_mfma_f32_16x16x32_bf16 v[196:199], v[80:83], a[164:167], v[196:199]
 s_waitcnt lgkmcnt(5)
 v_mfma_f32_16x16x32_bf16 v[204:207], v[96:99], a[164:167], v[204:207]
 ds_read_b128 v[80:83], v251 offset:19456
 v_mfma_f32_16x16x32_bf16 v[204:207], v[100:103], a[172:175], v[204:207]
 buffer_load_dwordx4 v230, s[8:11], s46 offen offset:2048 lds
 v_mfma_f32_16x16x32_bf16 v[204:207], v[104:107], a[180:183], v[204:207]
 s_waitcnt lgkmcnt(5)
 ds_read_b128 v[84:87], v251 offset:23552
 v_mfma_f32_16x16x32_bf16 v[204:207], v[108:111], a[188:191], v[204:207]
 v_mfma_f32_16x16x32_bf16 v[200:203], v[108:111], a[184:187], v[200:203]
 ds_read_b128 v[88:91], v251 offset:27648
 v_mfma_f32_16x16x32_bf16 v[200:203], v[104:107], a[176:179], v[200:203]
 buffer_load_dwordx4 v231, s[8:11], s46 offen offset:3072 lds
 v_mfma_f32_16x16x32_bf16 v[200:203], v[100:103], a[168:171], v[200:203]
 s_add_u32 s46, s46, 128
 s_waitcnt vmcnt(12)
 ds_read_b128 v[92:95], v251 offset:31744
 v_mfma_f32_16x16x32_bf16 v[200:203], v[96:99], a[160:163], v[200:203]
 s_barrier
 s_waitcnt lgkmcnt(5)
 v_mfma_f32_16x16x32_bf16 v[208:211], v[64:67], a[160:163], v[208:211]
 s_add_u32 m0, s55, 16384
 ds_read_b128 v[96:99], v251 offset:32768
Lw2_6:
 s_cbranch_execz Lw2_back
 v_mfma_f32_16x16x32_bf16 v[208:211], v[68:71], a[168:171], v[208:211]
 buffer_load_dwordx4 v255, s[4:7], s52 offen sc1 lds
 v_mfma_f32_16x16x32_bf16 v[208:211], v[72:75], a[176:179], v[208:211]
 s_waitcnt lgkmcnt(5)
 ds_read_b128 v[100:103], v251 offset:36864
 v_mfma_f32_16x16x32_bf16 v[208:211], v[76:79], a[184:187], v[208:211]
 v_mfma_f32_16x16x32_bf16 v[212:215], v[76:79], a[188:191], v[212:215]
 ds_read_b128 v[104:107], v251 offset:40960
 v_mfma_f32_16x16x32_bf16 v[212:215], v[72:75], a[180:183], v[212:215]
 buffer_load_dwordx4 v255, s[4:7], s52 offen offset:1024 sc1 lds
 v_mfma_f32_16x16x32_bf16 v[212:215], v[68:71], a[172:175], v[212:215]
 ds_read_b128 v[108:111], v251 offset:45056
 v_mfma_f32_16x16x32_bf16 v[212:215], v[64:67], a[164:167], v[212:215]
 s_waitcnt lgkmcnt(5)
 v_mfma_f32_16x16x32_bf16 v[220:223], v[80:83], a[164:167], v[220:223]
 ds_read_b128 v[64:67], v251 offset:33792
 v_mfma_f32_16x16x32_bf16 v[220:223], v[84:87], a[172:175], v[220:223]
 buffer_load_dwordx4 v255, s[4:7], s52 offen offset:2048 sc1 lds
 v_mfma_f32_16x16x32_bf16 v[220:223], v[88:91], a[180:183], v[220:223]
 s_waitcnt lgkmcnt(5)
 ds_read_b128 v[68:71], v251 offset:37888
 v_mfma_f32_16x16x32_bf16 v[220:223], v[92:95], a[188:191], v[220:223]
 v_mfma_f32_16x16x32_bf16 v[216:219], v[92:95], a[184:187], v[216:219]
 ds_read_b128 v[72:75], v251 offset:41984
 v_mfma_f32_16x16x32_bf16 v[216:219], v[88:91], a[176:179], v[216:219]
 buffer_load_dwordx4 v255, s[4:7], s52 offen offset:3072 sc1 lds
 v_mfma_f32_16x16x32_bf16 v[216:219], v[84:87], a[168:171], v[216:219]
 s_add_u32 s52, s52, 16384
 ds_read_b128 v[76:79], v251 offset:46080
 v_mfma_f32_16x16x32_bf16 v[216:219], v[80:83], a[160:163], v[216:219]
 s_waitcnt lgkmcnt(5)
 v_mfma_f32_16x16x32_bf16 v[192:195], v[96:99], a[192:195], v[192:195]
 s_add_u32 m0, s32, 4096
 ds_read_b128 v[80:83], v251 offset:34816
 v_mfma_f32_16x16x32_bf16 v[192:195], v[100:103], a[200:203], v[192:195]
 buffer_load_dwordx4 v228, s[8:11], s46 offen lds
 v_mfma_f32_16x16x32_bf16 v[192:195], v[104:107], a[208:211], v[192:195]
 s_waitcnt lgkmcnt(5)
 ds_read_b128 v[84:87], v251 offset:38912
 v_mfma_f32_16x16x32_bf16 v[192:195], v[108:111], a[216:219], v[192:195]
 v_mfma_f32_16x16x32_bf16 v[196:199], v[108:111], a[220:223], v[196:199]
 ds_read_b128 v[88:91], v251 offset:43008
 v_mfma_f32_16x16x32_bf16 v[196:199], v[104:107], a[212:215], v[196:199]
 buffer_load_dwordx4 v229, s[8:11], s46 offen offset:1024 lds
 v_mfma_f32_16x16x32_bf16 v[196:199], v[100:103], a[204:207], v[196:199]
 ds_read_b128 v[92:95], v251 offset:47104
 v_mfma_f32_16x16x32_bf16 v[196:199], v[96:99], a[196:199], v[196:199]
 s_waitcnt lgkmcnt(5)
 v_mfma_f32_16x16x32_bf16 v[204:207], v[64:67], a[196:199], v[204:207]
 ds_read_b128 v[96:99], v251 offset:35840
 v_mfma_f32_16x16x32_bf16 v[204:207], v[68:71], a[204:207], v[204:207]
 buffer_load_dwordx4 v230, s[8:11], s46 offen offset:2048 lds
 v_mfma_f32_16x16x32_bf16 v[204:207], v[72:75], a[212:215], v[204:207]
 s_waitcnt lgkmcnt(5)
 ds_read_b128 v[100:103], v251 offset:39936
 v_mfma_f32_16x16x32_bf16 v[204:207], v[76:79], a[220:223], v[204:207]
 v_mfma_f32_16x16x32_bf16 v[200:203], v[76:79], a[216:219], v[200:203]
 ds_read_b128 v[104:107], v251 offset:44032
 v_mfma_f32_16x16x32_bf16 v[200:203], v[72:75], a[208:211], v[200:203]
 buffer_load_dwordx4 v231, s[8:11], s46 offen offset:3072 lds
 v_mfma_f32_16x16x32_bf16 v[200:203], v[68:71], a[200:203], v[200:203]
 s_add_u32 s46, s46, 128
 s_waitcnt vmcnt(16)
 ds_read_b128 v[108:111], v251 offset:48128
 v_mfma_f32_16x16x32_bf16 v[200:203], v[64:67], a[192:195], v[200:203]
 s_barrier
 s_waitcnt lgkmcnt(5)
 v_mfma_f32_16x16x32_bf16 v[208:211], v[80:83], a[192:195], v[208:211]
 s_add_u32 m0, s44, 0
 ds_read_b128 v[64:67], v251 offset:49152
 v_mfma_f32_16x16x32_bf16 v[208:211], v[84:87], a[200:203], v[208:211]
 buffer_load_dwordx4 v255, s[4:7], s52 offen sc1 lds
 v_mfma_f32_16x16x32_bf16 v[208:211], v[88:91], a[208:211], v[208:211]
 s_waitcnt lgkmcnt(5)
 ds_read_b128 v[68:71], v251 offset:53248
 v_mfma_f32_16x16x32_bf16 v[208:211], v[92:95], a[216:219], v[208:211]
 v_mfma_f32_16x16x32_bf16 v[212:215], v[92:95], a[220:223], v[212:215]
 ds_read_b128 v[72:75], v251 offset:57344
 v_mfma_f32_16x16x32_bf16 v[212:215], v[88:91], a[212:215], v[212:215]
 buffer_load_dwordx4 v255, s[4:7], s52 offen offset:1024 sc1 lds
 v_mfma_f32_16x16x32_bf16 v[212:215], v[84:87], a[204:207], v[212:215]
 ds_read_b128 v[76:79], v251 offset:61440
 v_mfma_f32_16x16x32_bf16 v[212:215], v[80:83], a[196:199], v[212:215]
 s_waitcnt lgkmcnt(5)
 v_mfma_f32_16x16x32_bf16 v[220:223], v[96:99], a[196:199], v[220:223]
 ds_read_b128 v[80:83], v251 offset:50176
 v_mfma_f32_16x16x32_bf16 v[220:223], v[100:103], a[204:207], v[220:223]
 buffer_load_dwordx4 v255, s[4:7], s52 offen offset:2048 sc1 lds
 v_mfma_f32_16x16x32_bf16 v[220:223], v[104:107], a[212:215], v[220:223]
 s_waitcnt lgkmcnt(5)
 ds_read_b128 v[84:87], v251 offset:54272
 v_mfma_f32_16x16x32_bf16 v[220:223], v[108:111], a[220:223], v[220:223]
 v_mfma_f32_16x16x32_bf16 v[216:219], v[108:111], a[216:219], v[216:219]
 ds_read_b128 v[88:91], v251 offset:58368
 v_mfma_f32_16x16x32_bf16 v[216:219], v[104:107], a[208:211], v[216:219]
 buffer_load_dwordx4 v255, s[4:7], s52 offen offset:3072 sc1 lds
 v_mfma_f32_16x16x32_bf16 v[216:219], v[100:103], a[200:203], v[216:219]
 s_add_u32 s52, s52, 16384
 ds_read_b128 v[92:95], v251 offset:62464
 v_mfma_f32_16x16x32_bf16 v[216:219], v[96:99], a[192:195], v[216:219]
 s_waitcnt lgkmcnt(5)
 v_mfma_f32_16x16x32_bf16 v[192:195], v[64:67], a[224:227], v[192:195]
 s_add_u32 m0, s32, 8192
 ds_read_b128 v[96:99], v251 offset:51200
 v_mfma_f32_16x16x32_bf16 v[192:195], v[68:71], a[232:235], v[192:195]
 buffer_load_dwordx4 v228, s[8:11], s46 offen lds
 v_mfma_f32_16x16x32_bf16 v[192:195], v[72:75], a[240:243], v[192:195]
 s_waitcnt vmcnt(13) lgkmcnt(5)
 ds_read_b128 v[100:103], v251 offset:55296
 ds_read_b128 a[64:67], v246 offset:0
 v_mfma_f32_16x16x32_bf16 v[192:195], v[76:79], a[248:251], v[192:195]
 v_mfma_f32_16x16x32_bf16 v[196:199], v[76:79], a[252:255], v[196:199]
 ds_read_b128 v[104:107], v251 offset:59392
 ds_read_b128 a[68:71], v246 offset:2048
 v_mfma_f32_16x16x32_bf16 v[196:199], v[72:75], a[244:247], v[196:199]
 buffer_load_dwordx4 v229, s[8:11], s46 offen offset:1024 lds
 v_mfma_f32_16x16x32_bf16 v[196:199], v[68:71], a[236:239], v[196:199]
 ds_read_b128 v[108:111], v251 offset:63488
 ds_read_b128 a[72:75], v247 offset:0
 v_mfma_f32_16x16x32_bf16 v[196:199], v[64:67], a[228:231], v[196:199]
 s_waitcnt lgkmcnt(8)
 v_mfma_f32_16x16x32_bf16 v[204:207], v[80:83], a[228:231], v[204:207]
 ds_read_b128 v[64:67], v251 offset:52224
 ds_read_b128 a[76:79], v247 offset:2048
 v_mfma_f32_16x16x32_bf16 v[204:207], v[84:87], a[236:239], v[204:207]
 buffer_load_dwordx4 v230, s[8:11], s46 offen offset:2048 lds
 v_mfma_f32_16x16x32_bf16 v[204:207], v[88:91], a[244:247], v[204:207]
 s_waitcnt lgkmcnt(9)
 ds_read_b128 v[68:71], v251 offset:56320
 v_mfma_f32_16x16x32_bf16 v[204:207], v[92:95], a[252:255], v[204:207]
 v_mfma_f32_16x16x32_bf16 v[200:203], v[92:95], a[248:251], v[200:203]
 ds_read_b128 v[72:75], v251 offset:60416
 v_mfma_f32_16x16x32_bf16 v[200:203], v[88:91], a[240:243], v[200:203]
 buffer_load_dwordx4 v231, s[8:11], s46 offen offset:3072 lds
 v_mfma_f32_16x16x32_bf16 v[200:203], v[84:87], a[232:235], v[200:203]
 s_add_u32 s46, s46, 128
 ds_read_b128 v[76:79], v251 offset:64512
 v_mfma_f32_16x16x32_bf16 v[200:203], v[80:83], a[224:227], v[200:203]
 s_barrier
 s_waitcnt lgkmcnt(10)
 v_mfma_f32_16x16x32_bf16 v[208:211], v[96:99], a[224:227], v[208:211]
 s_add_u32 m0, s44, 16384
 ds_read_b128 v[80:83], v252 offset:0
 v_mfma_f32_16x16x32_bf16 v[208:211], v[100:103], a[232:235], v[208:211]
 s_waitcnt lgkmcnt(9)
 buffer_load_dwordx4 v255, s[4:7], s52 offen sc1 lds
 v_mfma_f32_16x16x32_bf16 v[208:211], v[104:107], a[240:243], v[208:211]
 s_waitcnt lgkmcnt(7)
 ds_read_b128 v[84:87], v252 offset:4096
 v_mfma_f32_16x16x32_bf16 v[208:211], v[108:111], a[248:251], v[208:211]
 v_mfma_f32_16x16x32_bf16 v[212:215], v[108:111], a[252:255], v[212:215]
 ds_read_b128 v[88:91], v252 offset:8192
 v_mfma_f32_16x16x32_bf16 v[212:215], v[104:107], a[244:247], v[212:215]
 buffer_load_dwordx4 v255, s[4:7], s52 offen offset:1024 sc1 lds
 v_mfma_f32_16x16x32_bf16 v[212:215], v[100:103], a[236:239], v[212:215]
 ds_read_b128 v[92:95], v252 offset:12288
 v_mfma_f32_16x16x32_bf16 v[212:215], v[96:99], a[228:231], v[212:215]
 s_waitcnt lgkmcnt(8)
 v_mfma_f32_16x16x32_bf16 v[220:223], v[64:67], a[228:231], v[220:223]
 s_waitcnt lgkmcnt(4)
 ds_read_b128 v[96:99], v252 offset:1024
 v_mfma_f32_16x16x32_bf16 v[220:223], v[68:71], a[236:239], v[220:223]
 buffer_load_dwordx4 v255, s[4:7], s52 offen offset:2048 sc1 lds
 v_mfma_f32_16x16x32_bf16 v[220:223], v[72:75], a[244:247], v[220:223]
 ds_read_b128 v[100:103], v252 offset:5120
 v_mfma_f32_16x16x32_bf16 v[220:223], v[76:79], a[252:255], v[220:223]
 v_mfma_f32_16x16x32_bf16 v[216:219], v[76:79], a[248:251], v[216:219]
 ds_read_b128 v[104:107], v252 offset:9216
 v_mfma_f32_16x16x32_bf16 v[216:219], v[72:75], a[240:243], v[216:219]
 buffer_load_dwordx4 v255, s[4:7], s52 offen offset:3072 sc1 lds
 v_mfma_f32_16x16x32_bf16 v[216:219], v[68:71], a[232:235], v[216:219]
 s_add_u32 s52, s52, 16384
 ds_read_b128 v[108:111], v252 offset:13312
 v_mfma_f32_16x16x32_bf16 v[216:219], v[64:67], a[224:227], v[216:219]
 s_waitcnt lgkmcnt(5)
 v_mfma_f32_16x16x32_bf16 v[192:195], v[80:83], a[0:3], v[192:195]
 s_add_u32 m0, s32, 12288
 ds_read_b128 v[64:67], v252 offset:2048
 v_mfma_f32_16x16x32_bf16 v[192:195], v[84:87], a[8:11], v[192:195]
 buffer_load_dwordx4 v228, s[8:11], s46 offen lds
 v_mfma_f32_16x16x32_bf16 v[192:195], v[88:91], a[16:19], v[192:195]
 s_waitcnt vmcnt(13) lgkmcnt(5)
 ds_read_b128 v[68:71], v252 offset:6144
 ds_read_b128 a[80:83], v246 offset:4096
 v_mfma_f32_16x16x32_bf16 v[192:195], v[92:95], a[24:27], v[192:195]
 v_mfma_f32_16x16x32_bf16 v[196:199], v[92:95], a[28:31], v[196:199]
 ds_read_b128 v[72:75], v252 offset:10240
 ds_read_b128 a[84:87], v246 offset:6144
 v_mfma_f32_16x16x32_bf16 v[196:199], v[88:91], a[20:23], v[196:199]
 buffer_load_dwordx4 v229, s[8:11], s46 offen offset:1024 lds
 v_mfma_f32_16x16x32_bf16 v[196:199], v[84:87], a[12:15], v[196:199]
 ds_read_b128 v[76:79], v252 offset:14336
 ds_read_b128 a[88:91], v247 offset:4096
 v_mfma_f32_16x16x32_bf16 v[196:199], v[80:83], a[4:7], v[196:199]
 s_waitcnt lgkmcnt(8)
 v_mfma_f32_16x16x32_bf16 v[204:207], v[96:99], a[4:7], v[204:207]
 ds_read_b128 v[80:83], v252 offset:3072
 ds_read_b128 a[92:95], v247 offset:6144
 v_mfma_f32_16x16x32_bf16 v[204:207], v[100:103], a[12:15], v[204:207]
 buffer_load_dwordx4 v230, s[8:11], s46 offen offset:2048 lds
 v_mfma_f32_16x16x32_bf16 v[204:207], v[104:107], a[20:23], v[204:207]
 s_waitcnt lgkmcnt(9)
 ds_read_b128 v[84:87], v252 offset:7168
 v_mfma_f32_16x16x32_bf16 v[204:207], v[108:111], a[28:31], v[204:207]
 v_mfma_f32_16x16x32_bf16 v[200:203], v[108:111], a[24:27], v[200:203]
 ds_read_b128 v[88:91], v252 offset:11264
 v_mfma_f32_16x16x32_bf16 v[200:203], v[104:107], a[16:19], v[200:203]
 buffer_load_dwordx4 v231, s[8:11], s46 offen offset:3072 lds
 v_mfma_f32_16x16x32_bf16 v[200:203], v[100:103], a[8:11], v[200:203]
 s_add_u32 s46, s46, 128
 ds_read_b128 v[92:95], v252 offset:15360
 v_mfma_f32_16x16x32_bf16 v[200:203], v[96:99], a[0:3], v[200:203]
 s_barrier
 s_waitcnt lgkmcnt(10)
 v_mfma_f32_16x16x32_bf16 v[208:211], v[64:67], a[0:3], v[208:211]
 s_add_u32 m0, s44, 32768
 ds_read_b128 v[96:99], v252 offset:16384
 v_mfma_f32_16x16x32_bf16 v[208:211], v[68:71], a[8:11], v[208:211]
 s_waitcnt lgkmcnt(9)
 buffer_load_dwordx4 v255, s[4:7], s60 offen sc1 lds
 v_mfma_f32_16x16x32_bf16 v[208:211], v[72:75], a[16:19], v[208:211]
 s_waitcnt lgkmcnt(7)
 ds_read_b128 v[100:103], v252 offset:20480
 v_mfma_f32_16x16x32_bf16 v[208:211], v[76:79], a[24:27], v[208:211]
 v_mfma_f32_16x16x32_bf16 v[212:215], v[76:79], a[28:31], v[212:215]
 ds_read_b128 v[104:107], v252 offset:24576
 v_mfma_f32_16x16x32_bf16 v[212:215], v[72:75], a[20:23], v[212:215]
 buffer_load_dwordx4 v255, s[4:7], s60 offen offset:1024 sc1 lds
 v_mfma_f32_16x16x32_bf16 v[212:215], v[68:71], a[12:15], v[212:215]
 ds_read_b128 v[108:111], v252 offset:28672
 v_mfma_f32_16x16x32_bf16 v[212:215], v[64:67], a[4:7], v[212:215]
 s_waitcnt lgkmcnt(8)
 v_mfma_f32_16x16x32_bf16 v[220:223], v[80:83], a[4:7], v[220:223]
 s_waitcnt lgkmcnt(4)
 ds_read_b128 v[64:67], v252 offset:17408
 v_mfma_f32_16x16x32_bf16 v[220:223], v[84:87], a[12:15], v[220:223]
 buffer_load_dwordx4 v255, s[4:7], s60 offen offset:2048 sc1 lds
 v_mfma_f32_16x16x32_bf16 v[220:223], v[88:91], a[20:23], v[220:223]
 ds_read_b128 v[68:71], v252 offset:21504
 v_mfma_f32_16x16x32_bf16 v[220:223], v[92:95], a[28:31], v[220:223]
 v_mfma_f32_16x16x32_bf16 v[216:219], v[92:95], a[24:27], v[216:219]
 ds_read_b128 v[72:75], v252 offset:25600
 v_mfma_f32_16x16x32_bf16 v[216:219], v[88:91], a[16:19], v[216:219]
 buffer_load_dwordx4 v255, s[4:7], s60 offen offset:3072 sc1 lds
 v_mfma_f32_16x16x32_bf16 v[216:219], v[84:87], a[8:11], v[216:219]
 s_add_u32 s60, s60, 16384
 ds_read_b128 v[76:79], v252 offset:29696
 v_mfma_f32_16x16x32_bf16 v[216:219], v[80:83], a[0:3], v[216:219]
 s_waitcnt lgkmcnt(5)
 v_mfma_f32_16x16x32_bf16 v[192:195], v[96:99], a[32:35], v[192:195]
 s_add_u32 m0, s44, 49152
 ds_read_b128 v[80:83], v252 offset:18432
 v_mfma_f32_16x16x32_bf16 v[192:195], v[100:103], a[40:43], v[192:195]
 buffer_load_dwordx4 v255, s[4:7], s60 offen sc1 lds
 v_mfma_f32_16x16x32_bf16 v[192:195], v[104:107], a[48:51], v[192:195]
 s_waitcnt vmcnt(13) lgkmcnt(5)
 ds_read_b128 v[84:87], v252 offset:22528
 ds_read_b128 a[96:99], v246 offset:8192
 v_mfma_f32_16x16x32_bf16 v[192:195], v[108:111], a[56:59], v[192:195]
 v_mfma_f32_16x16x32_bf16 v[196:199], v[108:111], a[60:63], v[196:199]
 ds_read_b128 v[88:91], v252 offset:26624
 ds_read_b128 a[100:103], v246 offset:10240
 v_mfma_f32_16x16x32_bf16 v[196:199], v[104:107], a[52:55], v[196:199]
 buffer_load_dwordx4 v255, s[4:7], s60 offen offset:1024 sc1 lds
 v_mfma_f32_16x16x32_bf16 v[196:199], v[100:103], a[44:47], v[196:199]
 ds_read_b128 v[92:95], v252 offset:30720
 ds_read_b128 a[104:107], v247 offset:8192
 v_mfma_f32_16x16x32_bf16 v[196:199], v[96:99], a[36:39], v[196:199]
 s_waitcnt lgkmcnt(8)
 v_mfma_f32_16x16x32_bf16 v[204:207], v[64:67], a[36:39], v[204:207]
 ds_read_b128 v[96:99], v252 offset:19456
 ds_read_b128 a[108:111], v247 offset:10240
 v_mfma_f32_16x16x32_bf16 v[204:207], v[68:71], a[44:47], v[204:207]
 buffer_load_dwordx4 v255, s[4:7], s60 offen offset:2048 sc1 lds
 v_mfma_f32_16x16x32_bf16 v[204:207], v[72:75], a[52:55], v[204:207]
 s_waitcnt lgkmcnt(9)
 ds_read_b128 v[100:103], v252 offset:23552
 v_mfma_f32_16x16x32_bf16 v[204:207], v[76:79], a[60:63], v[204:207]
 v_mfma_f32_16x16x32_bf16 v[200:203], v[76:79], a[56:59], v[200:203]
 ds_read_b128 v[104:107], v252 offset:27648
 v_mfma_f32_16x16x32_bf16 v[200:203], v[72:75], a[48:51], v[200:203]
 buffer_load_dwordx4 v255, s[4:7], s60 offen offset:3072 sc1 lds
 v_mfma_f32_16x16x32_bf16 v[200:203], v[68:71], a[40:43], v[200:203]
 s_add_u32 s60, s60, 16384
 ds_read_b128 v[108:111], v252 offset:31744
 v_mfma_f32_16x16x32_bf16 v[200:203], v[64:67], a[32:35], v[200:203]
 s_barrier
 s_waitcnt lgkmcnt(10)
 v_mfma_f32_16x16x32_bf16 v[208:211], v[80:83], a[32:35], v[208:211]
 s_add_u32 m0, s55, 0
 ds_read_b128 v[64:67], v251 offset:0
 v_mfma_f32_16x16x32_bf16 v[208:211], v[84:87], a[40:43], v[208:211]
 s_waitcnt lgkmcnt(9)
 buffer_load_dwordx4 v255, s[4:7], s60 offen sc1 lds
 v_mfma_f32_16x16x32_bf16 v[208:211], v[88:91], a[48:51], v[208:211]
 s_waitcnt lgkmcnt(7)
 ds_read_b128 v[68:71], v251 offset:4096
 v_mfma_f32_16x16x32_bf16 v[208:211], v[92:95], a[56:59], v[208:211]
 v_mfma_f32_16x16x32_bf16 v[212:215], v[92:95], a[60:63], v[212:215]
 ds_read_b128 v[72:75], v251 offset:8192
 v_mfma_f32_16x16x32_bf16 v[212:215], v[88:91], a[52:55], v[212:215]
 buffer_load_dwordx4 v255, s[4:7], s60 offen offset:1024 sc1 lds
 v_mfma_f32_16x16x32_bf16 v[212:215], v[84:87], a[44:47], v[212:215]
 ds_read_b128 v[76:79], v251 offset:12288
 v_mfma_f32_16x16x32_bf16 v[212:215], v[80:83], a[36:39], v[212:215]
 s_waitcnt lgkmcnt(8)
 v_mfma_f32_16x16x32_bf16 v[220:223], v[96:99], a[36:39], v[220:223]
 s_waitcnt lgkmcnt(4)
 ds_read_b128 v[80:83], v251 offset:1024
 v_mfma_f32_16x16x32_bf16 v[220:223], v[100:103], a[44:47], v[220:223]
 buffer_load_dwordx4 v255, s[4:7], s60 offen offset:2048 sc1 lds
 v_mfma_f32_16x16x32_bf16 v[220:223], v[104:107], a[52:55], v[220:223]
 ds_read_b128 v[84:87], v251 offset:5120
 v_mfma_f32_16x16x32_bf16 v[220:223], v[108:111], a[60:63], v[220:223]
 v_mfma_f32_16x16x32_bf16 v[216:219], v[108:111], a[56:59], v[216:219]
 ds_read_b128 v[88:91], v251 offset:9216
 v_mfma_f32_16x16x32_bf16 v[216:219], v[104:107], a[48:51], v[216:219]
 buffer_load_dwordx4 v255, s[4:7], s60 offen offset:3072 sc1 lds
 v_mfma_f32_16x16x32_bf16 v[216:219], v[100:103], a[40:43], v[216:219]
 s_add_u32 s60, s60, 16384
 ds_read_b128 v[92:95], v251 offset:13312
 v_mfma_f32_16x16x32_bf16 v[216:219], v[96:99], a[32:35], v[216:219]
 s_waitcnt lgkmcnt(5)
 v_mfma_f32_16x16x32_bf16 v[192:195], v[64:67], a[64:67], v[192:195]
 s_add_u32 m0, s32, 0
 ds_read_b128 v[96:99], v251 offset:2048
 v_mfma_f32_16x16x32_bf16 v[192:195], v[68:71], a[72:75], v[192:195]
 buffer_load_dwordx4 v224, s[16:19], s43 offen lds
 v_mfma_f32_16x16x32_bf16 v[192:195], v[72:75], a[80:83], v[192:195]
 s_waitcnt vmcnt(13) lgkmcnt(5)
 ds_read_b128 v[100:103], v251 offset:6144
 ds_read_b128 a[112:115], v246 offset:12288
 v_mfma_f32_16x16x32_bf16 v[192:195], v[76:79], a[88:91], v[192:195]
 v_mfma_f32_16x16x32_bf16 v[196:199], v[76:79], a[92:95], v[196:199]
 ds_read_b128 v[104:107], v251 offset:10240
 ds_read_b128 a[116:119], v246 offset:14336
 v_mfma_f32_16x16x32_bf16 v[196:199], v[72:75], a[84:87], v[196:199]
 buffer_load_dwordx4 v225, s[16:19], s43 offen offset:1024 lds
 v_mfma_f32_16x16x32_bf16 v[196:199], v[68:71], a[76:79], v[196:199]
 ds_read_b128 v[108:111], v251 offset:14336
 ds_read_b128 a[120:123], v247 offset:12288
 v_mfma_f32_16x16x32_bf16 v[196:199], v[64:67], a[68:71], v[196:199]
 s_waitcnt lgkmcnt(8)
 v_mfma_f32_16x16x32_bf16 v[204:207], v[80:83], a[68:71], v[204:207]
 ds_read_b128 v[64:67], v251 offset:3072
 ds_read_b128 a[124:127], v247 offset:14336
 v_mfma_f32_16x16x32_bf16 v[204:207], v[84:87], a[76:79], v[204:207]
 buffer_load_dwordx4 v226, s[16:19], s43 offen offset:2048 lds
 v_mfma_f32_16x16x32_bf16 v[204:207], v[88:91], a[84:87], v[204:207]
 s_waitcnt lgkmcnt(9)
 ds_read_b128 v[68:71], v251 offset:7168
 v_mfma_f32_16x16x32_bf16 v[204:207], v[92:95], a[92:95], v[204:207]
 v_mfma_f32_16x16x32_bf16 v[200:203], v[92:95], a[88:91], v[200:203]
 ds_read_b128 v[72:75], v251 offset:11264
 v_mfma_f32_16x16x32_bf16 v[200:203], v[88:91], a[80:83], v[200:203]
 buffer_load_dwordx4 v227, s[16:19], s43 offen offset:3072 lds
 v_mfma_f32_16x16x32_bf16 v[200:203], v[84:87], a[72:75], v[200:203]
 s_add_u32 s43, s43, 131072
 ds_read_b128 v[76:79], v251 offset:15360
 v_mfma_f32_16x16x32_bf16 v[200:203], v[80:83], a[64:67], v[200:203]
 s_barrier
 s_waitcnt lgkmcnt(10)
 v_mfma_f32_16x16x32_bf16 v[208:211], v[96:99], a[64:67], v[208:211]
 s_add_u32 m0, s55, 16384
 ds_read_b128 v[80:83], v251 offset:16384
 v_mfma_f32_16x16x32_bf16 v[208:211], v[100:103], a[72:75], v[208:211]
 s_waitcnt lgkmcnt(9)
 buffer_load_dwordx4 v255, s[4:7], s60 offen sc1 lds
 v_mfma_f32_16x16x32_bf16 v[208:211], v[104:107], a[80:83], v[208:211]
 s_waitcnt lgkmcnt(7)
 ds_read_b128 v[84:87], v251 offset:20480
 v_mfma_f32_16x16x32_bf16 v[208:211], v[108:111], a[88:91], v[208:211]
 v_mfma_f32_16x16x32_bf16 v[212:215], v[108:111], a[92:95], v[212:215]
 ds_read_b128 v[88:91], v251 offset:24576
 v_mfma_f32_16x16x32_bf16 v[212:215], v[104:107], a[84:87], v[212:215]
 buffer_load_dwordx4 v255, s[4:7], s60 offen offset:1024 sc1 lds
 v_mfma_f32_16x16x32_bf16 v[212:215], v[100:103], a[76:79], v[212:215]
 ds_read_b128 v[92:95], v251 offset:28672
 v_mfma_f32_16x16x32_bf16 v[212:215], v[96:99], a[68:71], v[212:215]
 s_waitcnt lgkmcnt(8)
 v_mfma_f32_16x16x32_bf16 v[220:223], v[64:67], a[68:71], v[220:223]
 s_waitcnt lgkmcnt(4)
 ds_read_b128 v[96:99], v251 offset:17408
 v_mfma_f32_16x16x32_bf16 v[220:223], v[68:71], a[76:79], v[220:223]
 buffer_load_dwordx4 v255, s[4:7], s60 offen offset:2048 sc1 lds
 v_mfma_f32_16x16x32_bf16 v[220:223], v[72:75], a[84:87], v[220:223]
 ds_read_b128 v[100:103], v251 offset:21504
 v_mfma_f32_16x16x32_bf16 v[220:223], v[76:79], a[92:95], v[220:223]
 v_mfma_f32_16x16x32_bf16 v[216:219], v[76:79], a[88:91], v[216:219]
 ds_read_b128 v[104:107], v251 offset:25600
 v_mfma_f32_16x16x32_bf16 v[216:219], v[72:75], a[80:83], v[216:219]
 buffer_load_dwordx4 v255, s[4:7], s60 offen offset:3072 sc1 lds
 v_mfma_f32_16x16x32_bf16 v[216:219], v[68:71], a[72:75], v[216:219]
 s_add_u32 s60, s60, 16384
 ds_read_b128 v[108:111], v251 offset:29696
 v_mfma_f32_16x16x32_bf16 v[216:219], v[64:67], a[64:67], v[216:219]
 s_waitcnt lgkmcnt(5)
 v_mfma_f32_16x16x32_bf16 v[192:195], v[80:83], a[96:99], v[192:195]
 ds_read_b128 v[64:67], v251 offset:18432
 v_mfma_f32_16x16x32_bf16 v[192:195], v[84:87], a[104:107], v[192:195]
 v_mfma_f32_16x16x32_bf16 v[192:195], v[88:91], a[112:115], v[192:195]
 s_waitcnt lgkmcnt(5)
 ds_read_b128 v[68:71], v251 offset:22528
 v_mfma_f32_16x16x32_bf16 v[192:195], v[92:95], a[120:123], v[192:195]
 v_mfma_f32_16x16x32_bf16 v[196:199], v[92:95], a[124:127], v[196:199]
 ds_read_b128 v[72:75], v251 offset:26624
 v_mfma_f32_16x16x32_bf16 v[196:199], v[88:91], a[116:119], v[196:199]
 v_mfma_f32_16x16x32_bf16 v[196:199], v[84:87], a[108:111], v[196:199]
 ds_read_b128 v[76:79], v251 offset:30720
 v_mfma_f32_16x16x32_bf16 v[196:199], v[80:83], a[100:103], v[196:199]
 s_waitcnt lgkmcnt(5)
 v_mfma_f32_16x16x32_bf16 v[200:203], v[96:99], a[96:99], v[200:203]
 ds_read_b128 v[80:83], v251 offset:19456
 v_mfma_f32_16x16x32_bf16 v[200:203], v[100:103], a[104:107], v[200:203]
 v_mfma_f32_16x16x32_bf16 v[200:203], v[104:107], a[112:115], v[200:203]
 s_waitcnt lgkmcnt(5)
 ds_read_b128 v[84:87], v251 offset:23552
 v_mfma_f32_16x16x32_bf16 v[200:203], v[108:111], a[120:123], v[200:203]
 v_mfma_f32_16x16x32_bf16 v[204:207], v[108:111], a[124:127], v[204:207]
 ds_read_b128 v[88:91], v251 offset:27648
 v_mfma_f32_16x16x32_bf16 v[204:207], v[104:107], a[116:119], v[204:207]
 v_mfma_f32_16x16x32_bf16 v[204:207], v[100:103], a[108:111], v[204:207]
 s_waitcnt vmcnt(16)
 ds_read_b128 v[92:95], v251 offset:31744
 v_mfma_f32_16x16x32_bf16 v[204:207], v[96:99], a[100:103], v[204:207]
 s_barrier
 s_waitcnt lgkmcnt(5)
 v_mfma_f32_16x16x32_bf16 v[208:211], v[64:67], a[96:99], v[208:211]
 s_add_u32 m0, s44, 0
 ds_read_b128 v[96:99], v251 offset:32768
 v_mfma_f32_16x16x32_bf16 v[208:211], v[68:71], a[104:107], v[208:211]
 buffer_load_dwordx4 v255, s[4:7], s60 offen sc1 lds
 v_mfma_f32_16x16x32_bf16 v[208:211], v[72:75], a[112:115], v[208:211]
 s_waitcnt lgkmcnt(5)
 ds_read_b128 v[100:103], v251 offset:36864
 v_mfma_f32_16x16x32_bf16 v[208:211], v[76:79], a[120:123], v[208:211]
 v_mfma_f32_16x16x32_bf16 v[212:215], v[76:79], a[124:127], v[212:215]
 ds_read_b128 v[104:107], v251 offset:40960
 v_mfma_f32_16x16x32_bf16 v[212:215], v[72:75], a[116:119], v[212:215]
 buffer_load_dwordx4 v255, s[4:7], s60 offen offset:1024 sc1 lds
 v_mfma_f32_16x16x32_bf16 v[212:215], v[68:71], a[108:111], v[212:215]
 ds_read_b128 v[108:111], v251 offset:45056
 v_cvt_pk_bf16_f32 v192, v192, v193
 v_mfma_f32_16x16x32_bf16 v[212:215], v[64:67], a[100:103], v[212:215]
 s_waitcnt lgkmcnt(5)
 v_cvt_pk_bf16_f32 v193, v194, v195
 v_cvt_pk_bf16_f32 v194, v200, v201
 v_mfma_f32_16x16x32_bf16 v[216:219], v[80:83], a[96:99], v[216:219]
 ds_read_b128 v[64:67], v251 offset:33792
 v_cvt_pk_bf16_f32 v195, v202, v203
 v_mfma_f32_16x16x32_bf16 v[216:219], v[84:87], a[104:107], v[216:219]
 buffer_load_dwordx4 v255, s[4:7], s60 offen offset:2048 sc1 lds
 v_mfma_f32_16x16x32_bf16 v[216:219], v[88:91], a[112:115], v[216:219]
 s_waitcnt lgkmcnt(5)
 ds_read_b128 v[68:71], v251 offset:37888
 v_cvt_pk_bf16_f32 v196, v196, v197
 v_mfma_f32_16x16x32_bf16 v[216:219], v[92:95], a[120:123], v[216:219]
 v_cvt_pk_bf16_f32 v197, v198, v199
 v_cvt_pk_bf16_f32 v198, v204, v205
 v_mfma_f32_16x16x32_bf16 v[220:223], v[92:95], a[124:127], v[220:223]
 ds_read_b128 v[72:75], v251 offset:41984
 v_cvt_pk_bf16_f32 v199, v206, v207
 v_mfma_f32_16x16x32_bf16 v[220:223], v[88:91], a[116:119], v[220:223]
 buffer_load_dwordx4 v255, s[4:7], s60 offen offset:3072 sc1 lds
 v_mfma_f32_16x16x32_bf16 v[220:223], v[84:87], a[108:111], v[220:223]
 s_add_u32 s60, s60, 16384
 ds_read_b128 v[76:79], v251 offset:46080
 v_mfma_f32_16x16x32_bf16 v[220:223], v[80:83], a[100:103], v[220:223]
 s_waitcnt lgkmcnt(5)
 buffer_store_dwordx4 v[192:195], v255, s[4:7], s63 offen sc1
 v_mfma_f32_16x16x32_bf16 v[0:3], v[96:99], a[128:131], v[136:139]
 ds_read_b128 v[80:83], v251 offset:34816
 v_mfma_f32_16x16x32_bf16 v[0:3], v[100:103], a[136:139], v[0:3]
 v_mfma_f32_16x16x32_bf16 v[0:3], v[104:107], a[144:147], v[0:3]
 s_waitcnt lgkmcnt(5)
 ds_read_b128 v[84:87], v251 offset:38912
 v_cvt_pk_bf16_f32 v208, v208, v209
 v_mfma_f32_16x16x32_bf16 v[0:3], v[108:111], a[152:155], v[0:3]
 v_cvt_pk_bf16_f32 v209, v210, v211
 v_cvt_pk_bf16_f32 v210, v216, v217
 v_mfma_f32_16x16x32_bf16 v[4:7], v[108:111], a[156:159], v[140:143]
 ds_read_b128 v[88:91], v251 offset:43008
 v_cvt_pk_bf16_f32 v211, v218, v219
 v_mfma_f32_16x16x32_bf16 v[4:7], v[104:107], a[148:151], v[4:7]
 v_mfma_f32_16x16x32_bf16 v[4:7], v[100:103], a[140:143], v[4:7]
 ds_read_b128 v[92:95], v251 offset:47104
 v_cvt_pk_bf16_f32 v212, v212, v213
 v_mfma_f32_16x16x32_bf16 v[4:7], v[96:99], a[132:135], v[4:7]
 s_waitcnt lgkmcnt(5)
 v_cvt_pk_bf16_f32 v213, v214, v215
 v_cvt_pk_bf16_f32 v214, v220, v221
 v_mfma_f32_16x16x32_bf16 v[12:15], v[64:67], a[132:135], v[140:143]
 ds_read_b128 v[96:99], v251 offset:35840
 v_cvt_pk_bf16_f32 v215, v222, v223
 v_mfma_f32_16x16x32_bf16 v[12:15], v[68:71], a[140:143], v[12:15]
 v_mfma_f32_16x16x32_bf16 v[12:15], v[72:75], a[148:151], v[12:15]
 s_waitcnt lgkmcnt(5)
 ds_read_b128 v[100:103], v251 offset:39936
 v_mfma_f32_16x16x32_bf16 v[12:15], v[76:79], a[156:159], v[12:15]
 buffer_store_dwordx4 v[196:199], v255, s[4:7], s63 offen offset:1024 sc1
 v_mfma_f32_16x16x32_bf16 v[8:11], v[76:79], a[152:155], v[136:139]
 ds_read_b128 v[104:107], v251 offset:44032
 v_mfma_f32_16x16x32_bf16 v[8:11], v[72:75], a[144:147], v[8:11]
 v_mfma_f32_16x16x32_bf16 v[8:11], v[68:71], a[136:139], v[8:11]
 s_waitcnt vmcnt(18)
 ds_read_b128 v[108:111], v251 offset:48128
 v_mfma_f32_16x16x32_bf16 v[8:11], v[64:67], a[128:131], v[8:11]
 s_barrier
 buffer_store_dwordx4 v[208:211], v255, s[4:7], s63 offen offset:2048 sc1
 s_waitcnt lgkmcnt(5)
 v_mfma_f32_16x16x32_bf16 v[16:19], v[80:83], a[128:131], v[136:139]
 s_add_u32 m0, s44, 16384
 ds_read_b128 v[64:67], v251 offset:49152
 v_mfma_f32_16x16x32_bf16 v[16:19], v[84:87], a[136:139], v[16:19]
 buffer_load_dwordx4 v255, s[4:7], s60 offen sc1 lds
 v_mfma_f32_16x16x32_bf16 v[16:19], v[88:91], a[144:147], v[16:19]
 s_waitcnt lgkmcnt(5)
 ds_read_b128 v[68:71], v251 offset:53248
 v_mfma_f32_16x16x32_bf16 v[16:19], v[92:95], a[152:155], v[16:19]
 buffer_store_dwordx4 v[212:215], v255, s[4:7], s63 offen offset:3072 sc1
 v_mfma_f32_16x16x32_bf16 v[20:23], v[92:95], a[156:159], v[140:143]
 ds_read_b128 v[72:75], v251 offset:57344
 v_mfma_f32_16x16x32_bf16 v[20:23], v[88:91], a[148:151], v[20:23]
 buffer_load_dwordx4 v255, s[4:7], s60 offen offset:1024 sc1 lds
 v_mfma_f32_16x16x32_bf16 v[20:23], v[84:87], a[140:143], v[20:23]
 ds_read_b128 v[76:79], v251 offset:61440
 v_mfma_f32_16x16x32_bf16 v[20:23], v[80:83], a[132:135], v[20:23]
 s_waitcnt lgkmcnt(5)
 v_mfma_f32_16x16x32_bf16 v[28:31], v[96:99], a[132:135], v[140:143]
 ds_read_b128 v[80:83], v251 offset:50176
 v_mfma_f32_16x16x32_bf16 v[28:31], v[100:103], a[140:143], v[28:31]
 buffer_load_dwordx4 v255, s[4:7], s60 offen offset:2048 sc1 lds
 v_mfma_f32_16x16x32_bf16 v[28:31], v[104:107], a[148:151], v[28:31]
 s_waitcnt lgkmcnt(5)
 ds_read_b128 v[84:87], v251 offset:54272
 v_mfma_f32_16x16x32_bf16 v[28:31], v[108:111], a[156:159], v[28:31]
 v_mfma_f32_16x16x32_bf16 v[24:27], v[108:111], a[152:155], v[136:139]
 ds_read_b128 v[88:91], v251 offset:58368
 v_mfma_f32_16x16x32_bf16 v[24:27], v[104:107], a[144:147], v[24:27]
 buffer_load_dwordx4 v255, s[4:7], s60 offen offset:3072 sc1 lds
 v_mfma_f32_16x16x32_bf16 v[24:27], v[100:103], a[136:139], v[24:27]
 s_add_u32 s60, s60, 16384
 ds_read_b128 v[92:95], v251 offset:62464
 v_mfma_f32_16x16x32_bf16 v[24:27], v[96:99], a[128:131], v[24:27]
 s_waitcnt lgkmcnt(5)
 v_mfma_f32_16x16x32_bf16 v[0:3], v[64:67], a[160:163], v[0:3]
Lw2_7:
 s_cbranch_execz Lw2_back
 ds_read_b128 v[96:99], v251 offset:51200
 v_mfma_f32_16x16x32_bf16 v[0:3], v[68:71], a[168:171], v[0:3]
 v_mfma_f32_16x16x32_bf16 v[0:3], v[72:75], a[176:179], v[0:3]
 s_waitcnt lgkmcnt(5)
 ds_read_b128 v[100:103], v251 offset:55296
 v_mfma_f32_16x16x32_bf16 v[0:3], v[76:79], a[184:187], v[0:3]
 v_mfma_f32_16x16x32_bf16 v[4:7], v[76:79], a[188:191], v[4:7]
 ds_read_b128 v[104:107], v251 offset:59392
 v_mfma_f32_16x16x32_bf16 v[4:7], v[72:75], a[180:183], v[4:7]
 v_mfma_f32_16x16x32_bf16 v[4:7], v[68:71], a[172:175], v[4:7]
 ds_read_b128 v[108:111], v251 offset:63488
 v_mfma_f32_16x16x32_bf16 v[4:7], v[64:67], a[164:167], v[4:7]
 s_waitcnt lgkmcnt(5)
 v_mfma_f32_16x16x32_bf16 v[12:15], v[80:83], a[164:167], v[12:15]
 ds_read_b128 v[64:67], v251 offset:52224
 v_mfma_f32_16x16x32_bf16 v[12:15], v[84:87], a[172:175], v[12:15]
 v_mfma_f32_16x16x32_bf16 v[12:15], v[88:91], a[180:183], v[12:15]
 s_waitcnt lgkmcnt(5)
 ds_read_b128 v[68:71], v251 offset:56320
 v_mfma_f32_16x16x32_bf16 v[12:15], v[92:95], a[188:191], v[12:15]
 v_mfma_f32_16x16x32_bf16 v[8:11], v[92:95], a[184:187], v[8:11]
 ds_read_b128 v[72:75], v251 offset:60416
 v_mfma_f32_16x16x32_bf16 v[8:11], v[88:91], a[176:179], v[8:11]
 v_mfma_f32_16x16x32_bf16 v[8:11], v[84:87], a[168:171], v[8:11]
 s_waitcnt vmcnt(20)
 ds_read_b128 v[76:79], v251 offset:64512
 v_mfma_f32_16x16x32_bf16 v[8:11], v[80:83], a[160:163], v[8:11]
 s_barrier
 s_waitcnt lgkmcnt(5)
 v_mfma_f32_16x16x32_bf16 v[16:19], v[96:99], a[160:163], v[16:19]
 s_add_u32 m0, s44, 32768
 ds_read_b128 v[80:83], v252 offset:0
 v_mfma_f32_16x16x32_bf16 v[16:19], v[100:103], a[168:171], v[16:19]
 buffer_load_dwordx4 v255, s[4:7], s60 offen sc1 lds
 v_mfma_f32_16x16x32_bf16 v[16:19], v[104:107], a[176:179], v[16:19]
 s_waitcnt lgkmcnt(5)
 ds_read_b128 v[84:87], v252 offset:4096
 v_mfma_f32_16x16x32_bf16 v[16:19], v[108:111], a[184:187], v[16:19]
 v_mfma_f32_16x16x32_bf16 v[20:23], v[108:111], a[188:191], v[20:23]
 ds_read_b128 v[88:91], v252 offset:8192
 v_mfma_f32_16x16x32_bf16 v[20:23], v[104:107], a[180:183], v[20:23]
 buffer_load_dwordx4 v255, s[4:7], s60 offen offset:1024 sc1 lds
 v_mfma_f32_16x16x32_bf16 v[20:23], v[100:103], a[172:175], v[20:23]
 ds_read_b128 v[92:95], v252 offset:12288
 v_mfma_f32_16x16x32_bf16 v[20:23], v[96:99], a[164:167], v[20:23]
 s_waitcnt lgkmcnt(5)
 v_mfma_f32_16x16x32_bf16 v[28:31], v[64:67], a[164:167], v[28:31]
 ds_read_b128 v[96:99], v252 offset:1024
 v_mfma_f32_16x16x32_bf16 v[28:31], v[68:71], a[172:175], v[28:31]
 buffer_load_dwordx4 v255, s[4:7], s60 offen offset:2048 sc1 lds
 v_mfma_f32_16x16x32_bf16 v[28:31], v[72:75], a[180:183], v[28:31]
 s_waitcnt lgkmcnt(5)
 ds_read_b128 v[100:103], v252 offset:5120
 v_mfma_f32_16x16x32_bf16 v[28:31], v[76:79], a[188:191], v[28:31]
 v_mfma_f32_16x16x32_bf16 v[24:27], v[76:79], a[184:187], v[24:27]
 ds_read_b128 v[104:107], v252 offset:9216
 v_mfma_f32_16x16x32_bf16 v[24:27], v[72:75], a[176:179], v[24:27]
 buffer_load_dwordx4 v255, s[4:7], s60 offen offset:3072 sc1 lds
 v_mfma_f32_16x16x32_bf16 v[24:27], v[68:71], a[168:171], v[24:27]
 s_add_u32 s60, s60, 16384
 ds_read_b128 v[108:111], v252 offset:13312
 v_mfma_f32_16x16x32_bf16 v[24:27], v[64:67], a[160:163], v[24:27]
 s_waitcnt lgkmcnt(5)
 v_mfma_f32_16x16x32_bf16 v[0:3], v[80:83], a[192:195], v[0:3]
 ds_read_b128 v[64:67], v252 offset:2048
 v_mfma_f32_16x16x32_bf16 v[0:3], v[84:87], a[200:203], v[0:3]
 v_mfma_f32_16x16x32_bf16 v[0:3], v[88:91], a[208:211], v[0:3]
 s_waitcnt lgkmcnt(5)
 ds_read_b128 v[68:71], v252 offset:6144
 v_mfma_f32_16x16x32_bf16 v[0:3], v[92:95], a[216:219], v[0:3]
 v_mfma_f32_16x16x32_bf16 v[4:7], v[92:95], a[220:223], v[4:7]
 ds_read_b128 v[72:75], v252 offset:10240
 v_mfma_f32_16x16x32_bf16 v[4:7], v[88:91], a[212:215], v[4:7]
 v_mfma_f32_16x16x32_bf16 v[4:7], v[84:87], a[204:207], v[4:7]
 ds_read_b128 v[76:79], v252 offset:14336
 v_mfma_f32_16x16x32_bf16 v[4:7], v[80:83], a[196:199], v[4:7]
 s_waitcnt lgkmcnt(5)
 v_mfma_f32_16x16x32_bf16 v[12:15], v[96:99], a[196:199], v[12:15]
 ds_read_b128 v[80:83], v252 offset:3072
 v_mfma_f32_16x16x32_bf16 v[12:15], v[100:103], a[204:207], v[12:15]
 v_mfma_f32_16x16x32_bf16 v[12:15], v[104:107], a[212:215], v[12:15]
 s_waitcnt lgkmcnt(5)
 ds_read_b128 v[84:87], v252 offset:7168
 v_mfma_f32_16x16x32_bf16 v[12:15], v[108:111], a[220:223], v[12:15]
 v_mfma_f32_16x16x32_bf16 v[8:11], v[108:111], a[216:219], v[8:11]
 ds_read_b128 v[88:91], v252 offset:11264
 v_mfma_f32_16x16x32_bf16 v[8:11], v[104:107], a[208:211], v[8:11]
 v_mfma_f32_16x16x32_bf16 v[8:11], v[100:103], a[200:203], v[8:11]
 s_waitcnt vmcnt(16)
 ds_read_b128 v[92:95], v252 offset:15360
 v_mfma_f32_16x16x32_bf16 v[8:11], v[96:99], a[192:195], v[8:11]
 s_barrier
 s_waitcnt lgkmcnt(5)
 v_mfma_f32_16x16x32_bf16 v[16:19], v[64:67], a[192:195], v[16:19]
 s_add_u32 m0, s44, 49152
 ds_read_b128 v[96:99], v252 offset:16384
 v_mfma_f32_16x16x32_bf16 v[16:19], v[68:71], a[200:203], v[16:19]
 buffer_load_dwordx4 v255, s[4:7], s60 offen sc1 lds
 v_mfma_f32_16x16x32_bf16 v[16:19], v[72:75], a[208:211], v[16:19]
 s_waitcnt lgkmcnt(5)
 ds_read_b128 v[100:103], v252 offset:20480
 v_mfma_f32_16x16x32_bf16 v[16:19], v[76:79], a[216:219], v[16:19]
 buffer_load_dwordx4 v[112:115], v255, s[4:7], s62 offen sc1
 v_mfma_f32_16x16x32_bf16 v[20:23], v[76:79], a[220:223], v[20:23]
 ds_read_b128 v[104:107], v252 offset:24576
 v_mfma_f32_16x16x32_bf16 v[20:23], v[72:75], a[212:215], v[20:23]
 buffer_load_dwordx4 v255, s[4:7], s60 offen offset:1024 sc1 lds
 v_mfma_f32_16x16x32_bf16 v[20:23], v[68:71], a[204:207], v[20:23]
 ds_read_b128 v[108:111], v252 offset:28672
 v_mfma_f32_16x16x32_bf16 v[20:23], v[64:67], a[196:199], v[20:23]
 s_waitcnt lgkmcnt(5)
 buffer_load_dwordx4 v[116:119], v255, s[4:7], s62 offen offset:1024 sc1
 v_mfma_f32_16x16x32_bf16 v[28:31], v[80:83], a[196:199], v[28:31]
 ds_read_b128 v[64:67], v252 offset:17408
 v_mfma_f32_16x16x32_bf16 v[28:31], v[84:87], a[204:207], v[28:31]
 buffer_load_dwordx4 v255, s[4:7], s60 offen offset:2048 sc1 lds
 v_mfma_f32_16x16x32_bf16 v[28:31], v[88:91], a[212:215], v[28:31]
 s_waitcnt lgkmcnt(5)
 ds_read_b128 v[68:71], v252 offset:21504
 v_mfma_f32_16x16x32_bf16 v[28:31], v[92:95], a[220:223], v[28:31]
 buffer_load_dwordx4 v[120:123], v255, s[4:7], s62 offen offset:2048 sc1
 v_mfma_f32_16x16x32_bf16 v[24:27], v[92:95], a[216:219], v[24:27]
 ds_read_b128 v[72:75], v252 offset:25600
 v_mfma_f32_16x16x32_bf16 v[24:27], v[88:91], a[208:211], v[24:27]
 buffer_load_dwordx4 v255, s[4:7], s60 offen offset:3072 sc1 lds
 v_mfma_f32_16x16x32_bf16 v[24:27], v[84:87], a[200:203], v[24:27]
 s_add_u32 s60, s60, 16384
 ds_read_b128 v[76:79], v252 offset:29696
 v_mfma_f32_16x16x32_bf16 v[24:27], v[80:83], a[192:195], v[24:27]
 s_waitcnt lgkmcnt(5)
 buffer_load_dwordx4 v[124:127], v255, s[4:7], s62 offen offset:3072 sc1
 v_mfma_f32_16x16x32_bf16 v[0:3], v[96:99], a[224:227], v[0:3]
 ds_read_b128 v[80:83], v252 offset:18432
 v_mfma_f32_16x16x32_bf16 v[0:3], v[100:103], a[232:235], v[0:3]
 v_mfma_f32_16x16x32_bf16 v[0:3], v[104:107], a[240:243], v[0:3]
 s_waitcnt lgkmcnt(5)
 ds_read_b128 v[84:87], v252 offset:22528
 v_mfma_f32_16x16x32_bf16 v[0:3], v[108:111], a[248:251], v[0:3]
 v_mfma_f32_16x16x32_bf16 v[4:7], v[108:111], a[252:255], v[4:7]
 ds_read_b128 v[88:91], v252 offset:26624
 v_mfma_f32_16x16x32_bf16 v[4:7], v[104:107], a[244:247], v[4:7]
 v_mfma_f32_16x16x32_bf16 v[4:7], v[100:103], a[236:239], v[4:7]
 ds_read_b128 v[92:95], v252 offset:30720
 v_mfma_f32_16x16x32_bf16 v[4:7], v[96:99], a[228:231], v[4:7]
 s_waitcnt lgkmcnt(5)
 v_mfma_f32_16x16x32_bf16 v[12:15], v[64:67], a[228:231], v[12:15]
 ds_read_b128 v[96:99], v252 offset:19456
 v_mfma_f32_16x16x32_bf16 v[12:15], v[68:71], a[236:239], v[12:15]
 v_mfma_f32_16x16x32_bf16 v[12:15], v[72:75], a[244:247], v[12:15]
 s_waitcnt lgkmcnt(5)
 ds_read_b128 v[100:103], v252 offset:23552
 v_mfma_f32_16x16x32_bf16 v[12:15], v[76:79], a[252:255], v[12:15]
 v_mfma_f32_16x16x32_bf16 v[8:11], v[76:79], a[248:251], v[8:11]
 ds_read_b128 v[104:107], v252 offset:27648
 v_mfma_f32_16x16x32_bf16 v[8:11], v[72:75], a[240:243], v[8:11]
 v_mfma_f32_16x16x32_bf16 v[8:11], v[68:71], a[232:235], v[8:11]
 s_waitcnt vmcnt(20)
 ds_read_b128 v[108:111], v252 offset:31744
 v_mfma_f32_16x16x32_bf16 v[8:11], v[64:67], a[224:227], v[8:11]
 s_barrier
 s_waitcnt lgkmcnt(5)
 v_mfma_f32_16x16x32_bf16 v[16:19], v[80:83], a[224:227], v[16:19]
 ds_read_b128 v[64:67], v251 offset:0
 v_mfma_f32_16x16x32_bf16 v[16:19], v[84:87], a[232:235], v[16:19]
 v_mfma_f32_16x16x32_bf16 v[16:19], v[88:91], a[240:243], v[16:19]
 s_waitcnt lgkmcnt(5)
 ds_read_b128 v[68:71], v251 offset:4096
 v_mfma_f32_16x16x32_bf16 v[16:19], v[92:95], a[248:251], v[16:19]
 v_mfma_f32_16x16x32_bf16 v[20:23], v[92:95], a[252:255], v[20:23]
 ds_read_b128 v[72:75], v251 offset:8192
 v_mfma_f32_16x16x32_bf16 v[20:23], v[88:91], a[244:247], v[20:23]
 v_mfma_f32_16x16x32_bf16 v[20:23], v[84:87], a[236:239], v[20:23]
 ds_read_b128 v[76:79], v251 offset:12288
 v_mfma_f32_16x16x32_bf16 v[20:23], v[80:83], a[228:231], v[20:23]
 s_waitcnt lgkmcnt(5)
 v_mfma_f32_16x16x32_bf16 v[28:31], v[96:99], a[228:231], v[28:31]
 ds_read_b128 v[80:83], v251 offset:1024
 v_mfma_f32_16x16x32_bf16 v[28:31], v[100:103], a[236:239], v[28:31]
 v_mfma_f32_16x16x32_bf16 v[28:31], v[104:107], a[244:247], v[28:31]
 s_waitcnt lgkmcnt(5)
 ds_read_b128 v[84:87], v251 offset:5120
 v_mfma_f32_16x16x32_bf16 v[28:31], v[108:111], a[252:255], v[28:31]
 v_mfma_f32_16x16x32_bf16 v[24:27], v[108:111], a[248:251], v[24:27]
 ds_read_b128 v[88:91], v251 offset:9216
 v_mfma_f32_16x16x32_bf16 v[24:27], v[104:107], a[240:243], v[24:27]
 v_mfma_f32_16x16x32_bf16 v[24:27], v[100:103], a[232:235], v[24:27]
 ds_read_b128 v[92:95], v251 offset:13312
 v_mfma_f32_16x16x32_bf16 v[24:27], v[96:99], a[224:227], v[24:27]
 s_waitcnt lgkmcnt(5)
 v_mfma_f32_16x16x32_bf16 v[0:3], v[64:67], a[0:3], v[0:3]
 s_add_u32 m0, s32, 4096
 ds_read_b128 v[96:99], v251 offset:2048
 v_mfma_f32_16x16x32_bf16 v[0:3], v[68:71], a[8:11], v[0:3]
 buffer_load_dwordx4 v224, s[16:19], s43 offen lds
 v_mfma_f32_16x16x32_bf16 v[0:3], v[72:75], a[16:19], v[0:3]
 s_waitcnt lgkmcnt(5)
 ds_read_b128 v[100:103], v251 offset:6144
 v_mfma_f32_16x16x32_bf16 v[0:3], v[76:79], a[24:27], v[0:3]
 v_mfma_f32_16x16x32_bf16 v[4:7], v[76:79], a[28:31], v[4:7]
 ds_read_b128 v[104:107], v251 offset:10240
 v_mfma_f32_16x16x32_bf16 v[4:7], v[72:75], a[20:23], v[4:7]
 buffer_load_dwordx4 v225, s[16:19], s43 offen offset:1024 lds
 v_mfma_f32_16x16x32_bf16 v[4:7], v[68:71], a[12:15], v[4:7]
 ds_read_b128 v[108:111], v251 offset:14336
 v_mfma_f32_16x16x32_bf16 v[4:7], v[64:67], a[4:7], v[4:7]
 s_waitcnt lgkmcnt(5)
 v_mfma_f32_16x16x32_bf16 v[12:15], v[80:83], a[4:7], v[12:15]
 ds_read_b128 v[64:67], v251 offset:3072
 v_mfma_f32_16x16x32_bf16 v[12:15], v[84:87], a[12:15], v[12:15]
 buffer_load_dwordx4 v226, s[16:19], s43 offen offset:2048 lds
 v_mfma_f32_16x16x32_bf16 v[12:15], v[88:91], a[20:23], v[12:15]
 s_waitcnt lgkmcnt(5)
 ds_read_b128 v[68:71], v251 offset:7168
 v_mfma_f32_16x16x32_bf16 v[12:15], v[92:95], a[28:31], v[12:15]
 v_mfma_f32_16x16x32_bf16 v[8:11], v[92:95], a[24:27], v[8:11]
 ds_read_b128 v[72:75], v251 offset:11264
 v_mfma_f32_16x16x32_bf16 v[8:11], v[88:91], a[16:19], v[8:11]
 buffer_load_dwordx4 v227, s[16:19], s43 offen offset:3072 lds
 v_mfma_f32_16x16x32_bf16 v[8:11], v[84:87], a[8:11], v[8:11]
 s_waitcnt vmcnt(16)
 s_add_u32 s43, s43, 131072
 ds_read_b128 v[76:79], v251 offset:15360
 v_mfma_f32_16x16x32_bf16 v[8:11], v[80:83], a[0:3], v[8:11]
 s_barrier
 s_waitcnt lgkmcnt(5)
 v_mfma_f32_16x16x32_bf16 v[16:19], v[96:99], a[0:3], v[16:19]
 s_add_u32 m0, s32, 8192
 ds_read_b128 v[80:83], v251 offset:16384
 v_mfma_f32_16x16x32_bf16 v[16:19], v[100:103], a[8:11], v[16:19]
 buffer_load_dwordx4 v224, s[16:19], s43 offen lds
 v_mfma_f32_16x16x32_bf16 v[16:19], v[104:107], a[16:19], v[16:19]
 s_waitcnt lgkmcnt(5)
 ds_read_b128 v[84:87], v251 offset:20480
 v_mfma_f32_16x16x32_bf16 v[16:19], v[108:111], a[24:27], v[16:19]
 s_waitcnt vmcnt(5)
 v_max3_u32 v232, v112, v113, v114
 v_max3_u32 v232, v232, v115, v116
 v_max3_u32 v232, v232, v117, v118
 v_max3_u32 v232, v232, v119, v120
 v_max3_u32 v232, v232, v121, v122
 v_max3_u32 v232, v232, v123, v124
 v_max3_u32 v232, v232, v125, v126
 v_max_u32 v232, v232, v127
 v_cmp_eq_u32 vcc, -1, v232
 s_nop 1
 s_cbranch_vccnz Ltag23
Ltag23b:
 v_mfma_f32_16x16x32_bf16 v[20:23], v[108:111], a[28:31], v[20:23]
 ds_read_b128 v[88:91], v251 offset:24576
 v_lshlrev_b32 v192, 16, v112
 v_mfma_f32_16x16x32_bf16 v[20:23], v[104:107], a[20:23], v[20:23]
 buffer_load_dwordx4 v225, s[16:19], s43 offen offset:1024 lds
 v_mfma_f32_16x16x32_bf16 v[20:23], v[100:103], a[12:15], v[20:23]
 ds_read_b128 v[92:95], v251 offset:28672
 v_and_b32 v193, 0xffff0000, v112
 v_mfma_f32_16x16x32_bf16 v[20:23], v[96:99], a[4:7], v[20:23]
 s_waitcnt lgkmcnt(5)
 v_mul_f32 v192, v192, v32
 v_mul_f32 v193, v193, v33
 v_mfma_f32_16x16x32_bf16 v[28:31], v[64:67], a[4:7], v[28:31]
 ds_read_b128 v[96:99], v251 offset:17408
 v_lshlrev_b32 v194, 16, v113
 v_mfma_f32_16x16x32_bf16 v[28:31], v[68:71], a[12:15], v[28:31]
 buffer_load_dwordx4 v226, s[16:19], s43 offen offset:2048 lds
 v_mfma_f32_16x16x32_bf16 v[28:31], v[72:75], a[20:23], v[28:31]
 s_waitcnt lgkmcnt(5)
 ds_read_b128 v[100:103], v251 offset:21504
 v_and_b32 v195, 0xffff0000, v113
 v_mfma_f32_16x16x32_bf16 v[28:31], v[76:79], a[28:31], v[28:31]
 v_mul_f32 v194, v194, v34
 v_mul_f32 v195, v195, v35
 v_mfma_f32_16x16x32_bf16 v[24:27], v[76:79], a[24:27], v[24:27]
 ds_read_b128 v[104:107], v251 offset:25600
 v_lshlrev_b32 v200, 16, v114
 v_mfma_f32_16x16x32_bf16 v[24:27], v[72:75], a[16:19], v[24:27]
 buffer_load_dwordx4 v227, s[16:19], s43 offen offset:3072 lds
 v_mfma_f32_16x16x32_bf16 v[24:27], v[68:71], a[8:11], v[24:27]
 s_add_u32 s43, s43, 131072
 ds_read_b128 v[108:111], v251 offset:29696
 v_and_b32 v201, 0xffff0000, v114
 v_mfma_f32_16x16x32_bf16 v[24:27], v[64:67], a[0:3], v[24:27]
 s_waitcnt lgkmcnt(5)
 v_mul_f32 v200, v200, v40
 v_mul_f32 v201, v201, v41
 v_mfma_f32_16x16x32_bf16 v[0:3], v[80:83], a[32:35], v[0:3]
 s_add_u32 m0, s32, 12288
 ds_read_b128 v[64:67], v251 offset:18432
 v_lshlrev_b32 v202, 16, v115
 v_mfma_f32_16x16x32_bf16 v[0:3], v[84:87], a[40:43], v[0:3]
 buffer_load_dwordx4 v224, s[16:19], s43 offen lds
 v_mfma_f32_16x16x32_bf16 v[0:3], v[88:91], a[48:51], v[0:3]
 s_waitcnt lgkmcnt(5)
 ds_read_b128 v[68:71], v251 offset:22528
 v_and_b32 v203, 0xffff0000, v115
 v_mfma_f32_16x16x32_bf16 v[0:3], v[92:95], a[56:59], v[0:3]
 v_mul_f32 v202, v202, v42
 v_mul_f32 v203, v203, v43
 v_mfma_f32_16x16x32_bf16 v[4:7], v[92:95], a[60:63], v[4:7]
 ds_read_b128 v[72:75], v251 offset:26624
 v_lshlrev_b32 v196, 16, v116
 v_mfma_f32_16x16x32_bf16 v[4:7], v[88:91], a[52:55], v[4:7]
 buffer_load_dwordx4 v225, s[16:19], s43 offen offset:1024 lds
 v_mfma_f32_16x16x32_bf16 v[4:7], v[84:87], a[44:47], v[4:7]
 ds_read_b128 v[76:79], v251 offset:30720
 v_and_b32 v197, 0xffff0000, v116
 v_mfma_f32_16x16x32_bf16 v[4:7], v[80:83], a[36:39], v[4:7]
 s_waitcnt lgkmcnt(5)
 v_mul_f32 v196, v196, v36
 v_mul_f32 v197, v197, v37
 v_mfma_f32_16x16x32_bf16 v[12:15], v[96:99], a[36:39], v[12:15]
 ds_read_b128 v[80:83], v251 offset:19456
 v_lshlrev_b32 v198, 16, v117
 v_mfma_f32_16x16x32_bf16 v[12:15], v[100:103], a[44:47], v[12:15]
 buffer_load_dwordx4 v226, s[16:19], s43 offen offset:2048 lds
 v_mfma_f32_16x16x32_bf16 v[12:15], v[104:107], a[52:55], v[12:15]
 s_waitcnt lgkmcnt(5)
 ds_read_b128 v[84:87], v251 offset:23552
 v_and_b32 v199, 0xffff0000, v117
 v_mfma_f32_16x16x32_bf16 v[12:15], v[108:111], a[60:63], v[12:15]
 v_mul_f32 v198, v198, v38
 v_mul_f32 v199, v199, v39
 v_mfma_f32_16x16x32_bf16 v[8:11], v[108:111], a[56:59], v[8:11]
 ds_read_b128 v[88:91], v251 offset:27648
 v_lshlrev_b32 v204, 16, v118
 v_mfma_f32_16x16x32_bf16 v[8:11], v[104:107], a[48:51], v[8:11]
 buffer_load_dwordx4 v227, s[16:19], s43 offen offset:3072 lds
 v_mfma_f32_16x16x32_bf16 v[8:11], v[100:103], a[40:43], v[8:11]
 s_add_u32 s43, s43, 131072
 ds_read_b128 v[92:95], v251 offset:31744
 v_and_b32 v205, 0xffff0000, v118
 v_mfma_f32_16x16x32_bf16 v[8:11], v[96:99], a[32:35], v[8:11]
 s_barrier
 v_mul_f32 v204, v204, v44
 v_mul_f32 v205, v205, v45
 s_waitcnt lgkmcnt(5)
 v_mfma_f32_16x16x32_bf16 v[16:19], v[64:67], a[32:35], v[16:19]
 s_add_u32 m0, s35, 0
 ds_read_b128 v[96:99], v251 offset:32768
 v_lshlrev_b32 v206, 16, v119
 v_mfma_f32_16x16x32_bf16 v[16:19], v[68:71], a[40:43], v[16:19]
 buffer_load_dwordx4 v224, s[16:19], s43 offen lds
 v_mfma_f32_16x16x32_bf16 v[16:19], v[72:75], a[48:51], v[16:19]
 s_waitcnt lgkmcnt(5)
 ds_read_b128 v[100:103], v251 offset:36864
 v_and_b32 v207, 0xffff0000, v119
 v_mfma_f32_16x16x32_bf16 v[16:19], v[76:79], a[56:59], v[16:19]
 v_mul_f32 v206, v206, v46
 v_mul_f32 v207, v207, v47
 v_mfma_f32_16x16x32_bf16 v[20:23], v[76:79], a[60:63], v[20:23]
 ds_read_b128 v[104:107], v251 offset:40960
 v_lshlrev_b32 v208, 16, v120
 v_mfma_f32_16x16x32_bf16 v[20:23], v[72:75], a[52:55], v[20:23]
 buffer_load_dwordx4 v225, s[16:19], s43 offen offset:1024 lds
 v_mfma_f32_16x16x32_bf16 v[20:23], v[68:71], a[44:47], v[20:23]
 ds_read_b128 v[108:111], v251 offset:45056
 v_and_b32 v209, 0xffff0000, v120
 v_mfma_f32_16x16x32_bf16 v[20:23], v[64:67], a[36:39], v[20:23]
 s_waitcnt lgkmcnt(5)
 v_mul_f32 v208, v208, v48
 v_mul_f32 v209, v209, v49
 v_mfma_f32_16x16x32_bf16 v[28:31], v[80:83], a[36:39], v[28:31]
 ds_read_b128 v[64:67], v251 offset:33792
 v_lshlrev_b32 v210, 16, v121
 v_mfma_f32_16x16x32_bf16 v[28:31], v[84:87], a[44:47], v[28:31]
 buffer_load_dwordx4 v226, s[16:19], s43 offen offset:2048 lds
 v_mfma_f32_16x16x32_bf16 v[28:31], v[88:91], a[52:55], v[28:31]
 s_waitcnt lgkmcnt(5)
 ds_read_b128 v[68:71], v251 offset:37888
 v_and_b32 v211, 0xffff0000, v121
 v_mfma_f32_16x16x32_bf16 v[28:31], v[92:95], a[60:63], v[28:31]
 v_mul_f32 v210, v210, v50
 v_mul_f32 v211, v211, v51
 v_mfma_f32_16x16x32_bf16 v[24:27], v[92:95], a[56:59], v[24:27]
 ds_read_b128 v[72:75], v251 offset:41984
 v_lshlrev_b32 v216, 16, v122
 v_mfma_f32_16x16x32_bf16 v[24:27], v[88:91], a[48:51], v[24:27]
 buffer_load_dwordx4 v227, s[16:19], s43 offen offset:3072 lds
 v_mfma_f32_16x16x32_bf16 v[24:27], v[84:87], a[40:43], v[24:27]
 s_add_u32 s43, s43, 131072
 ds_read_b128 v[76:79], v251 offset:46080
 v_and_b32 v217, 0xffff0000, v122
 v_mfma_f32_16x16x32_bf16 v[24:27], v[80:83], a[32:35], v[24:27]
 s_waitcnt lgkmcnt(5)
 v_mul_f32 v216, v216, v56
 v_mul_f32 v217, v217, v57
 v_mfma_f32_16x16x32_bf16 v[0:3], v[96:99], a[64:67], v[0:3]
 ds_read_b128 v[80:83], v251 offset:34816
 v_lshlrev_b32 v218, 16, v123
 v_mfma_f32_16x16x32_bf16 v[0:3], v[100:103], a[72:75], v[0:3]
 v_mfma_f32_16x16x32_bf16 v[0:3], v[104:107], a[80:83], v[0:3]
 s_waitcnt lgkmcnt(5)
 ds_read_b128 v[84:87], v251 offset:38912
 v_and_b32 v219, 0xffff0000, v123
 v_mfma_f32_16x16x32_bf16 v[0:3], v[108:111], a[88:91], v[0:3]
 v_mul_f32 v218, v218, v58
 v_mul_f32 v219, v219, v59
 v_mfma_f32_16x16x32_bf16 v[4:7], v[108:111], a[92:95], v[4:7]
 ds_read_b128 v[88:91], v251 offset:43008
 v_lshlrev_b32 v212, 16, v124
 v_mfma_f32_16x16x32_bf16 v[4:7], v[104:107], a[84:87], v[4:7]
 v_mfma_f32_16x16x32_bf16 v[4:7], v[100:103], a[76:79], v[4:7]
 ds_read_b128 v[92:95], v251 offset:47104
 v_and_b32 v213, 0xffff0000, v124
 v_mfma_f32_16x16x32_bf16 v[4:7], v[96:99], a[68:71], v[4:7]
 s_waitcnt lgkmcnt(5)
 v_mul_f32 v212, v212, v52
 v_mul_f32 v213, v213, v53
 v_mfma_f32_16x16x32_bf16 v[12:15], v[64:67], a[68:71], v[12:15]
 ds_read_b128 v[96:99], v251 offset:35840
 v_lshlrev_b32 v214, 16, v125
 v_mfma_f32_16x16x32_bf16 v[12:15], v[68:71], a[76:79], v[12:15]
 v_mfma_f32_16x16x32_bf16 v[12:15], v[72:75], a[84:87], v[12:15]
 s_waitcnt lgkmcnt(5)
 ds_read_b128 v[100:103], v251 offset:39936
 v_and_b32 v215, 0xffff0000, v125
 v_mfma_f32_16x16x32_bf16 v[12:15], v[76:79], a[92:95], v[12:15]
 v_mul_f32 v214, v214, v54
 v_mul_f32 v215, v215, v55
 v_mfma_f32_16x16x32_bf16 v[8:11], v[76:79], a[88:91], v[8:11]
 ds_read_b128 v[104:107], v251 offset:44032
 v_lshlrev_b32 v220, 16, v126
 v_mfma_f32_16x16x32_bf16 v[8:11], v[72:75], a[80:83], v[8:11]
 v_mfma_f32_16x16x32_bf16 v[8:11], v[68:71], a[72:75], v[8:11]
 ds_read_b128 v[108:111], v251 offset:48128
 v_and_b32 v221, 0xffff0000, v126
 v_mfma_f32_16x16x32_bf16 v[8:11], v[64:67], a[64:67], v[8:11]
 s_barrier
 v_mul_f32 v220, v220, v60
 v_mul_f32 v221, v221, v61
 s_waitcnt lgkmcnt(5)
 v_mfma_f32_16x16x32_bf16 v[16:19], v[80:83], a[64:67], v[16:19]
 ds_read_b128 v[64:67], v251 offset:49152
 v_lshlrev_b32 v222, 16, v127
 v_mfma_f32_16x16x32_bf16 v[16:19], v[84:87], a[72:75], v[16:19]
 v_and_b32 v223, 0xffff0000, v127
 v_mul_f32 v222, v222, v62
 v_mfma_f32_16x16x32_bf16 v[16:19], v[88:91], a[80:83], v[16:19]
 s_waitcnt lgkmcnt(5)
 ds_read_b128 v[68:71], v251 offset:53248
 v_mul_f32 v223, v223, v63
 v_mfma_f32_16x16x32_bf16 v[16:19], v[92:95], a[88:91], v[16:19]
 v_mfma_f32_16x16x32_bf16 v[20:23], v[92:95], a[92:95], v[20:23]
 ds_read_b128 v[72:75], v251 offset:57344
 v_mfma_f32_16x16x32_bf16 v[20:23], v[88:91], a[84:87], v[20:23]
 v_mfma_f32_16x16x32_bf16 v[20:23], v[84:87], a[76:79], v[20:23]
 ds_read_b128 v[76:79], v251 offset:61440
 v_mfma_f32_16x16x32_bf16 v[20:23], v[80:83], a[68:71], v[20:23]
 s_waitcnt lgkmcnt(5)
 v_mfma_f32_16x16x32_bf16 v[28:31], v[96:99], a[68:71], v[28:31]
 ds_read_b128 v[80:83], v251 offset:50176
 v_mfma_f32_16x16x32_bf16 v[28:31], v[100:103], a[76:79], v[28:31]
 v_mfma_f32_16x16x32_bf16 v[28:31], v[104:107], a[84:87], v[28:31]
 s_waitcnt lgkmcnt(5)
 ds_read_b128 v[84:87], v251 offset:54272
 v_mfma_f32_16x16x32_bf16 v[28:31], v[108:111], a[92:95], v[28:31]
 v_mfma_f32_16x16x32_bf16 v[24:27], v[108:111], a[88:91], v[24:27]
 ds_read_b128 v[88:91], v251 offset:58368
 v_mfma_f32_16x16x32_bf16 v[24:27], v[104:107], a[80:83], v[24:27]
 v_mfma_f32_16x16x32_bf16 v[24:27], v[100:103], a[72:75], v[24:27]
 ds_read_b128 v[92:95], v251 offset:62464
 v_mfma_f32_16x16x32_bf16 v[24:27], v[96:99], a[64:67], v[24:27]
 s_waitcnt lgkmcnt(5)
 v_mfma_f32_16x16x32_bf16 v[0:3], v[64:67], a[96:99], v[0:3]
 ds_read_b128 v[96:99], v251 offset:51200
 v_mfma_f32_16x16x32_bf16 v[0:3], v[68:71], a[104:107], v[0:3]
 v_mfma_f32_16x16x32_bf16 v[0:3], v[72:75], a[112:115], v[0:3]
 s_waitcnt lgkmcnt(5)
 ds_read_b128 v[100:103], v251 offset:55296
 v_mfma_f32_16x16x32_bf16 v[0:3], v[76:79], a[120:123], v[0:3]
 v_mfma_f32_16x16x32_bf16 v[4:7], v[76:79], a[124:127], v[4:7]
 ds_read_b128 v[104:107], v251 offset:59392
 v_mfma_f32_16x16x32_bf16 v[4:7], v[72:75], a[116:119], v[4:7]
 v_mfma_f32_16x16x32_bf16 v[4:7], v[68:71], a[108:111], v[4:7]
 ds_read_b128 v[108:111], v251 offset:63488
 v_mfma_f32_16x16x32_bf16 v[4:7], v[64:67], a[100:103], v[4:7]
 s_waitcnt lgkmcnt(5)
 v_mfma_f32_16x16x32_bf16 v[8:11], v[80:83], a[96:99], v[8:11]
 ds_read_b128 v[64:67], v251 offset:52224
 v_mfma_f32_16x16x32_bf16 v[8:11], v[84:87], a[104:107], v[8:11]
 v_mfma_f32_16x16x32_bf16 v[8:11], v[88:91], a[112:115], v[8:11]
 s_waitcnt lgkmcnt(5)
 ds_read_b128 v[68:71], v251 offset:56320
 v_mfma_f32_16x16x32_bf16 v[8:11], v[92:95], a[120:123], v[8:11]
 v_mfma_f32_16x16x32_bf16 v[12:15], v[92:95], a[124:127], v[12:15]
 ds_read_b128 v[72:75], v251 offset:60416
 v_mfma_f32_16x16x32_bf16 v[12:15], v[88:91], a[116:119], v[12:15]
 v_mfma_f32_16x16x32_bf16 v[12:15], v[84:87], a[108:111], v[12:15]
 ds_read_b128 v[76:79], v251 offset:64512
 v_mfma_f32_16x16x32_bf16 v[12:15], v[80:83], a[100:103], v[12:15]
 s_waitcnt lgkmcnt(5)
 v_mfma_f32_16x16x32_bf16 v[16:19], v[96:99], a[96:99], v[16:19]
 v_mfma_f32_16x16x32_bf16 v[16:19], v[100:103], a[104:107], v[16:19]
 v_mfma_f32_16x16x32_bf16 v[16:19], v[104:107], a[112:115], v[16:19]
 s_waitcnt lgkmcnt(4)
 v_fma_f32 v0, v0, v32, v192
 v_fma_f32 v1, v1, v33, v193
 v_mfma_f32_16x16x32_bf16 v[16:19], v[108:111], a[120:123], v[16:19]
 v_fma_f32 v2, v2, v34, v194
 v_fma_f32 v3, v3, v35, v195
 v_mfma_f32_16x16x32_bf16 v[20:23], v[108:111], a[124:127], v[20:23]
 v_fma_f32 v8, v8, v40, v200
 v_fma_f32 v9, v9, v41, v201
 v_mfma_f32_16x16x32_bf16 v[20:23], v[104:107], a[116:119], v[20:23]
 v_fma_f32 v10, v10, v42, v202
 v_fma_f32 v11, v11, v43, v203
 v_mfma_f32_16x16x32_bf16 v[20:23], v[100:103], a[108:111], v[20:23]
 v_cvt_pk_bf16_f32 v0, v0, v1
 v_cvt_pk_bf16_f32 v1, v2, v3
 v_mfma_f32_16x16x32_bf16 v[20:23], v[96:99], a[100:103], v[20:23]
 s_waitcnt lgkmcnt(1)
 v_cvt_pk_bf16_f32 v2, v8, v9
 v_cvt_pk_bf16_f32 v3, v10, v11
 v_mfma_f32_16x16x32_bf16 v[24:27], v[64:67], a[96:99], v[24:27]
 buffer_store_dwordx4 v[0:3], v255, s[4:7], s53 offen sc1
 v_fma_f32 v4, v4, v36, v196
 v_mfma_f32_16x16x32_bf16 v[24:27], v[68:71], a[104:107], v[24:27]
 v_fma_f32 v5, v5, v37, v197
 v_fma_f32 v6, v6, v38, v198
 v_mfma_f32_16x16x32_bf16 v[24:27], v[72:75], a[112:115], v[24:27]
 s_waitcnt lgkmcnt(0)
 v_fma_f32 v7, v7, v39, v199
 v_fma_f32 v12, v12, v44, v204
 v_mfma_f32_16x16x32_bf16 v[24:27], v[76:79], a[120:123], v[24:27]
 v_fma_f32 v13, v13, v45, v205
 v_fma_f32 v14, v14, v46, v206
 v_mfma_f32_16x16x32_bf16 v[28:31], v[76:79], a[124:127], v[28:31]
 v_fma_f32 v15, v15, v47, v207
 v_cvt_pk_bf16_f32 v4, v4, v5
 v_mfma_f32_16x16x32_bf16 v[28:31], v[72:75], a[116:119], v[28:31]
 v_cvt_pk_bf16_f32 v5, v6, v7
 v_cvt_pk_bf16_f32 v6, v12, v13
 v_mfma_f32_16x16x32_bf16 v[28:31], v[68:71], a[108:111], v[28:31]
 v_cvt_pk_bf16_f32 v7, v14, v15
 v_mfma_f32_16x16x32_bf16 v[28:31], v[64:67], a[100:103], v[28:31]
 buffer_store_dwordx4 v[4:7], v255, s[4:7], s54 offen sc1
 s_lshl_b32 s26, s41, 4
 s_add_u32 s26, s26, s42
 s_lshl_b32 s26, s26, 7
 s_add_u32 s26, s26, 83492864
 v_pk_fma_f32 v[16:17], v[16:17], v[48:49], v[208:209]
 v_pk_fma_f32 v[18:19], v[18:19], v[50:51], v[210:211]
 v_pk_fma_f32 v[24:25], v[24:25], v[56:57], v[216:217]
 v_pk_fma_f32 v[26:27], v[26:27], v[58:59], v[218:219]
 v_cvt_pk_bf16_f32 v16, v16, v17
 v_cvt_pk_bf16_f32 v17, v18, v19
 v_cvt_pk_bf16_f32 v18, v24, v25
 v_cvt_pk_bf16_f32 v19, v26, v27
 buffer_store_dwordx4 v[16:19], v255, s[4:7], s53 offen offset:1024 sc1
 v_pk_fma_f32 v[20:21], v[20:21], v[52:53], v[212:213]
 v_pk_fma_f32 v[22:23], v[22:23], v[54:55], v[214:215]
 v_pk_fma_f32 v[28:29], v[28:29], v[60:61], v[220:221]
 v_pk_fma_f32 v[30:31], v[30:31], v[62:63], v[222:223]
 v_cvt_pk_bf16_f32 v20, v20, v21
 v_cvt_pk_bf16_f32 v21, v22, v23
 v_cvt_pk_bf16_f32 v22, v28, v29
 v_cvt_pk_bf16_f32 v23, v30, v31
 buffer_store_dwordx4 v[20:23], v255, s[4:7], s54 offen offset:1024 sc1
 v_and_b32 v200, 0xffff, v234
 v_add_u32 v200, 0x20000, v200
 v_xor_b32 v201, 32, v200
 v_xor_b32 v202, 64, v200
 v_xor_b32 v203, 96, v200
 s_lshr_b32 s23, s21, 1
 s_lshl_b32 s23, s23, 11
 s_add_u32 s23, s23, 83492864
 v_and_b32 v233, 0xf0, v255
 v_min_u32 v233, 0xd0, v233
 v_lshl_add_u32 v233, v233, 3, s23
 s_lshl_b32 s23, s21, 2
 s_add_u32 s23, s23, s20
 s_mul_i32 s56, s23, 28672
 s_add_u32 s56, s56, 78643200
 s_lshl_b32 s57, s23, 14
 s_lshl_b32 s24, s22, 11
 s_add_u32 s57, s57, s24
 s_add_u32 s57, s57, 68157440
 s_lshr_b32 s23, s23, 1
 s_lshl_b32 s23, s23, 15
 s_and_b32 s24, s20, 1
 s_lshl_b32 s24, s24, 12
 s_add_u32 s23, s23, s24
 s_lshl_b32 s24, s22, 7
 s_add_u32 s58, s23, s24
 s_add_u32 s59, s58, 16384
 s_mov_b32 s12, s86
 s_mov_b32 s13, s87
 s_mov_b32 s14, 2097152
Lw2_8:
 s_cbranch_execz Lw2_back
 s_mov_b32 s15, 0x20000
 s_add_u32 s23, s44, 16384
 v_bfe_u32 v208, v255, 4, 4
 v_mul_u32_u24 v208, 144, v208
 v_lshrrev_b32 v209, 8, v255
 v_lshl_add_u32 v208, v209, 3, v208
 v_add_u32 v208, s23, v208
 v_lshrrev_b32 v211, 7, v255
 v_and_b32 v210, 0x70, v255
 v_mul_u32_u24 v209, 144, v211
 v_add3_u32 v209, v209, v210, s23
 v_and_b32 v212, 4, v211
 v_add_u32 v211, v211, v212
 v_lshl_add_u32 v210, v211, 10, v210
 s_waitcnt vmcnt(0)
 s_barrier
 buffer_store_dword v253, v254, s[4:7], s26 offen sc1
Lg7:
 s_add_u32 m0, s35, 4096
 s_nop 0
 buffer_load_dwordx4 v224, s[16:19], s43 offen lds
 ds_read_b64_tr_b16 a[0:1], v234 offset:0
 ds_read_b64_tr_b16 a[2:3], v234 offset:2048
 ds_read_b64_tr_b16 a[4:5], v235 offset:0
 ds_read_b64_tr_b16 a[6:7], v235 offset:2048
 buffer_load_dwordx4 v225, s[16:19], s43 offen offset:1024 lds
 ds_read_b64_tr_b16 a[8:9], v236 offset:0
 ds_read_b64_tr_b16 a[10:11], v236 offset:2048
 ds_read_b64_tr_b16 a[12:13], v237 offset:0
 ds_read_b64_tr_b16 a[14:15], v237 offset:2048
 buffer_load_dwordx4 v226, s[16:19], s43 offen offset:2048 lds
 ds_read_b64_tr_b16 a[16:17], v234 offset:16384
 ds_read_b64_tr_b16 a[18:19], v234 offset:18432
 ds_read_b64_tr_b16 a[20:21], v235 offset:16384
 ds_read_b64_tr_b16 a[22:23], v235 offset:18432
 buffer_load_dwordx4 v227, s[16:19], s43 offen offset:3072 lds
 s_add_u32 s43, s43, 131072
 ds_read_b64_tr_b16 a[24:25], v236 offset:16384
 ds_read_b64_tr_b16 a[26:27], v236 offset:18432
 ds_read_b64_tr_b16 a[28:29], v237 offset:16384
 ds_read_b64_tr_b16 a[30:31], v237 offset:18432
 s_add_u32 m0, s44, 0
 s_nop 0
 buffer_load_dwordx4 v224, s[16:19], s43 offen lds
 ds_read_b64_tr_b16 a[32:33], v234 offset:32768
 ds_read_b64_tr_b16 a[34:35], v234 offset:34816
 ds_read_b64_tr_b16 a[36:37], v235 offset:32768
 ds_read_b64_tr_b16 a[38:39], v235 offset:34816
 buffer_load_dwordx4 v225, s[16:19], s43 offen offset:1024 lds
 ds_read_b64_tr_b16 a[40:41], v236 offset:32768
 ds_read_b64_tr_b16 a[42:43], v236 offset:34816
 ds_read_b64_tr_b16 a[44:45], v237 offset:32768
 ds_read_b64_tr_b16 a[46:47], v237 offset:34816
 buffer_load_dwordx4 v226, s[16:19], s43 offen offset:2048 lds
 ds_read_b64_tr_b16 a[48:49], v234 offset:49152
 ds_read_b64_tr_b16 a[50:51], v234 offset:51200
 ds_read_b64_tr_b16 a[52:53], v235 offset:49152
 ds_read_b64_tr_b16 a[54:55], v235 offset:51200
 buffer_load_dwordx4 v227, s[16:19], s43 offen offset:3072 lds
 s_add_u32 s43, s43, 131072
 ds_read_b64_tr_b16 a[56:57], v236 offset:49152
 ds_read_b64_tr_b16 a[58:59], v236 offset:51200
 ds_read_b64_tr_b16 a[60:61], v237 offset:49152
 ds_read_b64_tr_b16 a[62:63], v237 offset:51200
 ds_read_b64_tr_b16 a[64:65], v234 offset:4096
 ds_read_b64_tr_b16 a[66:67], v234 offset:6144
 ds_read_b64_tr_b16 a[68:69], v235 offset:4096
 ds_read_b64_tr_b16 a[70:71], v235 offset:6144
 ds_read_b64_tr_b16 a[72:73], v236 offset:4096
 ds_read_b64_tr_b16 a[74:75], v236 offset:6144
 ds_read_b64_tr_b16 a[76:77], v237 offset:4096
 ds_read_b64_tr_b16 a[78:79], v237 offset:6144
 ds_read_b64_tr_b16 a[80:81], v234 offset:20480
 ds_read_b64_tr_b16 a[82:83], v234 offset:22528
 ds_read_b64_tr_b16 a[84:85], v235 offset:20480
 ds_read_b64_tr_b16 a[86:87], v235 offset:22528
 ds_read_b64_tr_b16 a[88:89], v236 offset:20480
 ds_read_b64_tr_b16 a[90:91], v236 offset:22528
 ds_read_b64_tr_b16 a[92:93], v237 offset:20480
 ds_read_b64_tr_b16 a[94:95], v237 offset:22528
 ds_read_b64_tr_b16 a[96:97], v234 offset:36864
 ds_read_b64_tr_b16 a[98:99], v234 offset:38912
 ds_read_b64_tr_b16 a[100:101], v235 offset:36864
 ds_read_b64_tr_b16 a[102:103], v235 offset:38912
 ds_read_b64_tr_b16 a[104:105], v236 offset:36864
 ds_read_b64_tr_b16 a[106:107], v236 offset:38912
 ds_read_b64_tr_b16 a[108:109], v237 offset:36864
 ds_read_b64_tr_b16 a[110:111], v237 offset:38912
 ds_read_b64_tr_b16 a[112:113], v234 offset:53248
 ds_read_b64_tr_b16 a[114:115], v234 offset:55296
 ds_read_b64_tr_b16 a[116:117], v235 offset:53248
 ds_read_b64_tr_b16 a[118:119], v235 offset:55296
 ds_read_b64_tr_b16 a[120:121], v236 offset:53248
 ds_read_b64_tr_b16 a[122:123], v236 offset:55296
 ds_read_b64_tr_b16 a[124:125], v237 offset:53248
 ds_read_b64_tr_b16 a[126:127], v237 offset:55296
 ds_read_b64_tr_b16 a[128:129], v234 offset:8192
 ds_read_b64_tr_b16 a[130:131], v234 offset:10240
 ds_read_b64_tr_b16 a[132:133], v235 offset:8192
 ds_read_b64_tr_b16 a[134:135], v235 offset:10240
 ds_read_b64_tr_b16 a[136:137], v236 offset:8192
 ds_read_b64_tr_b16 a[138:139], v236 offset:10240
 ds_read_b64_tr_b16 a[140:141], v237 offset:8192
 ds_read_b64_tr_b16 a[142:143], v237 offset:10240
 ds_read_b64_tr_b16 a[144:145], v234 offset:24576
 ds_read_b64_tr_b16 a[146:147], v234 offset:26624
 ds_read_b64_tr_b16 a[148:149], v235 offset:24576
 ds_read_b64_tr_b16 a[150:151], v235 offset:26624
 ds_read_b64_tr_b16 a[152:153], v236 offset:24576
 ds_read_b64_tr_b16 a[154:155], v236 offset:26624
 ds_read_b64_tr_b16 a[156:157], v237 offset:24576
 ds_read_b64_tr_b16 a[158:159], v237 offset:26624
 ds_read_b64_tr_b16 a[160:161], v234 offset:40960
 ds_read_b64_tr_b16 a[162:163], v234 offset:43008
 ds_read_b64_tr_b16 a[164:165], v235 offset:40960
 ds_read_b64_tr_b16 a[166:167], v235 offset:43008
 ds_read_b64_tr_b16 a[168:169], v236 offset:40960
 ds_read_b64_tr_b16 a[170:171], v236 offset:43008
 ds_read_b64_tr_b16 a[172:173], v237 offset:40960
 ds_read_b64_tr_b16 a[174:175], v237 offset:43008
 ds_read_b64_tr_b16 a[176:177], v234 offset:57344
 ds_read_b64_tr_b16 a[178:179], v234 offset:59392
 ds_read_b64_tr_b16 a[180:181], v235 offset:57344
 ds_read_b64_tr_b16 a[182:183], v235 offset:59392
 ds_read_b64_tr_b16 a[184:185], v236 offset:57344
 ds_read_b64_tr_b16 a[186:187], v236 offset:59392
 ds_read_b64_tr_b16 a[188:189], v237 offset:57344
 ds_read_b64_tr_b16 a[190:191], v237 offset:59392
 ds_read_b64_tr_b16 a[192:193], v234 offset:12288
 ds_read_b64_tr_b16 a[194:195], v234 offset:14336
 ds_read_b64_tr_b16 a[196:197], v235 offset:12288
 ds_read_b64_tr_b16 a[198:199], v235 offset:14336
 ds_read_b64_tr_b16 a[200:201], v236 offset:12288
 ds_read_b64_tr_b16 a[202:203], v236 offset:14336
 ds_read_b64_tr_b16 a[204:205], v237 offset:12288
 ds_read_b64_tr_b16 a[206:207], v237 offset:14336
 ds_read_b64_tr_b16 a[208:209], v234 offset:28672
 ds_read_b64_tr_b16 a[210:211], v234 offset:30720
 ds_read_b64_tr_b16 a[212:213], v235 offset:28672
 ds_read_b64_tr_b16 a[214:215], v235 offset:30720
 ds_read_b64_tr_b16 a[216:217], v236 offset:28672
 ds_read_b64_tr_b16 a[218:219], v236 offset:30720
 ds_read_b64_tr_b16 a[220:221], v237 offset:28672
 ds_read_b64_tr_b16 a[222:223], v237 offset:30720
 ds_read_b64_tr_b16 a[224:225], v234 offset:45056
 ds_read_b64_tr_b16 a[226:227], v234 offset:47104
 ds_read_b64_tr_b16 a[228:229], v235 offset:45056
 ds_read_b64_tr_b16 a[230:231], v235 offset:47104
 ds_read_b64_tr_b16 a[232:233], v236 offset:45056
 ds_read_b64_tr_b16 a[234:235], v236 offset:47104
 ds_read_b64_tr_b16 a[236:237], v237 offset:45056
 ds_read_b64_tr_b16 a[238:239], v237 offset:47104
 ds_read_b64_tr_b16 a[240:241], v234 offset:61440
 ds_read_b64_tr_b16 a[242:243], v234 offset:63488
 ds_read_b64_tr_b16 a[244:245], v235 offset:61440
 ds_read_b64_tr_b16 a[246:247], v235 offset:63488
 ds_read_b64_tr_b16 a[248:249], v236 offset:61440
 ds_read_b64_tr_b16 a[250:251], v236 offset:63488
 ds_read_b64_tr_b16 a[252:253], v237 offset:61440
 ds_read_b64_tr_b16 a[254:255], v237 offset:63488
 buffer_load_dword v232, v233, s[4:7], 0 offen sc1
 s_waitcnt vmcnt(0)
 s_barrier
 v_cmp_gt_u32 vcc, 1, v232
 s_mov_b32 s27, 0
 s_nop 0
 s_cbranch_vccz Lback25
Lspin24:
 buffer_load_dword v232, v233, s[4:7], 0 offen sc1
 s_add_u32 s27, s27, 1
 s_waitcnt vmcnt(0)
 v_cmp_gt_u32 vcc, 1, v232
 s_cmp_gt_u32 s27, 1048576
 s_cbranch_scc1 Lback25
 s_cbranch_vccnz Lspin24
Lback25:
 buffer_load_dwordx4 v[64:67], v255, s[4:7], s56 offen sc1
 buffer_load_dwordx4 v[68:71], v255, s[4:7], s56 offen offset:1024 sc1
 buffer_load_dwordx4 v[72:75], v255, s[4:7], s56 offen offset:2048 sc1
 buffer_load_dwordx4 v[76:79], v255, s[4:7], s56 offen offset:3072 sc1
 s_add_u32 s56, s56, 4096
 buffer_load_dwordx4 v[80:83], v255, s[4:7], s56 offen sc1
 buffer_load_dwordx4 v[84:87], v255, s[4:7], s56 offen offset:1024 sc1
 buffer_load_dwordx4 v[88:91], v255, s[4:7], s56 offen offset:2048 sc1
 buffer_load_dwordx4 v[92:95], v255, s[4:7], s56 offen offset:3072 sc1
 s_add_u32 s56, s56, 4096
 buffer_load_dwordx4 v[96:99], v255, s[4:7], s56 offen sc1
 buffer_load_dwordx4 v[100:103], v255, s[4:7], s56 offen offset:1024 sc1
 buffer_load_dwordx4 v[104:107], v255, s[4:7], s56 offen offset:2048 sc1
 s_waitcnt vmcnt(10)
 s_waitcnt lgkmcnt(15)
 v_mfma_f32_16x16x32_bf16 v[0:3], a[0:3], v[64:67], 0
 s_waitcnt lgkmcnt(15)
 v_mfma_f32_16x16x32_bf16 v[4:7], a[4:7], v[64:67], 0
 s_waitcnt lgkmcnt(15)
 v_mfma_f32_16x16x32_bf16 v[8:11], a[8:11], v[64:67], 0
 s_waitcnt lgkmcnt(15)
 v_mfma_f32_16x16x32_bf16 v[12:15], a[12:15], v[64:67], 0
 s_waitcnt vmcnt(9) lgkmcnt(15)
 buffer_load_dwordx4 v[108:111], v255, s[4:7], s56 offen offset:3072 sc1
 v_mfma_f32_16x16x32_bf16 v[0:3], a[16:19], v[68:71], v[0:3]
 s_add_u32 s56, s56, 4096
 ds_read_b64_tr_b16 a[0:1], v200 offset:0
 ds_read_b64_tr_b16 a[2:3], v200 offset:2048
 v_mfma_f32_16x16x32_bf16 v[4:7], a[20:23], v[68:71], v[4:7]
 ds_read_b64_tr_b16 a[4:5], v201 offset:0
 ds_read_b64_tr_b16 a[6:7], v201 offset:2048
 v_mfma_f32_16x16x32_bf16 v[8:11], a[24:27], v[68:71], v[8:11]
 s_waitcnt lgkmcnt(15)
 ds_read_b64_tr_b16 a[8:9], v202 offset:0
 ds_read_b64_tr_b16 a[10:11], v202 offset:2048
 v_mfma_f32_16x16x32_bf16 v[12:15], a[28:31], v[68:71], v[12:15]
 s_waitcnt vmcnt(9)
 buffer_load_dwordx4 v[112:115], v255, s[4:7], s56 offen sc1
 v_mfma_f32_16x16x32_bf16 v[0:3], a[32:35], v[72:75], v[0:3]
 ds_read_b64_tr_b16 a[12:13], v203 offset:0
 ds_read_b64_tr_b16 a[14:15], v203 offset:2048
 v_mfma_f32_16x16x32_bf16 v[4:7], a[36:39], v[72:75], v[4:7]
 s_waitcnt lgkmcnt(15)
 ds_read_b64_tr_b16 a[16:17], v200 offset:8192
 ds_read_b64_tr_b16 a[18:19], v200 offset:10240
 v_mfma_f32_16x16x32_bf16 v[8:11], a[40:43], v[72:75], v[8:11]
 ds_read_b64_tr_b16 a[20:21], v201 offset:8192
 ds_read_b64_tr_b16 a[22:23], v201 offset:10240
 v_mfma_f32_16x16x32_bf16 v[12:15], a[44:47], v[72:75], v[12:15]
 s_waitcnt vmcnt(9)
 buffer_load_dwordx4 v[116:119], v255, s[4:7], s56 offen offset:1024 sc1
 v_mfma_f32_16x16x32_bf16 v[0:3], a[48:51], v[76:79], v[0:3]
 s_waitcnt lgkmcnt(15)
 ds_read_b64_tr_b16 a[24:25], v202 offset:8192
 ds_read_b64_tr_b16 a[26:27], v202 offset:10240
 v_mfma_f32_16x16x32_bf16 v[4:7], a[52:55], v[76:79], v[4:7]
 ds_read_b64_tr_b16 a[28:29], v203 offset:8192
 ds_read_b64_tr_b16 a[30:31], v203 offset:10240
 v_mfma_f32_16x16x32_bf16 v[8:11], a[56:59], v[76:79], v[8:11]
 ds_read_b64_tr_b16 a[32:33], v200 offset:16384
 ds_read_b64_tr_b16 a[34:35], v200 offset:18432
 v_mfma_f32_16x16x32_bf16 v[12:15], a[60:63], v[76:79], v[12:15]
 s_waitcnt vmcnt(9) lgkmcnt(15)
 buffer_load_dwordx4 v[120:123], v255, s[4:7], s56 offen offset:2048 sc1
 v_mfma_f32_16x16x32_bf16 v[0:3], a[64:67], v[80:83], v[0:3]
 ds_read_b64_tr_b16 a[36:37], v201 offset:16384
 ds_read_b64_tr_b16 a[38:39], v201 offset:18432
 v_mfma_f32_16x16x32_bf16 v[4:7], a[68:71], v[80:83], v[4:7]
 ds_read_b64_tr_b16 a[40:41], v202 offset:16384
 ds_read_b64_tr_b16 a[42:43], v202 offset:18432
 v_mfma_f32_16x16x32_bf16 v[8:11], a[72:75], v[80:83], v[8:11]
 s_waitcnt lgkmcnt(15)
 ds_read_b64_tr_b16 a[44:45], v203 offset:16384
 ds_read_b64_tr_b16 a[46:47], v203 offset:18432
 v_mfma_f32_16x16x32_bf16 v[12:15], a[76:79], v[80:83], v[12:15]
 s_waitcnt vmcnt(9)
 buffer_load_dwordx4 v[124:127], v255, s[4:7], s56 offen offset:3072 sc1
 v_mfma_f32_16x16x32_bf16 v[0:3], a[80:83], v[84:87], v[0:3]
 s_add_u32 s56, s56, 4096
 ds_read_b64_tr_b16 a[48:49], v200 offset:24576
 ds_read_b64_tr_b16 a[50:51], v200 offset:26624
 v_mfma_f32_16x16x32_bf16 v[4:7], a[84:87], v[84:87], v[4:7]
 s_waitcnt lgkmcnt(15)
 ds_read_b64_tr_b16 a[52:53], v201 offset:24576
 ds_read_b64_tr_b16 a[54:55], v201 offset:26624
 v_mfma_f32_16x16x32_bf16 v[8:11], a[88:91], v[84:87], v[8:11]
 ds_read_b64_tr_b16 a[56:57], v202 offset:24576
 ds_read_b64_tr_b16 a[58:59], v202 offset:26624
 v_mfma_f32_16x16x32_bf16 v[12:15], a[92:95], v[84:87], v[12:15]
 s_waitcnt vmcnt(9)
 buffer_load_dwordx4 v[128:131], v255, s[4:7], s56 offen sc1
 v_mfma_f32_16x16x32_bf16 v[0:3], a[96:99], v[88:91], v[0:3]
 s_waitcnt lgkmcnt(15)
 ds_read_b64_tr_b16 a[60:61], v203 offset:24576
 ds_read_b64_tr_b16 a[62:63], v203 offset:26624
 v_mfma_f32_16x16x32_bf16 v[4:7], a[100:103], v[88:91], v[4:7]
 ds_read_b64_tr_b16 a[64:65], v200 offset:4096
 ds_read_b64_tr_b16 a[66:67], v200 offset:6144
 v_mfma_f32_16x16x32_bf16 v[8:11], a[104:107], v[88:91], v[8:11]
 ds_read_b64_tr_b16 a[68:69], v201 offset:4096
 ds_read_b64_tr_b16 a[70:71], v201 offset:6144
 v_mfma_f32_16x16x32_bf16 v[12:15], a[108:111], v[88:91], v[12:15]
 s_waitcnt vmcnt(9) lgkmcnt(15)
 buffer_load_dwordx4 v[132:135], v255, s[4:7], s56 offen offset:1024 sc1
 v_mfma_f32_16x16x32_bf16 v[0:3], a[112:115], v[92:95], v[0:3]
 ds_read_b64_tr_b16 a[72:73], v202 offset:4096
 ds_read_b64_tr_b16 a[74:75], v202 offset:6144
 v_mfma_f32_16x16x32_bf16 v[4:7], a[116:119], v[92:95], v[4:7]
 ds_read_b64_tr_b16 a[76:77], v203 offset:4096
 ds_read_b64_tr_b16 a[78:79], v203 offset:6144
 v_mfma_f32_16x16x32_bf16 v[8:11], a[120:123], v[92:95], v[8:11]
 s_waitcnt lgkmcnt(15)
 ds_read_b64_tr_b16 a[80:81], v200 offset:12288
 ds_read_b64_tr_b16 a[82:83], v200 offset:14336
 v_mfma_f32_16x16x32_bf16 v[12:15], a[124:127], v[92:95], v[12:15]
 s_waitcnt vmcnt(9)
 buffer_load_dwordx4 v[136:139], v255, s[4:7], s56 offen offset:2048 sc1
 v_mfma_f32_16x16x32_bf16 v[0:3], a[128:131], v[96:99], v[0:3]
 ds_read_b64_tr_b16 a[84:85], v201 offset:12288
 ds_read_b64_tr_b16 a[86:87], v201 offset:14336
 v_mfma_f32_16x16x32_bf16 v[4:7], a[132:135], v[96:99], v[4:7]
 s_waitcnt lgkmcnt(15)
 ds_read_b64_tr_b16 a[88:89], v202 offset:12288
 ds_read_b64_tr_b16 a[90:91], v202 offset:14336
 v_mfma_f32_16x16x32_bf16 v[8:11], a[136:139], v[96:99], v[8:11]
 ds_read_b64_tr_b16 a[92:93], v203 offset:12288
 ds_read_b64_tr_b16 a[94:95], v203 offset:14336
 v_mfma_f32_16x16x32_bf16 v[12:15], a[140:143], v[96:99], v[12:15]
 s_waitcnt vmcnt(9)
 buffer_load_dwordx4 v[140:143], v255, s[4:7], s56 offen offset:3072 sc1
 v_mfma_f32_16x16x32_bf16 v[0:3], a[144:147], v[100:103], v[0:3]
 s_waitcnt lgkmcnt(15)
 s_add_u32 s56, s56, 4096
 ds_read_b64_tr_b16 a[96:97], v200 offset:20480
 ds_read_b64_tr_b16 a[98:99], v200 offset:22528
 v_mfma_f32_16x16x32_bf16 v[4:7], a[148:151], v[100:103], v[4:7]
 ds_read_b64_tr_b16 a[100:101], v201 offset:20480
 ds_read_b64_tr_b16 a[102:103], v201 offset:22528
 v_mfma_f32_16x16x32_bf16 v[8:11], a[152:155], v[100:103], v[8:11]
 ds_read_b64_tr_b16 a[104:105], v202 offset:20480
 ds_read_b64_tr_b16 a[106:107], v202 offset:22528
 v_mfma_f32_16x16x32_bf16 v[12:15], a[156:159], v[100:103], v[12:15]
 s_waitcnt vmcnt(9) lgkmcnt(15)
 buffer_load_dwordx4 v[16:19], v255, s[4:7], s57 offen sc1
 v_mfma_f32_16x16x32_bf16 v[0:3], a[160:163], v[104:107], v[0:3]
 ds_read_b64_tr_b16 a[108:109], v203 offset:20480
 ds_read_b64_tr_b16 a[110:111], v203 offset:22528
 v_mfma_f32_16x16x32_bf16 v[4:7], a[164:167], v[104:107], v[4:7]
 ds_read_b64_tr_b16 a[112:113], v200 offset:28672
 ds_read_b64_tr_b16 a[114:115], v200 offset:30720
 v_mfma_f32_16x16x32_bf16 v[8:11], a[168:171], v[104:107], v[8:11]
 s_waitcnt lgkmcnt(15)
 ds_read_b64_tr_b16 a[116:117], v201 offset:28672
 ds_read_b64_tr_b16 a[118:119], v201 offset:30720
 v_mfma_f32_16x16x32_bf16 v[12:15], a[172:175], v[104:107], v[12:15]
 s_waitcnt vmcnt(9)
 buffer_load_dwordx4 v[20:23], v255, s[4:7], s57 offen offset:1024 sc1
 v_mfma_f32_16x16x32_bf16 v[0:3], a[176:179], v[108:111], v[0:3]
 ds_read_b64_tr_b16 a[120:121], v202 offset:28672
 ds_read_b64_tr_b16 a[122:123], v202 offset:30720
 v_mfma_f32_16x16x32_bf16 v[4:7], a[180:183], v[108:111], v[4:7]
 s_waitcnt lgkmcnt(15)
 ds_read_b64_tr_b16 a[124:125], v203 offset:28672
 ds_read_b64_tr_b16 a[126:127], v203 offset:30720
 v_mfma_f32_16x16x32_bf16 v[8:11], a[184:187], v[108:111], v[8:11]
 ds_read_b64_tr_b16 a[128:129], v238 offset:0
 ds_read_b64_tr_b16 a[130:131], v238 offset:2048
 v_mfma_f32_16x16x32_bf16 v[12:15], a[188:191], v[108:111], v[12:15]
 s_waitcnt vmcnt(9)
 buffer_load_dwordx4 v[144:147], v255, s[4:7], s56 offen sc1
 v_mfma_f32_16x16x32_bf16 v[0:3], a[192:195], v[112:115], v[0:3]
 s_waitcnt lgkmcnt(15)
 ds_read_b64_tr_b16 a[132:133], v239 offset:0
 ds_read_b64_tr_b16 a[134:135], v239 offset:2048
 v_mfma_f32_16x16x32_bf16 v[4:7], a[196:199], v[112:115], v[4:7]
 ds_read_b64_tr_b16 a[136:137], v240 offset:0
 ds_read_b64_tr_b16 a[138:139], v240 offset:2048
 v_mfma_f32_16x16x32_bf16 v[8:11], a[200:203], v[112:115], v[8:11]
 ds_read_b64_tr_b16 a[140:141], v241 offset:0
 ds_read_b64_tr_b16 a[142:143], v241 offset:2048
 v_mfma_f32_16x16x32_bf16 v[12:15], a[204:207], v[112:115], v[12:15]
 s_waitcnt vmcnt(9) lgkmcnt(15)
 buffer_load_dwordx4 v[148:151], v255, s[4:7], s56 offen offset:1024 sc1
 v_mfma_f32_16x16x32_bf16 v[0:3], a[208:211], v[116:119], v[0:3]
 ds_read_b64_tr_b16 a[144:145], v238 offset:4096
 ds_read_b64_tr_b16 a[146:147], v238 offset:6144
 v_mfma_f32_16x16x32_bf16 v[4:7], a[212:215], v[116:119], v[4:7]
 ds_read_b64_tr_b16 a[148:149], v239 offset:4096
 ds_read_b64_tr_b16 a[150:151], v239 offset:6144
 v_mfma_f32_16x16x32_bf16 v[8:11], a[216:219], v[116:119], v[8:11]
 s_waitcnt lgkmcnt(15)
 ds_read_b64_tr_b16 a[152:153], v240 offset:4096
 ds_read_b64_tr_b16 a[154:155], v240 offset:6144
 v_mfma_f32_16x16x32_bf16 v[12:15], a[220:223], v[116:119], v[12:15]
 s_waitcnt vmcnt(9)
 buffer_load_dwordx4 v[152:155], v255, s[4:7], s56 offen offset:2048 sc1
 v_mfma_f32_16x16x32_bf16 v[0:3], a[224:227], v[120:123], v[0:3]
 ds_read_b64_tr_b16 a[156:157], v241 offset:4096
 ds_read_b64_tr_b16 a[158:159], v241 offset:6144
 v_mfma_f32_16x16x32_bf16 v[4:7], a[228:231], v[120:123], v[4:7]
 s_waitcnt lgkmcnt(15)
 ds_read_b64_tr_b16 a[160:161], v238 offset:8192
 ds_read_b64_tr_b16 a[162:163], v238 offset:10240
 v_mfma_f32_16x16x32_bf16 v[8:11], a[232:235], v[120:123], v[8:11]
 ds_read_b64_tr_b16 a[164:165], v239 offset:8192
 ds_read_b64_tr_b16 a[166:167], v239 offset:10240
 v_mfma_f32_16x16x32_bf16 v[12:15], a[236:239], v[120:123], v[12:15]
 s_waitcnt vmcnt(9)
 buffer_load_dwordx4 v[156:159], v255, s[4:7], s56 offen offset:3072 sc1
 v_mfma_f32_16x16x32_bf16 v[0:3], a[240:243], v[124:127], v[0:3]
 s_waitcnt lgkmcnt(15)
 s_add_u32 s56, s56, 4096
 ds_read_b64_tr_b16 a[168:169], v240 offset:8192
 ds_read_b64_tr_b16 a[170:171], v240 offset:10240
 v_mfma_f32_16x16x32_bf16 v[4:7], a[244:247], v[124:127], v[4:7]
 ds_read_b64_tr_b16 a[172:173], v241 offset:8192
 ds_read_b64_tr_b16 a[174:175], v241 offset:10240
 v_mfma_f32_16x16x32_bf16 v[8:11], a[248:251], v[124:127], v[8:11]
 ds_read_b64_tr_b16 a[176:177], v238 offset:12288
 ds_read_b64_tr_b16 a[178:179], v238 offset:14336
 v_mfma_f32_16x16x32_bf16 v[12:15], a[252:255], v[124:127], v[12:15]
 s_waitcnt vmcnt(9) lgkmcnt(15)
 buffer_load_dwordx4 v[160:163], v255, s[4:7], s56 offen sc1
 v_mfma_f32_16x16x32_bf16 v[0:3], a[0:3], v[128:131], v[0:3]
 ds_read_b64_tr_b16 a[180:181], v239 offset:12288
 ds_read_b64_tr_b16 a[182:183], v239 offset:14336
 v_mfma_f32_16x16x32_bf16 v[4:7], a[4:7], v[128:131], v[4:7]
 ds_read_b64_tr_b16 a[184:185], v240 offset:12288
 ds_read_b64_tr_b16 a[186:187], v240 offset:14336
 v_mfma_f32_16x16x32_bf16 v[8:11], a[8:11], v[128:131], v[8:11]
 s_waitcnt lgkmcnt(15)
 ds_read_b64_tr_b16 a[188:189], v241 offset:12288
 ds_read_b64_tr_b16 a[190:191], v241 offset:14336
 v_mfma_f32_16x16x32_bf16 v[12:15], a[12:15], v[128:131], v[12:15]
 s_waitcnt vmcnt(9)
 buffer_load_dwordx4 v[164:167], v255, s[4:7], s56 offen offset:1024 sc1
 v_mfma_f32_16x16x32_bf16 v[0:3], a[16:19], v[132:135], v[0:3]
 v_mfma_f32_16x16x32_bf16 v[4:7], a[20:23], v[132:135], v[4:7]
 s_waitcnt lgkmcnt(15)
 v_mfma_f32_16x16x32_bf16 v[8:11], a[24:27], v[132:135], v[8:11]
 v_mfma_f32_16x16x32_bf16 v[12:15], a[28:31], v[132:135], v[12:15]
 s_waitcnt vmcnt(9)
 buffer_load_dwordx4 v[168:171], v255, s[4:7], s56 offen offset:2048 sc1
 v_mfma_f32_16x16x32_bf16 v[0:3], a[32:35], v[136:139], v[0:3]
 s_waitcnt lgkmcnt(15)
 v_mfma_f32_16x16x32_bf16 v[4:7], a[36:39], v[136:139], v[4:7]
 v_mfma_f32_16x16x32_bf16 v[8:11], a[40:43], v[136:139], v[8:11]
 v_mfma_f32_16x16x32_bf16 v[12:15], a[44:47], v[136:139], v[12:15]
 s_waitcnt vmcnt(9) lgkmcnt(15)
 buffer_load_dwordx4 v[172:175], v255, s[4:7], s56 offen offset:3072 sc1
 v_mfma_f32_16x16x32_bf16 v[0:3], a[48:51], v[140:143], v[0:3]
 s_add_u32 s56, s56, 4096
 v_mfma_f32_16x16x32_bf16 v[4:7], a[52:55], v[140:143], v[4:7]
 v_mfma_f32_16x16x32_bf16 v[8:11], a[56:59], v[140:143], v[8:11]
 s_waitcnt lgkmcnt(15)
 v_mfma_f32_16x16x32_bf16 v[12:15], a[60:63], v[140:143], v[12:15]
 s_waitcnt vmcnt(7)
 v_mfma_f32_16x16x32_bf16 v[0:3], a[64:67], v[144:147], v[0:3]
 v_mfma_f32_16x16x32_bf16 v[4:7], a[68:71], v[144:147], v[4:7]
 s_waitcnt lgkmcnt(15)
 v_mfma_f32_16x16x32_bf16 v[8:11], a[72:75], v[144:147], v[8:11]
 v_mfma_f32_16x16x32_bf16 v[12:15], a[76:79], v[144:147], v[12:15]
 s_waitcnt vmcnt(6)
 v_mfma_f32_16x16x32_bf16 v[0:3], a[80:83], v[148:151], v[0:3]
 s_waitcnt lgkmcnt(15)
 v_mfma_f32_16x16x32_bf16 v[4:7], a[84:87], v[148:151], v[4:7]
 v_mfma_f32_16x16x32_bf16 v[8:11], a[88:91], v[148:151], v[8:11]
 v_mfma_f32_16x16x32_bf16 v[12:15], a[92:95], v[148:151], v[12:15]
 s_waitcnt vmcnt(5) lgkmcnt(15)
 v_mfma_f32_16x16x32_bf16 v[0:3], a[96:99], v[152:155], v[0:3]
 v_mfma_f32_16x16x32_bf16 v[4:7], a[100:103], v[152:155], v[4:7]
 v_mfma_f32_16x16x32_bf16 v[8:11], a[104:107], v[152:155], v[8:11]
 s_waitcnt lgkmcnt(15)
 v_mfma_f32_16x16x32_bf16 v[12:15], a[108:111], v[152:155], v[12:15]
 s_waitcnt vmcnt(4)
 v_mfma_f32_16x16x32_bf16 v[0:3], a[112:115], v[156:159], v[0:3]
 v_mfma_f32_16x16x32_bf16 v[4:7], a[116:119], v[156:159], v[4:7]
 s_waitcnt lgkmcnt(15)
 v_mfma_f32_16x16x32_bf16 v[8:11], a[120:123], v[156:159], v[8:11]
 v_mfma_f32_16x16x32_bf16 v[12:15], a[124:127], v[156:159], v[12:15]
 s_waitcnt vmcnt(3)
 v_mfma_f32_16x16x32_bf16 v[0:3], a[128:131], v[160:163], v[0:3]
 s_waitcnt lgkmcnt(15)
 v_lshlrev_b32 v32, 16, v16
 v_and_b32 v33, 0xffff0000, v16
 v_mfma_f32_16x16x32_bf16 v[4:7], a[132:135], v[160:163], v[4:7]
 v_lshlrev_b32 v34, 16, v17
 v_and_b32 v35, 0xffff0000, v17
 v_mfma_f32_16x16x32_bf16 v[8:11], a[136:139], v[160:163], v[8:11]
 v_lshlrev_b32 v36, 16, v18
 v_and_b32 v37, 0xffff0000, v18
 v_mfma_f32_16x16x32_bf16 v[12:15], a[140:143], v[160:163], v[12:15]
 s_waitcnt vmcnt(2) lgkmcnt(15)
 v_lshlrev_b32 v38, 16, v19
 v_and_b32 v39, 0xffff0000, v19
 v_mfma_f32_16x16x32_bf16 v[0:3], a[144:147], v[164:167], v[0:3]
 v_lshlrev_b32 v40, 16, v20
 v_and_b32 v41, 0xffff0000, v20
 v_mfma_f32_16x16x32_bf16 v[4:7], a[148:151], v[164:167], v[4:7]
 v_lshlrev_b32 v42, 16, v21
 v_and_b32 v43, 0xffff0000, v21
 v_mfma_f32_16x16x32_bf16 v[8:11], a[152:155], v[164:167], v[8:11]
 s_waitcnt lgkmcnt(12)
 v_lshlrev_b32 v44, 16, v22
 v_and_b32 v45, 0xffff0000, v22
 v_mfma_f32_16x16x32_bf16 v[12:15], a[156:159], v[164:167], v[12:15]
 s_waitcnt vmcnt(1)
 v_lshlrev_b32 v46, 16, v23
 v_and_b32 v47, 0xffff0000, v23
 v_mfma_f32_16x16x32_bf16 v[0:3], a[160:163], v[168:171], v[0:3]
 v_mfma_f32_16x16x32_bf16 v[4:7], a[164:167], v[168:171], v[4:7]
 s_waitcnt lgkmcnt(6)
 v_mfma_f32_16x16x32_bf16 v[8:11], a[168:171], v[168:171], v[8:11]
 v_mfma_f32_16x16x32_bf16 v[12:15], a[172:175], v[168:171], v[12:15]
 s_waitcnt vmcnt(0)
 v_mfma_f32_16x16x32_bf16 v[0:3], a[176:179], v[172:175], v[0:3]
 s_waitcnt lgkmcnt(0)
 v_mfma_f32_16x16x32_bf16 v[4:7], a[180:183], v[172:175], v[4:7]
 v_mfma_f32_16x16x32_bf16 v[8:11], a[184:187], v[172:175], v[8:11]
 v_mfma_f32_16x16x32_bf16 v[12:15], a[188:191], v[172:175], v[12:15]
 s_nop 4
 v_pk_add_f32 v[0:1], v[0:1], v[32:33]
 v_pk_add_f32 v[2:3], v[2:3], v[34:35]
 v_cvt_pk_bf16_f32 v0, v0, v1
 v_cvt_pk_bf16_f32 v1, v2, v3
 ds_write_b64 v208, v[0:1] offset:0
 v_pk_add_f32 v[4:5], v[4:5], v[36:37]
 v_pk_add_f32 v[6:7], v[6:7], v[38:39]
 v_cvt_pk_bf16_f32 v4, v4, v5
 v_cvt_pk_bf16_f32 v5, v6, v7
 ds_write_b64 v208, v[4:5] offset:32
 v_pk_add_f32 v[8:9], v[8:9], v[40:41]
 v_pk_add_f32 v[10:11], v[10:11], v[42:43]
 v_cvt_pk_bf16_f32 v8, v8, v9
 v_cvt_pk_bf16_f32 v9, v10, v11
 ds_write_b64 v208, v[8:9] offset:64
 v_pk_add_f32 v[12:13], v[12:13], v[44:45]
 v_pk_add_f32 v[14:15], v[14:15], v[46:47]
 v_cvt_pk_bf16_f32 v12, v12, v13
 v_cvt_pk_bf16_f32 v13, v14, v15
 ds_write_b64 v208, v[12:13] offset:96
 s_waitcnt lgkmcnt(0)
 ds_read_b128 v[64:67], v209 offset:0
 ds_read_b128 v[68:71], v209 offset:1152
 s_waitcnt lgkmcnt(1)
 buffer_store_dwordx4 v[64:67], v210, s[12:15], s58 offen sc1
 s_waitcnt lgkmcnt(0)
 buffer_store_dwordx4 v[68:71], v210, s[12:15], s59 offen sc1
Lend:
 s_endpgm
Lspin2:
 s_mov_b32 s27, 0
Lspin2a:
 buffer_load_dword v235, v236, s[60:63], 0 offen sc1
 s_add_u32 s27, s27, 1
 s_cmp_gt_u32 s27, 1048576
 s_cbranch_scc1 Lspin2b
 s_waitcnt vmcnt(0)
 v_cmp_gt_u32 vcc, 32, v235
 s_nop 1
 s_cbranch_vccnz Lspin2a
Lspin2b:
 s_waitcnt vmcnt(0)
 s_branch Lback3
Lspin4:
 s_mov_b32 s27, 0
Lspin4a:
 buffer_load_dword v235, v236, s[4:7], 0 offen sc1
 s_add_u32 s27, s27, 1
 s_cmp_gt_u32 s27, 1048576
 s_cbranch_scc1 Lspin4b
 s_waitcnt vmcnt(0)
 v_cmp_gt_u32 vcc, 1, v235
 s_nop 1
 s_cbranch_vccnz Lspin4a
Lspin4b:
 s_waitcnt vmcnt(0)
 s_branch Lback5
Lspin6:
 s_mov_b32 s27, 0
Lspin6a:
 buffer_load_dword v235, v236, s[4:7], 0 offen sc1
 s_add_u32 s27, s27, 1
 s_cmp_gt_u32 s27, 1048576
 s_cbranch_scc1 Lspin6b
 s_waitcnt vmcnt(0)
 v_cmp_gt_u32 vcc, 1, v235
 s_nop 1
 s_cbranch_vccnz Lspin6a
Lspin6b:
 s_waitcnt vmcnt(0)
 s_branch Lback7
Lslow:
 s_waitcnt vmcnt(0) lgkmcnt(0)
 v_mov_b32 v184, 0xf149f2ca
 v_cmp_le_u32 vcc, 0x5f800000, v224
 s_nop 1
 s_cbranch_vccz Lslow0x
 s_lshl_b32 s23, s22, 1
 s_add_u32 s23, s23, 0
 v_mov_b32 v180, 0
 v_mov_b32 v181, 0xf149f2ca
 v_mov_b32 v164, v180
 v_mov_b32 v165, v180
 v_mov_b32 v166, v180
 v_mov_b32 v167, v180
 v_mov_b32 v168, v180
 v_mov_b32 v169, v180
 v_mov_b32 v170, v180
 v_mov_b32 v171, v180
 v_mov_b32 v172, v180
 v_mov_b32 v173, v180
 v_mov_b32 v174, v180
 v_mov_b32 v175, v180
 v_mov_b32 v176, v180
 v_mov_b32 v177, v180
 v_mov_b32 v178, v180
 v_mov_b32 v179, v180
 s_mov_b32 s24, 0
 s_mov_b32 s92, 65536
Lslow00:
 buffer_load_dwordx4 v[64:67], v255, s[12:15], s92 offen sc1
 buffer_load_dwordx4 v[68:71], v255, s[12:15], s92 offen offset:1024 sc1
 buffer_load_dwordx4 v[72:75], v255, s[12:15], s92 offen offset:2048 sc1
 buffer_load_dwordx4 v[76:79], v255, s[12:15], s92 offen offset:3072 sc1
 s_add_u32 s92, s92, 4096
 buffer_load_dwordx4 v[80:83], v255, s[12:15], s92 offen sc1
 buffer_load_dwordx4 v[84:87], v255, s[12:15], s92 offen offset:1024 sc1
 buffer_load_dwordx4 v[88:91], v255, s[12:15], s92 offen offset:2048 sc1
 buffer_load_dwordx4 v[92:95], v255, s[12:15], s92 offen offset:3072 sc1
 s_add_u32 s92, s92, 4096
 buffer_load_dwordx4 v[96:99], v255, s[12:15], s92 offen sc1
 buffer_load_dwordx4 v[100:103], v255, s[12:15], s92 offen offset:1024 sc1
 buffer_load_dwordx4 v[104:107], v255, s[12:15], s92 offen offset:2048 sc1
 buffer_load_dwordx4 v[108:111], v255, s[12:15], s92 offen offset:3072 sc1
 s_add_u32 s92, s92, 4096
 buffer_load_dwordx4 v[112:115], v255, s[12:15], s92 offen sc1
 buffer_load_dwordx4 v[116:119], v255, s[12:15], s92 offen offset:1024 sc1
 buffer_load_dwordx4 v[120:123], v255, s[12:15], s92 offen offset:2048 sc1
 buffer_load_dwordx4 v[124:127], v255, s[12:15], s92 offen offset:3072 sc1
 s_add_u32 s92, s92, 4096
 s_add_u32 s92, s92, 16384
 s_cmp_lg_u32 s24, s23
 s_cbranch_scc1 Lslow00n
 v_cmp_le_i32 vcc, 0, v248
 s_nop 1
 v_cndmask_b32 v164, v184, v180, vcc
 v_cmp_le_i32 vcc, 1, v248
 s_nop 1
 v_cndmask_b32 v165, v184, v180, vcc
 v_cmp_le_i32 vcc, 2, v248
 s_nop 1
 v_cndmask_b32 v166, v184, v180, vcc
 v_cmp_le_i32 vcc, 3, v248
 s_nop 1
 v_cndmask_b32 v167, v184, v180, vcc
 v_cmp_le_i32 vcc, 16, v248
 s_nop 1
 v_cndmask_b32 v168, v184, v180, vcc
 v_cmp_le_i32 vcc, 17, v248
 s_nop 1
 v_cndmask_b32 v169, v184, v180, vcc
 v_cmp_le_i32 vcc, 18, v248
 s_nop 1
 v_cndmask_b32 v170, v184, v180, vcc
 v_cmp_le_i32 vcc, 19, v248
 s_nop 1
 v_cndmask_b32 v171, v184, v180, vcc
 v_cmp_le_i32 vcc, 32, v248
 s_nop 1
 v_cndmask_b32 v172, v184, v180, vcc
 v_cmp_le_i32 vcc, 33, v248
 s_nop 1
 v_cndmask_b32 v173, v184, v180, vcc
 v_cmp_le_i32 vcc, 34, v248
 s_nop 1
 v_cndmask_b32 v174, v184, v180, vcc
 v_cmp_le_i32 vcc, 35, v248
 s_nop 1
 v_cndmask_b32 v175, v184, v180, vcc
 v_cmp_le_i32 vcc, 48, v248
 s_nop 1
 v_cndmask_b32 v176, v184, v180, vcc
 v_cmp_le_i32 vcc, 49, v248
 s_nop 1
 v_cndmask_b32 v177, v184, v180, vcc
 v_cmp_le_i32 vcc, 50, v248
 s_nop 1
 v_cndmask_b32 v178, v184, v180, vcc
 v_cmp_le_i32 vcc, 51, v248
 s_nop 1
 v_cndmask_b32 v179, v184, v180, vcc
Lslow00n:
 s_waitcnt vmcnt(0)
 s_nop 1
 v_mfma_f32_16x16x32_bf16 v[128:131], v[64:67], a[128:131], v[164:167]
 v_mfma_f32_16x16x32_bf16 v[128:131], v[68:71], a[132:135], v[128:131]
 v_mfma_f32_16x16x32_bf16 v[128:131], v[72:75], a[136:139], v[128:131]
 v_mfma_f32_16x16x32_bf16 v[128:131], v[76:79], a[140:143], v[128:131]
 v_mfma_f32_16x16x32_bf16 v[132:135], v[80:83], a[128:131], v[168:171]
 v_mfma_f32_16x16x32_bf16 v[132:135], v[84:87], a[132:135], v[132:135]
 v_mfma_f32_16x16x32_bf16 v[132:135], v[88:91], a[136:139], v[132:135]
 v_mfma_f32_16x16x32_bf16 v[132:135], v[92:95], a[140:143], v[132:135]
 v_mfma_f32_16x16x32_bf16 v[136:139], v[96:99], a[128:131], v[172:175]
 v_mfma_f32_16x16x32_bf16 v[136:139], v[100:103], a[132:135], v[136:139]
 v_mfma_f32_16x16x32_bf16 v[136:139], v[104:107], a[136:139], v[136:139]
 v_mfma_f32_16x16x32_bf16 v[136:139], v[108:111], a[140:143], v[136:139]
 v_mfma_f32_16x16x32_bf16 v[140:143], v[112:115], a[128:131], v[176:179]
 v_mfma_f32_16x16x32_bf16 v[140:143], v[116:119], a[132:135], v[140:143]
 v_mfma_f32_16x16x32_bf16 v[140:143], v[120:123], a[136:139], v[140:143]
 v_mfma_f32_16x16x32_bf16 v[140:143], v[124:127], a[140:143], v[140:143]
 s_nop 7
 v_max3_f32 v181, v181, v128, v129
 v_max3_f32 v181, v181, v130, v131
 v_max3_f32 v181, v181, v132, v133
 v_max3_f32 v181, v181, v134, v135
 v_max3_f32 v181, v181, v136, v137
 v_max3_f32 v181, v181, v138, v139
 v_max3_f32 v181, v181, v140, v141
 v_max3_f32 v181, v181, v142, v143
 s_add_u32 s24, s24, 1
 s_cmp_le_u32 s24, s23
 s_cbranch_scc1 Lslow00
 v_mov_b32 v182, v181
 s_nop 1
 v_permlane16_swap_b32 v181, v182
 v_max_f32 v181, v181, v182
 v_mov_b32 v182, v181
 s_nop 1
 v_permlane32_swap_b32 v181, v182
 v_max_f32 v181, v181, v182
 v_sub_f32 v180, 0, v181
 v_accvgpr_write_b32 a0, 0
 v_accvgpr_write_b32 a1, 0
 v_accvgpr_write_b32 a2, 0
 v_accvgpr_write_b32 a3, 0
 v_accvgpr_write_b32 a16, 0
 v_accvgpr_write_b32 a17, 0
 v_accvgpr_write_b32 a18, 0
 v_accvgpr_write_b32 a19, 0
 v_accvgpr_write_b32 a32, 0
 v_accvgpr_write_b32 a33, 0
 v_accvgpr_write_b32 a34, 0
 v_accvgpr_write_b32 a35, 0
 v_accvgpr_write_b32 a48, 0
 v_accvgpr_write_b32 a49, 0
 v_accvgpr_write_b32 a50, 0
 v_accvgpr_write_b32 a51, 0
 v_accvgpr_write_b32 a64, 0
 v_accvgpr_write_b32 a65, 0
 v_accvgpr_write_b32 a66, 0
 v_accvgpr_write_b32 a67, 0
 v_accvgpr_write_b32 a80, 0
 v_accvgpr_write_b32 a81, 0
 v_accvgpr_write_b32 a82, 0
 v_accvgpr_write_b32 a83, 0
 v_accvgpr_write_b32 a96, 0
 v_accvgpr_write_b32 a97, 0
 v_accvgpr_write_b32 a98, 0
 v_accvgpr_write_b32 a99, 0
 v_accvgpr_write_b32 a112, 0
 v_accvgpr_write_b32 a113, 0
 v_accvgpr_write_b32 a114, 0
 v_accvgpr_write_b32 a115, 0
 v_mov_b32 v224, 0
 v_mov_b32 v225, 0
 v_mov_b32 v226, 0
 v_mov_b32 v227, 0
 v_mov_b32 v164, v180
 v_mov_b32 v165, v180
 v_mov_b32 v166, v180
 v_mov_b32 v167, v180
 v_mov_b32 v168, v180
 v_mov_b32 v169, v180
 v_mov_b32 v170, v180
 v_mov_b32 v171, v180
 v_mov_b32 v172, v180
 v_mov_b32 v173, v180
 v_mov_b32 v174, v180
 v_mov_b32 v175, v180
 v_mov_b32 v176, v180
 v_mov_b32 v177, v180
 v_mov_b32 v178, v180
 v_mov_b32 v179, v180
 s_mov_b32 s24, 0
 s_mov_b32 s92, 65536
Lslow01:
 buffer_load_dwordx4 v[64:67], v255, s[12:15], s92 offen sc1
 buffer_load_dwordx4 v[68:71], v255, s[12:15], s92 offen offset:1024 sc1
 buffer_load_dwordx4 v[72:75], v255, s[12:15], s92 offen offset:2048 sc1
 buffer_load_dwordx4 v[76:79], v255, s[12:15], s92 offen offset:3072 sc1
 s_add_u32 s92, s92, 4096
 buffer_load_dwordx4 v[80:83], v255, s[12:15], s92 offen sc1
 buffer_load_dwordx4 v[84:87], v255, s[12:15], s92 offen offset:1024 sc1
 buffer_load_dwordx4 v[88:91], v255, s[12:15], s92 offen offset:2048 sc1
 buffer_load_dwordx4 v[92:95], v255, s[12:15], s92 offen offset:3072 sc1
 s_add_u32 s92, s92, 4096
 buffer_load_dwordx4 v[96:99], v255, s[12:15], s92 offen sc1
 buffer_load_dwordx4 v[100:103], v255, s[12:15], s92 offen offset:1024 sc1
 buffer_load_dwordx4 v[104:107], v255, s[12:15], s92 offen offset:2048 sc1
 buffer_load_dwordx4 v[108:111], v255, s[12:15], s92 offen offset:3072 sc1
 s_add_u32 s92, s92, 4096
 buffer_load_dwordx4 v[112:115], v255, s[12:15], s92 offen sc1
 buffer_load_dwordx4 v[116:119], v255, s[12:15], s92 offen offset:1024 sc1
 buffer_load_dwordx4 v[120:123], v255, s[12:15], s92 offen offset:2048 sc1
 buffer_load_dwordx4 v[124:127], v255, s[12:15], s92 offen offset:3072 sc1
 s_add_u32 s92, s92, 4096
 buffer_load_dwordx4 a[192:195], v255, s[12:15], s92 offen sc1
 buffer_load_dwordx4 a[196:199], v255, s[12:15], s92 offen offset:1024 sc1
 buffer_load_dwordx4 a[200:203], v255, s[12:15], s92 offen offset:2048 sc1
 buffer_load_dwordx4 a[204:207], v255, s[12:15], s92 offen offset:3072 sc1
 s_add_u32 s92, s92, 4096
 buffer_load_dwordx4 a[208:211], v255, s[12:15], s92 offen sc1
 buffer_load_dwordx4 a[212:215], v255, s[12:15], s92 offen offset:1024 sc1
 buffer_load_dwordx4 a[216:219], v255, s[12:15], s92 offen offset:2048 sc1
 buffer_load_dwordx4 a[220:223], v255, s[12:15], s92 offen offset:3072 sc1
 s_add_u32 s92, s92, 4096
 buffer_load_dwordx4 a[224:227], v255, s[12:15], s92 offen sc1
 buffer_load_dwordx4 a[228:231], v255, s[12:15], s92 offen offset:1024 sc1
 buffer_load_dwordx4 a[232:235], v255, s[12:15], s92 offen offset:2048 sc1
 buffer_load_dwordx4 a[236:239], v255, s[12:15], s92 offen offset:3072 sc1
 s_add_u32 s92, s92, 4096
 buffer_load_dwordx4 a[240:243], v255, s[12:15], s92 offen sc1
 buffer_load_dwordx4 a[244:247], v255, s[12:15], s92 offen offset:1024 sc1
 buffer_load_dwordx4 a[248:251], v255, s[12:15], s92 offen offset:2048 sc1
 buffer_load_dwordx4 a[252:255], v255, s[12:15], s92 offen offset:3072 sc1
 s_add_u32 s92, s92, 4096
 s_cmp_lg_u32 s24, s23
 s_cbranch_scc1 Lslow01n
 v_cmp_le_i32 vcc, 0, v248
 s_nop 1
 v_cndmask_b32 v164, v184, v180, vcc
 v_cmp_le_i32 vcc, 1, v248
 s_nop 1
 v_cndmask_b32 v165, v184, v180, vcc
 v_cmp_le_i32 vcc, 2, v248
 s_nop 1
 v_cndmask_b32 v166, v184, v180, vcc
 v_cmp_le_i32 vcc, 3, v248
 s_nop 1
 v_cndmask_b32 v167, v184, v180, vcc
 v_cmp_le_i32 vcc, 16, v248
 s_nop 1
 v_cndmask_b32 v168, v184, v180, vcc
 v_cmp_le_i32 vcc, 17, v248
 s_nop 1
 v_cndmask_b32 v169, v184, v180, vcc
 v_cmp_le_i32 vcc, 18, v248
 s_nop 1
 v_cndmask_b32 v170, v184, v180, vcc
 v_cmp_le_i32 vcc, 19, v248
 s_nop 1
 v_cndmask_b32 v171, v184, v180, vcc
 v_cmp_le_i32 vcc, 32, v248
 s_nop 1
 v_cndmask_b32 v172, v184, v180, vcc
 v_cmp_le_i32 vcc, 33, v248
 s_nop 1
 v_cndmask_b32 v173, v184, v180, vcc
 v_cmp_le_i32 vcc, 34, v248
 s_nop 1
 v_cndmask_b32 v174, v184, v180, vcc
 v_cmp_le_i32 vcc, 35, v248
 s_nop 1
 v_cndmask_b32 v175, v184, v180, vcc
 v_cmp_le_i32 vcc, 48, v248
 s_nop 1
 v_cndmask_b32 v176, v184, v180, vcc
 v_cmp_le_i32 vcc, 49, v248
 s_nop 1
 v_cndmask_b32 v177, v184, v180, vcc
 v_cmp_le_i32 vcc, 50, v248
 s_nop 1
 v_cndmask_b32 v178, v184, v180, vcc
 v_cmp_le_i32 vcc, 51, v248
 s_nop 1
 v_cndmask_b32 v179, v184, v180, vcc
Lslow01n:
 s_waitcnt vmcnt(0)
 s_nop 1
 v_mfma_f32_16x16x32_bf16 v[128:131], v[64:67], a[128:131], v[164:167]
 v_mfma_f32_16x16x32_bf16 v[128:131], v[68:71], a[132:135], v[128:131]
 v_mfma_f32_16x16x32_bf16 v[128:131], v[72:75], a[136:139], v[128:131]
 v_mfma_f32_16x16x32_bf16 v[128:131], v[76:79], a[140:143], v[128:131]
 v_mfma_f32_16x16x32_bf16 v[132:135], v[80:83], a[128:131], v[168:171]
 v_mfma_f32_16x16x32_bf16 v[132:135], v[84:87], a[132:135], v[132:135]
 v_mfma_f32_16x16x32_bf16 v[132:135], v[88:91], a[136:139], v[132:135]
 v_mfma_f32_16x16x32_bf16 v[132:135], v[92:95], a[140:143], v[132:135]
 v_mfma_f32_16x16x32_bf16 v[136:139], v[96:99], a[128:131], v[172:175]
 v_mfma_f32_16x16x32_bf16 v[136:139], v[100:103], a[132:135], v[136:139]
 v_mfma_f32_16x16x32_bf16 v[136:139], v[104:107], a[136:139], v[136:139]
 v_mfma_f32_16x16x32_bf16 v[136:139], v[108:111], a[140:143], v[136:139]
 v_mfma_f32_16x16x32_bf16 v[140:143], v[112:115], a[128:131], v[176:179]
 v_mfma_f32_16x16x32_bf16 v[140:143], v[116:119], a[132:135], v[140:143]
 v_mfma_f32_16x16x32_bf16 v[140:143], v[120:123], a[136:139], v[140:143]
 v_mfma_f32_16x16x32_bf16 v[140:143], v[124:127], a[140:143], v[140:143]
 s_nop 7
 v_exp_f32 v128, v128
 v_exp_f32 v129, v129
 v_exp_f32 v130, v130
 v_exp_f32 v131, v131
 v_exp_f32 v132, v132
 v_exp_f32 v133, v133
 v_exp_f32 v134, v134
 v_exp_f32 v135, v135
 v_exp_f32 v136, v136
 v_exp_f32 v137, v137
 v_exp_f32 v138, v138
 v_exp_f32 v139, v139
 v_exp_f32 v140, v140
 v_exp_f32 v141, v141
 v_exp_f32 v142, v142
 v_exp_f32 v143, v143
 s_nop 0
 v_cvt_pk_bf16_f32 v144, v128, v129
 v_cvt_pk_bf16_f32 v145, v130, v131
 v_cvt_pk_bf16_f32 v146, v132, v133
 v_cvt_pk_bf16_f32 v147, v134, v135
 v_cvt_pk_bf16_f32 v148, v136, v137
 v_cvt_pk_bf16_f32 v149, v138, v139
 v_cvt_pk_bf16_f32 v150, v140, v141
 v_cvt_pk_bf16_f32 v151, v142, v143
 s_nop 1
 v_mfma_f32_16x16x32_bf16 a[0:3], a[192:195], v[144:147], a[0:3]
 v_mfma_f32_16x16x32_bf16 a[0:3], a[196:199], v[148:151], a[0:3]
 v_mfma_f32_16x16x32_bf16 a[16:19], a[200:203], v[144:147], a[16:19]
 v_mfma_f32_16x16x32_bf16 a[16:19], a[204:207], v[148:151], a[16:19]
 v_mfma_f32_16x16x32_bf16 a[32:35], a[208:211], v[144:147], a[32:35]
 v_mfma_f32_16x16x32_bf16 a[32:35], a[212:215], v[148:151], a[32:35]
 v_mfma_f32_16x16x32_bf16 a[48:51], a[216:219], v[144:147], a[48:51]
 v_mfma_f32_16x16x32_bf16 a[48:51], a[220:223], v[148:151], a[48:51]
 v_mfma_f32_16x16x32_bf16 a[64:67], a[224:227], v[144:147], a[64:67]
 v_mfma_f32_16x16x32_bf16 a[64:67], a[228:231], v[148:151], a[64:67]
 v_mfma_f32_16x16x32_bf16 a[80:83], a[232:235], v[144:147], a[80:83]
 v_mfma_f32_16x16x32_bf16 a[80:83], a[236:239], v[148:151], a[80:83]
 v_mfma_f32_16x16x32_bf16 a[96:99], a[240:243], v[144:147], a[96:99]
 v_mfma_f32_16x16x32_bf16 a[96:99], a[244:247], v[148:151], a[96:99]
 v_mfma_f32_16x16x32_bf16 a[112:115], a[248:251], v[144:147], a[112:115]
 v_mfma_f32_16x16x32_bf16 a[112:115], a[252:255], v[148:151], a[112:115]
 v_smfmac_f32_16x16x64_bf16 v[224:227], v[244:247], v[144:151], v206
 s_nop 11
 s_add_u32 s24, s24, 1
 s_cmp_le_u32 s24, s23
 s_cbranch_scc1 Lslow01
 v_add_f32 v224, v224, v225
 v_rcp_f32 v226, v224
 v_accvgpr_read_b32 v0, a0
 v_accvgpr_read_b32 v1, a1
 v_accvgpr_read_b32 v2, a2
 v_accvgpr_read_b32 v3, a3
 v_accvgpr_read_b32 v64, a16
 v_accvgpr_read_b32 v65, a17
 v_accvgpr_read_b32 v66, a18
 v_accvgpr_read_b32 v67, a19
 v_mul_f32 v0, v0, v226
 v_mul_f32 v1, v1, v226
 v_mul_f32 v2, v2, v226
 v_mul_f32 v3, v3, v226
 v_mul_f32 v64, v64, v226
 v_mul_f32 v65, v65, v226
 v_mul_f32 v66, v66, v226
 v_mul_f32 v67, v67, v226
 v_cvt_pk_bf16_f32 v0, v0, v1
 v_cvt_pk_bf16_f32 v1, v2, v3
 v_cvt_pk_bf16_f32 v2, v64, v65
 v_cvt_pk_bf16_f32 v3, v66, v67
 buffer_store_dwordx4 v[0:3], v249, s[4:7], s98 offen sc1
 v_accvgpr_read_b32 v16, a32
 v_accvgpr_read_b32 v17, a33
 v_accvgpr_read_b32 v18, a34
 v_accvgpr_read_b32 v19, a35
 v_accvgpr_read_b32 v80, a48
 v_accvgpr_read_b32 v81, a49
 v_accvgpr_read_b32 v82, a50
 v_accvgpr_read_b32 v83, a51
 v_mul_f32 v16, v16, v226
 v_mul_f32 v17, v17, v226
 v_mul_f32 v18, v18, v226
 v_mul_f32 v19, v19, v226
 v_mul_f32 v80, v80, v226
 v_mul_f32 v81, v81, v226
 v_mul_f32 v82, v82, v226
 v_mul_f32 v83, v83, v226
 v_cvt_pk_bf16_f32 v16, v16, v17
 v_cvt_pk_bf16_f32 v17, v18, v19
 v_cvt_pk_bf16_f32 v18, v80, v81
 v_cvt_pk_bf16_f32 v19, v82, v83
 buffer_store_dwordx4 v[16:19], v250, s[4:7], s98 offen sc1
 v_accvgpr_read_b32 v32, a64
 v_accvgpr_read_b32 v33, a65
 v_accvgpr_read_b32 v34, a66
 v_accvgpr_read_b32 v35, a67
 v_accvgpr_read_b32 v96, a80
 v_accvgpr_read_b32 v97, a81
 v_accvgpr_read_b32 v98, a82
 v_accvgpr_read_b32 v99, a83
 v_mul_f32 v32, v32, v226
 v_mul_f32 v33, v33, v226
 v_mul_f32 v34, v34, v226
 v_mul_f32 v35, v35, v226
 v_mul_f32 v96, v96, v226
 v_mul_f32 v97, v97, v226
 v_mul_f32 v98, v98, v226
 v_mul_f32 v99, v99, v226
 v_cvt_pk_bf16_f32 v32, v32, v33
 v_cvt_pk_bf16_f32 v33, v34, v35
 v_cvt_pk_bf16_f32 v34, v96, v97
 v_cvt_pk_bf16_f32 v35, v98, v99
 buffer_store_dwordx4 v[32:35], v251, s[4:7], s98 offen sc1
 v_accvgpr_read_b32 v48, a96
 v_accvgpr_read_b32 v49, a97
 v_accvgpr_read_b32 v50, a98
 v_accvgpr_read_b32 v51, a99
 v_accvgpr_read_b32 v112, a112
 v_accvgpr_read_b32 v113, a113
 v_accvgpr_read_b32 v114, a114
 v_accvgpr_read_b32 v115, a115
 v_mul_f32 v48, v48, v226
 v_mul_f32 v49, v49, v226
 v_mul_f32 v50, v50, v226
 v_mul_f32 v51, v51, v226
 v_mul_f32 v112, v112, v226
 v_mul_f32 v113, v113, v226
 v_mul_f32 v114, v114, v226
 v_mul_f32 v115, v115, v226
 v_cvt_pk_bf16_f32 v48, v48, v49
 v_cvt_pk_bf16_f32 v49, v50, v51
 v_cvt_pk_bf16_f32 v50, v112, v113
 v_cvt_pk_bf16_f32 v51, v114, v115
 buffer_store_dwordx4 v[48:51], v252, s[4:7], s98 offen sc1
 s_nop 1
Lslow0x:
 v_cmp_le_u32 vcc, 0x5f800000, v228
 s_nop 1
 s_cbranch_vccz Lslow1x
 s_lshl_b32 s23, s22, 1
 s_add_u32 s23, s23, 1
 v_mov_b32 v180, 0
 v_mov_b32 v181, 0xf149f2ca
 v_mov_b32 v164, v180
 v_mov_b32 v165, v180
 v_mov_b32 v166, v180
 v_mov_b32 v167, v180
 v_mov_b32 v168, v180
 v_mov_b32 v169, v180
 v_mov_b32 v170, v180
 v_mov_b32 v171, v180
 v_mov_b32 v172, v180
 v_mov_b32 v173, v180
 v_mov_b32 v174, v180
 v_mov_b32 v175, v180
 v_mov_b32 v176, v180
 v_mov_b32 v177, v180
 v_mov_b32 v178, v180
 v_mov_b32 v179, v180
 s_mov_b32 s24, 0
 s_mov_b32 s92, 65536
Lslow10:
 buffer_load_dwordx4 v[64:67], v255, s[12:15], s92 offen sc1
 buffer_load_dwordx4 v[68:71], v255, s[12:15], s92 offen offset:1024 sc1
 buffer_load_dwordx4 v[72:75], v255, s[12:15], s92 offen offset:2048 sc1
 buffer_load_dwordx4 v[76:79], v255, s[12:15], s92 offen offset:3072 sc1
 s_add_u32 s92, s92, 4096
 buffer_load_dwordx4 v[80:83], v255, s[12:15], s92 offen sc1
 buffer_load_dwordx4 v[84:87], v255, s[12:15], s92 offen offset:1024 sc1
 buffer_load_dwordx4 v[88:91], v255, s[12:15], s92 offen offset:2048 sc1
 buffer_load_dwordx4 v[92:95], v255, s[12:15], s92 offen offset:3072 sc1
 s_add_u32 s92, s92, 4096
 buffer_load_dwordx4 v[96:99], v255, s[12:15], s92 offen sc1
 buffer_load_dwordx4 v[100:103], v255, s[12:15], s92 offen offset:1024 sc1
 buffer_load_dwordx4 v[104:107], v255, s[12:15], s92 offen offset:2048 sc1
 buffer_load_dwordx4 v[108:111], v255, s[12:15], s92 offen offset:3072 sc1
 s_add_u32 s92, s92, 4096
 buffer_load_dwordx4 v[112:115], v255, s[12:15], s92 offen sc1
 buffer_load_dwordx4 v[116:119], v255, s[12:15], s92 offen offset:1024 sc1
 buffer_load_dwordx4 v[120:123], v255, s[12:15], s92 offen offset:2048 sc1
 buffer_load_dwordx4 v[124:127], v255, s[12:15], s92 offen offset:3072 sc1
 s_add_u32 s92, s92, 4096
 s_add_u32 s92, s92, 16384
 s_cmp_lg_u32 s24, s23
 s_cbranch_scc1 Lslow10n
 v_cmp_le_i32 vcc, 0, v248
 s_nop 1
 v_cndmask_b32 v164, v184, v180, vcc
 v_cmp_le_i32 vcc, 1, v248
 s_nop 1
 v_cndmask_b32 v165, v184, v180, vcc
 v_cmp_le_i32 vcc, 2, v248
 s_nop 1
 v_cndmask_b32 v166, v184, v180, vcc
 v_cmp_le_i32 vcc, 3, v248
 s_nop 1
 v_cndmask_b32 v167, v184, v180, vcc
 v_cmp_le_i32 vcc, 16, v248
 s_nop 1
 v_cndmask_b32 v168, v184, v180, vcc
 v_cmp_le_i32 vcc, 17, v248
 s_nop 1
 v_cndmask_b32 v169, v184, v180, vcc
 v_cmp_le_i32 vcc, 18, v248
 s_nop 1
 v_cndmask_b32 v170, v184, v180, vcc
 v_cmp_le_i32 vcc, 19, v248
 s_nop 1
 v_cndmask_b32 v171, v184, v180, vcc
 v_cmp_le_i32 vcc, 32, v248
 s_nop 1
 v_cndmask_b32 v172, v184, v180, vcc
 v_cmp_le_i32 vcc, 33, v248
 s_nop 1
 v_cndmask_b32 v173, v184, v180, vcc
 v_cmp_le_i32 vcc, 34, v248
 s_nop 1
 v_cndmask_b32 v174, v184, v180, vcc
 v_cmp_le_i32 vcc, 35, v248
 s_nop 1
 v_cndmask_b32 v175, v184, v180, vcc
 v_cmp_le_i32 vcc, 48, v248
 s_nop 1
 v_cndmask_b32 v176, v184, v180, vcc
 v_cmp_le_i32 vcc, 49, v248
 s_nop 1
 v_cndmask_b32 v177, v184, v180, vcc
 v_cmp_le_i32 vcc, 50, v248
 s_nop 1
 v_cndmask_b32 v178, v184, v180, vcc
 v_cmp_le_i32 vcc, 51, v248
 s_nop 1
 v_cndmask_b32 v179, v184, v180, vcc
Lslow10n:
 s_waitcnt vmcnt(0)
 s_nop 1
 v_mfma_f32_16x16x32_bf16 v[128:131], v[64:67], a[144:147], v[164:167]
 v_mfma_f32_16x16x32_bf16 v[128:131], v[68:71], a[148:151], v[128:131]
 v_mfma_f32_16x16x32_bf16 v[128:131], v[72:75], a[152:155], v[128:131]
 v_mfma_f32_16x16x32_bf16 v[128:131], v[76:79], a[156:159], v[128:131]
 v_mfma_f32_16x16x32_bf16 v[132:135], v[80:83], a[144:147], v[168:171]
 v_mfma_f32_16x16x32_bf16 v[132:135], v[84:87], a[148:151], v[132:135]
 v_mfma_f32_16x16x32_bf16 v[132:135], v[88:91], a[152:155], v[132:135]
 v_mfma_f32_16x16x32_bf16 v[132:135], v[92:95], a[156:159], v[132:135]
 v_mfma_f32_16x16x32_bf16 v[136:139], v[96:99], a[144:147], v[172:175]
 v_mfma_f32_16x16x32_bf16 v[136:139], v[100:103], a[148:151], v[136:139]
 v_mfma_f32_16x16x32_bf16 v[136:139], v[104:107], a[152:155], v[136:139]
 v_mfma_f32_16x16x32_bf16 v[136:139], v[108:111], a[156:159], v[136:139]
 v_mfma_f32_16x16x32_bf16 v[140:143], v[112:115], a[144:147], v[176:179]
 v_mfma_f32_16x16x32_bf16 v[140:143], v[116:119], a[148:151], v[140:143]
 v_mfma_f32_16x16x32_bf16 v[140:143], v[120:123], a[152:155], v[140:143]
 v_mfma_f32_16x16x32_bf16 v[140:143], v[124:127], a[156:159], v[140:143]
 s_nop 7
 v_max3_f32 v181, v181, v128, v129
 v_max3_f32 v181, v181, v130, v131
 v_max3_f32 v181, v181, v132, v133
 v_max3_f32 v181, v181, v134, v135
 v_max3_f32 v181, v181, v136, v137
 v_max3_f32 v181, v181, v138, v139
 v_max3_f32 v181, v181, v140, v141
 v_max3_f32 v181, v181, v142, v143
 s_add_u32 s24, s24, 1
 s_cmp_le_u32 s24, s23
 s_cbranch_scc1 Lslow10
 v_mov_b32 v182, v181
 s_nop 1
 v_permlane16_swap_b32 v181, v182
 v_max_f32 v181, v181, v182
 v_mov_b32 v182, v181
 s_nop 1
 v_permlane32_swap_b32 v181, v182
 v_max_f32 v181, v181, v182
 v_sub_f32 v180, 0, v181
 v_accvgpr_write_b32 a4, 0
 v_accvgpr_write_b32 a5, 0
 v_accvgpr_write_b32 a6, 0
 v_accvgpr_write_b32 a7, 0
 v_accvgpr_write_b32 a20, 0
 v_accvgpr_write_b32 a21, 0
 v_accvgpr_write_b32 a22, 0
 v_accvgpr_write_b32 a23, 0
 v_accvgpr_write_b32 a36, 0
 v_accvgpr_write_b32 a37, 0
 v_accvgpr_write_b32 a38, 0
 v_accvgpr_write_b32 a39, 0
 v_accvgpr_write_b32 a52, 0
 v_accvgpr_write_b32 a53, 0
 v_accvgpr_write_b32 a54, 0
 v_accvgpr_write_b32 a55, 0
 v_accvgpr_write_b32 a68, 0
 v_accvgpr_write_b32 a69, 0
 v_accvgpr_write_b32 a70, 0
 v_accvgpr_write_b32 a71, 0
 v_accvgpr_write_b32 a84, 0
 v_accvgpr_write_b32 a85, 0
 v_accvgpr_write_b32 a86, 0
 v_accvgpr_write_b32 a87, 0
 v_accvgpr_write_b32 a100, 0
 v_accvgpr_write_b32 a101, 0
 v_accvgpr_write_b32 a102, 0
 v_accvgpr_write_b32 a103, 0
 v_accvgpr_write_b32 a116, 0
 v_accvgpr_write_b32 a117, 0
 v_accvgpr_write_b32 a118, 0
 v_accvgpr_write_b32 a119, 0
 v_mov_b32 v228, 0
 v_mov_b32 v229, 0
 v_mov_b32 v230, 0
 v_mov_b32 v231, 0
 v_mov_b32 v164, v180
 v_mov_b32 v165, v180
 v_mov_b32 v166, v180
 v_mov_b32 v167, v180
 v_mov_b32 v168, v180
 v_mov_b32 v169, v180
 v_mov_b32 v170, v180
 v_mov_b32 v171, v180
 v_mov_b32 v172, v180
 v_mov_b32 v173, v180
 v_mov_b32 v174, v180
 v_mov_b32 v175, v180
 v_mov_b32 v176, v180
 v_mov_b32 v177, v180
 v_mov_b32 v178, v180
 v_mov_b32 v179, v180
 s_mov_b32 s24, 0
 s_mov_b32 s92, 65536
Lslow11:
 buffer_load_dwordx4 v[64:67], v255, s[12:15], s92 offen sc1
 buffer_load_dwordx4 v[68:71], v255, s[12:15], s92 offen offset:1024 sc1
 buffer_load_dwordx4 v[72:75], v255, s[12:15], s92 offen offset:2048 sc1
 buffer_load_dwordx4 v[76:79], v255, s[12:15], s92 offen offset:3072 sc1
 s_add_u32 s92, s92, 4096
 buffer_load_dwordx4 v[80:83], v255, s[12:15], s92 offen sc1
 buffer_load_dwordx4 v[84:87], v255, s[12:15], s92 offen offset:1024 sc1
 buffer_load_dwordx4 v[88:91], v255, s[12:15], s92 offen offset:2048 sc1
 buffer_load_dwordx4 v[92:95], v255, s[12:15], s92 offen offset:3072 sc1
 s_add_u32 s92, s92, 4096
 buffer_load_dwordx4 v[96:99], v255, s[12:15], s92 offen sc1
 buffer_load_dwordx4 v[100:103], v255, s[12:15], s92 offen offset:1024 sc1
 buffer_load_dwordx4 v[104:107], v255, s[12:15], s92 offen offset:2048 sc1
 buffer_load_dwordx4 v[108:111], v255, s[12:15], s92 offen offset:3072 sc1
 s_add_u32 s92, s92, 4096
 buffer_load_dwordx4 v[112:115], v255, s[12:15], s92 offen sc1
 buffer_load_dwordx4 v[116:119], v255, s[12:15], s92 offen offset:1024 sc1
 buffer_load_dwordx4 v[120:123], v255, s[12:15], s92 offen offset:2048 sc1
 buffer_load_dwordx4 v[124:127], v255, s[12:15], s92 offen offset:3072 sc1
 s_add_u32 s92, s92, 4096
 buffer_load_dwordx4 a[192:195], v255, s[12:15], s92 offen sc1
 buffer_load_dwordx4 a[196:199], v255, s[12:15], s92 offen offset:1024 sc1
 buffer_load_dwordx4 a[200:203], v255, s[12:15], s92 offen offset:2048 sc1
 buffer_load_dwordx4 a[204:207], v255, s[12:15], s92 offen offset:3072 sc1
 s_add_u32 s92, s92, 4096
 buffer_load_dwordx4 a[208:211], v255, s[12:15], s92 offen sc1
 buffer_load_dwordx4 a[212:215], v255, s[12:15], s92 offen offset:1024 sc1
 buffer_load_dwordx4 a[216:219], v255, s[12:15], s92 offen offset:2048 sc1
 buffer_load_dwordx4 a[220:223], v255, s[12:15], s92 offen offset:3072 sc1
 s_add_u32 s92, s92, 4096
 buffer_load_dwordx4 a[224:227], v255, s[12:15], s92 offen sc1
 buffer_load_dwordx4 a[228:231], v255, s[12:15], s92 offen offset:1024 sc1
 buffer_load_dwordx4 a[232:235], v255, s[12:15], s92 offen offset:2048 sc1
 buffer_load_dwordx4 a[236:239], v255, s[12:15], s92 offen offset:3072 sc1
 s_add_u32 s92, s92, 4096
 buffer_load_dwordx4 a[240:243], v255, s[12:15], s92 offen sc1
 buffer_load_dwordx4 a[244:247], v255, s[12:15], s92 offen offset:1024 sc1
 buffer_load_dwordx4 a[248:251], v255, s[12:15], s92 offen offset:2048 sc1
 buffer_load_dwordx4 a[252:255], v255, s[12:15], s92 offen offset:3072 sc1
 s_add_u32 s92, s92, 4096
 s_cmp_lg_u32 s24, s23
 s_cbranch_scc1 Lslow11n
 v_cmp_le_i32 vcc, 0, v248
 s_nop 1
 v_cndmask_b32 v164, v184, v180, vcc
 v_cmp_le_i32 vcc, 1, v248
 s_nop 1
 v_cndmask_b32 v165, v184, v180, vcc
 v_cmp_le_i32 vcc, 2, v248
 s_nop 1
 v_cndmask_b32 v166, v184, v180, vcc
 v_cmp_le_i32 vcc, 3, v248
 s_nop 1
 v_cndmask_b32 v167, v184, v180, vcc
 v_cmp_le_i32 vcc, 16, v248
 s_nop 1
 v_cndmask_b32 v168, v184, v180, vcc
 v_cmp_le_i32 vcc, 17, v248
 s_nop 1
 v_cndmask_b32 v169, v184, v180, vcc
 v_cmp_le_i32 vcc, 18, v248
 s_nop 1
 v_cndmask_b32 v170, v184, v180, vcc
 v_cmp_le_i32 vcc, 19, v248
 s_nop 1
 v_cndmask_b32 v171, v184, v180, vcc
 v_cmp_le_i32 vcc, 32, v248
 s_nop 1
 v_cndmask_b32 v172, v184, v180, vcc
 v_cmp_le_i32 vcc, 33, v248
 s_nop 1
 v_cndmask_b32 v173, v184, v180, vcc
 v_cmp_le_i32 vcc, 34, v248
 s_nop 1
 v_cndmask_b32 v174, v184, v180, vcc
 v_cmp_le_i32 vcc, 35, v248
 s_nop 1
 v_cndmask_b32 v175, v184, v180, vcc
 v_cmp_le_i32 vcc, 48, v248
 s_nop 1
 v_cndmask_b32 v176, v184, v180, vcc
 v_cmp_le_i32 vcc, 49, v248
 s_nop 1
 v_cndmask_b32 v177, v184, v180, vcc
 v_cmp_le_i32 vcc, 50, v248
 s_nop 1
 v_cndmask_b32 v178, v184, v180, vcc
 v_cmp_le_i32 vcc, 51, v248
 s_nop 1
 v_cndmask_b32 v179, v184, v180, vcc
Lslow11n:
 s_waitcnt vmcnt(0)
 s_nop 1
 v_mfma_f32_16x16x32_bf16 v[128:131], v[64:67], a[144:147], v[164:167]
 v_mfma_f32_16x16x32_bf16 v[128:131], v[68:71], a[148:151], v[128:131]
 v_mfma_f32_16x16x32_bf16 v[128:131], v[72:75], a[152:155], v[128:131]
 v_mfma_f32_16x16x32_bf16 v[128:131], v[76:79], a[156:159], v[128:131]
 v_mfma_f32_16x16x32_bf16 v[132:135], v[80:83], a[144:147], v[168:171]
 v_mfma_f32_16x16x32_bf16 v[132:135], v[84:87], a[148:151], v[132:135]
 v_mfma_f32_16x16x32_bf16 v[132:135], v[88:91], a[152:155], v[132:135]
 v_mfma_f32_16x16x32_bf16 v[132:135], v[92:95], a[156:159], v[132:135]
 v_mfma_f32_16x16x32_bf16 v[136:139], v[96:99], a[144:147], v[172:175]
 v_mfma_f32_16x16x32_bf16 v[136:139], v[100:103], a[148:151], v[136:139]
 v_mfma_f32_16x16x32_bf16 v[136:139], v[104:107], a[152:155], v[136:139]
 v_mfma_f32_16x16x32_bf16 v[136:139], v[108:111], a[156:159], v[136:139]
 v_mfma_f32_16x16x32_bf16 v[140:143], v[112:115], a[144:147], v[176:179]
 v_mfma_f32_16x16x32_bf16 v[140:143], v[116:119], a[148:151], v[140:143]
 v_mfma_f32_16x16x32_bf16 v[140:143], v[120:123], a[152:155], v[140:143]
 v_mfma_f32_16x16x32_bf16 v[140:143], v[124:127], a[156:159], v[140:143]
 s_nop 7
 v_exp_f32 v128, v128
 v_exp_f32 v129, v129
 v_exp_f32 v130, v130
 v_exp_f32 v131, v131
 v_exp_f32 v132, v132
 v_exp_f32 v133, v133
 v_exp_f32 v134, v134
 v_exp_f32 v135, v135
 v_exp_f32 v136, v136
 v_exp_f32 v137, v137
 v_exp_f32 v138, v138
 v_exp_f32 v139, v139
 v_exp_f32 v140, v140
 v_exp_f32 v141, v141
 v_exp_f32 v142, v142
 v_exp_f32 v143, v143
 s_nop 0
 v_cvt_pk_bf16_f32 v144, v128, v129
 v_cvt_pk_bf16_f32 v145, v130, v131
 v_cvt_pk_bf16_f32 v146, v132, v133
 v_cvt_pk_bf16_f32 v147, v134, v135
 v_cvt_pk_bf16_f32 v148, v136, v137
 v_cvt_pk_bf16_f32 v149, v138, v139
 v_cvt_pk_bf16_f32 v150, v140, v141
 v_cvt_pk_bf16_f32 v151, v142, v143
 s_nop 1
 v_mfma_f32_16x16x32_bf16 a[4:7], a[192:195], v[144:147], a[4:7]
 v_mfma_f32_16x16x32_bf16 a[4:7], a[196:199], v[148:151], a[4:7]
 v_mfma_f32_16x16x32_bf16 a[20:23], a[200:203], v[144:147], a[20:23]
 v_mfma_f32_16x16x32_bf16 a[20:23], a[204:207], v[148:151], a[20:23]
 v_mfma_f32_16x16x32_bf16 a[36:39], a[208:211], v[144:147], a[36:39]
 v_mfma_f32_16x16x32_bf16 a[36:39], a[212:215], v[148:151], a[36:39]
 v_mfma_f32_16x16x32_bf16 a[52:55], a[216:219], v[144:147], a[52:55]
 v_mfma_f32_16x16x32_bf16 a[52:55], a[220:223], v[148:151], a[52:55]
 v_mfma_f32_16x16x32_bf16 a[68:71], a[224:227], v[144:147], a[68:71]
 v_mfma_f32_16x16x32_bf16 a[68:71], a[228:231], v[148:151], a[68:71]
 v_mfma_f32_16x16x32_bf16 a[84:87], a[232:235], v[144:147], a[84:87]
 v_mfma_f32_16x16x32_bf16 a[84:87], a[236:239], v[148:151], a[84:87]
 v_mfma_f32_16x16x32_bf16 a[100:103], a[240:243], v[144:147], a[100:103]
 v_mfma_f32_16x16x32_bf16 a[100:103], a[244:247], v[148:151], a[100:103]
 v_mfma_f32_16x16x32_bf16 a[116:119], a[248:251], v[144:147], a[116:119]
 v_mfma_f32_16x16x32_bf16 a[116:119], a[252:255], v[148:151], a[116:119]
 v_smfmac_f32_16x16x64_bf16 v[228:231], v[244:247], v[144:151], v206
 s_nop 11
 s_add_u32 s24, s24, 1
 s_cmp_le_u32 s24, s23
 s_cbranch_scc1 Lslow11
 v_add_f32 v228, v228, v229
 v_rcp_f32 v230, v228
 v_accvgpr_read_b32 v4, a4
 v_accvgpr_read_b32 v5, a5
 v_accvgpr_read_b32 v6, a6
 v_accvgpr_read_b32 v7, a7
 v_accvgpr_read_b32 v68, a20
 v_accvgpr_read_b32 v69, a21
 v_accvgpr_read_b32 v70, a22
 v_accvgpr_read_b32 v71, a23
 v_mul_f32 v4, v4, v230
 v_mul_f32 v5, v5, v230
 v_mul_f32 v6, v6, v230
 v_mul_f32 v7, v7, v230
 v_mul_f32 v68, v68, v230
 v_mul_f32 v69, v69, v230
 v_mul_f32 v70, v70, v230
 v_mul_f32 v71, v71, v230
 v_cvt_pk_bf16_f32 v4, v4, v5
 v_cvt_pk_bf16_f32 v5, v6, v7
 v_cvt_pk_bf16_f32 v6, v68, v69
 v_cvt_pk_bf16_f32 v7, v70, v71
 buffer_store_dwordx4 v[4:7], v249, s[4:7], s99 offen sc1
 v_accvgpr_read_b32 v20, a36
 v_accvgpr_read_b32 v21, a37
 v_accvgpr_read_b32 v22, a38
 v_accvgpr_read_b32 v23, a39
 v_accvgpr_read_b32 v84, a52
 v_accvgpr_read_b32 v85, a53
 v_accvgpr_read_b32 v86, a54
 v_accvgpr_read_b32 v87, a55
 v_mul_f32 v20, v20, v230
 v_mul_f32 v21, v21, v230
 v_mul_f32 v22, v22, v230
 v_mul_f32 v23, v23, v230
 v_mul_f32 v84, v84, v230
 v_mul_f32 v85, v85, v230
 v_mul_f32 v86, v86, v230
 v_mul_f32 v87, v87, v230
 v_cvt_pk_bf16_f32 v20, v20, v21
 v_cvt_pk_bf16_f32 v21, v22, v23
 v_cvt_pk_bf16_f32 v22, v84, v85
 v_cvt_pk_bf16_f32 v23, v86, v87
 buffer_store_dwordx4 v[20:23], v250, s[4:7], s99 offen sc1
 v_accvgpr_read_b32 v36, a68
 v_accvgpr_read_b32 v37, a69
 v_accvgpr_read_b32 v38, a70
 v_accvgpr_read_b32 v39, a71
 v_accvgpr_read_b32 v100, a84
 v_accvgpr_read_b32 v101, a85
 v_accvgpr_read_b32 v102, a86
 v_accvgpr_read_b32 v103, a87
 v_mul_f32 v36, v36, v230
 v_mul_f32 v37, v37, v230
 v_mul_f32 v38, v38, v230
 v_mul_f32 v39, v39, v230
 v_mul_f32 v100, v100, v230
 v_mul_f32 v101, v101, v230
 v_mul_f32 v102, v102, v230
 v_mul_f32 v103, v103, v230
 v_cvt_pk_bf16_f32 v36, v36, v37
 v_cvt_pk_bf16_f32 v37, v38, v39
 v_cvt_pk_bf16_f32 v38, v100, v101
 v_cvt_pk_bf16_f32 v39, v102, v103
 buffer_store_dwordx4 v[36:39], v251, s[4:7], s99 offen sc1
 v_accvgpr_read_b32 v52, a100
 v_accvgpr_read_b32 v53, a101
 v_accvgpr_read_b32 v54, a102
 v_accvgpr_read_b32 v55, a103
 v_accvgpr_read_b32 v116, a116
 v_accvgpr_read_b32 v117, a117
 v_accvgpr_read_b32 v118, a118
 v_accvgpr_read_b32 v119, a119
 v_mul_f32 v52, v52, v230
 v_mul_f32 v53, v53, v230
 v_mul_f32 v54, v54, v230
 v_mul_f32 v55, v55, v230
 v_mul_f32 v116, v116, v230
 v_mul_f32 v117, v117, v230
 v_mul_f32 v118, v118, v230
 v_mul_f32 v119, v119, v230
 v_cvt_pk_bf16_f32 v52, v52, v53
 v_cvt_pk_bf16_f32 v53, v54, v55
 v_cvt_pk_bf16_f32 v54, v116, v117
 v_cvt_pk_bf16_f32 v55, v118, v119
 buffer_store_dwordx4 v[52:55], v252, s[4:7], s99 offen sc1
 s_nop 1
Lslow1x:
 v_cmp_le_u32 vcc, 0x5f800000, v232
 s_nop 1
 s_cbranch_vccz Lslow2x
 s_lshl_b32 s23, s22, 1
 s_sub_u32 s23, 30, s23
 v_mov_b32 v180, 0
 v_mov_b32 v181, 0xf149f2ca
 v_mov_b32 v164, v180
 v_mov_b32 v165, v180
 v_mov_b32 v166, v180
 v_mov_b32 v167, v180
 v_mov_b32 v168, v180
 v_mov_b32 v169, v180
 v_mov_b32 v170, v180
 v_mov_b32 v171, v180
 v_mov_b32 v172, v180
 v_mov_b32 v173, v180
 v_mov_b32 v174, v180
 v_mov_b32 v175, v180
 v_mov_b32 v176, v180
 v_mov_b32 v177, v180
 v_mov_b32 v178, v180
 v_mov_b32 v179, v180
 s_mov_b32 s24, 0
 s_mov_b32 s92, 65536
Lslow20:
 buffer_load_dwordx4 v[64:67], v255, s[12:15], s92 offen sc1
 buffer_load_dwordx4 v[68:71], v255, s[12:15], s92 offen offset:1024 sc1
 buffer_load_dwordx4 v[72:75], v255, s[12:15], s92 offen offset:2048 sc1
 buffer_load_dwordx4 v[76:79], v255, s[12:15], s92 offen offset:3072 sc1
 s_add_u32 s92, s92, 4096
 buffer_load_dwordx4 v[80:83], v255, s[12:15], s92 offen sc1
 buffer_load_dwordx4 v[84:87], v255, s[12:15], s92 offen offset:1024 sc1
 buffer_load_dwordx4 v[88:91], v255, s[12:15], s92 offen offset:2048 sc1
 buffer_load_dwordx4 v[92:95], v255, s[12:15], s92 offen offset:3072 sc1
 s_add_u32 s92, s92, 4096
 buffer_load_dwordx4 v[96:99], v255, s[12:15], s92 offen sc1
 buffer_load_dwordx4 v[100:103], v255, s[12:15], s92 offen offset:1024 sc1
 buffer_load_dwordx4 v[104:107], v255, s[12:15], s92 offen offset:2048 sc1
 buffer_load_dwordx4 v[108:111], v255, s[12:15], s92 offen offset:3072 sc1
 s_add_u32 s92, s92, 4096
 buffer_load_dwordx4 v[112:115], v255, s[12:15], s92 offen sc1
 buffer_load_dwordx4 v[116:119], v255, s[12:15], s92 offen offset:1024 sc1
 buffer_load_dwordx4 v[120:123], v255, s[12:15], s92 offen offset:2048 sc1
 buffer_load_dwordx4 v[124:127], v255, s[12:15], s92 offen offset:3072 sc1
 s_add_u32 s92, s92, 4096
 s_add_u32 s92, s92, 16384
 s_cmp_lg_u32 s24, s23
 s_cbranch_scc1 Lslow20n
 v_cmp_le_i32 vcc, 0, v248
 s_nop 1
 v_cndmask_b32 v164, v184, v180, vcc
 v_cmp_le_i32 vcc, 1, v248
 s_nop 1
 v_cndmask_b32 v165, v184, v180, vcc
 v_cmp_le_i32 vcc, 2, v248
 s_nop 1
 v_cndmask_b32 v166, v184, v180, vcc
 v_cmp_le_i32 vcc, 3, v248
 s_nop 1
 v_cndmask_b32 v167, v184, v180, vcc
 v_cmp_le_i32 vcc, 16, v248
 s_nop 1
 v_cndmask_b32 v168, v184, v180, vcc
 v_cmp_le_i32 vcc, 17, v248
 s_nop 1
 v_cndmask_b32 v169, v184, v180, vcc
 v_cmp_le_i32 vcc, 18, v248
 s_nop 1
 v_cndmask_b32 v170, v184, v180, vcc
 v_cmp_le_i32 vcc, 19, v248
 s_nop 1
 v_cndmask_b32 v171, v184, v180, vcc
 v_cmp_le_i32 vcc, 32, v248
 s_nop 1
 v_cndmask_b32 v172, v184, v180, vcc
 v_cmp_le_i32 vcc, 33, v248
 s_nop 1
 v_cndmask_b32 v173, v184, v180, vcc
 v_cmp_le_i32 vcc, 34, v248
 s_nop 1
 v_cndmask_b32 v174, v184, v180, vcc
 v_cmp_le_i32 vcc, 35, v248
 s_nop 1
 v_cndmask_b32 v175, v184, v180, vcc
 v_cmp_le_i32 vcc, 48, v248
 s_nop 1
 v_cndmask_b32 v176, v184, v180, vcc
 v_cmp_le_i32 vcc, 49, v248
 s_nop 1
 v_cndmask_b32 v177, v184, v180, vcc
 v_cmp_le_i32 vcc, 50, v248
 s_nop 1
 v_cndmask_b32 v178, v184, v180, vcc
 v_cmp_le_i32 vcc, 51, v248
 s_nop 1
 v_cndmask_b32 v179, v184, v180, vcc
Lslow20n:
 s_waitcnt vmcnt(0)
 s_nop 1
 v_mfma_f32_16x16x32_bf16 v[128:131], v[64:67], a[160:163], v[164:167]
 v_mfma_f32_16x16x32_bf16 v[128:131], v[68:71], a[164:167], v[128:131]
 v_mfma_f32_16x16x32_bf16 v[128:131], v[72:75], a[168:171], v[128:131]
 v_mfma_f32_16x16x32_bf16 v[128:131], v[76:79], a[172:175], v[128:131]
 v_mfma_f32_16x16x32_bf16 v[132:135], v[80:83], a[160:163], v[168:171]
 v_mfma_f32_16x16x32_bf16 v[132:135], v[84:87], a[164:167], v[132:135]
 v_mfma_f32_16x16x32_bf16 v[132:135], v[88:91], a[168:171], v[132:135]
 v_mfma_f32_16x16x32_bf16 v[132:135], v[92:95], a[172:175], v[132:135]
 v_mfma_f32_16x16x32_bf16 v[136:139], v[96:99], a[160:163], v[172:175]
 v_mfma_f32_16x16x32_bf16 v[136:139], v[100:103], a[164:167], v[136:139]
 v_mfma_f32_16x16x32_bf16 v[136:139], v[104:107], a[168:171], v[136:139]
 v_mfma_f32_16x16x32_bf16 v[136:139], v[108:111], a[172:175], v[136:139]
 v_mfma_f32_16x16x32_bf16 v[140:143], v[112:115], a[160:163], v[176:179]
 v_mfma_f32_16x16x32_bf16 v[140:143], v[116:119], a[164:167], v[140:143]
 v_mfma_f32_16x16x32_bf16 v[140:143], v[120:123], a[168:171], v[140:143]
 v_mfma_f32_16x16x32_bf16 v[140:143], v[124:127], a[172:175], v[140:143]
 s_nop 7
 v_max3_f32 v181, v181, v128, v129
 v_max3_f32 v181, v181, v130, v131
 v_max3_f32 v181, v181, v132, v133
 v_max3_f32 v181, v181, v134, v135
 v_max3_f32 v181, v181, v136, v137
 v_max3_f32 v181, v181, v138, v139
 v_max3_f32 v181, v181, v140, v141
 v_max3_f32 v181, v181, v142, v143
 s_add_u32 s24, s24, 1
 s_cmp_le_u32 s24, s23
 s_cbranch_scc1 Lslow20
 v_mov_b32 v182, v181
 s_nop 1
 v_permlane16_swap_b32 v181, v182
 v_max_f32 v181, v181, v182
 v_mov_b32 v182, v181
 s_nop 1
 v_permlane32_swap_b32 v181, v182
 v_max_f32 v181, v181, v182
 v_sub_f32 v180, 0, v181
 v_accvgpr_write_b32 a8, 0
 v_accvgpr_write_b32 a9, 0
 v_accvgpr_write_b32 a10, 0
 v_accvgpr_write_b32 a11, 0
 v_accvgpr_write_b32 a24, 0
 v_accvgpr_write_b32 a25, 0
 v_accvgpr_write_b32 a26, 0
 v_accvgpr_write_b32 a27, 0
 v_accvgpr_write_b32 a40, 0
 v_accvgpr_write_b32 a41, 0
 v_accvgpr_write_b32 a42, 0
 v_accvgpr_write_b32 a43, 0
 v_accvgpr_write_b32 a56, 0
 v_accvgpr_write_b32 a57, 0
 v_accvgpr_write_b32 a58, 0
 v_accvgpr_write_b32 a59, 0
 v_accvgpr_write_b32 a72, 0
 v_accvgpr_write_b32 a73, 0
 v_accvgpr_write_b32 a74, 0
 v_accvgpr_write_b32 a75, 0
 v_accvgpr_write_b32 a88, 0
 v_accvgpr_write_b32 a89, 0
 v_accvgpr_write_b32 a90, 0
 v_accvgpr_write_b32 a91, 0
 v_accvgpr_write_b32 a104, 0
 v_accvgpr_write_b32 a105, 0
 v_accvgpr_write_b32 a106, 0
 v_accvgpr_write_b32 a107, 0
 v_accvgpr_write_b32 a120, 0
 v_accvgpr_write_b32 a121, 0
 v_accvgpr_write_b32 a122, 0
 v_accvgpr_write_b32 a123, 0
 v_mov_b32 v232, 0
 v_mov_b32 v233, 0
 v_mov_b32 v234, 0
 v_mov_b32 v235, 0
 v_mov_b32 v164, v180
 v_mov_b32 v165, v180
 v_mov_b32 v166, v180
 v_mov_b32 v167, v180
 v_mov_b32 v168, v180
 v_mov_b32 v169, v180
 v_mov_b32 v170, v180
 v_mov_b32 v171, v180
 v_mov_b32 v172, v180
 v_mov_b32 v173, v180
 v_mov_b32 v174, v180
 v_mov_b32 v175, v180
 v_mov_b32 v176, v180
 v_mov_b32 v177, v180
 v_mov_b32 v178, v180
 v_mov_b32 v179, v180
 s_mov_b32 s24, 0
 s_mov_b32 s92, 65536
Lslow21:
 buffer_load_dwordx4 v[64:67], v255, s[12:15], s92 offen sc1
 buffer_load_dwordx4 v[68:71], v255, s[12:15], s92 offen offset:1024 sc1
 buffer_load_dwordx4 v[72:75], v255, s[12:15], s92 offen offset:2048 sc1
 buffer_load_dwordx4 v[76:79], v255, s[12:15], s92 offen offset:3072 sc1
 s_add_u32 s92, s92, 4096
 buffer_load_dwordx4 v[80:83], v255, s[12:15], s92 offen sc1
 buffer_load_dwordx4 v[84:87], v255, s[12:15], s92 offen offset:1024 sc1
 buffer_load_dwordx4 v[88:91], v255, s[12:15], s92 offen offset:2048 sc1
 buffer_load_dwordx4 v[92:95], v255, s[12:15], s92 offen offset:3072 sc1
 s_add_u32 s92, s92, 4096
 buffer_load_dwordx4 v[96:99], v255, s[12:15], s92 offen sc1
 buffer_load_dwordx4 v[100:103], v255, s[12:15], s92 offen offset:1024 sc1
 buffer_load_dwordx4 v[104:107], v255, s[12:15], s92 offen offset:2048 sc1
 buffer_load_dwordx4 v[108:111], v255, s[12:15], s92 offen offset:3072 sc1
 s_add_u32 s92, s92, 4096
 buffer_load_dwordx4 v[112:115], v255, s[12:15], s92 offen sc1
 buffer_load_dwordx4 v[116:119], v255, s[12:15], s92 offen offset:1024 sc1
 buffer_load_dwordx4 v[120:123], v255, s[12:15], s92 offen offset:2048 sc1
 buffer_load_dwordx4 v[124:127], v255, s[12:15], s92 offen offset:3072 sc1
 s_add_u32 s92, s92, 4096
 buffer_load_dwordx4 a[192:195], v255, s[12:15], s92 offen sc1
 buffer_load_dwordx4 a[196:199], v255, s[12:15], s92 offen offset:1024 sc1
 buffer_load_dwordx4 a[200:203], v255, s[12:15], s92 offen offset:2048 sc1
 buffer_load_dwordx4 a[204:207], v255, s[12:15], s92 offen offset:3072 sc1
 s_add_u32 s92, s92, 4096
 buffer_load_dwordx4 a[208:211], v255, s[12:15], s92 offen sc1
 buffer_load_dwordx4 a[212:215], v255, s[12:15], s92 offen offset:1024 sc1
 buffer_load_dwordx4 a[216:219], v255, s[12:15], s92 offen offset:2048 sc1
 buffer_load_dwordx4 a[220:223], v255, s[12:15], s92 offen offset:3072 sc1
 s_add_u32 s92, s92, 4096
 buffer_load_dwordx4 a[224:227], v255, s[12:15], s92 offen sc1
 buffer_load_dwordx4 a[228:231], v255, s[12:15], s92 offen offset:1024 sc1
 buffer_load_dwordx4 a[232:235], v255, s[12:15], s92 offen offset:2048 sc1
 buffer_load_dwordx4 a[236:239], v255, s[12:15], s92 offen offset:3072 sc1
 s_add_u32 s92, s92, 4096
 buffer_load_dwordx4 a[240:243], v255, s[12:15], s92 offen sc1
 buffer_load_dwordx4 a[244:247], v255, s[12:15], s92 offen offset:1024 sc1
 buffer_load_dwordx4 a[248:251], v255, s[12:15], s92 offen offset:2048 sc1
 buffer_load_dwordx4 a[252:255], v255, s[12:15], s92 offen offset:3072 sc1
 s_add_u32 s92, s92, 4096
 s_cmp_lg_u32 s24, s23
 s_cbranch_scc1 Lslow21n
 v_cmp_le_i32 vcc, 0, v248
 s_nop 1
 v_cndmask_b32 v164, v184, v180, vcc
 v_cmp_le_i32 vcc, 1, v248
 s_nop 1
 v_cndmask_b32 v165, v184, v180, vcc
 v_cmp_le_i32 vcc, 2, v248
 s_nop 1
 v_cndmask_b32 v166, v184, v180, vcc
 v_cmp_le_i32 vcc, 3, v248
 s_nop 1
 v_cndmask_b32 v167, v184, v180, vcc
 v_cmp_le_i32 vcc, 16, v248
 s_nop 1
 v_cndmask_b32 v168, v184, v180, vcc
 v_cmp_le_i32 vcc, 17, v248
 s_nop 1
 v_cndmask_b32 v169, v184, v180, vcc
 v_cmp_le_i32 vcc, 18, v248
 s_nop 1
 v_cndmask_b32 v170, v184, v180, vcc
 v_cmp_le_i32 vcc, 19, v248
 s_nop 1
 v_cndmask_b32 v171, v184, v180, vcc
 v_cmp_le_i32 vcc, 32, v248
 s_nop 1
 v_cndmask_b32 v172, v184, v180, vcc
 v_cmp_le_i32 vcc, 33, v248
 s_nop 1
 v_cndmask_b32 v173, v184, v180, vcc
 v_cmp_le_i32 vcc, 34, v248
 s_nop 1
 v_cndmask_b32 v174, v184, v180, vcc
 v_cmp_le_i32 vcc, 35, v248
 s_nop 1
 v_cndmask_b32 v175, v184, v180, vcc
 v_cmp_le_i32 vcc, 48, v248
 s_nop 1
 v_cndmask_b32 v176, v184, v180, vcc
 v_cmp_le_i32 vcc, 49, v248
 s_nop 1
 v_cndmask_b32 v177, v184, v180, vcc
 v_cmp_le_i32 vcc, 50, v248
 s_nop 1
 v_cndmask_b32 v178, v184, v180, vcc
 v_cmp_le_i32 vcc, 51, v248
 s_nop 1
 v_cndmask_b32 v179, v184, v180, vcc
Lslow21n:
 s_waitcnt vmcnt(0)
 s_nop 1
 v_mfma_f32_16x16x32_bf16 v[128:131], v[64:67], a[160:163], v[164:167]
 v_mfma_f32_16x16x32_bf16 v[128:131], v[68:71], a[164:167], v[128:131]
 v_mfma_f32_16x16x32_bf16 v[128:131], v[72:75], a[168:171], v[128:131]
 v_mfma_f32_16x16x32_bf16 v[128:131], v[76:79], a[172:175], v[128:131]
 v_mfma_f32_16x16x32_bf16 v[132:135], v[80:83], a[160:163], v[168:171]
 v_mfma_f32_16x16x32_bf16 v[132:135], v[84:87], a[164:167], v[132:135]
 v_mfma_f32_16x16x32_bf16 v[132:135], v[88:91], a[168:171], v[132:135]
 v_mfma_f32_16x16x32_bf16 v[132:135], v[92:95], a[172:175], v[132:135]
 v_mfma_f32_16x16x32_bf16 v[136:139], v[96:99], a[160:163], v[172:175]
 v_mfma_f32_16x16x32_bf16 v[136:139], v[100:103], a[164:167], v[136:139]
 v_mfma_f32_16x16x32_bf16 v[136:139], v[104:107], a[168:171], v[136:139]
 v_mfma_f32_16x16x32_bf16 v[136:139], v[108:111], a[172:175], v[136:139]
 v_mfma_f32_16x16x32_bf16 v[140:143], v[112:115], a[160:163], v[176:179]
 v_mfma_f32_16x16x32_bf16 v[140:143], v[116:119], a[164:167], v[140:143]
 v_mfma_f32_16x16x32_bf16 v[140:143], v[120:123], a[168:171], v[140:143]
 v_mfma_f32_16x16x32_bf16 v[140:143], v[124:127], a[172:175], v[140:143]
 s_nop 7
 v_exp_f32 v128, v128
 v_exp_f32 v129, v129
 v_exp_f32 v130, v130
 v_exp_f32 v131, v131
 v_exp_f32 v132, v132
 v_exp_f32 v133, v133
 v_exp_f32 v134, v134
 v_exp_f32 v135, v135
 v_exp_f32 v136, v136
 v_exp_f32 v137, v137
 v_exp_f32 v138, v138
 v_exp_f32 v139, v139
 v_exp_f32 v140, v140
 v_exp_f32 v141, v141
 v_exp_f32 v142, v142
 v_exp_f32 v143, v143
 s_nop 0
 v_cvt_pk_bf16_f32 v144, v128, v129
 v_cvt_pk_bf16_f32 v145, v130, v131
 v_cvt_pk_bf16_f32 v146, v132, v133
 v_cvt_pk_bf16_f32 v147, v134, v135
 v_cvt_pk_bf16_f32 v148, v136, v137
 v_cvt_pk_bf16_f32 v149, v138, v139
 v_cvt_pk_bf16_f32 v150, v140, v141
 v_cvt_pk_bf16_f32 v151, v142, v143
 s_nop 1
 v_mfma_f32_16x16x32_bf16 a[8:11], a[192:195], v[144:147], a[8:11]
 v_mfma_f32_16x16x32_bf16 a[8:11], a[196:199], v[148:151], a[8:11]
 v_mfma_f32_16x16x32_bf16 a[24:27], a[200:203], v[144:147], a[24:27]
 v_mfma_f32_16x16x32_bf16 a[24:27], a[204:207], v[148:151], a[24:27]
 v_mfma_f32_16x16x32_bf16 a[40:43], a[208:211], v[144:147], a[40:43]
 v_mfma_f32_16x16x32_bf16 a[40:43], a[212:215], v[148:151], a[40:43]
 v_mfma_f32_16x16x32_bf16 a[56:59], a[216:219], v[144:147], a[56:59]
 v_mfma_f32_16x16x32_bf16 a[56:59], a[220:223], v[148:151], a[56:59]
 v_mfma_f32_16x16x32_bf16 a[72:75], a[224:227], v[144:147], a[72:75]
 v_mfma_f32_16x16x32_bf16 a[72:75], a[228:231], v[148:151], a[72:75]
 v_mfma_f32_16x16x32_bf16 a[88:91], a[232:235], v[144:147], a[88:91]
 v_mfma_f32_16x16x32_bf16 a[88:91], a[236:239], v[148:151], a[88:91]
 v_mfma_f32_16x16x32_bf16 a[104:107], a[240:243], v[144:147], a[104:107]
 v_mfma_f32_16x16x32_bf16 a[104:107], a[244:247], v[148:151], a[104:107]
 v_mfma_f32_16x16x32_bf16 a[120:123], a[248:251], v[144:147], a[120:123]
 v_mfma_f32_16x16x32_bf16 a[120:123], a[252:255], v[148:151], a[120:123]
 v_smfmac_f32_16x16x64_bf16 v[232:235], v[244:247], v[144:151], v206
 s_nop 11
 s_add_u32 s24, s24, 1
 s_cmp_le_u32 s24, s23
 s_cbranch_scc1 Lslow21
 v_add_f32 v232, v232, v233
 v_rcp_f32 v234, v232
 v_accvgpr_read_b32 v8, a8
 v_accvgpr_read_b32 v9, a9
 v_accvgpr_read_b32 v10, a10
 v_accvgpr_read_b32 v11, a11
 v_accvgpr_read_b32 v72, a24
 v_accvgpr_read_b32 v73, a25
 v_accvgpr_read_b32 v74, a26
 v_accvgpr_read_b32 v75, a27
 v_mul_f32 v8, v8, v234
 v_mul_f32 v9, v9, v234
 v_mul_f32 v10, v10, v234
 v_mul_f32 v11, v11, v234
 v_mul_f32 v72, v72, v234
 v_mul_f32 v73, v73, v234
 v_mul_f32 v74, v74, v234
 v_mul_f32 v75, v75, v234
 v_cvt_pk_bf16_f32 v8, v8, v9
 v_cvt_pk_bf16_f32 v9, v10, v11
 v_cvt_pk_bf16_f32 v10, v72, v73
 v_cvt_pk_bf16_f32 v11, v74, v75
 buffer_store_dwordx4 v[8:11], v249, s[4:7], s100 offen sc1
 v_accvgpr_read_b32 v24, a40
 v_accvgpr_read_b32 v25, a41
 v_accvgpr_read_b32 v26, a42
 v_accvgpr_read_b32 v27, a43
 v_accvgpr_read_b32 v88, a56
 v_accvgpr_read_b32 v89, a57
 v_accvgpr_read_b32 v90, a58
 v_accvgpr_read_b32 v91, a59
 v_mul_f32 v24, v24, v234
 v_mul_f32 v25, v25, v234
 v_mul_f32 v26, v26, v234
 v_mul_f32 v27, v27, v234
 v_mul_f32 v88, v88, v234
 v_mul_f32 v89, v89, v234
 v_mul_f32 v90, v90, v234
 v_mul_f32 v91, v91, v234
 v_cvt_pk_bf16_f32 v24, v24, v25
 v_cvt_pk_bf16_f32 v25, v26, v27
 v_cvt_pk_bf16_f32 v26, v88, v89
 v_cvt_pk_bf16_f32 v27, v90, v91
 buffer_store_dwordx4 v[24:27], v250, s[4:7], s100 offen sc1
 v_accvgpr_read_b32 v40, a72
 v_accvgpr_read_b32 v41, a73
 v_accvgpr_read_b32 v42, a74
 v_accvgpr_read_b32 v43, a75
 v_accvgpr_read_b32 v104, a88
 v_accvgpr_read_b32 v105, a89
 v_accvgpr_read_b32 v106, a90
 v_accvgpr_read_b32 v107, a91
 v_mul_f32 v40, v40, v234
 v_mul_f32 v41, v41, v234
 v_mul_f32 v42, v42, v234
 v_mul_f32 v43, v43, v234
 v_mul_f32 v104, v104, v234
 v_mul_f32 v105, v105, v234
 v_mul_f32 v106, v106, v234
 v_mul_f32 v107, v107, v234
 v_cvt_pk_bf16_f32 v40, v40, v41
 v_cvt_pk_bf16_f32 v41, v42, v43
 v_cvt_pk_bf16_f32 v42, v104, v105
 v_cvt_pk_bf16_f32 v43, v106, v107
 buffer_store_dwordx4 v[40:43], v251, s[4:7], s100 offen sc1
 v_accvgpr_read_b32 v56, a104
 v_accvgpr_read_b32 v57, a105
 v_accvgpr_read_b32 v58, a106
 v_accvgpr_read_b32 v59, a107
 v_accvgpr_read_b32 v120, a120
 v_accvgpr_read_b32 v121, a121
 v_accvgpr_read_b32 v122, a122
 v_accvgpr_read_b32 v123, a123
 v_mul_f32 v56, v56, v234
 v_mul_f32 v57, v57, v234
 v_mul_f32 v58, v58, v234
 v_mul_f32 v59, v59, v234
 v_mul_f32 v120, v120, v234
 v_mul_f32 v121, v121, v234
 v_mul_f32 v122, v122, v234
 v_mul_f32 v123, v123, v234
 v_cvt_pk_bf16_f32 v56, v56, v57
 v_cvt_pk_bf16_f32 v57, v58, v59
 v_cvt_pk_bf16_f32 v58, v120, v121
 v_cvt_pk_bf16_f32 v59, v122, v123
 buffer_store_dwordx4 v[56:59], v252, s[4:7], s100 offen sc1
 s_nop 1
Lslow2x:
 v_cmp_le_u32 vcc, 0x5f800000, v236
 s_nop 1
 s_cbranch_vccz Lslow3x
 s_lshl_b32 s23, s22, 1
 s_sub_u32 s23, 31, s23
 v_mov_b32 v180, 0
 v_mov_b32 v181, 0xf149f2ca
 v_mov_b32 v164, v180
 v_mov_b32 v165, v180
 v_mov_b32 v166, v180
 v_mov_b32 v167, v180
 v_mov_b32 v168, v180
 v_mov_b32 v169, v180
 v_mov_b32 v170, v180
 v_mov_b32 v171, v180
 v_mov_b32 v172, v180
 v_mov_b32 v173, v180
 v_mov_b32 v174, v180
 v_mov_b32 v175, v180
 v_mov_b32 v176, v180
 v_mov_b32 v177, v180
 v_mov_b32 v178, v180
 v_mov_b32 v179, v180
 s_mov_b32 s24, 0
 s_mov_b32 s92, 65536
Lslow30:
 buffer_load_dwordx4 v[64:67], v255, s[12:15], s92 offen sc1
 buffer_load_dwordx4 v[68:71], v255, s[12:15], s92 offen offset:1024 sc1
 buffer_load_dwordx4 v[72:75], v255, s[12:15], s92 offen offset:2048 sc1
 buffer_load_dwordx4 v[76:79], v255, s[12:15], s92 offen offset:3072 sc1
 s_add_u32 s92, s92, 4096
 buffer_load_dwordx4 v[80:83], v255, s[12:15], s92 offen sc1
 buffer_load_dwordx4 v[84:87], v255, s[12:15], s92 offen offset:1024 sc1
 buffer_load_dwordx4 v[88:91], v255, s[12:15], s92 offen offset:2048 sc1
 buffer_load_dwordx4 v[92:95], v255, s[12:15], s92 offen offset:3072 sc1
 s_add_u32 s92, s92, 4096
 buffer_load_dwordx4 v[96:99], v255, s[12:15], s92 offen sc1
 buffer_load_dwordx4 v[100:103], v255, s[12:15], s92 offen offset:1024 sc1
 buffer_load_dwordx4 v[104:107], v255, s[12:15], s92 offen offset:2048 sc1
 buffer_load_dwordx4 v[108:111], v255, s[12:15], s92 offen offset:3072 sc1
 s_add_u32 s92, s92, 4096
 buffer_load_dwordx4 v[112:115], v255, s[12:15], s92 offen sc1
 buffer_load_dwordx4 v[116:119], v255, s[12:15], s92 offen offset:1024 sc1
 buffer_load_dwordx4 v[120:123], v255, s[12:15], s92 offen offset:2048 sc1
 buffer_load_dwordx4 v[124:127], v255, s[12:15], s92 offen offset:3072 sc1
 s_add_u32 s92, s92, 4096
 s_add_u32 s92, s92, 16384
 s_cmp_lg_u32 s24, s23
 s_cbranch_scc1 Lslow30n
 v_cmp_le_i32 vcc, 0, v248
 s_nop 1
 v_cndmask_b32 v164, v184, v180, vcc
 v_cmp_le_i32 vcc, 1, v248
 s_nop 1
 v_cndmask_b32 v165, v184, v180, vcc
 v_cmp_le_i32 vcc, 2, v248
 s_nop 1
 v_cndmask_b32 v166, v184, v180, vcc
 v_cmp_le_i32 vcc, 3, v248
 s_nop 1
 v_cndmask_b32 v167, v184, v180, vcc
 v_cmp_le_i32 vcc, 16, v248
 s_nop 1
 v_cndmask_b32 v168, v184, v180, vcc
 v_cmp_le_i32 vcc, 17, v248
 s_nop 1
 v_cndmask_b32 v169, v184, v180, vcc
 v_cmp_le_i32 vcc, 18, v248
 s_nop 1
 v_cndmask_b32 v170, v184, v180, vcc
 v_cmp_le_i32 vcc, 19, v248
 s_nop 1
 v_cndmask_b32 v171, v184, v180, vcc
 v_cmp_le_i32 vcc, 32, v248
 s_nop 1
 v_cndmask_b32 v172, v184, v180, vcc
 v_cmp_le_i32 vcc, 33, v248
 s_nop 1
 v_cndmask_b32 v173, v184, v180, vcc
 v_cmp_le_i32 vcc, 34, v248
 s_nop 1
 v_cndmask_b32 v174, v184, v180, vcc
 v_cmp_le_i32 vcc, 35, v248
 s_nop 1
 v_cndmask_b32 v175, v184, v180, vcc
 v_cmp_le_i32 vcc, 48, v248
 s_nop 1
 v_cndmask_b32 v176, v184, v180, vcc
 v_cmp_le_i32 vcc, 49, v248
 s_nop 1
 v_cndmask_b32 v177, v184, v180, vcc
 v_cmp_le_i32 vcc, 50, v248
 s_nop 1
 v_cndmask_b32 v178, v184, v180, vcc
 v_cmp_le_i32 vcc, 51, v248
 s_nop 1
 v_cndmask_b32 v179, v184, v180, vcc
Lslow30n:
 s_waitcnt vmcnt(0)
 s_nop 1
 v_mfma_f32_16x16x32_bf16 v[128:131], v[64:67], a[176:179], v[164:167]
 v_mfma_f32_16x16x32_bf16 v[128:131], v[68:71], a[180:183], v[128:131]
 v_mfma_f32_16x16x32_bf16 v[128:131], v[72:75], a[184:187], v[128:131]
 v_mfma_f32_16x16x32_bf16 v[128:131], v[76:79], a[188:191], v[128:131]
 v_mfma_f32_16x16x32_bf16 v[132:135], v[80:83], a[176:179], v[168:171]
 v_mfma_f32_16x16x32_bf16 v[132:135], v[84:87], a[180:183], v[132:135]
 v_mfma_f32_16x16x32_bf16 v[132:135], v[88:91], a[184:187], v[132:135]
 v_mfma_f32_16x16x32_bf16 v[132:135], v[92:95], a[188:191], v[132:135]
 v_mfma_f32_16x16x32_bf16 v[136:139], v[96:99], a[176:179], v[172:175]
 v_mfma_f32_16x16x32_bf16 v[136:139], v[100:103], a[180:183], v[136:139]
 v_mfma_f32_16x16x32_bf16 v[136:139], v[104:107], a[184:187], v[136:139]
 v_mfma_f32_16x16x32_bf16 v[136:139], v[108:111], a[188:191], v[136:139]
 v_mfma_f32_16x16x32_bf16 v[140:143], v[112:115], a[176:179], v[176:179]
 v_mfma_f32_16x16x32_bf16 v[140:143], v[116:119], a[180:183], v[140:143]
 v_mfma_f32_16x16x32_bf16 v[140:143], v[120:123], a[184:187], v[140:143]
 v_mfma_f32_16x16x32_bf16 v[140:143], v[124:127], a[188:191], v[140:143]
 s_nop 7
 v_max3_f32 v181, v181, v128, v129
 v_max3_f32 v181, v181, v130, v131
 v_max3_f32 v181, v181, v132, v133
 v_max3_f32 v181, v181, v134, v135
 v_max3_f32 v181, v181, v136, v137
 v_max3_f32 v181, v181, v138, v139
 v_max3_f32 v181, v181, v140, v141
 v_max3_f32 v181, v181, v142, v143
 s_add_u32 s24, s24, 1
 s_cmp_le_u32 s24, s23
 s_cbranch_scc1 Lslow30
 v_mov_b32 v182, v181
 s_nop 1
 v_permlane16_swap_b32 v181, v182
 v_max_f32 v181, v181, v182
 v_mov_b32 v182, v181
 s_nop 1
 v_permlane32_swap_b32 v181, v182
 v_max_f32 v181, v181, v182
 v_sub_f32 v180, 0, v181
 v_accvgpr_write_b32 a12, 0
 v_accvgpr_write_b32 a13, 0
 v_accvgpr_write_b32 a14, 0
 v_accvgpr_write_b32 a15, 0
 v_accvgpr_write_b32 a28, 0
 v_accvgpr_write_b32 a29, 0
 v_accvgpr_write_b32 a30, 0
 v_accvgpr_write_b32 a31, 0
 v_accvgpr_write_b32 a44, 0
 v_accvgpr_write_b32 a45, 0
 v_accvgpr_write_b32 a46, 0
 v_accvgpr_write_b32 a47, 0
 v_accvgpr_write_b32 a60, 0
 v_accvgpr_write_b32 a61, 0
 v_accvgpr_write_b32 a62, 0
 v_accvgpr_write_b32 a63, 0
 v_accvgpr_write_b32 a76, 0
 v_accvgpr_write_b32 a77, 0
 v_accvgpr_write_b32 a78, 0
 v_accvgpr_write_b32 a79, 0
 v_accvgpr_write_b32 a92, 0
 v_accvgpr_write_b32 a93, 0
 v_accvgpr_write_b32 a94, 0
 v_accvgpr_write_b32 a95, 0
 v_accvgpr_write_b32 a108, 0
 v_accvgpr_write_b32 a109, 0
 v_accvgpr_write_b32 a110, 0
 v_accvgpr_write_b32 a111, 0
 v_accvgpr_write_b32 a124, 0
 v_accvgpr_write_b32 a125, 0
 v_accvgpr_write_b32 a126, 0
 v_accvgpr_write_b32 a127, 0
 v_mov_b32 v236, 0
 v_mov_b32 v237, 0
 v_mov_b32 v238, 0
 v_mov_b32 v239, 0
 v_mov_b32 v164, v180
 v_mov_b32 v165, v180
 v_mov_b32 v166, v180
 v_mov_b32 v167, v180
 v_mov_b32 v168, v180
 v_mov_b32 v169, v180
 v_mov_b32 v170, v180
 v_mov_b32 v171, v180
 v_mov_b32 v172, v180
 v_mov_b32 v173, v180
 v_mov_b32 v174, v180
 v_mov_b32 v175, v180
 v_mov_b32 v176, v180
 v_mov_b32 v177, v180
 v_mov_b32 v178, v180
 v_mov_b32 v179, v180
 s_mov_b32 s24, 0
 s_mov_b32 s92, 65536
Lslow31:
 buffer_load_dwordx4 v[64:67], v255, s[12:15], s92 offen sc1
 buffer_load_dwordx4 v[68:71], v255, s[12:15], s92 offen offset:1024 sc1
 buffer_load_dwordx4 v[72:75], v255, s[12:15], s92 offen offset:2048 sc1
 buffer_load_dwordx4 v[76:79], v255, s[12:15], s92 offen offset:3072 sc1
 s_add_u32 s92, s92, 4096
 buffer_load_dwordx4 v[80:83], v255, s[12:15], s92 offen sc1
 buffer_load_dwordx4 v[84:87], v255, s[12:15], s92 offen offset:1024 sc1
 buffer_load_dwordx4 v[88:91], v255, s[12:15], s92 offen offset:2048 sc1
 buffer_load_dwordx4 v[92:95], v255, s[12:15], s92 offen offset:3072 sc1
 s_add_u32 s92, s92, 4096
 buffer_load_dwordx4 v[96:99], v255, s[12:15], s92 offen sc1
 buffer_load_dwordx4 v[100:103], v255, s[12:15], s92 offen offset:1024 sc1
 buffer_load_dwordx4 v[104:107], v255, s[12:15], s92 offen offset:2048 sc1
 buffer_load_dwordx4 v[108:111], v255, s[12:15], s92 offen offset:3072 sc1
 s_add_u32 s92, s92, 4096
 buffer_load_dwordx4 v[112:115], v255, s[12:15], s92 offen sc1
 buffer_load_dwordx4 v[116:119], v255, s[12:15], s92 offen offset:1024 sc1
 buffer_load_dwordx4 v[120:123], v255, s[12:15], s92 offen offset:2048 sc1
 buffer_load_dwordx4 v[124:127], v255, s[12:15], s92 offen offset:3072 sc1
 s_add_u32 s92, s92, 4096
 buffer_load_dwordx4 a[192:195], v255, s[12:15], s92 offen sc1
 buffer_load_dwordx4 a[196:199], v255, s[12:15], s92 offen offset:1024 sc1
 buffer_load_dwordx4 a[200:203], v255, s[12:15], s92 offen offset:2048 sc1
 buffer_load_dwordx4 a[204:207], v255, s[12:15], s92 offen offset:3072 sc1
 s_add_u32 s92, s92, 4096
 buffer_load_dwordx4 a[208:211], v255, s[12:15], s92 offen sc1
 buffer_load_dwordx4 a[212:215], v255, s[12:15], s92 offen offset:1024 sc1
 buffer_load_dwordx4 a[216:219], v255, s[12:15], s92 offen offset:2048 sc1
 buffer_load_dwordx4 a[220:223], v255, s[12:15], s92 offen offset:3072 sc1
 s_add_u32 s92, s92, 4096
 buffer_load_dwordx4 a[224:227], v255, s[12:15], s92 offen sc1
 buffer_load_dwordx4 a[228:231], v255, s[12:15], s92 offen offset:1024 sc1
 buffer_load_dwordx4 a[232:235], v255, s[12:15], s92 offen offset:2048 sc1
 buffer_load_dwordx4 a[236:239], v255, s[12:15], s92 offen offset:3072 sc1
 s_add_u32 s92, s92, 4096
 buffer_load_dwordx4 a[240:243], v255, s[12:15], s92 offen sc1
 buffer_load_dwordx4 a[244:247], v255, s[12:15], s92 offen offset:1024 sc1
 buffer_load_dwordx4 a[248:251], v255, s[12:15], s92 offen offset:2048 sc1
 buffer_load_dwordx4 a[252:255], v255, s[12:15], s92 offen offset:3072 sc1
 s_add_u32 s92, s92, 4096
 s_cmp_lg_u32 s24, s23
 s_cbranch_scc1 Lslow31n
 v_cmp_le_i32 vcc, 0, v248
 s_nop 1
 v_cndmask_b32 v164, v184, v180, vcc
 v_cmp_le_i32 vcc, 1, v248
 s_nop 1
 v_cndmask_b32 v165, v184, v180, vcc
 v_cmp_le_i32 vcc, 2, v248
 s_nop 1
 v_cndmask_b32 v166, v184, v180, vcc
 v_cmp_le_i32 vcc, 3, v248
 s_nop 1
 v_cndmask_b32 v167, v184, v180, vcc
 v_cmp_le_i32 vcc, 16, v248
 s_nop 1
 v_cndmask_b32 v168, v184, v180, vcc
 v_cmp_le_i32 vcc, 17, v248
 s_nop 1
 v_cndmask_b32 v169, v184, v180, vcc
 v_cmp_le_i32 vcc, 18, v248
 s_nop 1
 v_cndmask_b32 v170, v184, v180, vcc
 v_cmp_le_i32 vcc, 19, v248
 s_nop 1
 v_cndmask_b32 v171, v184, v180, vcc
 v_cmp_le_i32 vcc, 32, v248
 s_nop 1
 v_cndmask_b32 v172, v184, v180, vcc
 v_cmp_le_i32 vcc, 33, v248
 s_nop 1
 v_cndmask_b32 v173, v184, v180, vcc
 v_cmp_le_i32 vcc, 34, v248
 s_nop 1
 v_cndmask_b32 v174, v184, v180, vcc
 v_cmp_le_i32 vcc, 35, v248
 s_nop 1
 v_cndmask_b32 v175, v184, v180, vcc
 v_cmp_le_i32 vcc, 48, v248
 s_nop 1
 v_cndmask_b32 v176, v184, v180, vcc
 v_cmp_le_i32 vcc, 49, v248
 s_nop 1
 v_cndmask_b32 v177, v184, v180, vcc
 v_cmp_le_i32 vcc, 50, v248
 s_nop 1
 v_cndmask_b32 v178, v184, v180, vcc
 v_cmp_le_i32 vcc, 51, v248
 s_nop 1
 v_cndmask_b32 v179, v184, v180, vcc
Lslow31n:
 s_waitcnt vmcnt(0)
 s_nop 1
 v_mfma_f32_16x16x32_bf16 v[128:131], v[64:67], a[176:179], v[164:167]
 v_mfma_f32_16x16x32_bf16 v[128:131], v[68:71], a[180:183], v[128:131]
 v_mfma_f32_16x16x32_bf16 v[128:131], v[72:75], a[184:187], v[128:131]
 v_mfma_f32_16x16x32_bf16 v[128:131], v[76:79], a[188:191], v[128:131]
 v_mfma_f32_16x16x32_bf16 v[132:135], v[80:83], a[176:179], v[168:171]
 v_mfma_f32_16x16x32_bf16 v[132:135], v[84:87], a[180:183], v[132:135]
 v_mfma_f32_16x16x32_bf16 v[132:135], v[88:91], a[184:187], v[132:135]
 v_mfma_f32_16x16x32_bf16 v[132:135], v[92:95], a[188:191], v[132:135]
 v_mfma_f32_16x16x32_bf16 v[136:139], v[96:99], a[176:179], v[172:175]
 v_mfma_f32_16x16x32_bf16 v[136:139], v[100:103], a[180:183], v[136:139]
 v_mfma_f32_16x16x32_bf16 v[136:139], v[104:107], a[184:187], v[136:139]
 v_mfma_f32_16x16x32_bf16 v[136:139], v[108:111], a[188:191], v[136:139]
 v_mfma_f32_16x16x32_bf16 v[140:143], v[112:115], a[176:179], v[176:179]
 v_mfma_f32_16x16x32_bf16 v[140:143], v[116:119], a[180:183], v[140:143]
 v_mfma_f32_16x16x32_bf16 v[140:143], v[120:123], a[184:187], v[140:143]
 v_mfma_f32_16x16x32_bf16 v[140:143], v[124:127], a[188:191], v[140:143]
 s_nop 7
 v_exp_f32 v128, v128
 v_exp_f32 v129, v129
 v_exp_f32 v130, v130
 v_exp_f32 v131, v131
 v_exp_f32 v132, v132
 v_exp_f32 v133, v133
 v_exp_f32 v134, v134
 v_exp_f32 v135, v135
 v_exp_f32 v136, v136
 v_exp_f32 v137, v137
 v_exp_f32 v138, v138
 v_exp_f32 v139, v139
 v_exp_f32 v140, v140
 v_exp_f32 v141, v141
 v_exp_f32 v142, v142
 v_exp_f32 v143, v143
 s_nop 0
 v_cvt_pk_bf16_f32 v144, v128, v129
 v_cvt_pk_bf16_f32 v145, v130, v131
 v_cvt_pk_bf16_f32 v146, v132, v133
 v_cvt_pk_bf16_f32 v147, v134, v135
 v_cvt_pk_bf16_f32 v148, v136, v137
 v_cvt_pk_bf16_f32 v149, v138, v139
 v_cvt_pk_bf16_f32 v150, v140, v141
 v_cvt_pk_bf16_f32 v151, v142, v143
 s_nop 1
 v_mfma_f32_16x16x32_bf16 a[12:15], a[192:195], v[144:147], a[12:15]
 v_mfma_f32_16x16x32_bf16 a[12:15], a[196:199], v[148:151], a[12:15]
 v_mfma_f32_16x16x32_bf16 a[28:31], a[200:203], v[144:147], a[28:31]
 v_mfma_f32_16x16x32_bf16 a[28:31], a[204:207], v[148:151], a[28:31]
 v_mfma_f32_16x16x32_bf16 a[44:47], a[208:211], v[144:147], a[44:47]
 v_mfma_f32_16x16x32_bf16 a[44:47], a[212:215], v[148:151], a[44:47]
 v_mfma_f32_16x16x32_bf16 a[60:63], a[216:219], v[144:147], a[60:63]
 v_mfma_f32_16x16x32_bf16 a[60:63], a[220:223], v[148:151], a[60:63]
 v_mfma_f32_16x16x32_bf16 a[76:79], a[224:227], v[144:147], a[76:79]
 v_mfma_f32_16x16x32_bf16 a[76:79], a[228:231], v[148:151], a[76:79]
 v_mfma_f32_16x16x32_bf16 a[92:95], a[232:235], v[144:147], a[92:95]
 v_mfma_f32_16x16x32_bf16 a[92:95], a[236:239], v[148:151], a[92:95]
 v_mfma_f32_16x16x32_bf16 a[108:111], a[240:243], v[144:147], a[108:111]
 v_mfma_f32_16x16x32_bf16 a[108:111], a[244:247], v[148:151], a[108:111]
 v_mfma_f32_16x16x32_bf16 a[124:127], a[248:251], v[144:147], a[124:127]
 v_mfma_f32_16x16x32_bf16 a[124:127], a[252:255], v[148:151], a[124:127]
 v_smfmac_f32_16x16x64_bf16 v[236:239], v[244:247], v[144:151], v206
 s_nop 11
 s_add_u32 s24, s24, 1
 s_cmp_le_u32 s24, s23
 s_cbranch_scc1 Lslow31
 v_add_f32 v236, v236, v237
 v_rcp_f32 v238, v236
 v_accvgpr_read_b32 v12, a12
 v_accvgpr_read_b32 v13, a13
 v_accvgpr_read_b32 v14, a14
 v_accvgpr_read_b32 v15, a15
 v_accvgpr_read_b32 v76, a28
 v_accvgpr_read_b32 v77, a29
 v_accvgpr_read_b32 v78, a30
 v_accvgpr_read_b32 v79, a31
 v_mul_f32 v12, v12, v238
 v_mul_f32 v13, v13, v238
 v_mul_f32 v14, v14, v238
 v_mul_f32 v15, v15, v238
 v_mul_f32 v76, v76, v238
 v_mul_f32 v77, v77, v238
 v_mul_f32 v78, v78, v238
 v_mul_f32 v79, v79, v238
 v_cvt_pk_bf16_f32 v12, v12, v13
 v_cvt_pk_bf16_f32 v13, v14, v15
 v_cvt_pk_bf16_f32 v14, v76, v77
 v_cvt_pk_bf16_f32 v15, v78, v79
 buffer_store_dwordx4 v[12:15], v249, s[4:7], s101 offen sc1
 v_accvgpr_read_b32 v28, a44
 v_accvgpr_read_b32 v29, a45
 v_accvgpr_read_b32 v30, a46
 v_accvgpr_read_b32 v31, a47
 v_accvgpr_read_b32 v92, a60
 v_accvgpr_read_b32 v93, a61
 v_accvgpr_read_b32 v94, a62
 v_accvgpr_read_b32 v95, a63
 v_mul_f32 v28, v28, v238
 v_mul_f32 v29, v29, v238
 v_mul_f32 v30, v30, v238
 v_mul_f32 v31, v31, v238
 v_mul_f32 v92, v92, v238
 v_mul_f32 v93, v93, v238
 v_mul_f32 v94, v94, v238
 v_mul_f32 v95, v95, v238
 v_cvt_pk_bf16_f32 v28, v28, v29
 v_cvt_pk_bf16_f32 v29, v30, v31
 v_cvt_pk_bf16_f32 v30, v92, v93
 v_cvt_pk_bf16_f32 v31, v94, v95
 buffer_store_dwordx4 v[28:31], v250, s[4:7], s101 offen sc1
 v_accvgpr_read_b32 v44, a76
 v_accvgpr_read_b32 v45, a77
 v_accvgpr_read_b32 v46, a78
 v_accvgpr_read_b32 v47, a79
 v_accvgpr_read_b32 v108, a92
 v_accvgpr_read_b32 v109, a93
 v_accvgpr_read_b32 v110, a94
 v_accvgpr_read_b32 v111, a95
 v_mul_f32 v44, v44, v238
 v_mul_f32 v45, v45, v238
 v_mul_f32 v46, v46, v238
 v_mul_f32 v47, v47, v238
 v_mul_f32 v108, v108, v238
 v_mul_f32 v109, v109, v238
 v_mul_f32 v110, v110, v238
 v_mul_f32 v111, v111, v238
 v_cvt_pk_bf16_f32 v44, v44, v45
 v_cvt_pk_bf16_f32 v45, v46, v47
 v_cvt_pk_bf16_f32 v46, v108, v109
 v_cvt_pk_bf16_f32 v47, v110, v111
 buffer_store_dwordx4 v[44:47], v251, s[4:7], s101 offen sc1
 v_accvgpr_read_b32 v60, a108
 v_accvgpr_read_b32 v61, a109
 v_accvgpr_read_b32 v62, a110
 v_accvgpr_read_b32 v63, a111
 v_accvgpr_read_b32 v124, a124
 v_accvgpr_read_b32 v125, a125
 v_accvgpr_read_b32 v126, a126
 v_accvgpr_read_b32 v127, a127
 v_mul_f32 v60, v60, v238
 v_mul_f32 v61, v61, v238
 v_mul_f32 v62, v62, v238
 v_mul_f32 v63, v63, v238
 v_mul_f32 v124, v124, v238
 v_mul_f32 v125, v125, v238
 v_mul_f32 v126, v126, v238
 v_mul_f32 v127, v127, v238
 v_cvt_pk_bf16_f32 v60, v60, v61
 v_cvt_pk_bf16_f32 v61, v62, v63
 v_cvt_pk_bf16_f32 v62, v124, v125
 v_cvt_pk_bf16_f32 v63, v126, v127
 buffer_store_dwordx4 v[60:63], v252, s[4:7], s101 offen sc1
 s_nop 1
Lslow3x:
 s_waitcnt vmcnt(0)
 buffer_store_dword v253, v163, s[4:7], s54 offen sc1
 s_waitcnt vmcnt(0)
 s_branch Lslow_back
Lspin14:
 s_mov_b32 s27, 0
Lspin14a:
 buffer_load_dword v232, v131, s[4:7], 0 offen sc1
 s_add_u32 s27, s27, 1
 s_cmp_gt_u32 s27, 1048576
 s_cbranch_scc1 Lspin14b
 s_waitcnt vmcnt(0)
 v_cmp_gt_u32 vcc, 1, v232
 s_nop 1
 s_cbranch_vccnz Lspin14a
Lspin14b:
 s_waitcnt vmcnt(0)
 s_branch Lback15
Lspin16:
 s_mov_b32 s27, 0
Lspin16a:
 buffer_load_dword v232, v233, s[4:7], 0 offen sc1
 s_add_u32 s27, s27, 1
 s_cmp_gt_u32 s27, 1048576
 s_cbranch_scc1 Lspin16b
 s_waitcnt vmcnt(0)
 v_cmp_gt_u32 vcc, 1, v232
 s_nop 1
 s_cbranch_vccnz Lspin16a
Lspin16b:
 s_waitcnt vmcnt(0)
 s_branch Lback17
Ltag18:
 s_mov_b32 s27, 0
Ltag18a:
 buffer_load_dwordx4 v[160:163], v255, s[4:7], s95 offen sc1
 buffer_load_dwordx4 v[172:175], v255, s[4:7], s95 offen offset:1024 sc1
 s_add_u32 s27, s27, 1
 s_waitcnt vmcnt(0)
 v_max3_u32 v232, v160, v161, v162
 v_max3_u32 v232, v232, v163, v172
 v_max3_u32 v232, v232, v173, v174
 v_max_u32 v232, v232, v175
 v_cmp_eq_u32 vcc, -1, v232
 s_cmp_gt_u32 s27, 1048576
 s_cbranch_scc1 Ltag18b
 s_cbranch_vccnz Ltag18a
 s_branch Ltag18b
Lzs:
 s_mov_b32 s27, 0
Lzsa:
 buffer_load_dwordx4 v[112:115], v165, s[4:7], s50 offen sc1
 buffer_load_dwordx4 v[116:119], v165, s[4:7], s50 offen offset:16 sc1
 buffer_load_dwordx4 v[120:123], v165, s[4:7], s50 offen offset:32 sc1
 buffer_load_dwordx4 v[124:127], v165, s[4:7], s50 offen offset:48 sc1
 s_add_u32 s27, s27, 1
 s_waitcnt vmcnt(0)
 s_cmp_gt_u32 s27, 1048576
 s_cbranch_scc1 Lzs_back
 v_max3_u32 v144, v112, v113, v114
 v_max3_u32 v144, v144, v115, v116
 v_max3_u32 v144, v144, v117, v118
 v_max3_u32 v144, v144, v119, v120
 v_max3_u32 v144, v144, v121, v122
 v_max3_u32 v144, v144, v123, v124
 v_max3_u32 v144, v144, v125, v126
 v_max_u32 v144, v144, v127
 v_cmp_eq_u32 vcc, -1, v144
 s_nop 1
 s_cbranch_vccnz Lzsa
 s_branch Lzs_back
Ltag23:
 s_mov_b32 s27, 0
Ltag23a:
 buffer_load_dwordx4 v[112:115], v255, s[4:7], s62 offen sc1
 buffer_load_dwordx4 v[116:119], v255, s[4:7], s62 offen offset:1024 sc1
 buffer_load_dwordx4 v[120:123], v255, s[4:7], s62 offen offset:2048 sc1
 buffer_load_dwordx4 v[124:127], v255, s[4:7], s62 offen offset:3072 sc1
 s_add_u32 s27, s27, 1
 s_waitcnt vmcnt(0)
 v_max3_u32 v232, v112, v113, v114
 v_max3_u32 v232, v232, v115, v116
 v_max3_u32 v232, v232, v117, v118
 v_max3_u32 v232, v232, v119, v120
 v_max3_u32 v232, v232, v121, v122
 v_max3_u32 v232, v232, v123, v124
 v_max3_u32 v232, v232, v125, v126
 v_max_u32 v232, v232, v127
 v_cmp_eq_u32 vcc, -1, v232
 s_cmp_gt_u32 s27, 1048576
 s_cbranch_scc1 Ltag23b
 s_cbranch_vccnz Ltag23a
 s_branch Ltag23b
Lidle5:
 s_waitcnt vmcnt(0)
 s_add_u32 m0, s32, 0
 s_nop 0
 buffer_load_dwordx4 v224, s[16:19], s43 offen lds
 buffer_load_dwordx4 v225, s[16:19], s43 offen offset:1024 lds
 buffer_load_dwordx4 v226, s[16:19], s43 offen offset:2048 lds
 buffer_load_dwordx4 v227, s[16:19], s43 offen offset:3072 lds
 s_add_u32 s43, s43, 131072
 s_add_u32 m0, s32, 4096
 s_nop 0
 buffer_load_dwordx4 v224, s[16:19], s43 offen lds
 buffer_load_dwordx4 v225, s[16:19], s43 offen offset:1024 lds
 buffer_load_dwordx4 v226, s[16:19], s43 offen offset:2048 lds
 buffer_load_dwordx4 v227, s[16:19], s43 offen offset:3072 lds
 s_add_u32 s43, s43, 131072
 s_add_u32 m0, s32, 8192
 s_nop 0
 buffer_load_dwordx4 v224, s[16:19], s43 offen lds
 buffer_load_dwordx4 v225, s[16:19], s43 offen offset:1024 lds
 buffer_load_dwordx4 v226, s[16:19], s43 offen offset:2048 lds
 buffer_load_dwordx4 v227, s[16:19], s43 offen offset:3072 lds
 s_add_u32 s43, s43, 131072
 s_add_u32 m0, s32, 12288
 s_nop 0
 buffer_load_dwordx4 v224, s[16:19], s43 offen lds
 buffer_load_dwordx4 v225, s[16:19], s43 offen offset:1024 lds
 buffer_load_dwordx4 v226, s[16:19], s43 offen offset:2048 lds
 buffer_load_dwordx4 v227, s[16:19], s43 offen offset:3072 lds
 s_add_u32 s43, s43, 131072
 s_add_u32 m0, s35, 0
 s_nop 0
 buffer_load_dwordx4 v224, s[16:19], s43 offen lds
 buffer_load_dwordx4 v225, s[16:19], s43 offen offset:1024 lds
 buffer_load_dwordx4 v226, s[16:19], s43 offen offset:2048 lds
 buffer_load_dwordx4 v227, s[16:19], s43 offen offset:3072 lds
 s_add_u32 s43, s43, 131072
 v_and_b32 v200, 0xffff, v234
 v_add_u32 v200, 0x20000, v200
 v_xor_b32 v201, 32, v200
 v_xor_b32 v202, 64, v200
 v_xor_b32 v203, 96, v200
 s_lshr_b32 s23, s21, 1
 s_lshl_b32 s23, s23, 11
 s_add_u32 s23, s23, 83492864
 v_and_b32 v233, 0xf0, v255
 v_min_u32 v233, 0xd0, v233
 v_lshl_add_u32 v233, v233, 3, s23
 s_lshl_b32 s23, s21, 2
 s_add_u32 s23, s23, s20
 s_mul_i32 s56, s23, 28672
 s_add_u32 s56, s56, 78643200
 s_lshl_b32 s57, s23, 14
 s_lshl_b32 s24, s22, 11
 s_add_u32 s57, s57, s24
 s_add_u32 s57, s57, 68157440
 s_lshr_b32 s23, s23, 1
 s_lshl_b32 s23, s23, 15
 s_and_b32 s24, s20, 1
 s_lshl_b32 s24, s24, 12
 s_add_u32 s23, s23, s24
 s_lshl_b32 s24, s22, 7
 s_add_u32 s58, s23, s24
 s_add_u32 s59, s58, 16384
 s_mov_b32 s12, s86
 s_mov_b32 s13, s87
 s_mov_b32 s14, 2097152
 s_mov_b32 s15, 0x20000
 s_add_u32 s23, s44, 16384
 v_bfe_u32 v208, v255, 4, 4
 v_mul_u32_u24 v208, 144, v208
 v_lshrrev_b32 v209, 8, v255
 v_lshl_add_u32 v208, v209, 3, v208
 v_add_u32 v208, s23, v208
 v_lshrrev_b32 v211, 7, v255
 v_and_b32 v210, 0x70, v255
 v_mul_u32_u24 v209, 144, v211
 v_add3_u32 v209, v209, v210, s23
 v_and_b32 v212, 4, v211
 v_add_u32 v211, v211, v212
 v_lshl_add_u32 v210, v211, 10, v210
 s_waitcnt vmcnt(0)
 s_barrier
 s_branch Lg7
Lcode_end:
 s_endpgm
.fill 4340, 4, 0xbf810000
.section .rodata,"a"
.p2align 6
.amdhsa_kernel sequential_preLN__compressed_kv_cla__mixer_gmlp__prompt_kernel
  .amdhsa_next_free_vgpr 512
  .amdhsa_next_free_sgpr 102
  .amdhsa_accum_offset 256
  .amdhsa_group_segment_fixed_size 0
  .amdhsa_kernarg_size 112
  .amdhsa_user_sgpr_count 2
  .amdhsa_user_sgpr_kernarg_segment_ptr 1
  .amdhsa_system_sgpr_workgroup_id_x 1
.end_amdhsa_kernel
```
